```python
import torch

def _softmax(x, axis=-1):
    return torch.softmax(x, dim=axis)
def _gelu(x):
    return torch.nn.functional.gelu(x, approximate="tanh")
def _silu(x):
    return torch.nn.functional.silu(x)
def _sigmoid(x):
    return torch.sigmoid(x)
def _layernorm(x, axis=-1, eps=1e-5):
    m = x.mean(dim=axis, keepdim=True)
    v = x.var(dim=axis, keepdim=True, unbiased=False)
    return (x - m) / torch.sqrt(v + eps)
def _scatter_add(tgt, idx, src, axis=0):
    return tgt.clone().index_add_(axis, idx, src)
def _segment_sum(src, seg, n):
    out = torch.zeros((n,) + src.shape[1:], dtype=src.dtype)
    return out.index_add_(0, seg, src)
def _pad(x, pw):
    flat = tuple(v for pair in reversed(pw) for v in pair)
    return torch.nn.functional.pad(x, flat)

kernel_name = 'sequential_preLN__spectral_gfnet__dense_activation_gelu__prompt'

def setup_inputs():

    _w = (lambda a: (lambda t: t.to(torch.bfloat16) if t.is_floating_point() else t)(torch.as_tensor(a)))
    def _A_setup():
        B, S, D = 1, 2048, 576
        Df = D // 2 + 1
        return {
            "x": _w((lambda *s: torch.randn(*s, dtype=torch.bfloat16) * 0.05)(B, S, D)),
            "w_r": _w((lambda *s: torch.randn(*s, dtype=torch.bfloat16) * 0.8)(S, Df) * 0.02),
            "w_i": _w((lambda *s: torch.randn(*s, dtype=torch.bfloat16) * 0.8)(S, Df) * 0.02),
        }
    _A_in = _A_setup()

    def _B_setup():
        B, S, D, F = 1, 2048, 576, 4608
        return {
            "x": _w((lambda *s: torch.randn(*s, dtype=torch.bfloat16) * 0.05)(B, S, D)),
            "w1": _w((lambda *s: torch.randn(*s, dtype=torch.bfloat16) * 0.8)(D, F) * (D ** -0.5)),
            "b1": _w((lambda *s: torch.randn(*s, dtype=torch.bfloat16) * 12.8)(F) * 0.01),
            "w2": _w((lambda *s: torch.randn(*s, dtype=torch.bfloat16) * 0.2)(F, D) * (F ** -0.5)),
            "b2": _w((lambda *s: torch.randn(*s, dtype=torch.bfloat16) * 3.2)(D) * 0.01),
        }
    _B_in = _B_setup()

    return {
        "A_x": _A_in["x"],
        "A_w_r": _A_in["w_r"],
        "A_w_i": _A_in["w_i"],
        "B_x": _B_in["x"],
        "B_w1": _B_in["w1"],
        "B_b1": _B_in["b1"],
        "B_w2": _B_in["w2"],
        "B_b2": _B_in["b2"],
    }

def reference(A_x, A_w_r, A_w_i, B_x, B_w1, B_b1, B_w2, B_b2):
    def _A_ref(x, w_r, w_i):
        B, S, D = x.shape
        X = (lambda x, axes=(-2,-1): torch.fft.rfft2(x.float(), dim=axes))(x, axes=(-2, -1))
        W = w_r + 1j * w_i
        X = X * W
        y = (lambda x, s, axes=(-2,-1): torch.fft.irfft2(x, s=s, dim=axes).to(torch.bfloat16))(X, (S, D), axes=(-2, -1))
        return y

    def _B_ref(x, w1, b1, w2, b2):
        h = torch.einsum("bsd,df->bsf", x, w1) + b1
        h = _gelu(h)
        return torch.einsum("bsf,fd->bsd", h, w2) + b2

    x = A_x
    h = x + _A_ref(_layernorm(x, axis=-1), A_w_r, A_w_i)
    h2 = h + _B_ref(_layernorm(h, axis=-1), B_w1, B_b1, B_w2, B_b2)
    return h2
```

```asm
; @launch kernel=mega_kernel grid=(256,1,1) block=(256,1,1) lds=153664
.amdgcn_target "amdgcn-amd-amdhsa--gfx950"
.text
.globl mega_kernel
.p2align 8
.type mega_kernel,@function
mega_kernel:
k1_kernel:
s_cmp_ge_u32 s2, 16
s_cbranch_scc1 k1_pf_done
s_getpc_b64 s[52:53]
k1_pf_pc:
s_sub_u32 s52, s52, k1_pf_pc-k1_kernel
s_subb_u32 s53, s53, 0
v_lshlrev_b32 v254, 6, v0
global_load_dword v255, v254, s[52:53]
k1_pf_done:
s_cmp_ge_u32 s2, 256
s_cbranch_scc1 mega_kernel_exit
s_cmp_lg_u32 s2, 0
s_cbranch_scc1 nonce_1
v_cmp_gt_u32 vcc, 64, v0
s_nop 1
s_cmp_eq_u64 vcc, 0
s_cbranch_scc1 nonce_1
s_memrealtime s[98:99]
s_load_dwordx2 s[88:89], s[0:1], 72
s_waitcnt lgkmcnt(0)
s_or_b32 s98, s98, 1
s_and_b32 s89, s89, 0xffff
s_mov_b32 s90, 256
s_mov_b32 s91, 0x20000
v_mov_b32 v1, s98
v_mov_b32 v2, 0
s_mov_b64 exec, 1
buffer_store_dword v1, v2, s[88:91], 0 offen sc1
s_mov_b64 exec, -1
nonce_1:
s_load_dwordx2 s[4:5], s[0:1], 80
s_load_dwordx2 s[6:7], s[0:1], 0
s_load_dwordx2 s[20:21], s[0:1], 8
s_load_dwordx2 s[42:43], s[0:1], 16
s_load_dwordx2 s[40:41], s[0:1], 48
v_lshrrev_b32 v2, 6, v0
v_and_b32 v1, 63, v0
v_readfirstlane_b32 s22, v2
v_and_b32 v3, 15, v1
v_lshrrev_b32 v4, 4, v1
v_lshlrev_b32 v5, 4, v1
s_cmp_ge_u32 s2, 192
s_cbranch_scc1 k1_kernel_side
s_and_b32 s23, s2, 31
s_lshr_b32 s24, s2, 5
v_and_b32 v10, 7, v3
v_xor_b32 v6, v4, v10
v_lshlrev_b32 v6, 4, v6
v_lshl_add_u32 v6, v10, 7, v6
v_lshrrev_b32 v10, 3, v3
v_lshl_add_u32 v6, v10, 10, v6
v_xor_b32 v7, 64, v6
v_add_u32 v8, 40960, v6
v_add_u32 v9, 40960, v7
s_cmp_eq_u32 s22, 3
s_cbranch_scc1 k1_kernel_helper
s_mul_i32 s31, s24, 48
s_lshl_b32 s32, s22, 4
s_add_u32 s31, s31, s32
v_add_u32 v11, s31, v3
v_cvt_f32_u32 v228, v11
v_cmp_eq_u32 s[50:51], 0, v11
v_mov_b32 v229, 0x43900000
s_nop 1
v_cndmask_b32 v228, v228, v229, s[50:51]
v_mul_f32 v228, 0x3ae38e39, v228
v_cos_f32 v230, v228
v_sin_f32 v231, v228
v_mul_f32 v229, 0x42000000, v228
v_fract_f32 v229, v229
v_cos_f32 v232, v229
v_sin_f32 v233, v229
v_cvt_f32_u32 v229, v4
v_mul_f32 v229, 0x41000000, v229
v_mul_f32 v229, v229, v228
v_fract_f32 v229, v229
v_cos_f32 v238, v229
v_sin_f32 v239, v229
v_add_f32 v234, v230, v230
v_pk_mul_f32 v[236:237], v[238:239], v[230:231] op_sel:[0,0] op_sel_hi:[1,0]
v_pk_fma_f32 v[240:241], v[238:239], v[230:231], v[236:237] op_sel:[1,1,0] op_sel_hi:[0,1,1] neg_lo:[1,0,0]
v_pk_fma_f32 v[242:243], v[240:241], v[234:235], v[238:239] op_sel:[0,0,0] op_sel_hi:[1,0,1] neg_lo:[0,0,1] neg_hi:[0,0,1]
v_pk_fma_f32 v[244:245], v[242:243], v[234:235], v[240:241] op_sel:[0,0,0] op_sel_hi:[1,0,1] neg_lo:[0,0,1] neg_hi:[0,0,1]
v_pk_fma_f32 v[246:247], v[244:245], v[234:235], v[242:243] op_sel:[0,0,0] op_sel_hi:[1,0,1] neg_lo:[0,0,1] neg_hi:[0,0,1]
v_pk_fma_f32 v[248:249], v[246:247], v[234:235], v[244:245] op_sel:[0,0,0] op_sel_hi:[1,0,1] neg_lo:[0,0,1] neg_hi:[0,0,1]
v_pk_fma_f32 v[250:251], v[248:249], v[234:235], v[246:247] op_sel:[0,0,0] op_sel_hi:[1,0,1] neg_lo:[0,0,1] neg_hi:[0,0,1]
v_pk_fma_f32 v[252:253], v[250:251], v[234:235], v[248:249] op_sel:[0,0,0] op_sel_hi:[1,0,1] neg_lo:[0,0,1] neg_hi:[0,0,1]
v_cvt_pk_bf16_f32 v16, v238, v240
v_cvt_pk_bf16_f32 v88, -v239, -v241
v_cvt_pk_bf16_f32 v17, v242, v244
v_cvt_pk_bf16_f32 v89, -v243, -v245
v_cvt_pk_bf16_f32 v18, v246, v248
v_cvt_pk_bf16_f32 v90, -v247, -v249
v_cvt_pk_bf16_f32 v19, v250, v252
v_cvt_pk_bf16_f32 v91, -v251, -v253
v_pk_mul_f32 v[236:237], v[238:239], v[232:233] op_sel:[0,0] op_sel_hi:[1,0]
v_pk_fma_f32 v[238:239], v[238:239], v[232:233], v[236:237] op_sel:[1,1,0] op_sel_hi:[0,1,1] neg_lo:[1,0,0]
v_pk_mul_f32 v[236:237], v[238:239], v[230:231] op_sel:[0,0] op_sel_hi:[1,0]
v_pk_fma_f32 v[240:241], v[238:239], v[230:231], v[236:237] op_sel:[1,1,0] op_sel_hi:[0,1,1] neg_lo:[1,0,0]
v_pk_fma_f32 v[242:243], v[240:241], v[234:235], v[238:239] op_sel:[0,0,0] op_sel_hi:[1,0,1] neg_lo:[0,0,1] neg_hi:[0,0,1]
v_pk_fma_f32 v[244:245], v[242:243], v[234:235], v[240:241] op_sel:[0,0,0] op_sel_hi:[1,0,1] neg_lo:[0,0,1] neg_hi:[0,0,1]
v_pk_fma_f32 v[246:247], v[244:245], v[234:235], v[242:243] op_sel:[0,0,0] op_sel_hi:[1,0,1] neg_lo:[0,0,1] neg_hi:[0,0,1]
v_pk_fma_f32 v[248:249], v[246:247], v[234:235], v[244:245] op_sel:[0,0,0] op_sel_hi:[1,0,1] neg_lo:[0,0,1] neg_hi:[0,0,1]
v_pk_fma_f32 v[250:251], v[248:249], v[234:235], v[246:247] op_sel:[0,0,0] op_sel_hi:[1,0,1] neg_lo:[0,0,1] neg_hi:[0,0,1]
v_pk_fma_f32 v[252:253], v[250:251], v[234:235], v[248:249] op_sel:[0,0,0] op_sel_hi:[1,0,1] neg_lo:[0,0,1] neg_hi:[0,0,1]
v_cvt_pk_bf16_f32 v20, v238, v240
v_cvt_pk_bf16_f32 v92, -v239, -v241
v_cvt_pk_bf16_f32 v21, v242, v244
v_cvt_pk_bf16_f32 v93, -v243, -v245
v_cvt_pk_bf16_f32 v22, v246, v248
v_cvt_pk_bf16_f32 v94, -v247, -v249
v_cvt_pk_bf16_f32 v23, v250, v252
v_cvt_pk_bf16_f32 v95, -v251, -v253
v_pk_mul_f32 v[236:237], v[238:239], v[232:233] op_sel:[0,0] op_sel_hi:[1,0]
v_pk_fma_f32 v[238:239], v[238:239], v[232:233], v[236:237] op_sel:[1,1,0] op_sel_hi:[0,1,1] neg_lo:[1,0,0]
v_pk_mul_f32 v[236:237], v[238:239], v[230:231] op_sel:[0,0] op_sel_hi:[1,0]
v_pk_fma_f32 v[240:241], v[238:239], v[230:231], v[236:237] op_sel:[1,1,0] op_sel_hi:[0,1,1] neg_lo:[1,0,0]
v_pk_fma_f32 v[242:243], v[240:241], v[234:235], v[238:239] op_sel:[0,0,0] op_sel_hi:[1,0,1] neg_lo:[0,0,1] neg_hi:[0,0,1]
v_pk_fma_f32 v[244:245], v[242:243], v[234:235], v[240:241] op_sel:[0,0,0] op_sel_hi:[1,0,1] neg_lo:[0,0,1] neg_hi:[0,0,1]
v_pk_fma_f32 v[246:247], v[244:245], v[234:235], v[242:243] op_sel:[0,0,0] op_sel_hi:[1,0,1] neg_lo:[0,0,1] neg_hi:[0,0,1]
v_pk_fma_f32 v[248:249], v[246:247], v[234:235], v[244:245] op_sel:[0,0,0] op_sel_hi:[1,0,1] neg_lo:[0,0,1] neg_hi:[0,0,1]
v_pk_fma_f32 v[250:251], v[248:249], v[234:235], v[246:247] op_sel:[0,0,0] op_sel_hi:[1,0,1] neg_lo:[0,0,1] neg_hi:[0,0,1]
v_pk_fma_f32 v[252:253], v[250:251], v[234:235], v[248:249] op_sel:[0,0,0] op_sel_hi:[1,0,1] neg_lo:[0,0,1] neg_hi:[0,0,1]
v_cvt_pk_bf16_f32 v24, v238, v240
v_cvt_pk_bf16_f32 v96, -v239, -v241
v_cvt_pk_bf16_f32 v25, v242, v244
v_cvt_pk_bf16_f32 v97, -v243, -v245
v_cvt_pk_bf16_f32 v26, v246, v248
v_cvt_pk_bf16_f32 v98, -v247, -v249
v_cvt_pk_bf16_f32 v27, v250, v252
v_cvt_pk_bf16_f32 v99, -v251, -v253
v_pk_mul_f32 v[236:237], v[238:239], v[232:233] op_sel:[0,0] op_sel_hi:[1,0]
v_pk_fma_f32 v[238:239], v[238:239], v[232:233], v[236:237] op_sel:[1,1,0] op_sel_hi:[0,1,1] neg_lo:[1,0,0]
v_pk_mul_f32 v[236:237], v[238:239], v[230:231] op_sel:[0,0] op_sel_hi:[1,0]
v_pk_fma_f32 v[240:241], v[238:239], v[230:231], v[236:237] op_sel:[1,1,0] op_sel_hi:[0,1,1] neg_lo:[1,0,0]
v_pk_fma_f32 v[242:243], v[240:241], v[234:235], v[238:239] op_sel:[0,0,0] op_sel_hi:[1,0,1] neg_lo:[0,0,1] neg_hi:[0,0,1]
v_pk_fma_f32 v[244:245], v[242:243], v[234:235], v[240:241] op_sel:[0,0,0] op_sel_hi:[1,0,1] neg_lo:[0,0,1] neg_hi:[0,0,1]
v_pk_fma_f32 v[246:247], v[244:245], v[234:235], v[242:243] op_sel:[0,0,0] op_sel_hi:[1,0,1] neg_lo:[0,0,1] neg_hi:[0,0,1]
v_pk_fma_f32 v[248:249], v[246:247], v[234:235], v[244:245] op_sel:[0,0,0] op_sel_hi:[1,0,1] neg_lo:[0,0,1] neg_hi:[0,0,1]
v_pk_fma_f32 v[250:251], v[248:249], v[234:235], v[246:247] op_sel:[0,0,0] op_sel_hi:[1,0,1] neg_lo:[0,0,1] neg_hi:[0,0,1]
v_pk_fma_f32 v[252:253], v[250:251], v[234:235], v[248:249] op_sel:[0,0,0] op_sel_hi:[1,0,1] neg_lo:[0,0,1] neg_hi:[0,0,1]
v_cvt_pk_bf16_f32 v28, v238, v240
v_cvt_pk_bf16_f32 v100, -v239, -v241
v_cvt_pk_bf16_f32 v29, v242, v244
v_cvt_pk_bf16_f32 v101, -v243, -v245
v_cvt_pk_bf16_f32 v30, v246, v248
v_cvt_pk_bf16_f32 v102, -v247, -v249
v_cvt_pk_bf16_f32 v31, v250, v252
v_cvt_pk_bf16_f32 v103, -v251, -v253
v_pk_mul_f32 v[236:237], v[238:239], v[232:233] op_sel:[0,0] op_sel_hi:[1,0]
v_pk_fma_f32 v[238:239], v[238:239], v[232:233], v[236:237] op_sel:[1,1,0] op_sel_hi:[0,1,1] neg_lo:[1,0,0]
s_waitcnt lgkmcnt(0)
s_mov_b32 s12, s6
s_and_b32 s13, s7, 0xffff
s_mov_b32 s14, 2359296
s_mov_b32 s15, 0x20000
v_lshrrev_b32 v14, 3, v1
v_and_b32 v15, 7, v1
v_xor_b32 v15, v15, v14
v_lshlrev_b32 v15, 4, v15
v_mul_u32_u24 v14, 73728, v14
v_add_u32 v14, v14, v15
s_mul_i32 s27, s23, 2304
s_add_u32 s28, s22, 0
s_bfe_u32 s29, s28, 0x10001
s_lshl_b32 s29, s29, 1
s_and_b32 s30, s28, 1
s_add_u32 s29, s29, s30
s_mul_i32 s29, s29, 589824
s_lshr_b32 s30, s28, 2
s_mul_i32 s30, s30, 1152
s_add_u32 s29, s29, s30
s_add_u32 s29, s29, s27
s_lshl_b32 s28, s28, 10
s_add_u32 s30, s29, 0
s_add_u32 m0, s28, 0
s_nop 0
buffer_load_dwordx4 v14, s[12:15], s30 offen lds
s_add_u32 s30, s29, 128
s_add_u32 m0, s28, 8192
s_nop 0
buffer_load_dwordx4 v14, s[12:15], s30 offen lds
s_add_u32 s30, s29, 256
s_add_u32 m0, s28, 16384
s_nop 0
buffer_load_dwordx4 v14, s[12:15], s30 offen lds
s_add_u32 s28, s22, 3
s_bfe_u32 s29, s28, 0x10001
s_lshl_b32 s29, s29, 1
s_and_b32 s30, s28, 1
s_add_u32 s29, s29, s30
s_mul_i32 s29, s29, 589824
s_lshr_b32 s30, s28, 2
s_mul_i32 s30, s30, 1152
s_add_u32 s29, s29, s30
s_add_u32 s29, s29, s27
s_lshl_b32 s28, s28, 10
s_add_u32 s30, s29, 0
s_add_u32 m0, s28, 0
s_nop 0
buffer_load_dwordx4 v14, s[12:15], s30 offen lds
s_add_u32 s30, s29, 128
s_add_u32 m0, s28, 8192
s_nop 0
buffer_load_dwordx4 v14, s[12:15], s30 offen lds
s_add_u32 s30, s29, 256
s_add_u32 m0, s28, 16384
s_nop 0
buffer_load_dwordx4 v14, s[12:15], s30 offen lds
s_cmp_eq_u32 s22, 2
s_cbranch_scc1 k1_kernel_edma
s_add_u32 s28, s22, 6
s_bfe_u32 s29, s28, 0x10001
s_lshl_b32 s29, s29, 1
s_and_b32 s30, s28, 1
s_add_u32 s29, s29, s30
s_mul_i32 s29, s29, 589824
s_lshr_b32 s30, s28, 2
s_mul_i32 s30, s30, 1152
s_add_u32 s29, s29, s30
s_add_u32 s29, s29, s27
s_lshl_b32 s28, s28, 10
s_add_u32 s30, s29, 0
s_add_u32 m0, s28, 0
s_nop 0
buffer_load_dwordx4 v14, s[12:15], s30 offen lds
s_add_u32 s30, s29, 128
s_add_u32 m0, s28, 8192
s_nop 0
buffer_load_dwordx4 v14, s[12:15], s30 offen lds
s_add_u32 s30, s29, 256
s_add_u32 m0, s28, 16384
s_nop 0
buffer_load_dwordx4 v14, s[12:15], s30 offen lds
k1_kernel_edma:
v_pk_mul_f32 v[236:237], v[238:239], v[230:231] op_sel:[0,0] op_sel_hi:[1,0]
v_pk_fma_f32 v[240:241], v[238:239], v[230:231], v[236:237] op_sel:[1,1,0] op_sel_hi:[0,1,1] neg_lo:[1,0,0]
v_pk_fma_f32 v[242:243], v[240:241], v[234:235], v[238:239] op_sel:[0,0,0] op_sel_hi:[1,0,1] neg_lo:[0,0,1] neg_hi:[0,0,1]
v_pk_fma_f32 v[244:245], v[242:243], v[234:235], v[240:241] op_sel:[0,0,0] op_sel_hi:[1,0,1] neg_lo:[0,0,1] neg_hi:[0,0,1]
v_pk_fma_f32 v[246:247], v[244:245], v[234:235], v[242:243] op_sel:[0,0,0] op_sel_hi:[1,0,1] neg_lo:[0,0,1] neg_hi:[0,0,1]
v_pk_fma_f32 v[248:249], v[246:247], v[234:235], v[244:245] op_sel:[0,0,0] op_sel_hi:[1,0,1] neg_lo:[0,0,1] neg_hi:[0,0,1]
v_pk_fma_f32 v[250:251], v[248:249], v[234:235], v[246:247] op_sel:[0,0,0] op_sel_hi:[1,0,1] neg_lo:[0,0,1] neg_hi:[0,0,1]
v_pk_fma_f32 v[252:253], v[250:251], v[234:235], v[248:249] op_sel:[0,0,0] op_sel_hi:[1,0,1] neg_lo:[0,0,1] neg_hi:[0,0,1]
v_cvt_pk_bf16_f32 v32, v238, v240
v_cvt_pk_bf16_f32 v104, -v239, -v241
v_cvt_pk_bf16_f32 v33, v242, v244
v_cvt_pk_bf16_f32 v105, -v243, -v245
v_cvt_pk_bf16_f32 v34, v246, v248
v_cvt_pk_bf16_f32 v106, -v247, -v249
v_cvt_pk_bf16_f32 v35, v250, v252
v_cvt_pk_bf16_f32 v107, -v251, -v253
v_pk_mul_f32 v[236:237], v[238:239], v[232:233] op_sel:[0,0] op_sel_hi:[1,0]
v_pk_fma_f32 v[238:239], v[238:239], v[232:233], v[236:237] op_sel:[1,1,0] op_sel_hi:[0,1,1] neg_lo:[1,0,0]
v_pk_mul_f32 v[236:237], v[238:239], v[230:231] op_sel:[0,0] op_sel_hi:[1,0]
v_pk_fma_f32 v[240:241], v[238:239], v[230:231], v[236:237] op_sel:[1,1,0] op_sel_hi:[0,1,1] neg_lo:[1,0,0]
v_pk_fma_f32 v[242:243], v[240:241], v[234:235], v[238:239] op_sel:[0,0,0] op_sel_hi:[1,0,1] neg_lo:[0,0,1] neg_hi:[0,0,1]
v_pk_fma_f32 v[244:245], v[242:243], v[234:235], v[240:241] op_sel:[0,0,0] op_sel_hi:[1,0,1] neg_lo:[0,0,1] neg_hi:[0,0,1]
v_pk_fma_f32 v[246:247], v[244:245], v[234:235], v[242:243] op_sel:[0,0,0] op_sel_hi:[1,0,1] neg_lo:[0,0,1] neg_hi:[0,0,1]
v_pk_fma_f32 v[248:249], v[246:247], v[234:235], v[244:245] op_sel:[0,0,0] op_sel_hi:[1,0,1] neg_lo:[0,0,1] neg_hi:[0,0,1]
v_pk_fma_f32 v[250:251], v[248:249], v[234:235], v[246:247] op_sel:[0,0,0] op_sel_hi:[1,0,1] neg_lo:[0,0,1] neg_hi:[0,0,1]
v_pk_fma_f32 v[252:253], v[250:251], v[234:235], v[248:249] op_sel:[0,0,0] op_sel_hi:[1,0,1] neg_lo:[0,0,1] neg_hi:[0,0,1]
v_cvt_pk_bf16_f32 v36, v238, v240
v_cvt_pk_bf16_f32 v108, -v239, -v241
v_cvt_pk_bf16_f32 v37, v242, v244
v_cvt_pk_bf16_f32 v109, -v243, -v245
v_cvt_pk_bf16_f32 v38, v246, v248
v_cvt_pk_bf16_f32 v110, -v247, -v249
v_cvt_pk_bf16_f32 v39, v250, v252
v_cvt_pk_bf16_f32 v111, -v251, -v253
v_pk_mul_f32 v[236:237], v[238:239], v[232:233] op_sel:[0,0] op_sel_hi:[1,0]
v_pk_fma_f32 v[238:239], v[238:239], v[232:233], v[236:237] op_sel:[1,1,0] op_sel_hi:[0,1,1] neg_lo:[1,0,0]
v_pk_mul_f32 v[236:237], v[238:239], v[230:231] op_sel:[0,0] op_sel_hi:[1,0]
v_pk_fma_f32 v[240:241], v[238:239], v[230:231], v[236:237] op_sel:[1,1,0] op_sel_hi:[0,1,1] neg_lo:[1,0,0]
v_pk_fma_f32 v[242:243], v[240:241], v[234:235], v[238:239] op_sel:[0,0,0] op_sel_hi:[1,0,1] neg_lo:[0,0,1] neg_hi:[0,0,1]
v_pk_fma_f32 v[244:245], v[242:243], v[234:235], v[240:241] op_sel:[0,0,0] op_sel_hi:[1,0,1] neg_lo:[0,0,1] neg_hi:[0,0,1]
v_pk_fma_f32 v[246:247], v[244:245], v[234:235], v[242:243] op_sel:[0,0,0] op_sel_hi:[1,0,1] neg_lo:[0,0,1] neg_hi:[0,0,1]
v_pk_fma_f32 v[248:249], v[246:247], v[234:235], v[244:245] op_sel:[0,0,0] op_sel_hi:[1,0,1] neg_lo:[0,0,1] neg_hi:[0,0,1]
v_pk_fma_f32 v[250:251], v[248:249], v[234:235], v[246:247] op_sel:[0,0,0] op_sel_hi:[1,0,1] neg_lo:[0,0,1] neg_hi:[0,0,1]
v_pk_fma_f32 v[252:253], v[250:251], v[234:235], v[248:249] op_sel:[0,0,0] op_sel_hi:[1,0,1] neg_lo:[0,0,1] neg_hi:[0,0,1]
v_cvt_pk_bf16_f32 v40, v238, v240
v_cvt_pk_bf16_f32 v112, -v239, -v241
v_cvt_pk_bf16_f32 v41, v242, v244
v_cvt_pk_bf16_f32 v113, -v243, -v245
v_cvt_pk_bf16_f32 v42, v246, v248
v_cvt_pk_bf16_f32 v114, -v247, -v249
v_cvt_pk_bf16_f32 v43, v250, v252
v_cvt_pk_bf16_f32 v115, -v251, -v253
v_pk_mul_f32 v[236:237], v[238:239], v[232:233] op_sel:[0,0] op_sel_hi:[1,0]
v_pk_fma_f32 v[238:239], v[238:239], v[232:233], v[236:237] op_sel:[1,1,0] op_sel_hi:[0,1,1] neg_lo:[1,0,0]
v_pk_mul_f32 v[236:237], v[238:239], v[230:231] op_sel:[0,0] op_sel_hi:[1,0]
v_pk_fma_f32 v[240:241], v[238:239], v[230:231], v[236:237] op_sel:[1,1,0] op_sel_hi:[0,1,1] neg_lo:[1,0,0]
v_pk_fma_f32 v[242:243], v[240:241], v[234:235], v[238:239] op_sel:[0,0,0] op_sel_hi:[1,0,1] neg_lo:[0,0,1] neg_hi:[0,0,1]
v_pk_fma_f32 v[244:245], v[242:243], v[234:235], v[240:241] op_sel:[0,0,0] op_sel_hi:[1,0,1] neg_lo:[0,0,1] neg_hi:[0,0,1]
v_pk_fma_f32 v[246:247], v[244:245], v[234:235], v[242:243] op_sel:[0,0,0] op_sel_hi:[1,0,1] neg_lo:[0,0,1] neg_hi:[0,0,1]
v_pk_fma_f32 v[248:249], v[246:247], v[234:235], v[244:245] op_sel:[0,0,0] op_sel_hi:[1,0,1] neg_lo:[0,0,1] neg_hi:[0,0,1]
v_pk_fma_f32 v[250:251], v[248:249], v[234:235], v[246:247] op_sel:[0,0,0] op_sel_hi:[1,0,1] neg_lo:[0,0,1] neg_hi:[0,0,1]
v_pk_fma_f32 v[252:253], v[250:251], v[234:235], v[248:249] op_sel:[0,0,0] op_sel_hi:[1,0,1] neg_lo:[0,0,1] neg_hi:[0,0,1]
v_cvt_pk_bf16_f32 v44, v238, v240
v_cvt_pk_bf16_f32 v116, -v239, -v241
v_cvt_pk_bf16_f32 v45, v242, v244
v_cvt_pk_bf16_f32 v117, -v243, -v245
v_cvt_pk_bf16_f32 v46, v246, v248
v_cvt_pk_bf16_f32 v118, -v247, -v249
v_cvt_pk_bf16_f32 v47, v250, v252
v_cvt_pk_bf16_f32 v119, -v251, -v253
v_pk_mul_f32 v[236:237], v[238:239], v[232:233] op_sel:[0,0] op_sel_hi:[1,0]
v_pk_fma_f32 v[238:239], v[238:239], v[232:233], v[236:237] op_sel:[1,1,0] op_sel_hi:[0,1,1] neg_lo:[1,0,0]
v_pk_mul_f32 v[236:237], v[238:239], v[230:231] op_sel:[0,0] op_sel_hi:[1,0]
v_pk_fma_f32 v[240:241], v[238:239], v[230:231], v[236:237] op_sel:[1,1,0] op_sel_hi:[0,1,1] neg_lo:[1,0,0]
v_pk_fma_f32 v[242:243], v[240:241], v[234:235], v[238:239] op_sel:[0,0,0] op_sel_hi:[1,0,1] neg_lo:[0,0,1] neg_hi:[0,0,1]
v_pk_fma_f32 v[244:245], v[242:243], v[234:235], v[240:241] op_sel:[0,0,0] op_sel_hi:[1,0,1] neg_lo:[0,0,1] neg_hi:[0,0,1]
v_pk_fma_f32 v[246:247], v[244:245], v[234:235], v[242:243] op_sel:[0,0,0] op_sel_hi:[1,0,1] neg_lo:[0,0,1] neg_hi:[0,0,1]
v_pk_fma_f32 v[248:249], v[246:247], v[234:235], v[244:245] op_sel:[0,0,0] op_sel_hi:[1,0,1] neg_lo:[0,0,1] neg_hi:[0,0,1]
v_pk_fma_f32 v[250:251], v[248:249], v[234:235], v[246:247] op_sel:[0,0,0] op_sel_hi:[1,0,1] neg_lo:[0,0,1] neg_hi:[0,0,1]
v_pk_fma_f32 v[252:253], v[250:251], v[234:235], v[248:249] op_sel:[0,0,0] op_sel_hi:[1,0,1] neg_lo:[0,0,1] neg_hi:[0,0,1]
v_cvt_pk_bf16_f32 v48, v238, v240
v_cvt_pk_bf16_f32 v120, -v239, -v241
v_cvt_pk_bf16_f32 v49, v242, v244
v_cvt_pk_bf16_f32 v121, -v243, -v245
v_cvt_pk_bf16_f32 v50, v246, v248
v_cvt_pk_bf16_f32 v122, -v247, -v249
v_cvt_pk_bf16_f32 v51, v250, v252
v_cvt_pk_bf16_f32 v123, -v251, -v253
v_pk_mul_f32 v[236:237], v[238:239], v[232:233] op_sel:[0,0] op_sel_hi:[1,0]
v_pk_fma_f32 v[238:239], v[238:239], v[232:233], v[236:237] op_sel:[1,1,0] op_sel_hi:[0,1,1] neg_lo:[1,0,0]
v_pk_mul_f32 v[236:237], v[238:239], v[230:231] op_sel:[0,0] op_sel_hi:[1,0]
v_pk_fma_f32 v[240:241], v[238:239], v[230:231], v[236:237] op_sel:[1,1,0] op_sel_hi:[0,1,1] neg_lo:[1,0,0]
v_pk_fma_f32 v[242:243], v[240:241], v[234:235], v[238:239] op_sel:[0,0,0] op_sel_hi:[1,0,1] neg_lo:[0,0,1] neg_hi:[0,0,1]
v_pk_fma_f32 v[244:245], v[242:243], v[234:235], v[240:241] op_sel:[0,0,0] op_sel_hi:[1,0,1] neg_lo:[0,0,1] neg_hi:[0,0,1]
v_pk_fma_f32 v[246:247], v[244:245], v[234:235], v[242:243] op_sel:[0,0,0] op_sel_hi:[1,0,1] neg_lo:[0,0,1] neg_hi:[0,0,1]
v_pk_fma_f32 v[248:249], v[246:247], v[234:235], v[244:245] op_sel:[0,0,0] op_sel_hi:[1,0,1] neg_lo:[0,0,1] neg_hi:[0,0,1]
v_pk_fma_f32 v[250:251], v[248:249], v[234:235], v[246:247] op_sel:[0,0,0] op_sel_hi:[1,0,1] neg_lo:[0,0,1] neg_hi:[0,0,1]
v_pk_fma_f32 v[252:253], v[250:251], v[234:235], v[248:249] op_sel:[0,0,0] op_sel_hi:[1,0,1] neg_lo:[0,0,1] neg_hi:[0,0,1]
v_cvt_pk_bf16_f32 v52, v238, v240
v_cvt_pk_bf16_f32 v124, -v239, -v241
v_cvt_pk_bf16_f32 v53, v242, v244
v_cvt_pk_bf16_f32 v125, -v243, -v245
v_cvt_pk_bf16_f32 v54, v246, v248
v_cvt_pk_bf16_f32 v126, -v247, -v249
v_cvt_pk_bf16_f32 v55, v250, v252
v_cvt_pk_bf16_f32 v127, -v251, -v253
v_pk_mul_f32 v[236:237], v[238:239], v[232:233] op_sel:[0,0] op_sel_hi:[1,0]
v_pk_fma_f32 v[238:239], v[238:239], v[232:233], v[236:237] op_sel:[1,1,0] op_sel_hi:[0,1,1] neg_lo:[1,0,0]
v_pk_mul_f32 v[236:237], v[238:239], v[230:231] op_sel:[0,0] op_sel_hi:[1,0]
v_pk_fma_f32 v[240:241], v[238:239], v[230:231], v[236:237] op_sel:[1,1,0] op_sel_hi:[0,1,1] neg_lo:[1,0,0]
v_pk_fma_f32 v[242:243], v[240:241], v[234:235], v[238:239] op_sel:[0,0,0] op_sel_hi:[1,0,1] neg_lo:[0,0,1] neg_hi:[0,0,1]
v_pk_fma_f32 v[244:245], v[242:243], v[234:235], v[240:241] op_sel:[0,0,0] op_sel_hi:[1,0,1] neg_lo:[0,0,1] neg_hi:[0,0,1]
v_pk_fma_f32 v[246:247], v[244:245], v[234:235], v[242:243] op_sel:[0,0,0] op_sel_hi:[1,0,1] neg_lo:[0,0,1] neg_hi:[0,0,1]
v_pk_fma_f32 v[248:249], v[246:247], v[234:235], v[244:245] op_sel:[0,0,0] op_sel_hi:[1,0,1] neg_lo:[0,0,1] neg_hi:[0,0,1]
v_pk_fma_f32 v[250:251], v[248:249], v[234:235], v[246:247] op_sel:[0,0,0] op_sel_hi:[1,0,1] neg_lo:[0,0,1] neg_hi:[0,0,1]
v_pk_fma_f32 v[252:253], v[250:251], v[234:235], v[248:249] op_sel:[0,0,0] op_sel_hi:[1,0,1] neg_lo:[0,0,1] neg_hi:[0,0,1]
v_cvt_pk_bf16_f32 v56, v238, v240
v_cvt_pk_bf16_f32 v128, -v239, -v241
v_cvt_pk_bf16_f32 v57, v242, v244
v_cvt_pk_bf16_f32 v129, -v243, -v245
v_cvt_pk_bf16_f32 v58, v246, v248
v_cvt_pk_bf16_f32 v130, -v247, -v249
v_cvt_pk_bf16_f32 v59, v250, v252
v_cvt_pk_bf16_f32 v131, -v251, -v253
v_pk_mul_f32 v[236:237], v[238:239], v[232:233] op_sel:[0,0] op_sel_hi:[1,0]
v_pk_fma_f32 v[238:239], v[238:239], v[232:233], v[236:237] op_sel:[1,1,0] op_sel_hi:[0,1,1] neg_lo:[1,0,0]
v_pk_mul_f32 v[236:237], v[238:239], v[230:231] op_sel:[0,0] op_sel_hi:[1,0]
v_pk_fma_f32 v[240:241], v[238:239], v[230:231], v[236:237] op_sel:[1,1,0] op_sel_hi:[0,1,1] neg_lo:[1,0,0]
v_pk_fma_f32 v[242:243], v[240:241], v[234:235], v[238:239] op_sel:[0,0,0] op_sel_hi:[1,0,1] neg_lo:[0,0,1] neg_hi:[0,0,1]
v_pk_fma_f32 v[244:245], v[242:243], v[234:235], v[240:241] op_sel:[0,0,0] op_sel_hi:[1,0,1] neg_lo:[0,0,1] neg_hi:[0,0,1]
v_pk_fma_f32 v[246:247], v[244:245], v[234:235], v[242:243] op_sel:[0,0,0] op_sel_hi:[1,0,1] neg_lo:[0,0,1] neg_hi:[0,0,1]
v_pk_fma_f32 v[248:249], v[246:247], v[234:235], v[244:245] op_sel:[0,0,0] op_sel_hi:[1,0,1] neg_lo:[0,0,1] neg_hi:[0,0,1]
v_pk_fma_f32 v[250:251], v[248:249], v[234:235], v[246:247] op_sel:[0,0,0] op_sel_hi:[1,0,1] neg_lo:[0,0,1] neg_hi:[0,0,1]
v_pk_fma_f32 v[252:253], v[250:251], v[234:235], v[248:249] op_sel:[0,0,0] op_sel_hi:[1,0,1] neg_lo:[0,0,1] neg_hi:[0,0,1]
v_cvt_pk_bf16_f32 v60, v238, v240
v_cvt_pk_bf16_f32 v132, -v239, -v241
v_cvt_pk_bf16_f32 v61, v242, v244
v_cvt_pk_bf16_f32 v133, -v243, -v245
v_cvt_pk_bf16_f32 v62, v246, v248
v_cvt_pk_bf16_f32 v134, -v247, -v249
v_cvt_pk_bf16_f32 v63, v250, v252
v_cvt_pk_bf16_f32 v135, -v251, -v253
v_pk_mul_f32 v[236:237], v[238:239], v[232:233] op_sel:[0,0] op_sel_hi:[1,0]
v_pk_fma_f32 v[238:239], v[238:239], v[232:233], v[236:237] op_sel:[1,1,0] op_sel_hi:[0,1,1] neg_lo:[1,0,0]
v_pk_mul_f32 v[236:237], v[238:239], v[230:231] op_sel:[0,0] op_sel_hi:[1,0]
v_pk_fma_f32 v[240:241], v[238:239], v[230:231], v[236:237] op_sel:[1,1,0] op_sel_hi:[0,1,1] neg_lo:[1,0,0]
v_pk_fma_f32 v[242:243], v[240:241], v[234:235], v[238:239] op_sel:[0,0,0] op_sel_hi:[1,0,1] neg_lo:[0,0,1] neg_hi:[0,0,1]
v_pk_fma_f32 v[244:245], v[242:243], v[234:235], v[240:241] op_sel:[0,0,0] op_sel_hi:[1,0,1] neg_lo:[0,0,1] neg_hi:[0,0,1]
v_pk_fma_f32 v[246:247], v[244:245], v[234:235], v[242:243] op_sel:[0,0,0] op_sel_hi:[1,0,1] neg_lo:[0,0,1] neg_hi:[0,0,1]
v_pk_fma_f32 v[248:249], v[246:247], v[234:235], v[244:245] op_sel:[0,0,0] op_sel_hi:[1,0,1] neg_lo:[0,0,1] neg_hi:[0,0,1]
v_pk_fma_f32 v[250:251], v[248:249], v[234:235], v[246:247] op_sel:[0,0,0] op_sel_hi:[1,0,1] neg_lo:[0,0,1] neg_hi:[0,0,1]
v_pk_fma_f32 v[252:253], v[250:251], v[234:235], v[248:249] op_sel:[0,0,0] op_sel_hi:[1,0,1] neg_lo:[0,0,1] neg_hi:[0,0,1]
v_cvt_pk_bf16_f32 v64, v238, v240
v_cvt_pk_bf16_f32 v136, -v239, -v241
v_cvt_pk_bf16_f32 v65, v242, v244
v_cvt_pk_bf16_f32 v137, -v243, -v245
v_cvt_pk_bf16_f32 v66, v246, v248
v_cvt_pk_bf16_f32 v138, -v247, -v249
v_cvt_pk_bf16_f32 v67, v250, v252
v_cvt_pk_bf16_f32 v139, -v251, -v253
v_pk_mul_f32 v[236:237], v[238:239], v[232:233] op_sel:[0,0] op_sel_hi:[1,0]
v_pk_fma_f32 v[238:239], v[238:239], v[232:233], v[236:237] op_sel:[1,1,0] op_sel_hi:[0,1,1] neg_lo:[1,0,0]
v_pk_mul_f32 v[236:237], v[238:239], v[230:231] op_sel:[0,0] op_sel_hi:[1,0]
v_pk_fma_f32 v[240:241], v[238:239], v[230:231], v[236:237] op_sel:[1,1,0] op_sel_hi:[0,1,1] neg_lo:[1,0,0]
v_pk_fma_f32 v[242:243], v[240:241], v[234:235], v[238:239] op_sel:[0,0,0] op_sel_hi:[1,0,1] neg_lo:[0,0,1] neg_hi:[0,0,1]
v_pk_fma_f32 v[244:245], v[242:243], v[234:235], v[240:241] op_sel:[0,0,0] op_sel_hi:[1,0,1] neg_lo:[0,0,1] neg_hi:[0,0,1]
v_pk_fma_f32 v[246:247], v[244:245], v[234:235], v[242:243] op_sel:[0,0,0] op_sel_hi:[1,0,1] neg_lo:[0,0,1] neg_hi:[0,0,1]
v_pk_fma_f32 v[248:249], v[246:247], v[234:235], v[244:245] op_sel:[0,0,0] op_sel_hi:[1,0,1] neg_lo:[0,0,1] neg_hi:[0,0,1]
v_pk_fma_f32 v[250:251], v[248:249], v[234:235], v[246:247] op_sel:[0,0,0] op_sel_hi:[1,0,1] neg_lo:[0,0,1] neg_hi:[0,0,1]
v_pk_fma_f32 v[252:253], v[250:251], v[234:235], v[248:249] op_sel:[0,0,0] op_sel_hi:[1,0,1] neg_lo:[0,0,1] neg_hi:[0,0,1]
v_cvt_pk_bf16_f32 v68, v238, v240
v_cvt_pk_bf16_f32 v140, -v239, -v241
v_cvt_pk_bf16_f32 v69, v242, v244
v_cvt_pk_bf16_f32 v141, -v243, -v245
v_cvt_pk_bf16_f32 v70, v246, v248
v_cvt_pk_bf16_f32 v142, -v247, -v249
v_cvt_pk_bf16_f32 v71, v250, v252
v_cvt_pk_bf16_f32 v143, -v251, -v253
v_pk_mul_f32 v[236:237], v[238:239], v[232:233] op_sel:[0,0] op_sel_hi:[1,0]
v_pk_fma_f32 v[238:239], v[238:239], v[232:233], v[236:237] op_sel:[1,1,0] op_sel_hi:[0,1,1] neg_lo:[1,0,0]
v_pk_mul_f32 v[236:237], v[238:239], v[230:231] op_sel:[0,0] op_sel_hi:[1,0]
v_pk_fma_f32 v[240:241], v[238:239], v[230:231], v[236:237] op_sel:[1,1,0] op_sel_hi:[0,1,1] neg_lo:[1,0,0]
v_pk_fma_f32 v[242:243], v[240:241], v[234:235], v[238:239] op_sel:[0,0,0] op_sel_hi:[1,0,1] neg_lo:[0,0,1] neg_hi:[0,0,1]
v_pk_fma_f32 v[244:245], v[242:243], v[234:235], v[240:241] op_sel:[0,0,0] op_sel_hi:[1,0,1] neg_lo:[0,0,1] neg_hi:[0,0,1]
v_pk_fma_f32 v[246:247], v[244:245], v[234:235], v[242:243] op_sel:[0,0,0] op_sel_hi:[1,0,1] neg_lo:[0,0,1] neg_hi:[0,0,1]
v_pk_fma_f32 v[248:249], v[246:247], v[234:235], v[244:245] op_sel:[0,0,0] op_sel_hi:[1,0,1] neg_lo:[0,0,1] neg_hi:[0,0,1]
v_pk_fma_f32 v[250:251], v[248:249], v[234:235], v[246:247] op_sel:[0,0,0] op_sel_hi:[1,0,1] neg_lo:[0,0,1] neg_hi:[0,0,1]
v_pk_fma_f32 v[252:253], v[250:251], v[234:235], v[248:249] op_sel:[0,0,0] op_sel_hi:[1,0,1] neg_lo:[0,0,1] neg_hi:[0,0,1]
v_cvt_pk_bf16_f32 v72, v238, v240
v_cvt_pk_bf16_f32 v144, -v239, -v241
v_cvt_pk_bf16_f32 v73, v242, v244
v_cvt_pk_bf16_f32 v145, -v243, -v245
v_cvt_pk_bf16_f32 v74, v246, v248
v_cvt_pk_bf16_f32 v146, -v247, -v249
v_cvt_pk_bf16_f32 v75, v250, v252
v_cvt_pk_bf16_f32 v147, -v251, -v253
v_pk_mul_f32 v[236:237], v[238:239], v[232:233] op_sel:[0,0] op_sel_hi:[1,0]
v_pk_fma_f32 v[238:239], v[238:239], v[232:233], v[236:237] op_sel:[1,1,0] op_sel_hi:[0,1,1] neg_lo:[1,0,0]
v_pk_mul_f32 v[236:237], v[238:239], v[230:231] op_sel:[0,0] op_sel_hi:[1,0]
v_pk_fma_f32 v[240:241], v[238:239], v[230:231], v[236:237] op_sel:[1,1,0] op_sel_hi:[0,1,1] neg_lo:[1,0,0]
v_pk_fma_f32 v[242:243], v[240:241], v[234:235], v[238:239] op_sel:[0,0,0] op_sel_hi:[1,0,1] neg_lo:[0,0,1] neg_hi:[0,0,1]
v_pk_fma_f32 v[244:245], v[242:243], v[234:235], v[240:241] op_sel:[0,0,0] op_sel_hi:[1,0,1] neg_lo:[0,0,1] neg_hi:[0,0,1]
v_pk_fma_f32 v[246:247], v[244:245], v[234:235], v[242:243] op_sel:[0,0,0] op_sel_hi:[1,0,1] neg_lo:[0,0,1] neg_hi:[0,0,1]
v_pk_fma_f32 v[248:249], v[246:247], v[234:235], v[244:245] op_sel:[0,0,0] op_sel_hi:[1,0,1] neg_lo:[0,0,1] neg_hi:[0,0,1]
v_pk_fma_f32 v[250:251], v[248:249], v[234:235], v[246:247] op_sel:[0,0,0] op_sel_hi:[1,0,1] neg_lo:[0,0,1] neg_hi:[0,0,1]
v_pk_fma_f32 v[252:253], v[250:251], v[234:235], v[248:249] op_sel:[0,0,0] op_sel_hi:[1,0,1] neg_lo:[0,0,1] neg_hi:[0,0,1]
v_cvt_pk_bf16_f32 v76, v238, v240
v_cvt_pk_bf16_f32 v148, -v239, -v241
v_cvt_pk_bf16_f32 v77, v242, v244
v_cvt_pk_bf16_f32 v149, -v243, -v245
v_cvt_pk_bf16_f32 v78, v246, v248
v_cvt_pk_bf16_f32 v150, -v247, -v249
v_cvt_pk_bf16_f32 v79, v250, v252
v_cvt_pk_bf16_f32 v151, -v251, -v253
v_pk_mul_f32 v[236:237], v[238:239], v[232:233] op_sel:[0,0] op_sel_hi:[1,0]
v_pk_fma_f32 v[238:239], v[238:239], v[232:233], v[236:237] op_sel:[1,1,0] op_sel_hi:[0,1,1] neg_lo:[1,0,0]
v_pk_mul_f32 v[236:237], v[238:239], v[230:231] op_sel:[0,0] op_sel_hi:[1,0]
v_pk_fma_f32 v[240:241], v[238:239], v[230:231], v[236:237] op_sel:[1,1,0] op_sel_hi:[0,1,1] neg_lo:[1,0,0]
v_pk_fma_f32 v[242:243], v[240:241], v[234:235], v[238:239] op_sel:[0,0,0] op_sel_hi:[1,0,1] neg_lo:[0,0,1] neg_hi:[0,0,1]
v_pk_fma_f32 v[244:245], v[242:243], v[234:235], v[240:241] op_sel:[0,0,0] op_sel_hi:[1,0,1] neg_lo:[0,0,1] neg_hi:[0,0,1]
v_pk_fma_f32 v[246:247], v[244:245], v[234:235], v[242:243] op_sel:[0,0,0] op_sel_hi:[1,0,1] neg_lo:[0,0,1] neg_hi:[0,0,1]
v_pk_fma_f32 v[248:249], v[246:247], v[234:235], v[244:245] op_sel:[0,0,0] op_sel_hi:[1,0,1] neg_lo:[0,0,1] neg_hi:[0,0,1]
v_pk_fma_f32 v[250:251], v[248:249], v[234:235], v[246:247] op_sel:[0,0,0] op_sel_hi:[1,0,1] neg_lo:[0,0,1] neg_hi:[0,0,1]
v_pk_fma_f32 v[252:253], v[250:251], v[234:235], v[248:249] op_sel:[0,0,0] op_sel_hi:[1,0,1] neg_lo:[0,0,1] neg_hi:[0,0,1]
v_cvt_pk_bf16_f32 v80, v238, v240
v_cvt_pk_bf16_f32 v152, -v239, -v241
v_cvt_pk_bf16_f32 v81, v242, v244
v_cvt_pk_bf16_f32 v153, -v243, -v245
v_cvt_pk_bf16_f32 v82, v246, v248
v_cvt_pk_bf16_f32 v154, -v247, -v249
v_cvt_pk_bf16_f32 v83, v250, v252
v_cvt_pk_bf16_f32 v155, -v251, -v253
v_pk_mul_f32 v[236:237], v[238:239], v[232:233] op_sel:[0,0] op_sel_hi:[1,0]
v_pk_fma_f32 v[238:239], v[238:239], v[232:233], v[236:237] op_sel:[1,1,0] op_sel_hi:[0,1,1] neg_lo:[1,0,0]
v_pk_mul_f32 v[236:237], v[238:239], v[230:231] op_sel:[0,0] op_sel_hi:[1,0]
v_pk_fma_f32 v[240:241], v[238:239], v[230:231], v[236:237] op_sel:[1,1,0] op_sel_hi:[0,1,1] neg_lo:[1,0,0]
v_pk_fma_f32 v[242:243], v[240:241], v[234:235], v[238:239] op_sel:[0,0,0] op_sel_hi:[1,0,1] neg_lo:[0,0,1] neg_hi:[0,0,1]
v_pk_fma_f32 v[244:245], v[242:243], v[234:235], v[240:241] op_sel:[0,0,0] op_sel_hi:[1,0,1] neg_lo:[0,0,1] neg_hi:[0,0,1]
v_pk_fma_f32 v[246:247], v[244:245], v[234:235], v[242:243] op_sel:[0,0,0] op_sel_hi:[1,0,1] neg_lo:[0,0,1] neg_hi:[0,0,1]
v_pk_fma_f32 v[248:249], v[246:247], v[234:235], v[244:245] op_sel:[0,0,0] op_sel_hi:[1,0,1] neg_lo:[0,0,1] neg_hi:[0,0,1]
v_pk_fma_f32 v[250:251], v[248:249], v[234:235], v[246:247] op_sel:[0,0,0] op_sel_hi:[1,0,1] neg_lo:[0,0,1] neg_hi:[0,0,1]
v_pk_fma_f32 v[252:253], v[250:251], v[234:235], v[248:249] op_sel:[0,0,0] op_sel_hi:[1,0,1] neg_lo:[0,0,1] neg_hi:[0,0,1]
v_cvt_pk_bf16_f32 v84, v238, v240
v_cvt_pk_bf16_f32 v156, -v239, -v241
v_cvt_pk_bf16_f32 v85, v242, v244
v_cvt_pk_bf16_f32 v157, -v243, -v245
v_cvt_pk_bf16_f32 v86, v246, v248
v_cvt_pk_bf16_f32 v158, -v247, -v249
v_cvt_pk_bf16_f32 v87, v250, v252
v_cvt_pk_bf16_f32 v159, -v251, -v253
v_mov_b32 v12, 0
v_mov_b32 v13, 0xbe800000
v_cmp_eq_u32 vcc, 64, v11
s_nop 1
v_cndmask_b32 v12, v12, v13, vcc
v_cmp_eq_u32 vcc, 128, v11
s_nop 1
v_cndmask_b32 v12, v12, v13, vcc
v_cmp_eq_u32 vcc, 256, v11
s_nop 1
v_cndmask_b32 v12, v12, v13, vcc
s_waitcnt lgkmcnt(0)
s_mov_b32 s8, s4
s_and_b32 s9, s5, 0xffff
s_mov_b32 s10, 39878656
s_mov_b32 s11, 0x20000
s_mov_b32 s12, s6
s_and_b32 s13, s7, 0xffff
s_mov_b32 s14, 2359296
s_mov_b32 s15, 0x20000
v_lshrrev_b32 v14, 3, v1
v_and_b32 v15, 7, v1
v_xor_b32 v15, v15, v14
v_lshlrev_b32 v15, 4, v15
v_mul_u32_u24 v14, 73728, v14
v_add_u32 v14, v14, v15
s_mul_i32 s27, s23, 2304
s_add_u32 s28, s22, 0
s_bfe_u32 s29, s28, 0x10001
s_lshl_b32 s29, s29, 1
s_and_b32 s30, s28, 1
s_add_u32 s29, s29, s30
s_mul_i32 s29, s29, 589824
s_lshr_b32 s30, s28, 2
s_mul_i32 s30, s30, 1152
s_add_u32 s29, s29, s30
s_add_u32 s29, s29, s27
s_lshl_b32 s28, s28, 10
s_add_u32 s30, s29, 896
s_add_u32 m0, s28, 57344
s_nop 0
buffer_load_dwordx4 v14, s[12:15], s30 offen lds
s_add_u32 s30, s29, 1024
s_add_u32 m0, s28, 65536
s_nop 0
buffer_load_dwordx4 v14, s[12:15], s30 offen lds
s_add_u32 s28, s22, 3
s_bfe_u32 s29, s28, 0x10001
s_lshl_b32 s29, s29, 1
s_and_b32 s30, s28, 1
s_add_u32 s29, s29, s30
s_mul_i32 s29, s29, 589824
s_lshr_b32 s30, s28, 2
s_mul_i32 s30, s30, 1152
s_add_u32 s29, s29, s30
s_add_u32 s29, s29, s27
s_lshl_b32 s28, s28, 10
s_add_u32 s30, s29, 896
s_add_u32 m0, s28, 57344
s_nop 0
buffer_load_dwordx4 v14, s[12:15], s30 offen lds
s_add_u32 s30, s29, 1024
s_add_u32 m0, s28, 65536
s_nop 0
buffer_load_dwordx4 v14, s[12:15], s30 offen lds
s_cmp_eq_u32 s22, 2
s_cbranch_scc1 k1_kernel_nodma
s_add_u32 s28, s22, 6
s_bfe_u32 s29, s28, 0x10001
s_lshl_b32 s29, s29, 1
s_and_b32 s30, s28, 1
s_add_u32 s29, s29, s30
s_mul_i32 s29, s29, 589824
s_lshr_b32 s30, s28, 2
s_mul_i32 s30, s30, 1152
s_add_u32 s29, s29, s30
s_add_u32 s29, s29, s27
s_lshl_b32 s28, s28, 10
s_add_u32 s30, s29, 896
s_add_u32 m0, s28, 57344
s_nop 0
buffer_load_dwordx4 v14, s[12:15], s30 offen lds
s_add_u32 s30, s29, 1024
s_add_u32 m0, s28, 65536
s_nop 0
buffer_load_dwordx4 v14, s[12:15], s30 offen lds
k1_kernel_nodma:
s_load_dwordx2 s[98:99], s[0:1], 72
s_waitcnt lgkmcnt(0)
s_mov_b32 s88, s98
s_and_b32 s89, s99, 0xffff
s_mov_b32 s90, 256
s_mov_b32 s91, 0x20000
v_mov_b32 v250, 0
s_cmp_lg_u32 s22, 0
s_cbranch_scc1 g_2
buffer_load_dword v251, v250, s[88:91], 0 offen sc1
g_2:
s_cmp_eq_u32 s22, 2
s_cbranch_scc1 k1_kernel_w4
s_waitcnt vmcnt(6)
s_branch k1_kernel_w4j
k1_kernel_w4:
s_waitcnt vmcnt(4)
k1_kernel_w4j:
s_barrier
ds_read_b128 v[192:195], v6 offset:0
ds_read_b128 v[196:199], v6 offset:2048
ds_read_b128 v[200:203], v6 offset:4096
ds_read_b128 v[204:207], v6 offset:6144
ds_read_b128 v[208:211], v7 offset:0
ds_read_b128 v[212:215], v7 offset:2048
ds_read_b128 v[216:219], v7 offset:4096
ds_read_b128 v[220:223], v7 offset:6144
s_waitcnt lgkmcnt(4)
v_mfma_f32_16x16x32_bf16 v[160:163], v[192:195], v[16:19], 0
v_mfma_f32_16x16x32_bf16 v[164:167], v[192:195], v[88:91], 0
v_mfma_f32_16x16x32_bf16 v[168:171], v[196:199], v[16:19], 0
v_mfma_f32_16x16x32_bf16 v[172:175], v[196:199], v[88:91], 0
ds_read_b128 v[224:227], v6 offset:8192
ds_read_b128 v[228:231], v6 offset:10240
ds_read_b128 v[232:235], v6 offset:12288
ds_read_b128 v[236:239], v6 offset:14336
v_mfma_f32_16x16x32_bf16 v[176:179], v[200:203], v[16:19], 0
v_mfma_f32_16x16x32_bf16 v[180:183], v[200:203], v[88:91], 0
v_mfma_f32_16x16x32_bf16 v[184:187], v[204:207], v[16:19], 0
v_mfma_f32_16x16x32_bf16 v[188:191], v[204:207], v[88:91], 0
s_waitcnt lgkmcnt(4)
v_mfma_f32_16x16x32_bf16 v[160:163], v[208:211], v[20:23], v[160:163]
v_mfma_f32_16x16x32_bf16 v[164:167], v[208:211], v[92:95], v[164:167]
v_mfma_f32_16x16x32_bf16 v[168:171], v[212:215], v[20:23], v[168:171]
v_mfma_f32_16x16x32_bf16 v[172:175], v[212:215], v[92:95], v[172:175]
ds_read_b128 v[192:195], v7 offset:8192
ds_read_b128 v[196:199], v7 offset:10240
ds_read_b128 v[200:203], v7 offset:12288
ds_read_b128 v[204:207], v7 offset:14336
v_mfma_f32_16x16x32_bf16 v[176:179], v[216:219], v[20:23], v[176:179]
v_mfma_f32_16x16x32_bf16 v[180:183], v[216:219], v[92:95], v[180:183]
v_mfma_f32_16x16x32_bf16 v[184:187], v[220:223], v[20:23], v[184:187]
v_mfma_f32_16x16x32_bf16 v[188:191], v[220:223], v[92:95], v[188:191]
s_waitcnt lgkmcnt(4)
v_mfma_f32_16x16x32_bf16 v[160:163], v[224:227], v[24:27], v[160:163]
v_mfma_f32_16x16x32_bf16 v[164:167], v[224:227], v[96:99], v[164:167]
v_mfma_f32_16x16x32_bf16 v[168:171], v[228:231], v[24:27], v[168:171]
v_mfma_f32_16x16x32_bf16 v[172:175], v[228:231], v[96:99], v[172:175]
ds_read_b128 v[208:211], v6 offset:16384
ds_read_b128 v[212:215], v6 offset:18432
ds_read_b128 v[216:219], v6 offset:20480
ds_read_b128 v[220:223], v6 offset:22528
v_mfma_f32_16x16x32_bf16 v[176:179], v[232:235], v[24:27], v[176:179]
v_mfma_f32_16x16x32_bf16 v[180:183], v[232:235], v[96:99], v[180:183]
v_mfma_f32_16x16x32_bf16 v[184:187], v[236:239], v[24:27], v[184:187]
v_mfma_f32_16x16x32_bf16 v[188:191], v[236:239], v[96:99], v[188:191]
s_waitcnt lgkmcnt(4)
v_mfma_f32_16x16x32_bf16 v[160:163], v[192:195], v[28:31], v[160:163]
v_mfma_f32_16x16x32_bf16 v[164:167], v[192:195], v[100:103], v[164:167]
v_mfma_f32_16x16x32_bf16 v[168:171], v[196:199], v[28:31], v[168:171]
v_mfma_f32_16x16x32_bf16 v[172:175], v[196:199], v[100:103], v[172:175]
ds_read_b128 v[224:227], v7 offset:16384
ds_read_b128 v[228:231], v7 offset:18432
ds_read_b128 v[232:235], v7 offset:20480
ds_read_b128 v[236:239], v7 offset:22528
v_mfma_f32_16x16x32_bf16 v[176:179], v[200:203], v[28:31], v[176:179]
v_mfma_f32_16x16x32_bf16 v[180:183], v[200:203], v[100:103], v[180:183]
v_mfma_f32_16x16x32_bf16 v[184:187], v[204:207], v[28:31], v[184:187]
v_mfma_f32_16x16x32_bf16 v[188:191], v[204:207], v[100:103], v[188:191]
s_waitcnt lgkmcnt(4)
v_mfma_f32_16x16x32_bf16 v[160:163], v[208:211], v[32:35], v[160:163]
v_mfma_f32_16x16x32_bf16 v[164:167], v[208:211], v[104:107], v[164:167]
v_mfma_f32_16x16x32_bf16 v[168:171], v[212:215], v[32:35], v[168:171]
v_mfma_f32_16x16x32_bf16 v[172:175], v[212:215], v[104:107], v[172:175]
v_mfma_f32_16x16x32_bf16 v[176:179], v[216:219], v[32:35], v[176:179]
v_mfma_f32_16x16x32_bf16 v[180:183], v[216:219], v[104:107], v[180:183]
v_mfma_f32_16x16x32_bf16 v[184:187], v[220:223], v[32:35], v[184:187]
v_mfma_f32_16x16x32_bf16 v[188:191], v[220:223], v[104:107], v[188:191]
s_waitcnt lgkmcnt(0)
v_mfma_f32_16x16x32_bf16 v[160:163], v[224:227], v[36:39], v[160:163]
v_mfma_f32_16x16x32_bf16 v[164:167], v[224:227], v[108:111], v[164:167]
v_mfma_f32_16x16x32_bf16 v[168:171], v[228:231], v[36:39], v[168:171]
v_mfma_f32_16x16x32_bf16 v[172:175], v[228:231], v[108:111], v[172:175]
v_mfma_f32_16x16x32_bf16 v[176:179], v[232:235], v[36:39], v[176:179]
v_mfma_f32_16x16x32_bf16 v[180:183], v[232:235], v[108:111], v[180:183]
v_mfma_f32_16x16x32_bf16 v[184:187], v[236:239], v[36:39], v[184:187]
v_mfma_f32_16x16x32_bf16 v[188:191], v[236:239], v[108:111], v[188:191]
s_barrier
ds_read_b128 v[192:195], v6 offset:24576
ds_read_b128 v[196:199], v6 offset:26624
ds_read_b128 v[200:203], v6 offset:28672
ds_read_b128 v[204:207], v6 offset:30720
ds_read_b128 v[208:211], v7 offset:24576
ds_read_b128 v[212:215], v7 offset:26624
ds_read_b128 v[216:219], v7 offset:28672
ds_read_b128 v[220:223], v7 offset:30720
s_waitcnt lgkmcnt(4)
v_mfma_f32_16x16x32_bf16 v[160:163], v[192:195], v[40:43], v[160:163]
v_mfma_f32_16x16x32_bf16 v[164:167], v[192:195], v[112:115], v[164:167]
v_mfma_f32_16x16x32_bf16 v[168:171], v[196:199], v[40:43], v[168:171]
v_mfma_f32_16x16x32_bf16 v[172:175], v[196:199], v[112:115], v[172:175]
ds_read_b128 v[224:227], v6 offset:32768
ds_read_b128 v[228:231], v6 offset:34816
ds_read_b128 v[232:235], v6 offset:36864
ds_read_b128 v[236:239], v6 offset:38912
v_mfma_f32_16x16x32_bf16 v[176:179], v[200:203], v[40:43], v[176:179]
v_mfma_f32_16x16x32_bf16 v[180:183], v[200:203], v[112:115], v[180:183]
v_mfma_f32_16x16x32_bf16 v[184:187], v[204:207], v[40:43], v[184:187]
v_mfma_f32_16x16x32_bf16 v[188:191], v[204:207], v[112:115], v[188:191]
s_waitcnt lgkmcnt(4)
v_mfma_f32_16x16x32_bf16 v[160:163], v[208:211], v[44:47], v[160:163]
v_mfma_f32_16x16x32_bf16 v[164:167], v[208:211], v[116:119], v[164:167]
v_mfma_f32_16x16x32_bf16 v[168:171], v[212:215], v[44:47], v[168:171]
v_mfma_f32_16x16x32_bf16 v[172:175], v[212:215], v[116:119], v[172:175]
ds_read_b128 v[192:195], v7 offset:32768
ds_read_b128 v[196:199], v7 offset:34816
ds_read_b128 v[200:203], v7 offset:36864
ds_read_b128 v[204:207], v7 offset:38912
v_mfma_f32_16x16x32_bf16 v[176:179], v[216:219], v[44:47], v[176:179]
v_mfma_f32_16x16x32_bf16 v[180:183], v[216:219], v[116:119], v[180:183]
v_mfma_f32_16x16x32_bf16 v[184:187], v[220:223], v[44:47], v[184:187]
v_mfma_f32_16x16x32_bf16 v[188:191], v[220:223], v[116:119], v[188:191]
s_waitcnt lgkmcnt(4)
v_mfma_f32_16x16x32_bf16 v[160:163], v[224:227], v[48:51], v[160:163]
v_mfma_f32_16x16x32_bf16 v[164:167], v[224:227], v[120:123], v[164:167]
v_mfma_f32_16x16x32_bf16 v[168:171], v[228:231], v[48:51], v[168:171]
v_mfma_f32_16x16x32_bf16 v[172:175], v[228:231], v[120:123], v[172:175]
ds_read_b128 v[208:211], v8 offset:0
ds_read_b128 v[212:215], v8 offset:2048
ds_read_b128 v[216:219], v8 offset:4096
ds_read_b128 v[220:223], v8 offset:6144
v_mfma_f32_16x16x32_bf16 v[176:179], v[232:235], v[48:51], v[176:179]
v_mfma_f32_16x16x32_bf16 v[180:183], v[232:235], v[120:123], v[180:183]
v_mfma_f32_16x16x32_bf16 v[184:187], v[236:239], v[48:51], v[184:187]
v_mfma_f32_16x16x32_bf16 v[188:191], v[236:239], v[120:123], v[188:191]
s_waitcnt lgkmcnt(4)
v_mfma_f32_16x16x32_bf16 v[160:163], v[192:195], v[52:55], v[160:163]
v_mfma_f32_16x16x32_bf16 v[164:167], v[192:195], v[124:127], v[164:167]
v_mfma_f32_16x16x32_bf16 v[168:171], v[196:199], v[52:55], v[168:171]
v_mfma_f32_16x16x32_bf16 v[172:175], v[196:199], v[124:127], v[172:175]
ds_read_b128 v[224:227], v9 offset:0
ds_read_b128 v[228:231], v9 offset:2048
ds_read_b128 v[232:235], v9 offset:4096
ds_read_b128 v[236:239], v9 offset:6144
v_mfma_f32_16x16x32_bf16 v[176:179], v[200:203], v[52:55], v[176:179]
v_mfma_f32_16x16x32_bf16 v[180:183], v[200:203], v[124:127], v[180:183]
v_mfma_f32_16x16x32_bf16 v[184:187], v[204:207], v[52:55], v[184:187]
v_mfma_f32_16x16x32_bf16 v[188:191], v[204:207], v[124:127], v[188:191]
s_waitcnt lgkmcnt(4)
v_mfma_f32_16x16x32_bf16 v[160:163], v[208:211], v[56:59], v[160:163]
v_mfma_f32_16x16x32_bf16 v[164:167], v[208:211], v[128:131], v[164:167]
v_mfma_f32_16x16x32_bf16 v[168:171], v[212:215], v[56:59], v[168:171]
v_mfma_f32_16x16x32_bf16 v[172:175], v[212:215], v[128:131], v[172:175]
v_mfma_f32_16x16x32_bf16 v[176:179], v[216:219], v[56:59], v[176:179]
v_mfma_f32_16x16x32_bf16 v[180:183], v[216:219], v[128:131], v[180:183]
v_mfma_f32_16x16x32_bf16 v[184:187], v[220:223], v[56:59], v[184:187]
v_mfma_f32_16x16x32_bf16 v[188:191], v[220:223], v[128:131], v[188:191]
s_waitcnt lgkmcnt(0)
v_mfma_f32_16x16x32_bf16 v[160:163], v[224:227], v[60:63], v[160:163]
v_mfma_f32_16x16x32_bf16 v[164:167], v[224:227], v[132:135], v[164:167]
v_mfma_f32_16x16x32_bf16 v[168:171], v[228:231], v[60:63], v[168:171]
v_mfma_f32_16x16x32_bf16 v[172:175], v[228:231], v[132:135], v[172:175]
v_mfma_f32_16x16x32_bf16 v[176:179], v[232:235], v[60:63], v[176:179]
v_mfma_f32_16x16x32_bf16 v[180:183], v[232:235], v[132:135], v[180:183]
v_mfma_f32_16x16x32_bf16 v[184:187], v[236:239], v[60:63], v[184:187]
v_mfma_f32_16x16x32_bf16 v[188:191], v[236:239], v[132:135], v[188:191]
s_waitcnt vmcnt(0)
s_cmp_lg_u32 s22, 0
s_cbranch_scc1 g_3
v_readfirstlane_b32 s96, v251
s_nop 3
s_cmp_lg_u32 s96, 0
s_cbranch_scc1 g_3_ok
s_mov_b32 s97, 0
g_3_l:
buffer_load_dword v251, v250, s[88:91], 0 offen sc1
s_waitcnt vmcnt(0)
v_readfirstlane_b32 s96, v251
s_add_u32 s97, s97, 1
s_cmp_gt_u32 s97, 200000
s_cbranch_scc1 g_3_ok
s_cmp_eq_u32 s96, 0
s_cbranch_scc1 g_3_l
g_3_ok:
v_mov_b32 v250, 153600
ds_write_b32 v250, v251
s_waitcnt lgkmcnt(0)
g_3:
s_barrier
ds_read_b128 v[192:195], v8 offset:8192
ds_read_b128 v[196:199], v8 offset:10240
ds_read_b128 v[200:203], v8 offset:12288
ds_read_b128 v[204:207], v8 offset:14336
ds_read_b128 v[208:211], v9 offset:8192
ds_read_b128 v[212:215], v9 offset:10240
ds_read_b128 v[216:219], v9 offset:12288
ds_read_b128 v[220:223], v9 offset:14336
s_waitcnt lgkmcnt(4)
v_mfma_f32_16x16x32_bf16 v[160:163], v[192:195], v[64:67], v[160:163]
v_mfma_f32_16x16x32_bf16 v[164:167], v[192:195], v[136:139], v[164:167]
v_mfma_f32_16x16x32_bf16 v[168:171], v[196:199], v[64:67], v[168:171]
v_mfma_f32_16x16x32_bf16 v[172:175], v[196:199], v[136:139], v[172:175]
ds_read_b128 v[224:227], v8 offset:16384
ds_read_b128 v[228:231], v8 offset:18432
ds_read_b128 v[232:235], v8 offset:20480
ds_read_b128 v[236:239], v8 offset:22528
v_mfma_f32_16x16x32_bf16 v[176:179], v[200:203], v[64:67], v[176:179]
v_mfma_f32_16x16x32_bf16 v[180:183], v[200:203], v[136:139], v[180:183]
v_mfma_f32_16x16x32_bf16 v[184:187], v[204:207], v[64:67], v[184:187]
v_mfma_f32_16x16x32_bf16 v[188:191], v[204:207], v[136:139], v[188:191]
s_waitcnt lgkmcnt(4)
v_mfma_f32_16x16x32_bf16 v[160:163], v[208:211], v[68:71], v[160:163]
v_mfma_f32_16x16x32_bf16 v[164:167], v[208:211], v[140:143], v[164:167]
v_mfma_f32_16x16x32_bf16 v[168:171], v[212:215], v[68:71], v[168:171]
v_mfma_f32_16x16x32_bf16 v[172:175], v[212:215], v[140:143], v[172:175]
ds_read_b128 v[192:195], v9 offset:16384
ds_read_b128 v[196:199], v9 offset:18432
ds_read_b128 v[200:203], v9 offset:20480
ds_read_b128 v[204:207], v9 offset:22528
v_mfma_f32_16x16x32_bf16 v[176:179], v[216:219], v[68:71], v[176:179]
v_mfma_f32_16x16x32_bf16 v[180:183], v[216:219], v[140:143], v[180:183]
v_mfma_f32_16x16x32_bf16 v[184:187], v[220:223], v[68:71], v[184:187]
v_mfma_f32_16x16x32_bf16 v[188:191], v[220:223], v[140:143], v[188:191]
s_waitcnt lgkmcnt(4)
v_mfma_f32_16x16x32_bf16 v[160:163], v[224:227], v[72:75], v[160:163]
v_mfma_f32_16x16x32_bf16 v[164:167], v[224:227], v[144:147], v[164:167]
v_mfma_f32_16x16x32_bf16 v[168:171], v[228:231], v[72:75], v[168:171]
v_mfma_f32_16x16x32_bf16 v[172:175], v[228:231], v[144:147], v[172:175]
ds_read_b128 v[208:211], v8 offset:24576
ds_read_b128 v[212:215], v8 offset:26624
ds_read_b128 v[216:219], v8 offset:28672
ds_read_b128 v[220:223], v8 offset:30720
v_mfma_f32_16x16x32_bf16 v[176:179], v[232:235], v[72:75], v[176:179]
v_mfma_f32_16x16x32_bf16 v[180:183], v[232:235], v[144:147], v[180:183]
v_mfma_f32_16x16x32_bf16 v[184:187], v[236:239], v[72:75], v[184:187]
v_mfma_f32_16x16x32_bf16 v[188:191], v[236:239], v[144:147], v[188:191]
s_waitcnt lgkmcnt(4)
v_mfma_f32_16x16x32_bf16 v[160:163], v[192:195], v[76:79], v[160:163]
v_mfma_f32_16x16x32_bf16 v[164:167], v[192:195], v[148:151], v[164:167]
v_mfma_f32_16x16x32_bf16 v[168:171], v[196:199], v[76:79], v[168:171]
v_mfma_f32_16x16x32_bf16 v[172:175], v[196:199], v[148:151], v[172:175]
ds_read_b128 v[224:227], v9 offset:24576
ds_read_b128 v[228:231], v9 offset:26624
ds_read_b128 v[232:235], v9 offset:28672
ds_read_b128 v[236:239], v9 offset:30720
v_mfma_f32_16x16x32_bf16 v[176:179], v[200:203], v[76:79], v[176:179]
v_mfma_f32_16x16x32_bf16 v[180:183], v[200:203], v[148:151], v[180:183]
v_mfma_f32_16x16x32_bf16 v[184:187], v[204:207], v[76:79], v[184:187]
v_mfma_f32_16x16x32_bf16 v[188:191], v[204:207], v[148:151], v[188:191]
s_waitcnt lgkmcnt(4)
v_mfma_f32_16x16x32_bf16 v[160:163], v[208:211], v[80:83], v[160:163]
v_mfma_f32_16x16x32_bf16 v[164:167], v[208:211], v[152:155], v[164:167]
v_mfma_f32_16x16x32_bf16 v[168:171], v[212:215], v[80:83], v[168:171]
v_mfma_f32_16x16x32_bf16 v[172:175], v[212:215], v[152:155], v[172:175]
v_mfma_f32_16x16x32_bf16 v[176:179], v[216:219], v[80:83], v[176:179]
v_mfma_f32_16x16x32_bf16 v[180:183], v[216:219], v[152:155], v[180:183]
v_mfma_f32_16x16x32_bf16 v[184:187], v[220:223], v[80:83], v[184:187]
v_mfma_f32_16x16x32_bf16 v[188:191], v[220:223], v[152:155], v[188:191]
s_waitcnt lgkmcnt(0)
v_mfma_f32_16x16x32_bf16 v[160:163], v[224:227], v[84:87], v[160:163]
v_mfma_f32_16x16x32_bf16 v[164:167], v[224:227], v[156:159], v[164:167]
v_mfma_f32_16x16x32_bf16 v[168:171], v[228:231], v[84:87], v[168:171]
v_mfma_f32_16x16x32_bf16 v[172:175], v[228:231], v[156:159], v[172:175]
v_mfma_f32_16x16x32_bf16 v[176:179], v[232:235], v[84:87], v[176:179]
v_mfma_f32_16x16x32_bf16 v[180:183], v[232:235], v[156:159], v[180:183]
v_mfma_f32_16x16x32_bf16 v[184:187], v[236:239], v[84:87], v[184:187]
v_mfma_f32_16x16x32_bf16 v[188:191], v[236:239], v[156:159], v[188:191]
s_barrier
v_add_u32 v14, 73728, v5
v_lshlrev_b32 v15, 6, v4
v_add_u32 v15, 90112, v15
v_lshlrev_b32 v10, 7, v3
v_lshl_add_u32 v10, v4, 4, v10
ds_read_b128 v[16:19], v14 offset:0
ds_read_b128 v[20:23], v14 offset:1024
ds_read_b128 v[24:27], v14 offset:2048
ds_read_b128 v[28:31], v14 offset:3072
ds_read_b128 v[32:35], v14 offset:4096
ds_read_b128 v[36:39], v14 offset:5120
ds_read_b128 v[40:43], v14 offset:6144
ds_read_b128 v[44:47], v14 offset:7168
ds_read_b128 v[48:51], v15 offset:0
ds_read_b128 v[52:55], v15 offset:16
ds_read_b128 v[56:59], v15 offset:32
ds_read_b128 v[60:63], v15 offset:48
ds_read_b128 v[64:67], v15 offset:256
ds_read_b128 v[68:71], v15 offset:272
ds_read_b128 v[72:75], v15 offset:288
ds_read_b128 v[76:79], v15 offset:304
s_waitcnt lgkmcnt(4)
v_fma_f32 v160, -v48, v12, v160
v_mul_f32 v160, v160, v49
v_mul_f32 v164, v164, v49
v_cndmask_b32 v164, v164, v160, s[50:51]
v_cndmask_b32 v160, v160, v50, s[50:51]
v_cvt_pk_bf16_f32 v80, v160, v164
v_fma_f32 v161, -v52, v12, v161
v_mul_f32 v161, v161, v53
v_mul_f32 v165, v165, v53
v_cndmask_b32 v165, v165, v161, s[50:51]
v_cndmask_b32 v161, v161, v54, s[50:51]
v_cvt_pk_bf16_f32 v81, v161, v165
v_fma_f32 v162, -v56, v12, v162
v_mul_f32 v162, v162, v57
v_mul_f32 v166, v166, v57
v_cndmask_b32 v166, v166, v162, s[50:51]
v_cndmask_b32 v162, v162, v58, s[50:51]
v_cvt_pk_bf16_f32 v82, v162, v166
v_fma_f32 v163, -v60, v12, v163
v_mul_f32 v163, v163, v61
v_mul_f32 v167, v167, v61
v_cndmask_b32 v167, v167, v163, s[50:51]
v_cndmask_b32 v163, v163, v62, s[50:51]
v_cvt_pk_bf16_f32 v83, v163, v167
s_waitcnt lgkmcnt(0)
v_fma_f32 v168, -v64, v12, v168
v_mul_f32 v168, v168, v65
v_mul_f32 v172, v172, v65
v_cndmask_b32 v172, v172, v168, s[50:51]
v_cndmask_b32 v168, v168, v66, s[50:51]
v_cvt_pk_bf16_f32 v84, v168, v172
v_fma_f32 v169, -v68, v12, v169
v_mul_f32 v169, v169, v69
v_mul_f32 v173, v173, v69
v_cndmask_b32 v173, v173, v169, s[50:51]
v_cndmask_b32 v169, v169, v70, s[50:51]
v_cvt_pk_bf16_f32 v85, v169, v173
v_fma_f32 v170, -v72, v12, v170
v_mul_f32 v170, v170, v73
v_mul_f32 v174, v174, v73
v_cndmask_b32 v174, v174, v170, s[50:51]
v_cndmask_b32 v170, v170, v74, s[50:51]
v_cvt_pk_bf16_f32 v86, v170, v174
v_fma_f32 v171, -v76, v12, v171
v_mul_f32 v171, v171, v77
v_mul_f32 v175, v175, v77
v_cndmask_b32 v175, v175, v171, s[50:51]
v_cndmask_b32 v171, v171, v78, s[50:51]
v_cvt_pk_bf16_f32 v87, v171, v175
v_mfma_f32_16x16x32_bf16 v[88:91], v[16:19], v[80:83], 0
v_mfma_f32_16x16x32_bf16 v[92:95], v[20:23], v[80:83], 0
v_mfma_f32_16x16x32_bf16 v[96:99], v[32:35], v[80:83], 0
v_mfma_f32_16x16x32_bf16 v[100:103], v[36:39], v[80:83], 0
v_mfma_f32_16x16x32_bf16 v[88:91], v[24:27], v[84:87], v[88:91]
v_mfma_f32_16x16x32_bf16 v[92:95], v[28:31], v[84:87], v[92:95]
v_mfma_f32_16x16x32_bf16 v[96:99], v[40:43], v[84:87], v[96:99]
v_mfma_f32_16x16x32_bf16 v[100:103], v[44:47], v[84:87], v[100:103]
s_lshl_b32 s33, s23, 1
s_add_u32 s33, s33, 0
s_mul_i32 s37, s33, 36864
s_lshl_b32 s38, s31, 7
s_add_u32 s37, s37, s38
s_add_u32 s37, s37, 0
v_cvt_pk_bf16_f32 v104, v88, v92
v_cvt_pk_bf16_f32 v105, v89, v93
v_cvt_pk_bf16_f32 v106, v90, v94
v_cvt_pk_bf16_f32 v107, v91, v95
buffer_store_dwordx4 v[104:107], v10, s[8:11], s37 offen offset:0 sc1
v_cvt_pk_bf16_f32 v108, v96, v100
v_cvt_pk_bf16_f32 v109, v97, v101
v_cvt_pk_bf16_f32 v110, v98, v102
v_cvt_pk_bf16_f32 v111, v99, v103
buffer_store_dwordx4 v[108:111], v10, s[8:11], s37 offen offset:64 sc1
ds_read_b128 v[16:19], v14 offset:8192
ds_read_b128 v[20:23], v14 offset:9216
ds_read_b128 v[24:27], v14 offset:10240
ds_read_b128 v[28:31], v14 offset:11264
ds_read_b128 v[32:35], v14 offset:12288
ds_read_b128 v[36:39], v14 offset:13312
ds_read_b128 v[40:43], v14 offset:14336
ds_read_b128 v[44:47], v14 offset:15360
ds_read_b128 v[48:51], v15 offset:512
ds_read_b128 v[52:55], v15 offset:528
ds_read_b128 v[56:59], v15 offset:544
ds_read_b128 v[60:63], v15 offset:560
ds_read_b128 v[64:67], v15 offset:768
ds_read_b128 v[68:71], v15 offset:784
ds_read_b128 v[72:75], v15 offset:800
ds_read_b128 v[76:79], v15 offset:816
s_waitcnt lgkmcnt(4)
v_fma_f32 v176, -v48, v12, v176
v_mul_f32 v176, v176, v49
v_mul_f32 v180, v180, v49
v_cndmask_b32 v180, v180, v176, s[50:51]
v_cndmask_b32 v176, v176, v50, s[50:51]
v_cvt_pk_bf16_f32 v80, v176, v180
v_fma_f32 v177, -v52, v12, v177
v_mul_f32 v177, v177, v53
v_mul_f32 v181, v181, v53
v_cndmask_b32 v181, v181, v177, s[50:51]
v_cndmask_b32 v177, v177, v54, s[50:51]
v_cvt_pk_bf16_f32 v81, v177, v181
v_fma_f32 v178, -v56, v12, v178
v_mul_f32 v178, v178, v57
v_mul_f32 v182, v182, v57
v_cndmask_b32 v182, v182, v178, s[50:51]
v_cndmask_b32 v178, v178, v58, s[50:51]
v_cvt_pk_bf16_f32 v82, v178, v182
v_fma_f32 v179, -v60, v12, v179
v_mul_f32 v179, v179, v61
v_mul_f32 v183, v183, v61
v_cndmask_b32 v183, v183, v179, s[50:51]
v_cndmask_b32 v179, v179, v62, s[50:51]
v_cvt_pk_bf16_f32 v83, v179, v183
s_waitcnt lgkmcnt(0)
v_fma_f32 v184, -v64, v12, v184
v_mul_f32 v184, v184, v65
v_mul_f32 v188, v188, v65
v_cndmask_b32 v188, v188, v184, s[50:51]
v_cndmask_b32 v184, v184, v66, s[50:51]
v_cvt_pk_bf16_f32 v84, v184, v188
v_fma_f32 v185, -v68, v12, v185
v_mul_f32 v185, v185, v69
v_mul_f32 v189, v189, v69
v_cndmask_b32 v189, v189, v185, s[50:51]
v_cndmask_b32 v185, v185, v70, s[50:51]
v_cvt_pk_bf16_f32 v85, v185, v189
v_fma_f32 v186, -v72, v12, v186
v_mul_f32 v186, v186, v73
v_mul_f32 v190, v190, v73
v_cndmask_b32 v190, v190, v186, s[50:51]
v_cndmask_b32 v186, v186, v74, s[50:51]
v_cvt_pk_bf16_f32 v86, v186, v190
v_fma_f32 v187, -v76, v12, v187
v_mul_f32 v187, v187, v77
v_mul_f32 v191, v191, v77
v_cndmask_b32 v191, v191, v187, s[50:51]
v_cndmask_b32 v187, v187, v78, s[50:51]
v_cvt_pk_bf16_f32 v87, v187, v191
v_mfma_f32_16x16x32_bf16 v[88:91], v[16:19], v[80:83], 0
v_mfma_f32_16x16x32_bf16 v[92:95], v[20:23], v[80:83], 0
v_mfma_f32_16x16x32_bf16 v[96:99], v[32:35], v[80:83], 0
v_mfma_f32_16x16x32_bf16 v[100:103], v[36:39], v[80:83], 0
v_mfma_f32_16x16x32_bf16 v[88:91], v[24:27], v[84:87], v[88:91]
v_mfma_f32_16x16x32_bf16 v[92:95], v[28:31], v[84:87], v[92:95]
v_mfma_f32_16x16x32_bf16 v[96:99], v[40:43], v[84:87], v[96:99]
v_mfma_f32_16x16x32_bf16 v[100:103], v[44:47], v[84:87], v[100:103]
s_lshl_b32 s33, s23, 1
s_add_u32 s33, s33, 1
s_mul_i32 s37, s33, 36864
s_lshl_b32 s38, s31, 7
s_add_u32 s37, s37, s38
s_add_u32 s37, s37, 0
v_cvt_pk_bf16_f32 v112, v88, v92
v_cvt_pk_bf16_f32 v113, v89, v93
v_cvt_pk_bf16_f32 v114, v90, v94
v_cvt_pk_bf16_f32 v115, v91, v95
buffer_store_dwordx4 v[112:115], v10, s[8:11], s37 offen offset:0 sc1
v_cvt_pk_bf16_f32 v116, v96, v100
v_cvt_pk_bf16_f32 v117, v97, v101
v_cvt_pk_bf16_f32 v118, v98, v102
v_cvt_pk_bf16_f32 v119, v99, v103
buffer_store_dwordx4 v[116:119], v10, s[8:11], s37 offen offset:64 sc1
s_branch k1_kernel_end
k1_kernel_helper:
v_mov_b32 v13, 0xc4100000
v_add_u32 v14, 73728, v5
v_lshrrev_b32 v10, 3, v1
v_and_b32 v11, 7, v1
v_xor_b32 v11, v11, v10
v_lshlrev_b32 v11, 4, v11
v_mul_u32_u24 v10, 73728, v10
v_add_u32 v10, v10, v11
s_mul_i32 s27, s23, 2304
s_lshl_b32 s33, s23, 1
s_add_u32 s33, s33, 0
v_cvt_f32_u32 v228, v3
v_cvt_f32_u32 v229, v4
v_cvt_f32_u32 v230, s33
v_fmamk_f32 v229, v229, 0x43800000, v230
v_mov_b32 v231, v228
v_mul_f32 v231, 0x3a000000, v231
v_mul_f32 v232, v231, v229
v_mov_b32 v234, v232
v_fmamk_f32 v235, v231, 0x42800000, v232
v_fmamk_f32 v236, v231, 0x43000000, v232
v_fmamk_f32 v237, v231, 0x43400000, v232
v_cos_f32 v238, v234
v_sin_f32 v239, v234
v_cos_f32 v240, v235
v_sin_f32 v241, v235
v_cos_f32 v242, v236
v_sin_f32 v243, v236
v_cos_f32 v244, v237
v_sin_f32 v245, v237
v_cvt_pk_bf16_f32 v16, v238, v239
v_cvt_pk_bf16_f32 v20, -v239, v238
v_cvt_pk_bf16_f32 v17, v240, v241
v_cvt_pk_bf16_f32 v21, -v241, v240
v_cvt_pk_bf16_f32 v18, v242, v243
v_cvt_pk_bf16_f32 v22, -v243, v242
v_cvt_pk_bf16_f32 v19, v244, v245
v_cvt_pk_bf16_f32 v23, -v245, v244
ds_write_b128 v14, v[16:19] offset:0
ds_write_b128 v14, v[20:23] offset:1024
v_fmamk_f32 v234, v231, 0x44800000, v232
v_fmamk_f32 v235, v231, 0x44880000, v232
v_fmamk_f32 v236, v231, 0x44900000, v232
v_fmamk_f32 v237, v231, 0x44980000, v232
v_cos_f32 v238, v234
v_sin_f32 v239, v234
v_cos_f32 v240, v235
v_sin_f32 v241, v235
v_cos_f32 v242, v236
v_sin_f32 v243, v236
v_cos_f32 v244, v237
v_sin_f32 v245, v237
v_cvt_pk_bf16_f32 v24, v238, v239
v_cvt_pk_bf16_f32 v28, -v239, v238
v_cvt_pk_bf16_f32 v25, v240, v241
v_cvt_pk_bf16_f32 v29, -v241, v240
v_cvt_pk_bf16_f32 v26, v242, v243
v_cvt_pk_bf16_f32 v30, -v243, v242
v_cvt_pk_bf16_f32 v27, v244, v245
v_cvt_pk_bf16_f32 v31, -v245, v244
ds_write_b128 v14, v[24:27] offset:2048
ds_write_b128 v14, v[28:31] offset:3072
v_add_f32 v231, 0x41800000, v228
v_mul_f32 v231, 0x3a000000, v231
v_mul_f32 v232, v231, v229
v_mov_b32 v234, v232
v_fmamk_f32 v235, v231, 0x42800000, v232
v_fmamk_f32 v236, v231, 0x43000000, v232
v_fmamk_f32 v237, v231, 0x43400000, v232
v_cos_f32 v238, v234
v_sin_f32 v239, v234
v_cos_f32 v240, v235
v_sin_f32 v241, v235
v_cos_f32 v242, v236
v_sin_f32 v243, v236
v_cos_f32 v244, v237
v_sin_f32 v245, v237
v_cvt_pk_bf16_f32 v16, v238, v239
v_cvt_pk_bf16_f32 v20, -v239, v238
v_cvt_pk_bf16_f32 v17, v240, v241
v_cvt_pk_bf16_f32 v21, -v241, v240
v_cvt_pk_bf16_f32 v18, v242, v243
v_cvt_pk_bf16_f32 v22, -v243, v242
v_cvt_pk_bf16_f32 v19, v244, v245
v_cvt_pk_bf16_f32 v23, -v245, v244
ds_write_b128 v14, v[16:19] offset:4096
ds_write_b128 v14, v[20:23] offset:5120
v_fmamk_f32 v234, v231, 0x44800000, v232
v_fmamk_f32 v235, v231, 0x44880000, v232
v_fmamk_f32 v236, v231, 0x44900000, v232
v_fmamk_f32 v237, v231, 0x44980000, v232
v_cos_f32 v238, v234
v_sin_f32 v239, v234
v_cos_f32 v240, v235
v_sin_f32 v241, v235
v_cos_f32 v242, v236
v_sin_f32 v243, v236
v_cos_f32 v244, v237
v_sin_f32 v245, v237
v_cvt_pk_bf16_f32 v24, v238, v239
v_cvt_pk_bf16_f32 v28, -v239, v238
v_cvt_pk_bf16_f32 v25, v240, v241
v_cvt_pk_bf16_f32 v29, -v241, v240
v_cvt_pk_bf16_f32 v26, v242, v243
v_cvt_pk_bf16_f32 v30, -v243, v242
v_cvt_pk_bf16_f32 v27, v244, v245
v_cvt_pk_bf16_f32 v31, -v245, v244
ds_write_b128 v14, v[24:27] offset:6144
ds_write_b128 v14, v[28:31] offset:7168
s_waitcnt lgkmcnt(0)
s_mov_b32 s12, s6
s_and_b32 s13, s7, 0xffff
s_mov_b32 s14, 2359296
s_mov_b32 s15, 0x20000
s_mov_b32 s8, s4
s_and_b32 s9, s5, 0xffff
s_mov_b32 s10, 39878656
s_mov_b32 s11, 0x20000
s_add_u32 s30, s27, 384
s_mov_b32 m0, 24576
s_nop 0
buffer_load_dwordx4 v10, s[12:15], s30 offen lds
s_add_u32 s30, s27, 590208
s_mov_b32 m0, 25600
s_nop 0
buffer_load_dwordx4 v10, s[12:15], s30 offen lds
s_add_u32 s30, s27, 1180032
s_mov_b32 m0, 26624
s_nop 0
buffer_load_dwordx4 v10, s[12:15], s30 offen lds
s_add_u32 s30, s27, 1769856
s_mov_b32 m0, 27648
s_nop 0
buffer_load_dwordx4 v10, s[12:15], s30 offen lds
s_add_u32 s30, s27, 1536
s_mov_b32 m0, 28672
s_nop 0
buffer_load_dwordx4 v10, s[12:15], s30 offen lds
s_add_u32 s30, s27, 591360
s_mov_b32 m0, 29696
s_nop 0
buffer_load_dwordx4 v10, s[12:15], s30 offen lds
s_add_u32 s30, s27, 1181184
s_mov_b32 m0, 30720
s_nop 0
buffer_load_dwordx4 v10, s[12:15], s30 offen lds
s_add_u32 s30, s27, 1771008
s_mov_b32 m0, 31744
s_nop 0
buffer_load_dwordx4 v10, s[12:15], s30 offen lds
s_add_u32 s30, s27, 512
s_mov_b32 m0, 32768
s_nop 0
buffer_load_dwordx4 v10, s[12:15], s30 offen lds
s_add_u32 s30, s27, 590336
s_mov_b32 m0, 33792
s_nop 0
buffer_load_dwordx4 v10, s[12:15], s30 offen lds
s_add_u32 s30, s27, 1180160
s_mov_b32 m0, 34816
s_nop 0
buffer_load_dwordx4 v10, s[12:15], s30 offen lds
s_add_u32 s30, s27, 1769984
s_mov_b32 m0, 35840
s_nop 0
buffer_load_dwordx4 v10, s[12:15], s30 offen lds
s_add_u32 s30, s27, 1664
s_mov_b32 m0, 36864
s_nop 0
buffer_load_dwordx4 v10, s[12:15], s30 offen lds
s_add_u32 s30, s27, 591488
s_mov_b32 m0, 37888
s_nop 0
buffer_load_dwordx4 v10, s[12:15], s30 offen lds
s_add_u32 s30, s27, 1181312
s_mov_b32 m0, 38912
s_nop 0
buffer_load_dwordx4 v10, s[12:15], s30 offen lds
s_add_u32 s30, s27, 1771136
s_mov_b32 m0, 39936
s_nop 0
buffer_load_dwordx4 v10, s[12:15], s30 offen lds
s_add_u32 s30, s27, 640
s_mov_b32 m0, 40960
s_nop 0
buffer_load_dwordx4 v10, s[12:15], s30 offen lds
s_add_u32 s30, s27, 590464
s_mov_b32 m0, 41984
s_nop 0
buffer_load_dwordx4 v10, s[12:15], s30 offen lds
s_add_u32 s30, s27, 1180288
s_mov_b32 m0, 43008
s_nop 0
buffer_load_dwordx4 v10, s[12:15], s30 offen lds
s_add_u32 s30, s27, 1770112
s_mov_b32 m0, 44032
s_nop 0
buffer_load_dwordx4 v10, s[12:15], s30 offen lds
s_add_u32 s30, s27, 1792
s_mov_b32 m0, 45056
s_nop 0
buffer_load_dwordx4 v10, s[12:15], s30 offen lds
s_add_u32 s30, s27, 591616
s_mov_b32 m0, 46080
s_nop 0
buffer_load_dwordx4 v10, s[12:15], s30 offen lds
s_add_u32 s30, s27, 1181440
s_mov_b32 m0, 47104
s_nop 0
buffer_load_dwordx4 v10, s[12:15], s30 offen lds
s_add_u32 s30, s27, 1771264
s_mov_b32 m0, 48128
s_nop 0
buffer_load_dwordx4 v10, s[12:15], s30 offen lds
s_add_u32 s30, s27, 768
s_mov_b32 m0, 49152
s_nop 0
buffer_load_dwordx4 v10, s[12:15], s30 offen lds
s_add_u32 s30, s27, 590592
s_mov_b32 m0, 50176
s_nop 0
buffer_load_dwordx4 v10, s[12:15], s30 offen lds
s_add_u32 s30, s27, 1180416
s_mov_b32 m0, 51200
s_nop 0
buffer_load_dwordx4 v10, s[12:15], s30 offen lds
s_add_u32 s30, s27, 1770240
s_mov_b32 m0, 52224
s_nop 0
buffer_load_dwordx4 v10, s[12:15], s30 offen lds
s_add_u32 s30, s27, 1920
s_mov_b32 m0, 53248
s_nop 0
buffer_load_dwordx4 v10, s[12:15], s30 offen lds
s_add_u32 s30, s27, 591744
s_mov_b32 m0, 54272
s_nop 0
buffer_load_dwordx4 v10, s[12:15], s30 offen lds
s_add_u32 s30, s27, 1181568
s_mov_b32 m0, 55296
s_nop 0
buffer_load_dwordx4 v10, s[12:15], s30 offen lds
s_add_u32 s30, s27, 1771392
s_mov_b32 m0, 56320
s_nop 0
buffer_load_dwordx4 v10, s[12:15], s30 offen lds
s_lshl_b32 s33, s23, 1
s_add_u32 s33, s33, 1
v_cvt_f32_u32 v228, v3
v_cvt_f32_u32 v229, v4
v_cvt_f32_u32 v230, s33
v_fmamk_f32 v229, v229, 0x43800000, v230
v_mov_b32 v231, v228
v_mul_f32 v231, 0x3a000000, v231
v_mul_f32 v232, v231, v229
v_mov_b32 v234, v232
v_fmamk_f32 v235, v231, 0x42800000, v232
v_fmamk_f32 v236, v231, 0x43000000, v232
v_fmamk_f32 v237, v231, 0x43400000, v232
v_cos_f32 v238, v234
v_sin_f32 v239, v234
v_cos_f32 v240, v235
v_sin_f32 v241, v235
v_cos_f32 v242, v236
v_sin_f32 v243, v236
v_cos_f32 v244, v237
v_sin_f32 v245, v237
v_cvt_pk_bf16_f32 v16, v238, v239
v_cvt_pk_bf16_f32 v20, -v239, v238
v_cvt_pk_bf16_f32 v17, v240, v241
v_cvt_pk_bf16_f32 v21, -v241, v240
v_cvt_pk_bf16_f32 v18, v242, v243
v_cvt_pk_bf16_f32 v22, -v243, v242
v_cvt_pk_bf16_f32 v19, v244, v245
v_cvt_pk_bf16_f32 v23, -v245, v244
ds_write_b128 v14, v[16:19] offset:8192
ds_write_b128 v14, v[20:23] offset:9216
v_fmamk_f32 v234, v231, 0x44800000, v232
v_fmamk_f32 v235, v231, 0x44880000, v232
v_fmamk_f32 v236, v231, 0x44900000, v232
v_fmamk_f32 v237, v231, 0x44980000, v232
v_cos_f32 v238, v234
v_sin_f32 v239, v234
v_cos_f32 v240, v235
v_sin_f32 v241, v235
v_cos_f32 v242, v236
v_sin_f32 v243, v236
v_cos_f32 v244, v237
v_sin_f32 v245, v237
v_cvt_pk_bf16_f32 v24, v238, v239
v_cvt_pk_bf16_f32 v28, -v239, v238
v_cvt_pk_bf16_f32 v25, v240, v241
v_cvt_pk_bf16_f32 v29, -v241, v240
v_cvt_pk_bf16_f32 v26, v242, v243
v_cvt_pk_bf16_f32 v30, -v243, v242
v_cvt_pk_bf16_f32 v27, v244, v245
v_cvt_pk_bf16_f32 v31, -v245, v244
ds_write_b128 v14, v[24:27] offset:10240
ds_write_b128 v14, v[28:31] offset:11264
v_add_f32 v231, 0x41800000, v228
v_mul_f32 v231, 0x3a000000, v231
v_mul_f32 v232, v231, v229
v_mov_b32 v234, v232
v_fmamk_f32 v235, v231, 0x42800000, v232
v_fmamk_f32 v236, v231, 0x43000000, v232
v_fmamk_f32 v237, v231, 0x43400000, v232
v_cos_f32 v238, v234
v_sin_f32 v239, v234
v_cos_f32 v240, v235
v_sin_f32 v241, v235
v_cos_f32 v242, v236
v_sin_f32 v243, v236
v_cos_f32 v244, v237
v_sin_f32 v245, v237
v_cvt_pk_bf16_f32 v16, v238, v239
v_cvt_pk_bf16_f32 v20, -v239, v238
v_cvt_pk_bf16_f32 v17, v240, v241
v_cvt_pk_bf16_f32 v21, -v241, v240
v_cvt_pk_bf16_f32 v18, v242, v243
v_cvt_pk_bf16_f32 v22, -v243, v242
v_cvt_pk_bf16_f32 v19, v244, v245
v_cvt_pk_bf16_f32 v23, -v245, v244
ds_write_b128 v14, v[16:19] offset:12288
ds_write_b128 v14, v[20:23] offset:13312
v_fmamk_f32 v234, v231, 0x44800000, v232
v_fmamk_f32 v235, v231, 0x44880000, v232
v_fmamk_f32 v236, v231, 0x44900000, v232
v_fmamk_f32 v237, v231, 0x44980000, v232
v_cos_f32 v238, v234
v_sin_f32 v239, v234
v_cos_f32 v240, v235
v_sin_f32 v241, v235
v_cos_f32 v242, v236
v_sin_f32 v243, v236
v_cos_f32 v244, v237
v_sin_f32 v245, v237
v_cvt_pk_bf16_f32 v24, v238, v239
v_cvt_pk_bf16_f32 v28, -v239, v238
v_cvt_pk_bf16_f32 v25, v240, v241
v_cvt_pk_bf16_f32 v29, -v241, v240
v_cvt_pk_bf16_f32 v26, v242, v243
v_cvt_pk_bf16_f32 v30, -v243, v242
v_cvt_pk_bf16_f32 v27, v244, v245
v_cvt_pk_bf16_f32 v31, -v245, v244
ds_write_b128 v14, v[24:27] offset:14336
ds_write_b128 v14, v[28:31] offset:15360
v_mov_b32 v32, 0x3f803f80
v_mov_b32 v33, 0x3f803f80
v_mov_b32 v34, 0x3f803f80
v_mov_b32 v35, 0x3f803f80
s_waitcnt lgkmcnt(0)
s_barrier
ds_read_b128 v[72:75], v6 offset:0
ds_read_b128 v[76:79], v6 offset:2048
ds_read_b128 v[80:83], v6 offset:4096
ds_read_b128 v[84:87], v6 offset:6144
ds_read_b128 v[88:91], v7 offset:0
ds_read_b128 v[92:95], v7 offset:2048
ds_read_b128 v[96:99], v7 offset:4096
ds_read_b128 v[100:103], v7 offset:6144
s_waitcnt lgkmcnt(4)
v_mfma_f32_16x16x32_bf16 v[40:43], v[72:75], v[32:35], 0
v_mfma_f32_16x16x32_bf16 v[56:59], v[72:75], v[72:75], 0
v_mfma_f32_16x16x32_bf16 v[44:47], v[76:79], v[32:35], 0
v_mfma_f32_16x16x32_bf16 v[60:63], v[76:79], v[76:79], 0
ds_read_b128 v[104:107], v6 offset:8192
ds_read_b128 v[108:111], v6 offset:10240
ds_read_b128 v[112:115], v6 offset:12288
ds_read_b128 v[116:119], v6 offset:14336
v_mfma_f32_16x16x32_bf16 v[48:51], v[80:83], v[32:35], 0
v_mfma_f32_16x16x32_bf16 v[64:67], v[80:83], v[80:83], 0
v_mfma_f32_16x16x32_bf16 v[52:55], v[84:87], v[32:35], 0
v_mfma_f32_16x16x32_bf16 v[68:71], v[84:87], v[84:87], 0
s_waitcnt lgkmcnt(4)
v_mfma_f32_16x16x32_bf16 v[40:43], v[88:91], v[32:35], v[40:43]
v_mfma_f32_16x16x32_bf16 v[56:59], v[88:91], v[88:91], v[56:59]
v_mfma_f32_16x16x32_bf16 v[44:47], v[92:95], v[32:35], v[44:47]
v_mfma_f32_16x16x32_bf16 v[60:63], v[92:95], v[92:95], v[60:63]
ds_read_b128 v[72:75], v7 offset:8192
ds_read_b128 v[76:79], v7 offset:10240
ds_read_b128 v[80:83], v7 offset:12288
ds_read_b128 v[84:87], v7 offset:14336
v_mfma_f32_16x16x32_bf16 v[48:51], v[96:99], v[32:35], v[48:51]
v_mfma_f32_16x16x32_bf16 v[64:67], v[96:99], v[96:99], v[64:67]
v_mfma_f32_16x16x32_bf16 v[52:55], v[100:103], v[32:35], v[52:55]
v_mfma_f32_16x16x32_bf16 v[68:71], v[100:103], v[100:103], v[68:71]
s_waitcnt lgkmcnt(4)
v_mfma_f32_16x16x32_bf16 v[40:43], v[104:107], v[32:35], v[40:43]
v_mfma_f32_16x16x32_bf16 v[56:59], v[104:107], v[104:107], v[56:59]
v_mfma_f32_16x16x32_bf16 v[44:47], v[108:111], v[32:35], v[44:47]
v_mfma_f32_16x16x32_bf16 v[60:63], v[108:111], v[108:111], v[60:63]
ds_read_b128 v[88:91], v6 offset:16384
ds_read_b128 v[92:95], v6 offset:18432
ds_read_b128 v[96:99], v6 offset:20480
ds_read_b128 v[100:103], v6 offset:22528
v_mfma_f32_16x16x32_bf16 v[48:51], v[112:115], v[32:35], v[48:51]
v_mfma_f32_16x16x32_bf16 v[64:67], v[112:115], v[112:115], v[64:67]
v_mfma_f32_16x16x32_bf16 v[52:55], v[116:119], v[32:35], v[52:55]
v_mfma_f32_16x16x32_bf16 v[68:71], v[116:119], v[116:119], v[68:71]
s_waitcnt lgkmcnt(4)
v_mfma_f32_16x16x32_bf16 v[40:43], v[72:75], v[32:35], v[40:43]
v_mfma_f32_16x16x32_bf16 v[56:59], v[72:75], v[72:75], v[56:59]
v_mfma_f32_16x16x32_bf16 v[44:47], v[76:79], v[32:35], v[44:47]
v_mfma_f32_16x16x32_bf16 v[60:63], v[76:79], v[76:79], v[60:63]
ds_read_b128 v[104:107], v7 offset:16384
ds_read_b128 v[108:111], v7 offset:18432
ds_read_b128 v[112:115], v7 offset:20480
ds_read_b128 v[116:119], v7 offset:22528
v_mfma_f32_16x16x32_bf16 v[48:51], v[80:83], v[32:35], v[48:51]
v_mfma_f32_16x16x32_bf16 v[64:67], v[80:83], v[80:83], v[64:67]
v_mfma_f32_16x16x32_bf16 v[52:55], v[84:87], v[32:35], v[52:55]
v_mfma_f32_16x16x32_bf16 v[68:71], v[84:87], v[84:87], v[68:71]
s_waitcnt lgkmcnt(4)
v_mfma_f32_16x16x32_bf16 v[40:43], v[88:91], v[32:35], v[40:43]
v_mfma_f32_16x16x32_bf16 v[56:59], v[88:91], v[88:91], v[56:59]
v_mfma_f32_16x16x32_bf16 v[44:47], v[92:95], v[32:35], v[44:47]
v_mfma_f32_16x16x32_bf16 v[60:63], v[92:95], v[92:95], v[60:63]
v_mfma_f32_16x16x32_bf16 v[48:51], v[96:99], v[32:35], v[48:51]
v_mfma_f32_16x16x32_bf16 v[64:67], v[96:99], v[96:99], v[64:67]
v_mfma_f32_16x16x32_bf16 v[52:55], v[100:103], v[32:35], v[52:55]
v_mfma_f32_16x16x32_bf16 v[68:71], v[100:103], v[100:103], v[68:71]
s_waitcnt lgkmcnt(0)
v_mfma_f32_16x16x32_bf16 v[40:43], v[104:107], v[32:35], v[40:43]
v_mfma_f32_16x16x32_bf16 v[56:59], v[104:107], v[104:107], v[56:59]
v_mfma_f32_16x16x32_bf16 v[44:47], v[108:111], v[32:35], v[44:47]
v_mfma_f32_16x16x32_bf16 v[60:63], v[108:111], v[108:111], v[60:63]
v_mfma_f32_16x16x32_bf16 v[48:51], v[112:115], v[32:35], v[48:51]
v_mfma_f32_16x16x32_bf16 v[64:67], v[112:115], v[112:115], v[64:67]
v_mfma_f32_16x16x32_bf16 v[52:55], v[116:119], v[32:35], v[52:55]
v_mfma_f32_16x16x32_bf16 v[68:71], v[116:119], v[116:119], v[68:71]
s_waitcnt vmcnt(8)
s_waitcnt lgkmcnt(0)
s_barrier
ds_read_b128 v[72:75], v6 offset:24576
ds_read_b128 v[76:79], v6 offset:26624
ds_read_b128 v[80:83], v6 offset:28672
ds_read_b128 v[84:87], v6 offset:30720
ds_read_b128 v[88:91], v7 offset:24576
ds_read_b128 v[92:95], v7 offset:26624
ds_read_b128 v[96:99], v7 offset:28672
ds_read_b128 v[100:103], v7 offset:30720
s_waitcnt lgkmcnt(4)
v_mfma_f32_16x16x32_bf16 v[40:43], v[72:75], v[32:35], v[40:43]
v_mfma_f32_16x16x32_bf16 v[56:59], v[72:75], v[72:75], v[56:59]
v_mfma_f32_16x16x32_bf16 v[44:47], v[76:79], v[32:35], v[44:47]
v_mfma_f32_16x16x32_bf16 v[60:63], v[76:79], v[76:79], v[60:63]
ds_read_b128 v[104:107], v6 offset:32768
ds_read_b128 v[108:111], v6 offset:34816
ds_read_b128 v[112:115], v6 offset:36864
ds_read_b128 v[116:119], v6 offset:38912
v_mfma_f32_16x16x32_bf16 v[48:51], v[80:83], v[32:35], v[48:51]
v_mfma_f32_16x16x32_bf16 v[64:67], v[80:83], v[80:83], v[64:67]
v_mfma_f32_16x16x32_bf16 v[52:55], v[84:87], v[32:35], v[52:55]
v_mfma_f32_16x16x32_bf16 v[68:71], v[84:87], v[84:87], v[68:71]
s_waitcnt lgkmcnt(4)
v_mfma_f32_16x16x32_bf16 v[40:43], v[88:91], v[32:35], v[40:43]
v_mfma_f32_16x16x32_bf16 v[56:59], v[88:91], v[88:91], v[56:59]
v_mfma_f32_16x16x32_bf16 v[44:47], v[92:95], v[32:35], v[44:47]
v_mfma_f32_16x16x32_bf16 v[60:63], v[92:95], v[92:95], v[60:63]
ds_read_b128 v[72:75], v7 offset:32768
ds_read_b128 v[76:79], v7 offset:34816
ds_read_b128 v[80:83], v7 offset:36864
ds_read_b128 v[84:87], v7 offset:38912
v_mfma_f32_16x16x32_bf16 v[48:51], v[96:99], v[32:35], v[48:51]
v_mfma_f32_16x16x32_bf16 v[64:67], v[96:99], v[96:99], v[64:67]
v_mfma_f32_16x16x32_bf16 v[52:55], v[100:103], v[32:35], v[52:55]
v_mfma_f32_16x16x32_bf16 v[68:71], v[100:103], v[100:103], v[68:71]
s_waitcnt lgkmcnt(4)
v_mfma_f32_16x16x32_bf16 v[40:43], v[104:107], v[32:35], v[40:43]
v_mfma_f32_16x16x32_bf16 v[56:59], v[104:107], v[104:107], v[56:59]
v_mfma_f32_16x16x32_bf16 v[44:47], v[108:111], v[32:35], v[44:47]
v_mfma_f32_16x16x32_bf16 v[60:63], v[108:111], v[108:111], v[60:63]
ds_read_b128 v[88:91], v8 offset:0
ds_read_b128 v[92:95], v8 offset:2048
ds_read_b128 v[96:99], v8 offset:4096
ds_read_b128 v[100:103], v8 offset:6144
v_mfma_f32_16x16x32_bf16 v[48:51], v[112:115], v[32:35], v[48:51]
v_mfma_f32_16x16x32_bf16 v[64:67], v[112:115], v[112:115], v[64:67]
v_mfma_f32_16x16x32_bf16 v[52:55], v[116:119], v[32:35], v[52:55]
v_mfma_f32_16x16x32_bf16 v[68:71], v[116:119], v[116:119], v[68:71]
s_waitcnt lgkmcnt(4)
v_mfma_f32_16x16x32_bf16 v[40:43], v[72:75], v[32:35], v[40:43]
v_mfma_f32_16x16x32_bf16 v[56:59], v[72:75], v[72:75], v[56:59]
v_mfma_f32_16x16x32_bf16 v[44:47], v[76:79], v[32:35], v[44:47]
v_mfma_f32_16x16x32_bf16 v[60:63], v[76:79], v[76:79], v[60:63]
ds_read_b128 v[104:107], v9 offset:0
ds_read_b128 v[108:111], v9 offset:2048
ds_read_b128 v[112:115], v9 offset:4096
ds_read_b128 v[116:119], v9 offset:6144
v_mfma_f32_16x16x32_bf16 v[48:51], v[80:83], v[32:35], v[48:51]
v_mfma_f32_16x16x32_bf16 v[64:67], v[80:83], v[80:83], v[64:67]
v_mfma_f32_16x16x32_bf16 v[52:55], v[84:87], v[32:35], v[52:55]
v_mfma_f32_16x16x32_bf16 v[68:71], v[84:87], v[84:87], v[68:71]
s_waitcnt lgkmcnt(4)
v_mfma_f32_16x16x32_bf16 v[40:43], v[88:91], v[32:35], v[40:43]
v_mfma_f32_16x16x32_bf16 v[56:59], v[88:91], v[88:91], v[56:59]
v_mfma_f32_16x16x32_bf16 v[44:47], v[92:95], v[32:35], v[44:47]
v_mfma_f32_16x16x32_bf16 v[60:63], v[92:95], v[92:95], v[60:63]
v_mfma_f32_16x16x32_bf16 v[48:51], v[96:99], v[32:35], v[48:51]
v_mfma_f32_16x16x32_bf16 v[64:67], v[96:99], v[96:99], v[64:67]
v_mfma_f32_16x16x32_bf16 v[52:55], v[100:103], v[32:35], v[52:55]
v_mfma_f32_16x16x32_bf16 v[68:71], v[100:103], v[100:103], v[68:71]
s_waitcnt lgkmcnt(0)
v_mfma_f32_16x16x32_bf16 v[40:43], v[104:107], v[32:35], v[40:43]
v_mfma_f32_16x16x32_bf16 v[56:59], v[104:107], v[104:107], v[56:59]
v_mfma_f32_16x16x32_bf16 v[44:47], v[108:111], v[32:35], v[44:47]
v_mfma_f32_16x16x32_bf16 v[60:63], v[108:111], v[108:111], v[60:63]
v_mfma_f32_16x16x32_bf16 v[48:51], v[112:115], v[32:35], v[48:51]
v_mfma_f32_16x16x32_bf16 v[64:67], v[112:115], v[112:115], v[64:67]
v_mfma_f32_16x16x32_bf16 v[52:55], v[116:119], v[32:35], v[52:55]
v_mfma_f32_16x16x32_bf16 v[68:71], v[116:119], v[116:119], v[68:71]
s_waitcnt vmcnt(0)
s_waitcnt lgkmcnt(0)
s_barrier
ds_read_b128 v[72:75], v8 offset:8192
ds_read_b128 v[76:79], v8 offset:10240
ds_read_b128 v[80:83], v8 offset:12288
ds_read_b128 v[84:87], v8 offset:14336
ds_read_b128 v[88:91], v9 offset:8192
ds_read_b128 v[92:95], v9 offset:10240
ds_read_b128 v[96:99], v9 offset:12288
ds_read_b128 v[100:103], v9 offset:14336
s_waitcnt lgkmcnt(4)
v_mfma_f32_16x16x32_bf16 v[40:43], v[72:75], v[32:35], v[40:43]
v_mfma_f32_16x16x32_bf16 v[56:59], v[72:75], v[72:75], v[56:59]
v_mfma_f32_16x16x32_bf16 v[44:47], v[76:79], v[32:35], v[44:47]
v_mfma_f32_16x16x32_bf16 v[60:63], v[76:79], v[76:79], v[60:63]
ds_read_b128 v[104:107], v8 offset:16384
ds_read_b128 v[108:111], v8 offset:18432
ds_read_b128 v[112:115], v8 offset:20480
ds_read_b128 v[116:119], v8 offset:22528
v_mfma_f32_16x16x32_bf16 v[48:51], v[80:83], v[32:35], v[48:51]
v_mfma_f32_16x16x32_bf16 v[64:67], v[80:83], v[80:83], v[64:67]
v_mfma_f32_16x16x32_bf16 v[52:55], v[84:87], v[32:35], v[52:55]
v_mfma_f32_16x16x32_bf16 v[68:71], v[84:87], v[84:87], v[68:71]
s_waitcnt lgkmcnt(4)
v_mfma_f32_16x16x32_bf16 v[40:43], v[88:91], v[32:35], v[40:43]
v_mfma_f32_16x16x32_bf16 v[56:59], v[88:91], v[88:91], v[56:59]
v_mfma_f32_16x16x32_bf16 v[44:47], v[92:95], v[32:35], v[44:47]
v_mfma_f32_16x16x32_bf16 v[60:63], v[92:95], v[92:95], v[60:63]
ds_read_b128 v[72:75], v9 offset:16384
ds_read_b128 v[76:79], v9 offset:18432
ds_read_b128 v[80:83], v9 offset:20480
ds_read_b128 v[84:87], v9 offset:22528
v_mfma_f32_16x16x32_bf16 v[48:51], v[96:99], v[32:35], v[48:51]
v_mfma_f32_16x16x32_bf16 v[64:67], v[96:99], v[96:99], v[64:67]
v_mfma_f32_16x16x32_bf16 v[52:55], v[100:103], v[32:35], v[52:55]
v_mfma_f32_16x16x32_bf16 v[68:71], v[100:103], v[100:103], v[68:71]
s_waitcnt lgkmcnt(4)
v_mfma_f32_16x16x32_bf16 v[40:43], v[104:107], v[32:35], v[40:43]
v_mfma_f32_16x16x32_bf16 v[56:59], v[104:107], v[104:107], v[56:59]
v_mfma_f32_16x16x32_bf16 v[44:47], v[108:111], v[32:35], v[44:47]
v_mfma_f32_16x16x32_bf16 v[60:63], v[108:111], v[108:111], v[60:63]
ds_read_b128 v[88:91], v8 offset:24576
ds_read_b128 v[92:95], v8 offset:26624
ds_read_b128 v[96:99], v8 offset:28672
ds_read_b128 v[100:103], v8 offset:30720
v_mfma_f32_16x16x32_bf16 v[48:51], v[112:115], v[32:35], v[48:51]
v_mfma_f32_16x16x32_bf16 v[64:67], v[112:115], v[112:115], v[64:67]
v_mfma_f32_16x16x32_bf16 v[52:55], v[116:119], v[32:35], v[52:55]
v_mfma_f32_16x16x32_bf16 v[68:71], v[116:119], v[116:119], v[68:71]
s_waitcnt lgkmcnt(4)
v_mfma_f32_16x16x32_bf16 v[40:43], v[72:75], v[32:35], v[40:43]
v_mfma_f32_16x16x32_bf16 v[56:59], v[72:75], v[72:75], v[56:59]
v_mfma_f32_16x16x32_bf16 v[44:47], v[76:79], v[32:35], v[44:47]
v_mfma_f32_16x16x32_bf16 v[60:63], v[76:79], v[76:79], v[60:63]
ds_read_b128 v[104:107], v9 offset:24576
ds_read_b128 v[108:111], v9 offset:26624
ds_read_b128 v[112:115], v9 offset:28672
ds_read_b128 v[116:119], v9 offset:30720
v_mfma_f32_16x16x32_bf16 v[48:51], v[80:83], v[32:35], v[48:51]
v_mfma_f32_16x16x32_bf16 v[64:67], v[80:83], v[80:83], v[64:67]
v_mfma_f32_16x16x32_bf16 v[52:55], v[84:87], v[32:35], v[52:55]
v_mfma_f32_16x16x32_bf16 v[68:71], v[84:87], v[84:87], v[68:71]
s_waitcnt lgkmcnt(4)
v_mfma_f32_16x16x32_bf16 v[40:43], v[88:91], v[32:35], v[40:43]
v_mfma_f32_16x16x32_bf16 v[56:59], v[88:91], v[88:91], v[56:59]
v_mfma_f32_16x16x32_bf16 v[44:47], v[92:95], v[32:35], v[44:47]
v_mfma_f32_16x16x32_bf16 v[60:63], v[92:95], v[92:95], v[60:63]
v_mfma_f32_16x16x32_bf16 v[48:51], v[96:99], v[32:35], v[48:51]
v_mfma_f32_16x16x32_bf16 v[64:67], v[96:99], v[96:99], v[64:67]
v_mfma_f32_16x16x32_bf16 v[52:55], v[100:103], v[32:35], v[52:55]
v_mfma_f32_16x16x32_bf16 v[68:71], v[100:103], v[100:103], v[68:71]
s_waitcnt lgkmcnt(0)
v_mfma_f32_16x16x32_bf16 v[40:43], v[104:107], v[32:35], v[40:43]
v_mfma_f32_16x16x32_bf16 v[56:59], v[104:107], v[104:107], v[56:59]
v_mfma_f32_16x16x32_bf16 v[44:47], v[108:111], v[32:35], v[44:47]
v_mfma_f32_16x16x32_bf16 v[60:63], v[108:111], v[108:111], v[60:63]
v_mfma_f32_16x16x32_bf16 v[48:51], v[112:115], v[32:35], v[48:51]
v_mfma_f32_16x16x32_bf16 v[64:67], v[112:115], v[112:115], v[64:67]
v_mfma_f32_16x16x32_bf16 v[52:55], v[116:119], v[32:35], v[52:55]
v_mfma_f32_16x16x32_bf16 v[68:71], v[116:119], v[116:119], v[68:71]
v_and_b32 v11, 3, v3
v_cmp_eq_u32 s[52:53], 1, v11
v_cmp_eq_u32 s[54:55], 2, v11
v_cmp_eq_u32 s[56:57], 3, v11
v_lshrrev_b32 v11, 2, v3
v_cmp_eq_u32 s[58:59], v11, v4
v_lshlrev_b32 v12, 4, v3
v_add_u32 v12, 90112, v12
v_mov_b32 v120, v40
v_mov_b32 v121, v56
v_cndmask_b32 v120, v120, v41, s[52:53]
v_cndmask_b32 v121, v121, v57, s[52:53]
v_cndmask_b32 v120, v120, v42, s[54:55]
v_cndmask_b32 v121, v121, v58, s[54:55]
v_cndmask_b32 v120, v120, v43, s[56:57]
v_cndmask_b32 v121, v121, v59, s[56:57]
v_mov_b32 v122, v120
v_mul_f32 v120, 0x3ae38e39, v120
v_mul_f32 v121, 0x3ae38e39, v121
v_fma_f32 v121, -v120, v120, v121
v_max_f32 v121, 0, v121
v_cvt_pk_bf16_f32 v123, v120, v121
v_lshlrev_b32 v124, 16, v123
v_and_b32 v125, 0xffff0000, v123
v_add_f32 v125, 0x3727c5ac, v125
v_cvt_pk_bf16_f32 v125, v125, v125
v_and_b32 v125, 0xffff0000, v125
v_sqrt_f32 v125, v125
s_nop 0
v_cvt_pk_bf16_f32 v125, v125, v125
v_and_b32 v125, 0xffff0000, v125
v_rcp_f32 v125, v125
v_fma_f32 v126, v124, v13, v122
v_mul_f32 v126, v126, v125
v_mov_b32 v132, v44
v_mov_b32 v133, v60
v_cndmask_b32 v132, v132, v45, s[52:53]
v_cndmask_b32 v133, v133, v61, s[52:53]
v_cndmask_b32 v132, v132, v46, s[54:55]
v_cndmask_b32 v133, v133, v62, s[54:55]
v_cndmask_b32 v132, v132, v47, s[56:57]
v_cndmask_b32 v133, v133, v63, s[56:57]
v_mov_b32 v134, v132
v_mul_f32 v132, 0x3ae38e39, v132
v_mul_f32 v133, 0x3ae38e39, v133
v_fma_f32 v133, -v132, v132, v133
v_max_f32 v133, 0, v133
v_cvt_pk_bf16_f32 v135, v132, v133
v_lshlrev_b32 v136, 16, v135
v_and_b32 v137, 0xffff0000, v135
v_add_f32 v137, 0x3727c5ac, v137
v_cvt_pk_bf16_f32 v137, v137, v137
v_and_b32 v137, 0xffff0000, v137
v_sqrt_f32 v137, v137
s_nop 0
v_cvt_pk_bf16_f32 v137, v137, v137
v_and_b32 v137, 0xffff0000, v137
v_rcp_f32 v137, v137
v_fma_f32 v138, v136, v13, v134
v_mul_f32 v138, v138, v137
v_mov_b32 v144, v48
v_mov_b32 v145, v64
v_cndmask_b32 v144, v144, v49, s[52:53]
v_cndmask_b32 v145, v145, v65, s[52:53]
v_cndmask_b32 v144, v144, v50, s[54:55]
v_cndmask_b32 v145, v145, v66, s[54:55]
v_cndmask_b32 v144, v144, v51, s[56:57]
v_cndmask_b32 v145, v145, v67, s[56:57]
v_mov_b32 v146, v144
v_mul_f32 v144, 0x3ae38e39, v144
v_mul_f32 v145, 0x3ae38e39, v145
v_fma_f32 v145, -v144, v144, v145
v_max_f32 v145, 0, v145
v_cvt_pk_bf16_f32 v147, v144, v145
v_lshlrev_b32 v148, 16, v147
v_and_b32 v149, 0xffff0000, v147
v_add_f32 v149, 0x3727c5ac, v149
v_cvt_pk_bf16_f32 v149, v149, v149
v_and_b32 v149, 0xffff0000, v149
v_sqrt_f32 v149, v149
s_nop 0
v_cvt_pk_bf16_f32 v149, v149, v149
v_and_b32 v149, 0xffff0000, v149
v_rcp_f32 v149, v149
v_fma_f32 v150, v148, v13, v146
v_mul_f32 v150, v150, v149
v_mov_b32 v156, v52
v_mov_b32 v157, v68
v_cndmask_b32 v156, v156, v53, s[52:53]
v_cndmask_b32 v157, v157, v69, s[52:53]
v_cndmask_b32 v156, v156, v54, s[54:55]
v_cndmask_b32 v157, v157, v70, s[54:55]
v_cndmask_b32 v156, v156, v55, s[56:57]
v_cndmask_b32 v157, v157, v71, s[56:57]
v_mov_b32 v158, v156
v_mul_f32 v156, 0x3ae38e39, v156
v_mul_f32 v157, 0x3ae38e39, v157
v_fma_f32 v157, -v156, v156, v157
v_max_f32 v157, 0, v157
v_cvt_pk_bf16_f32 v159, v156, v157
v_lshlrev_b32 v160, 16, v159
v_and_b32 v161, 0xffff0000, v159
v_add_f32 v161, 0x3727c5ac, v161
v_cvt_pk_bf16_f32 v161, v161, v161
v_and_b32 v161, 0xffff0000, v161
v_sqrt_f32 v161, v161
s_nop 0
v_cvt_pk_bf16_f32 v161, v161, v161
v_and_b32 v161, 0xffff0000, v161
v_rcp_f32 v161, v161
v_fma_f32 v162, v160, v13, v158
v_mul_f32 v162, v162, v161
s_mov_b64 s[60:61], exec
s_mov_b64 exec, s[58:59]
ds_write_b128 v12, v[124:127] offset:0
ds_write_b128 v12, v[136:139] offset:256
ds_write_b128 v12, v[148:151] offset:512
ds_write_b128 v12, v[160:163] offset:768
s_mov_b64 exec, s[60:61]
s_waitcnt lgkmcnt(0)
s_barrier
s_branch k1_kernel_end
k1_kernel_side:
s_getpc_b64 s[52:53]
k1_pf_pc2:
s_sub_u32 s52, s52, k1_pf_pc2-k1_kernel
s_subb_u32 s53, s53, 0
s_sub_u32 s54, s2, 192
s_lshr_b32 s54, s54, 3
s_mul_i32 s54, s54, 10240
s_add_u32 s54, s54, 16384
v_lshlrev_b32 v254, 6, v0
v_add_u32 v254, s54, v254
global_load_dword v255, v254, s[52:53]
s_load_dwordx2 s[48:49], s[0:1], 32
s_sub_u32 s23, s2, 192
s_mul_i32 s55, s23, 9
s_add_u32 s55, s55, s22
s_mul_i32 s54, s22, 27648
s_add_u32 s54, s54, 40960
s_waitcnt lgkmcnt(0)
s_mov_b32 s8, s4
s_and_b32 s9, s5, 0xffff
s_mov_b32 s10, 39878656
s_mov_b32 s11, 0x20000
s_mov_b32 s16, s20
s_and_b32 s17, s21, 0xffff
s_mov_b32 s18, 1183744
s_mov_b32 s19, 0x20000
s_mov_b32 s44, s42
s_and_b32 s45, s43, 0xffff
s_mov_b32 s46, 1183744
s_mov_b32 s47, 0x20000
s_mov_b32 s12, s48
s_and_b32 s13, s49, 0xffff
s_mov_b32 s14, 5308416
s_mov_b32 s15, 0x20000
s_mul_i32 s24, s23, 18496
s_lshl_b32 s25, s22, 10
s_add_u32 s25, s25, 0
s_add_u32 s26, s25, s24
s_add_u32 m0, s25, 0
s_nop 0
buffer_load_dwordx4 v5, s[16:19], s26 offen lds
s_lshl_b32 s25, s22, 10
s_add_u32 s25, s25, 4096
s_add_u32 s26, s25, s24
s_add_u32 m0, s25, 0
s_nop 0
buffer_load_dwordx4 v5, s[16:19], s26 offen lds
s_lshl_b32 s25, s22, 10
s_add_u32 s25, s25, 8192
s_add_u32 s26, s25, s24
s_add_u32 m0, s25, 0
s_nop 0
buffer_load_dwordx4 v5, s[16:19], s26 offen lds
s_lshl_b32 s25, s22, 10
s_add_u32 s25, s25, 12288
s_add_u32 s26, s25, s24
s_add_u32 m0, s25, 0
s_nop 0
buffer_load_dwordx4 v5, s[16:19], s26 offen lds
s_cmp_ge_u32 s22, 3
s_cbranch_scc1 k1_kernel_skip0
s_lshl_b32 s25, s22, 10
s_add_u32 s25, s25, 16384
s_add_u32 s26, s25, s24
s_add_u32 m0, s25, 0
s_nop 0
buffer_load_dwordx4 v5, s[16:19], s26 offen lds
k1_kernel_skip0:
s_lshl_b32 s25, s22, 10
s_add_u32 s25, s25, 0
s_add_u32 s26, s25, s24
s_add_u32 m0, s25, 19456
s_nop 0
buffer_load_dwordx4 v5, s[44:47], s26 offen lds
s_lshl_b32 s25, s22, 10
s_add_u32 s25, s25, 4096
s_add_u32 s26, s25, s24
s_add_u32 m0, s25, 19456
s_nop 0
buffer_load_dwordx4 v5, s[44:47], s26 offen lds
s_lshl_b32 s25, s22, 10
s_add_u32 s25, s25, 8192
s_add_u32 s26, s25, s24
s_add_u32 m0, s25, 19456
s_nop 0
buffer_load_dwordx4 v5, s[44:47], s26 offen lds
s_lshl_b32 s25, s22, 10
s_add_u32 s25, s25, 12288
s_add_u32 s26, s25, s24
s_add_u32 m0, s25, 19456
s_nop 0
buffer_load_dwordx4 v5, s[44:47], s26 offen lds
s_cmp_ge_u32 s22, 3
s_cbranch_scc1 k1_kernel_skip1
s_lshl_b32 s25, s22, 10
s_add_u32 s25, s25, 16384
s_add_u32 s26, s25, s24
s_add_u32 m0, s25, 19456
s_nop 0
buffer_load_dwordx4 v5, s[44:47], s26 offen lds
k1_kernel_skip1:
s_lshl_b32 s27, s23, 5
v_and_b32 v40, 31, v1
v_add_u32 v40, s27, v40
v_sub_u32 v41, 0, v40
v_and_b32 v41, 2047, v41
v_mul_u32_u24 v42, 578, v40
v_mul_u32_u24 v43, 578, v41
s_cmp_lg_u32 s22, 3
s_cbranch_scc1 k1_kernel_nopql
buffer_load_ushort v44, v42, s[16:19], 0 offen offset:0
buffer_load_ushort v45, v42, s[44:47], 0 offen offset:0
buffer_load_ushort v46, v42, s[16:19], 0 offen offset:576
buffer_load_ushort v47, v42, s[44:47], 0 offen offset:576
buffer_load_ushort v48, v43, s[16:19], 0 offen offset:0
buffer_load_ushort v49, v43, s[44:47], 0 offen offset:0
buffer_load_ushort v50, v43, s[16:19], 0 offen offset:576
buffer_load_ushort v51, v43, s[44:47], 0 offen offset:576
k1_kernel_nopql:
s_waitcnt vmcnt(0)
s_barrier
s_cmp_lg_u32 s22, 3
s_cbranch_scc1 k1_kernel_nopq
v_cmp_gt_u32 vcc, 32, v1
s_and_saveexec_b64 s[30:31], vcc
v_lshlrev_b32 v44, 16, v44
v_lshlrev_b32 v45, 16, v45
v_lshlrev_b32 v46, 16, v46
v_lshlrev_b32 v47, 16, v47
v_lshlrev_b32 v48, 16, v48
v_lshlrev_b32 v49, 16, v49
v_lshlrev_b32 v50, 16, v50
v_lshlrev_b32 v51, 16, v51
v_add_f32 v52, v44, v48
v_sub_f32 v53, v45, v49
v_add_f32 v54, v46, v50
v_sub_f32 v55, v47, v51
v_add_f32 v56, v52, v54
v_add_f32 v57, v53, v55
v_sub_f32 v58, v52, v54
v_sub_f32 v59, v53, v55
v_mul_f32 v56, 0x3e800000, v56
v_mul_f32 v57, 0x3e800000, v57
v_mul_f32 v58, 0x3e800000, v58
v_mul_f32 v59, 0x3e800000, v59
v_cvt_pk_bf16_f32 v60, v56, v57
v_cvt_pk_bf16_f32 v61, v58, v59
v_lshlrev_b32 v62, 2, v40
s_mov_b32 s28, 7340032
s_mov_b32 s29, 9699328
buffer_store_dword v60, v62, s[8:11], s28 offen sc1
buffer_store_dword v61, v62, s[8:11], s29 offen sc1
s_mov_b64 exec, s[30:31]
k1_kernel_nopq:
v_lshrrev_b32 v6, 3, v1
v_and_b32 v7, 7, v1
s_mul_i32 s27, s22, 72
v_add_u32 v8, s27, v6
v_mul_u32_u24 v9, 2312, v7
v_lshl_add_u32 v9, v8, 1, v9
v_lshlrev_b32 v10, 13, v6
v_lshl_add_u32 v10, v7, 4, v10
v_cmp_eq_u32 vcc, 0, v8
v_mov_b32 v11, 0x7fffff00
s_nop 0
v_cndmask_b32 v11, v10, v11, vcc
s_lshl_b32 s28, s23, 7
s_mul_i32 s29, s22, 589824
s_add_u32 s28, s28, s29
s_add_u32 s28, s28, 7340032
ds_read_u16 v172, v9 offset:0
ds_read_u16 v176, v9 offset:19456
ds_read_u16 v173, v9 offset:578
ds_read_u16 v177, v9 offset:20034
ds_read_u16 v174, v9 offset:1156
ds_read_u16 v178, v9 offset:20612
ds_read_u16 v175, v9 offset:1734
ds_read_u16 v179, v9 offset:21190
s_waitcnt lgkmcnt(0)
v_lshl_or_b32 v180, v176, 16, v172
v_lshl_or_b32 v181, v177, 16, v173
v_lshl_or_b32 v182, v178, 16, v174
v_lshl_or_b32 v183, v179, 16, v175
s_add_u32 s30, s28, 0
buffer_store_dwordx4 v[180:183], v11, s[8:11], s30 offen sc1
ds_read_u16 v184, v9 offset:16
ds_read_u16 v188, v9 offset:19472
ds_read_u16 v185, v9 offset:594
ds_read_u16 v189, v9 offset:20050
ds_read_u16 v186, v9 offset:1172
ds_read_u16 v190, v9 offset:20628
ds_read_u16 v187, v9 offset:1750
ds_read_u16 v191, v9 offset:21206
s_waitcnt lgkmcnt(0)
v_lshl_or_b32 v192, v188, 16, v184
v_lshl_or_b32 v193, v189, 16, v185
v_lshl_or_b32 v194, v190, 16, v186
v_lshl_or_b32 v195, v191, 16, v187
s_add_u32 s30, s28, 65536
buffer_store_dwordx4 v[192:195], v10, s[8:11], s30 offen sc1
ds_read_u16 v172, v9 offset:32
ds_read_u16 v176, v9 offset:19488
ds_read_u16 v173, v9 offset:610
ds_read_u16 v177, v9 offset:20066
ds_read_u16 v174, v9 offset:1188
ds_read_u16 v178, v9 offset:20644
ds_read_u16 v175, v9 offset:1766
ds_read_u16 v179, v9 offset:21222
s_waitcnt lgkmcnt(0)
v_lshl_or_b32 v180, v176, 16, v172
v_lshl_or_b32 v181, v177, 16, v173
v_lshl_or_b32 v182, v178, 16, v174
v_lshl_or_b32 v183, v179, 16, v175
s_add_u32 s30, s28, 131072
buffer_store_dwordx4 v[180:183], v10, s[8:11], s30 offen sc1
ds_read_u16 v184, v9 offset:48
ds_read_u16 v188, v9 offset:19504
ds_read_u16 v185, v9 offset:626
ds_read_u16 v189, v9 offset:20082
ds_read_u16 v186, v9 offset:1204
ds_read_u16 v190, v9 offset:20660
ds_read_u16 v187, v9 offset:1782
ds_read_u16 v191, v9 offset:21238
s_waitcnt lgkmcnt(0)
v_lshl_or_b32 v192, v188, 16, v184
v_lshl_or_b32 v193, v189, 16, v185
v_lshl_or_b32 v194, v190, 16, v186
v_lshl_or_b32 v195, v191, 16, v187
s_add_u32 s30, s28, 196608
buffer_store_dwordx4 v[192:195], v10, s[8:11], s30 offen sc1
ds_read_u16 v172, v9 offset:64
ds_read_u16 v176, v9 offset:19520
ds_read_u16 v173, v9 offset:642
ds_read_u16 v177, v9 offset:20098
ds_read_u16 v174, v9 offset:1220
ds_read_u16 v178, v9 offset:20676
ds_read_u16 v175, v9 offset:1798
ds_read_u16 v179, v9 offset:21254
s_waitcnt lgkmcnt(0)
v_lshl_or_b32 v180, v176, 16, v172
v_lshl_or_b32 v181, v177, 16, v173
v_lshl_or_b32 v182, v178, 16, v174
v_lshl_or_b32 v183, v179, 16, v175
s_add_u32 s30, s28, 262144
buffer_store_dwordx4 v[180:183], v10, s[8:11], s30 offen sc1
ds_read_u16 v184, v9 offset:80
ds_read_u16 v188, v9 offset:19536
ds_read_u16 v185, v9 offset:658
ds_read_u16 v189, v9 offset:20114
ds_read_u16 v186, v9 offset:1236
ds_read_u16 v190, v9 offset:20692
ds_read_u16 v187, v9 offset:1814
ds_read_u16 v191, v9 offset:21270
s_waitcnt lgkmcnt(0)
v_lshl_or_b32 v192, v188, 16, v184
v_lshl_or_b32 v193, v189, 16, v185
v_lshl_or_b32 v194, v190, 16, v186
v_lshl_or_b32 v195, v191, 16, v187
s_add_u32 s30, s28, 327680
buffer_store_dwordx4 v[192:195], v10, s[8:11], s30 offen sc1
ds_read_u16 v172, v9 offset:96
ds_read_u16 v176, v9 offset:19552
ds_read_u16 v173, v9 offset:674
ds_read_u16 v177, v9 offset:20130
ds_read_u16 v174, v9 offset:1252
ds_read_u16 v178, v9 offset:20708
ds_read_u16 v175, v9 offset:1830
ds_read_u16 v179, v9 offset:21286
s_waitcnt lgkmcnt(0)
v_lshl_or_b32 v180, v176, 16, v172
v_lshl_or_b32 v181, v177, 16, v173
v_lshl_or_b32 v182, v178, 16, v174
v_lshl_or_b32 v183, v179, 16, v175
s_add_u32 s30, s28, 393216
buffer_store_dwordx4 v[180:183], v10, s[8:11], s30 offen sc1
ds_read_u16 v184, v9 offset:112
ds_read_u16 v188, v9 offset:19568
ds_read_u16 v185, v9 offset:690
ds_read_u16 v189, v9 offset:20146
ds_read_u16 v186, v9 offset:1268
ds_read_u16 v190, v9 offset:20724
ds_read_u16 v187, v9 offset:1846
ds_read_u16 v191, v9 offset:21302
s_waitcnt lgkmcnt(0)
v_lshl_or_b32 v192, v188, 16, v184
v_lshl_or_b32 v193, v189, 16, v185
v_lshl_or_b32 v194, v190, 16, v186
v_lshl_or_b32 v195, v191, 16, v187
s_add_u32 s30, s28, 458752
buffer_store_dwordx4 v[192:195], v10, s[8:11], s30 offen sc1
ds_read_u16 v172, v9 offset:128
ds_read_u16 v176, v9 offset:19584
ds_read_u16 v173, v9 offset:706
ds_read_u16 v177, v9 offset:20162
ds_read_u16 v174, v9 offset:1284
ds_read_u16 v178, v9 offset:20740
ds_read_u16 v175, v9 offset:1862
ds_read_u16 v179, v9 offset:21318
s_waitcnt lgkmcnt(0)
v_lshl_or_b32 v180, v176, 16, v172
v_lshl_or_b32 v181, v177, 16, v173
v_lshl_or_b32 v182, v178, 16, v174
v_lshl_or_b32 v183, v179, 16, v175
s_add_u32 s30, s28, 524288
buffer_store_dwordx4 v[180:183], v10, s[8:11], s30 offen sc1
s_cmp_lg_u32 s22, 0
s_cbranch_scc1 g_4
s_load_dwordx2 s[98:99], s[0:1], 72
s_waitcnt lgkmcnt(0)
s_mov_b32 s88, s98
s_and_b32 s89, s99, 0xffff
s_mov_b32 s90, 256
s_mov_b32 s91, 0x20000
v_mov_b32 v14, 0
s_mov_b32 s97, 0
gete_5:
buffer_load_dword v15, v14, s[88:91], 0 offen sc1
s_waitcnt vmcnt(0)
v_readfirstlane_b32 s96, v15
s_add_u32 s97, s97, 1
s_cmp_gt_u32 s97, 200000
s_cbranch_scc1 gete_5_d
s_cmp_eq_u32 s96, 0
s_cbranch_scc1 gete_5
gete_5_d:
v_mov_b32 v14, 153600
ds_write_b32 v14, v15
s_waitcnt lgkmcnt(0)
g_4:
s_lshl_b32 s52, s23, 2
s_add_u32 s52, s52, 39846912
s_waitcnt vmcnt(0) lgkmcnt(0)
s_barrier
s_cmp_lg_u32 s22, 0
s_cbranch_scc1 sig_6
v_mov_b32 v14, s96
v_mov_b32 v15, 0
s_mov_b64 exec, 1
buffer_store_dword v14, v15, s[8:11], s52 offen sc1
s_mov_b64 exec, -1
sig_6:
v_mov_b32 v14, 153600
ds_read_b32 v14, v14
s_waitcnt lgkmcnt(0)
v_readfirstlane_b32 s96, v14
v_add_u32 v6, 0, v1
v_mul_u32_u24 v7, 3641, v6
v_lshrrev_b32 v7, 16, v7
v_mul_u32_u24 v8, 18, v7
v_sub_u32 v8, v6, v8
v_lshlrev_b32 v8, 4, v8
v_mul_u32_u24 v9, 9216, v7
v_add_u32 v16, v9, v8
v_add_u32 v6, 64, v1
v_mul_u32_u24 v7, 3641, v6
v_lshrrev_b32 v7, 16, v7
v_mul_u32_u24 v8, 18, v7
v_sub_u32 v8, v6, v8
v_lshlrev_b32 v8, 4, v8
v_mul_u32_u24 v9, 9216, v7
v_add_u32 v17, v9, v8
v_add_u32 v6, 128, v1
v_mul_u32_u24 v7, 3641, v6
v_lshrrev_b32 v7, 16, v7
v_mul_u32_u24 v8, 18, v7
v_sub_u32 v8, v6, v8
v_lshlrev_b32 v8, 4, v8
v_mul_u32_u24 v9, 9216, v7
v_add_u32 v18, v9, v8
v_add_u32 v6, 192, v1
v_mul_u32_u24 v7, 3641, v6
v_lshrrev_b32 v7, 16, v7
v_mul_u32_u24 v8, 18, v7
v_sub_u32 v8, v6, v8
v_lshlrev_b32 v8, 4, v8
v_mul_u32_u24 v9, 9216, v7
v_add_u32 v19, v9, v8
v_add_u32 v6, 256, v1
v_mul_u32_u24 v7, 3641, v6
v_lshrrev_b32 v7, 16, v7
v_mul_u32_u24 v8, 18, v7
v_sub_u32 v8, v6, v8
v_lshlrev_b32 v8, 4, v8
v_mul_u32_u24 v9, 9216, v7
v_add_u32 v20, v9, v8
v_add_u32 v6, 320, v1
v_mul_u32_u24 v7, 3641, v6
v_lshrrev_b32 v7, 16, v7
v_mul_u32_u24 v8, 18, v7
v_sub_u32 v8, v6, v8
v_lshlrev_b32 v8, 4, v8
v_mul_u32_u24 v9, 9216, v7
v_add_u32 v21, v9, v8
v_add_u32 v6, 384, v1
v_mul_u32_u24 v7, 3641, v6
v_lshrrev_b32 v7, 16, v7
v_mul_u32_u24 v8, 18, v7
v_sub_u32 v8, v6, v8
v_lshlrev_b32 v8, 4, v8
v_mul_u32_u24 v9, 9216, v7
v_add_u32 v22, v9, v8
v_add_u32 v6, 448, v1
v_mul_u32_u24 v7, 3641, v6
v_lshrrev_b32 v7, 16, v7
v_mul_u32_u24 v8, 18, v7
v_sub_u32 v8, v6, v8
v_lshlrev_b32 v8, 4, v8
v_mul_u32_u24 v9, 9216, v7
v_add_u32 v23, v9, v8
v_add_u32 v6, 512, v1
v_mul_u32_u24 v7, 3641, v6
v_lshrrev_b32 v7, 16, v7
v_mul_u32_u24 v8, 18, v7
v_sub_u32 v8, v6, v8
v_lshlrev_b32 v8, 4, v8
v_mul_u32_u24 v9, 9216, v7
v_add_u32 v24, v9, v8
s_add_u32 s56, s55, 0
s_mul_hi_u32 s57, s56, 238609295
s_mul_i32 s58, s57, 18
s_sub_u32 s58, s56, s58
s_lshr_b32 s59, s57, 2
s_and_b32 s57, s57, 3
s_add_u32 s53, s54, 0
s_mul_i32 s28, s58, 294912
s_mul_i32 s29, s59, 1152
s_add_u32 s28, s28, s29
s_mul_i32 s29, s57, 288
s_add_u32 s28, s28, s29
s_add_u32 m0, s53, 0
s_nop 0
buffer_load_dwordx4 v16, s[12:15], s28 offen lds
s_add_u32 m0, s53, 1024
s_nop 0
buffer_load_dwordx4 v17, s[12:15], s28 offen lds
s_add_u32 m0, s53, 2048
s_nop 0
buffer_load_dwordx4 v18, s[12:15], s28 offen lds
s_add_u32 m0, s53, 3072
s_nop 0
buffer_load_dwordx4 v19, s[12:15], s28 offen lds
s_add_u32 m0, s53, 4096
s_nop 0
buffer_load_dwordx4 v20, s[12:15], s28 offen lds
s_add_u32 m0, s53, 5120
s_nop 0
buffer_load_dwordx4 v21, s[12:15], s28 offen lds
s_add_u32 m0, s53, 6144
s_nop 0
buffer_load_dwordx4 v22, s[12:15], s28 offen lds
s_add_u32 m0, s53, 7168
s_nop 0
buffer_load_dwordx4 v23, s[12:15], s28 offen lds
s_add_u32 m0, s53, 8192
s_nop 0
buffer_load_dwordx4 v24, s[12:15], s28 offen lds
s_add_u32 s56, s55, 4
s_mul_hi_u32 s57, s56, 238609295
s_mul_i32 s58, s57, 18
s_sub_u32 s58, s56, s58
s_lshr_b32 s59, s57, 2
s_and_b32 s57, s57, 3
s_add_u32 s53, s54, 9216
s_mul_i32 s28, s58, 294912
s_mul_i32 s29, s59, 1152
s_add_u32 s28, s28, s29
s_mul_i32 s29, s57, 288
s_add_u32 s28, s28, s29
s_add_u32 m0, s53, 0
s_nop 0
buffer_load_dwordx4 v16, s[12:15], s28 offen lds
s_add_u32 m0, s53, 1024
s_nop 0
buffer_load_dwordx4 v17, s[12:15], s28 offen lds
s_add_u32 m0, s53, 2048
s_nop 0
buffer_load_dwordx4 v18, s[12:15], s28 offen lds
s_add_u32 m0, s53, 3072
s_nop 0
buffer_load_dwordx4 v19, s[12:15], s28 offen lds
s_add_u32 m0, s53, 4096
s_nop 0
buffer_load_dwordx4 v20, s[12:15], s28 offen lds
s_add_u32 m0, s53, 5120
s_nop 0
buffer_load_dwordx4 v21, s[12:15], s28 offen lds
s_add_u32 m0, s53, 6144
s_nop 0
buffer_load_dwordx4 v22, s[12:15], s28 offen lds
s_add_u32 m0, s53, 7168
s_nop 0
buffer_load_dwordx4 v23, s[12:15], s28 offen lds
s_add_u32 m0, s53, 8192
s_nop 0
buffer_load_dwordx4 v24, s[12:15], s28 offen lds
s_cmp_lg_u32 s22, 0
s_cbranch_scc1 u3_7
s_add_u32 s56, s55, 8
s_mul_hi_u32 s57, s56, 238609295
s_mul_i32 s58, s57, 18
s_sub_u32 s58, s56, s58
s_lshr_b32 s59, s57, 2
s_and_b32 s57, s57, 3
s_add_u32 s53, s54, 18432
s_mul_i32 s28, s58, 294912
s_mul_i32 s29, s59, 1152
s_add_u32 s28, s28, s29
s_mul_i32 s29, s57, 288
s_add_u32 s28, s28, s29
s_add_u32 m0, s53, 0
s_nop 0
buffer_load_dwordx4 v16, s[12:15], s28 offen lds
s_add_u32 m0, s53, 1024
s_nop 0
buffer_load_dwordx4 v17, s[12:15], s28 offen lds
s_add_u32 m0, s53, 2048
s_nop 0
buffer_load_dwordx4 v18, s[12:15], s28 offen lds
s_add_u32 m0, s53, 3072
s_nop 0
buffer_load_dwordx4 v19, s[12:15], s28 offen lds
s_add_u32 m0, s53, 4096
s_nop 0
buffer_load_dwordx4 v20, s[12:15], s28 offen lds
s_add_u32 m0, s53, 5120
s_nop 0
buffer_load_dwordx4 v21, s[12:15], s28 offen lds
s_add_u32 m0, s53, 6144
s_nop 0
buffer_load_dwordx4 v22, s[12:15], s28 offen lds
s_add_u32 m0, s53, 7168
s_nop 0
buffer_load_dwordx4 v23, s[12:15], s28 offen lds
s_add_u32 m0, s53, 8192
s_nop 0
buffer_load_dwordx4 v24, s[12:15], s28 offen lds
u3_7:
s_waitcnt vmcnt(0)
s_add_u32 s56, s55, 0
s_mul_hi_u32 s57, s56, 238609295
s_mul_i32 s58, s57, 18
s_sub_u32 s58, s56, s58
s_lshr_b32 s59, s57, 2
s_and_b32 s57, s57, 3
s_add_u32 s53, s54, 0
v_lshrrev_b32 v6, 4, v1
v_lshlrev_b32 v6, 3, v6
v_bfe_u32 v7, v1, 2, 2
v_add_u32 v6, v6, v7
v_mul_u32_u24 v6, 288, v6
v_and_b32 v7, 3, v1
v_lshl_add_u32 v6, v7, 3, v6
v_add_u32 v6, s53, v6
ds_read_b64_tr_b16 v[64:65], v6 offset:0
ds_read_b64_tr_b16 v[66:67], v6 offset:1152
ds_read_b64_tr_b16 v[68:69], v6 offset:32
ds_read_b64_tr_b16 v[70:71], v6 offset:1184
ds_read_b64_tr_b16 v[72:73], v6 offset:64
ds_read_b64_tr_b16 v[74:75], v6 offset:1216
ds_read_b64_tr_b16 v[76:77], v6 offset:96
ds_read_b64_tr_b16 v[78:79], v6 offset:1248
s_waitcnt lgkmcnt(4)
ds_read_b64_tr_b16 v[80:81], v6 offset:128
ds_read_b64_tr_b16 v[82:83], v6 offset:1280
ds_read_b64_tr_b16 v[84:85], v6 offset:160
ds_read_b64_tr_b16 v[86:87], v6 offset:1312
ds_read_b64_tr_b16 v[88:89], v6 offset:192
ds_read_b64_tr_b16 v[90:91], v6 offset:1344
ds_read_b64_tr_b16 v[92:93], v6 offset:224
ds_read_b64_tr_b16 v[94:95], v6 offset:1376
s_waitcnt lgkmcnt(4)
ds_read_b64_tr_b16 v[96:97], v6 offset:256
ds_read_b64_tr_b16 v[98:99], v6 offset:1408
s_add_u32 s56, s55, 4
s_mul_hi_u32 s57, s56, 238609295
s_mul_i32 s58, s57, 18
s_sub_u32 s58, s56, s58
s_lshr_b32 s59, s57, 2
s_and_b32 s57, s57, 3
s_add_u32 s53, s54, 9216
v_lshrrev_b32 v6, 4, v1
v_lshlrev_b32 v6, 3, v6
v_bfe_u32 v7, v1, 2, 2
v_add_u32 v6, v6, v7
v_mul_u32_u24 v6, 288, v6
v_and_b32 v7, 3, v1
v_lshl_add_u32 v6, v7, 3, v6
v_add_u32 v6, s53, v6
ds_read_b64_tr_b16 v[100:101], v6 offset:0
ds_read_b64_tr_b16 v[102:103], v6 offset:1152
ds_read_b64_tr_b16 v[104:105], v6 offset:32
ds_read_b64_tr_b16 v[106:107], v6 offset:1184
ds_read_b64_tr_b16 v[108:109], v6 offset:64
ds_read_b64_tr_b16 v[110:111], v6 offset:1216
ds_read_b64_tr_b16 v[112:113], v6 offset:96
ds_read_b64_tr_b16 v[114:115], v6 offset:1248
s_waitcnt lgkmcnt(4)
ds_read_b64_tr_b16 v[116:117], v6 offset:128
ds_read_b64_tr_b16 v[118:119], v6 offset:1280
ds_read_b64_tr_b16 v[120:121], v6 offset:160
ds_read_b64_tr_b16 v[122:123], v6 offset:1312
ds_read_b64_tr_b16 v[124:125], v6 offset:192
ds_read_b64_tr_b16 v[126:127], v6 offset:1344
ds_read_b64_tr_b16 v[128:129], v6 offset:224
ds_read_b64_tr_b16 v[130:131], v6 offset:1376
s_waitcnt lgkmcnt(4)
ds_read_b64_tr_b16 v[132:133], v6 offset:256
ds_read_b64_tr_b16 v[134:135], v6 offset:1408
s_cmp_lg_u32 s22, 0
s_cbranch_scc1 u3r_8
s_add_u32 s56, s55, 8
s_mul_hi_u32 s57, s56, 238609295
s_mul_i32 s58, s57, 18
s_sub_u32 s58, s56, s58
s_lshr_b32 s59, s57, 2
s_and_b32 s57, s57, 3
s_add_u32 s53, s54, 18432
v_lshrrev_b32 v6, 4, v1
v_lshlrev_b32 v6, 3, v6
v_bfe_u32 v7, v1, 2, 2
v_add_u32 v6, v6, v7
v_mul_u32_u24 v6, 288, v6
v_and_b32 v7, 3, v1
v_lshl_add_u32 v6, v7, 3, v6
v_add_u32 v6, s53, v6
ds_read_b64_tr_b16 v[136:137], v6 offset:0
ds_read_b64_tr_b16 v[138:139], v6 offset:1152
ds_read_b64_tr_b16 v[140:141], v6 offset:32
ds_read_b64_tr_b16 v[142:143], v6 offset:1184
ds_read_b64_tr_b16 v[144:145], v6 offset:64
ds_read_b64_tr_b16 v[146:147], v6 offset:1216
ds_read_b64_tr_b16 v[148:149], v6 offset:96
ds_read_b64_tr_b16 v[150:151], v6 offset:1248
s_waitcnt lgkmcnt(4)
ds_read_b64_tr_b16 v[152:153], v6 offset:128
ds_read_b64_tr_b16 v[154:155], v6 offset:1280
ds_read_b64_tr_b16 v[156:157], v6 offset:160
ds_read_b64_tr_b16 v[158:159], v6 offset:1312
ds_read_b64_tr_b16 v[160:161], v6 offset:192
ds_read_b64_tr_b16 v[162:163], v6 offset:1344
ds_read_b64_tr_b16 v[164:165], v6 offset:224
ds_read_b64_tr_b16 v[166:167], v6 offset:1376
s_waitcnt lgkmcnt(4)
ds_read_b64_tr_b16 v[168:169], v6 offset:256
ds_read_b64_tr_b16 v[170:171], v6 offset:1408
u3r_8:
s_waitcnt lgkmcnt(0)
s_barrier
s_add_u32 s56, s55, 0
s_mul_hi_u32 s57, s56, 238609295
s_mul_i32 s58, s57, 18
s_sub_u32 s58, s56, s58
s_lshr_b32 s59, s57, 2
s_and_b32 s57, s57, 3
s_lshl_b32 s33, s59, 2
s_add_u32 s33, s33, s57
s_mul_i32 s33, s33, 165888
s_lshl_b32 s34, s58, 10
s_add_u32 s34, s34, s33
s_add_u32 s34, s34, 9961472
s_add_u32 s36, s34, 0
buffer_store_dwordx4 v[64:67], v5, s[8:11], s36 offen sc1
s_add_u32 s36, s34, 18432
buffer_store_dwordx4 v[68:71], v5, s[8:11], s36 offen sc1
s_add_u32 s36, s34, 36864
buffer_store_dwordx4 v[72:75], v5, s[8:11], s36 offen sc1
s_add_u32 s36, s34, 55296
buffer_store_dwordx4 v[76:79], v5, s[8:11], s36 offen sc1
s_add_u32 s36, s34, 73728
buffer_store_dwordx4 v[80:83], v5, s[8:11], s36 offen sc1
s_add_u32 s36, s34, 92160
buffer_store_dwordx4 v[84:87], v5, s[8:11], s36 offen sc1
s_add_u32 s36, s34, 110592
buffer_store_dwordx4 v[88:91], v5, s[8:11], s36 offen sc1
s_add_u32 s36, s34, 129024
buffer_store_dwordx4 v[92:95], v5, s[8:11], s36 offen sc1
s_add_u32 s36, s34, 147456
buffer_store_dwordx4 v[96:99], v5, s[8:11], s36 offen sc1
s_add_u32 s56, s55, 4
s_mul_hi_u32 s57, s56, 238609295
s_mul_i32 s58, s57, 18
s_sub_u32 s58, s56, s58
s_lshr_b32 s59, s57, 2
s_and_b32 s57, s57, 3
s_lshl_b32 s33, s59, 2
s_add_u32 s33, s33, s57
s_mul_i32 s33, s33, 165888
s_lshl_b32 s34, s58, 10
s_add_u32 s34, s34, s33
s_add_u32 s34, s34, 9961472
s_add_u32 s36, s34, 0
buffer_store_dwordx4 v[100:103], v5, s[8:11], s36 offen sc1
s_add_u32 s36, s34, 18432
buffer_store_dwordx4 v[104:107], v5, s[8:11], s36 offen sc1
s_add_u32 s36, s34, 36864
buffer_store_dwordx4 v[108:111], v5, s[8:11], s36 offen sc1
s_add_u32 s36, s34, 55296
buffer_store_dwordx4 v[112:115], v5, s[8:11], s36 offen sc1
s_add_u32 s36, s34, 73728
buffer_store_dwordx4 v[116:119], v5, s[8:11], s36 offen sc1
s_add_u32 s36, s34, 92160
buffer_store_dwordx4 v[120:123], v5, s[8:11], s36 offen sc1
s_add_u32 s36, s34, 110592
buffer_store_dwordx4 v[124:127], v5, s[8:11], s36 offen sc1
s_add_u32 s36, s34, 129024
buffer_store_dwordx4 v[128:131], v5, s[8:11], s36 offen sc1
s_add_u32 s36, s34, 147456
buffer_store_dwordx4 v[132:135], v5, s[8:11], s36 offen sc1
s_cmp_lg_u32 s22, 0
s_cbranch_scc1 u3s_9
s_add_u32 s56, s55, 8
s_mul_hi_u32 s57, s56, 238609295
s_mul_i32 s58, s57, 18
s_sub_u32 s58, s56, s58
s_lshr_b32 s59, s57, 2
s_and_b32 s57, s57, 3
s_lshl_b32 s33, s59, 2
s_add_u32 s33, s33, s57
s_mul_i32 s33, s33, 165888
s_lshl_b32 s34, s58, 10
s_add_u32 s34, s34, s33
s_add_u32 s34, s34, 9961472
s_add_u32 s36, s34, 0
buffer_store_dwordx4 v[136:139], v5, s[8:11], s36 offen sc1
s_add_u32 s36, s34, 18432
buffer_store_dwordx4 v[140:143], v5, s[8:11], s36 offen sc1
s_add_u32 s36, s34, 36864
buffer_store_dwordx4 v[144:147], v5, s[8:11], s36 offen sc1
s_add_u32 s36, s34, 55296
buffer_store_dwordx4 v[148:151], v5, s[8:11], s36 offen sc1
s_add_u32 s36, s34, 73728
buffer_store_dwordx4 v[152:155], v5, s[8:11], s36 offen sc1
s_add_u32 s36, s34, 92160
buffer_store_dwordx4 v[156:159], v5, s[8:11], s36 offen sc1
s_add_u32 s36, s34, 110592
buffer_store_dwordx4 v[160:163], v5, s[8:11], s36 offen sc1
s_add_u32 s36, s34, 129024
buffer_store_dwordx4 v[164:167], v5, s[8:11], s36 offen sc1
s_add_u32 s36, s34, 147456
buffer_store_dwordx4 v[168:171], v5, s[8:11], s36 offen sc1
u3s_9:
s_lshl_b32 s52, s23, 2
s_add_u32 s52, s52, 39847936
s_waitcnt vmcnt(0) lgkmcnt(0)
s_barrier
s_cmp_lg_u32 s22, 0
s_cbranch_scc1 sig_10
v_mov_b32 v14, s96
v_mov_b32 v15, 0
s_mov_b64 exec, 1
buffer_store_dword v14, v15, s[8:11], s52 offen sc1
s_mov_b64 exec, -1
sig_10:
s_mul_i32 s55, s23, 6
s_add_u32 s55, s55, s22
s_load_dwordx2 s[40:41], s[0:1], 48
s_waitcnt lgkmcnt(0)
s_mov_b32 s36, s40
s_and_b32 s37, s41, 0xffff
s_mov_b32 s38, 5308416
s_mov_b32 s39, 0x20000
v_add_u32 v6, 0, v1
v_mul_u32_u24 v7, 3277, v6
v_lshrrev_b32 v7, 16, v7
v_mul_u32_u24 v8, 20, v7
v_sub_u32 v8, v6, v8
v_lshlrev_b32 v8, 4, v8
v_cmp_le_u32 vcc, 16, v7
v_mov_b32 v10, 128
s_nop 0
v_cndmask_b32 v10, 0, v10, vcc
v_add_u32 v10, v10, v7
v_mul_u32_u24 v10, 1152, v10
v_add_u32 v16, v10, v8
v_add_u32 v6, 64, v1
v_mul_u32_u24 v7, 3277, v6
v_lshrrev_b32 v7, 16, v7
v_mul_u32_u24 v8, 20, v7
v_sub_u32 v8, v6, v8
v_lshlrev_b32 v8, 4, v8
v_cmp_le_u32 vcc, 16, v7
v_mov_b32 v10, 128
s_nop 0
v_cndmask_b32 v10, 0, v10, vcc
v_add_u32 v10, v10, v7
v_mul_u32_u24 v10, 1152, v10
v_add_u32 v17, v10, v8
v_add_u32 v6, 128, v1
v_mul_u32_u24 v7, 3277, v6
v_lshrrev_b32 v7, 16, v7
v_mul_u32_u24 v8, 20, v7
v_sub_u32 v8, v6, v8
v_lshlrev_b32 v8, 4, v8
v_cmp_le_u32 vcc, 16, v7
v_mov_b32 v10, 128
s_nop 0
v_cndmask_b32 v10, 0, v10, vcc
v_add_u32 v10, v10, v7
v_mul_u32_u24 v10, 1152, v10
v_add_u32 v18, v10, v8
v_add_u32 v6, 192, v1
v_mul_u32_u24 v7, 3277, v6
v_lshrrev_b32 v7, 16, v7
v_mul_u32_u24 v8, 20, v7
v_sub_u32 v8, v6, v8
v_lshlrev_b32 v8, 4, v8
v_cmp_le_u32 vcc, 16, v7
v_mov_b32 v10, 128
s_nop 0
v_cndmask_b32 v10, 0, v10, vcc
v_add_u32 v10, v10, v7
v_mul_u32_u24 v10, 1152, v10
v_add_u32 v19, v10, v8
v_add_u32 v6, 256, v1
v_mul_u32_u24 v7, 3277, v6
v_lshrrev_b32 v7, 16, v7
v_mul_u32_u24 v8, 20, v7
v_sub_u32 v8, v6, v8
v_lshlrev_b32 v8, 4, v8
v_cmp_le_u32 vcc, 16, v7
v_mov_b32 v10, 128
s_nop 0
v_cndmask_b32 v10, 0, v10, vcc
v_add_u32 v10, v10, v7
v_mul_u32_u24 v10, 1152, v10
v_add_u32 v20, v10, v8
v_add_u32 v6, 320, v1
v_mul_u32_u24 v7, 3277, v6
v_lshrrev_b32 v7, 16, v7
v_mul_u32_u24 v8, 20, v7
v_sub_u32 v8, v6, v8
v_lshlrev_b32 v8, 4, v8
v_cmp_le_u32 vcc, 16, v7
v_mov_b32 v10, 128
s_nop 0
v_cndmask_b32 v10, 0, v10, vcc
v_add_u32 v10, v10, v7
v_mul_u32_u24 v10, 1152, v10
v_add_u32 v21, v10, v8
v_add_u32 v6, 384, v1
v_mul_u32_u24 v7, 3277, v6
v_lshrrev_b32 v7, 16, v7
v_mul_u32_u24 v8, 20, v7
v_sub_u32 v8, v6, v8
v_lshlrev_b32 v8, 4, v8
v_cmp_le_u32 vcc, 16, v7
v_mov_b32 v10, 128
s_nop 0
v_cndmask_b32 v10, 0, v10, vcc
v_add_u32 v10, v10, v7
v_mul_u32_u24 v10, 1152, v10
v_add_u32 v22, v10, v8
v_add_u32 v6, 448, v1
v_mul_u32_u24 v7, 3277, v6
v_lshrrev_b32 v7, 16, v7
v_mul_u32_u24 v8, 20, v7
v_sub_u32 v8, v6, v8
v_lshlrev_b32 v8, 4, v8
v_cmp_le_u32 vcc, 16, v7
v_mov_b32 v10, 128
s_nop 0
v_cndmask_b32 v10, 0, v10, vcc
v_add_u32 v10, v10, v7
v_mul_u32_u24 v10, 1152, v10
v_add_u32 v23, v10, v8
v_add_u32 v6, 512, v1
v_mul_u32_u24 v7, 3277, v6
v_lshrrev_b32 v7, 16, v7
v_mul_u32_u24 v8, 20, v7
v_sub_u32 v8, v6, v8
v_lshlrev_b32 v8, 4, v8
v_cmp_le_u32 vcc, 16, v7
v_mov_b32 v10, 128
s_nop 0
v_cndmask_b32 v10, 0, v10, vcc
v_add_u32 v10, v10, v7
v_mul_u32_u24 v10, 1152, v10
v_add_u32 v24, v10, v8
v_add_u32 v6, 576, v1
v_mul_u32_u24 v7, 3277, v6
v_lshrrev_b32 v7, 16, v7
v_mul_u32_u24 v8, 20, v7
v_sub_u32 v8, v6, v8
v_lshlrev_b32 v8, 4, v8
v_cmp_le_u32 vcc, 16, v7
v_mov_b32 v10, 128
s_nop 0
v_cndmask_b32 v10, 0, v10, vcc
v_add_u32 v10, v10, v7
v_mul_u32_u24 v10, 1152, v10
v_add_u32 v25, v10, v8
s_mul_i32 s54, s22, 20480
s_add_u32 s56, s55, 0
s_mul_hi_u32 s57, s56, 238609295
s_mul_i32 s58, s57, 18
s_sub_u32 s58, s56, s58
s_lshr_b32 s59, s57, 2
s_and_b32 s57, s57, 3
s_mov_b32 s53, s54
s_and_b32 s28, s58, 1
s_mul_i32 s28, s28, 288
s_lshr_b32 s29, s58, 1
s_lshl_b32 s29, s29, 4
s_add_u32 s28, s28, s29
s_mul_i32 s29, s59, 576
s_add_u32 s28, s28, s29
s_mul_i32 s28, s28, 1152
s_mul_i32 s29, s57, 9
s_lshr_b32 s29, s29, 1
s_lshl_b32 s29, s29, 6
s_add_u32 s28, s28, s29
s_add_u32 m0, s53, 0
s_nop 0
buffer_load_dwordx4 v16, s[36:39], s28 offen lds
s_add_u32 m0, s53, 1024
s_nop 0
buffer_load_dwordx4 v17, s[36:39], s28 offen lds
s_add_u32 m0, s53, 2048
s_nop 0
buffer_load_dwordx4 v18, s[36:39], s28 offen lds
s_add_u32 m0, s53, 3072
s_nop 0
buffer_load_dwordx4 v19, s[36:39], s28 offen lds
s_add_u32 m0, s53, 4096
s_nop 0
buffer_load_dwordx4 v20, s[36:39], s28 offen lds
s_add_u32 m0, s53, 5120
s_nop 0
buffer_load_dwordx4 v21, s[36:39], s28 offen lds
s_add_u32 m0, s53, 6144
s_nop 0
buffer_load_dwordx4 v22, s[36:39], s28 offen lds
s_add_u32 m0, s53, 7168
s_nop 0
buffer_load_dwordx4 v23, s[36:39], s28 offen lds
s_add_u32 m0, s53, 8192
s_nop 0
buffer_load_dwordx4 v24, s[36:39], s28 offen lds
s_add_u32 m0, s53, 9216
s_nop 0
buffer_load_dwordx4 v25, s[36:39], s28 offen lds
s_cmp_ge_u32 s22, 2
s_cbranch_scc1 u2_11
s_add_u32 s56, s55, 4
s_mul_hi_u32 s57, s56, 238609295
s_mul_i32 s58, s57, 18
s_sub_u32 s58, s56, s58
s_lshr_b32 s59, s57, 2
s_and_b32 s57, s57, 3
s_add_u32 s53, s54, 10240
s_and_b32 s28, s58, 1
s_mul_i32 s28, s28, 288
s_lshr_b32 s29, s58, 1
s_lshl_b32 s29, s29, 4
s_add_u32 s28, s28, s29
s_mul_i32 s29, s59, 576
s_add_u32 s28, s28, s29
s_mul_i32 s28, s28, 1152
s_mul_i32 s29, s57, 9
s_lshr_b32 s29, s29, 1
s_lshl_b32 s29, s29, 6
s_add_u32 s28, s28, s29
s_add_u32 m0, s53, 0
s_nop 0
buffer_load_dwordx4 v16, s[36:39], s28 offen lds
s_add_u32 m0, s53, 1024
s_nop 0
buffer_load_dwordx4 v17, s[36:39], s28 offen lds
s_add_u32 m0, s53, 2048
s_nop 0
buffer_load_dwordx4 v18, s[36:39], s28 offen lds
s_add_u32 m0, s53, 3072
s_nop 0
buffer_load_dwordx4 v19, s[36:39], s28 offen lds
s_add_u32 m0, s53, 4096
s_nop 0
buffer_load_dwordx4 v20, s[36:39], s28 offen lds
s_add_u32 m0, s53, 5120
s_nop 0
buffer_load_dwordx4 v21, s[36:39], s28 offen lds
s_add_u32 m0, s53, 6144
s_nop 0
buffer_load_dwordx4 v22, s[36:39], s28 offen lds
s_add_u32 m0, s53, 7168
s_nop 0
buffer_load_dwordx4 v23, s[36:39], s28 offen lds
s_add_u32 m0, s53, 8192
s_nop 0
buffer_load_dwordx4 v24, s[36:39], s28 offen lds
s_add_u32 m0, s53, 9216
s_nop 0
buffer_load_dwordx4 v25, s[36:39], s28 offen lds
u2_11:
s_waitcnt vmcnt(0)
s_add_u32 s56, s55, 0
s_mul_hi_u32 s57, s56, 238609295
s_mul_i32 s58, s57, 18
s_sub_u32 s58, s56, s58
s_lshr_b32 s59, s57, 2
s_and_b32 s57, s57, 3
s_mov_b32 s53, s54
v_and_b32 v7, 3, v1
v_lshrrev_b32 v11, 2, v1
v_mul_u32_u24 v11, 320, v11
v_lshl_add_u32 v11, v7, 4, v11
v_add_u32 v11, s53, v11
s_and_b32 s37, s57, 1
s_lshl_b32 s38, s37, 3
s_cmp_eq_u32 s37, 0
s_cselect_b32 s39, 8, 64
v_add_u32 v12, s39, v11
v_add_u32 v11, s38, v11
s_lshl_b32 s33, s59, 2
s_add_u32 s33, s33, s57
s_mul_i32 s33, s33, 165888
s_lshl_b32 s34, s58, 10
s_add_u32 s34, s34, s33
s_add_u32 s34, s34, 15269888
ds_read_b64_tr_b16 v[64:65], v11 offset:0
ds_read_b64_tr_b16 v[66:67], v11 offset:5120
ds_read_b64_tr_b16 v[68:69], v12 offset:0
ds_read_b64_tr_b16 v[70:71], v12 offset:5120
ds_read_b64_tr_b16 v[72:73], v11 offset:64
ds_read_b64_tr_b16 v[74:75], v11 offset:5184
ds_read_b64_tr_b16 v[76:77], v12 offset:64
ds_read_b64_tr_b16 v[78:79], v12 offset:5184
ds_read_b64_tr_b16 v[80:81], v11 offset:128
ds_read_b64_tr_b16 v[82:83], v11 offset:5248
ds_read_b64_tr_b16 v[84:85], v12 offset:128
ds_read_b64_tr_b16 v[86:87], v12 offset:5248
ds_read_b64_tr_b16 v[88:89], v11 offset:192
ds_read_b64_tr_b16 v[90:91], v11 offset:5312
ds_read_b64_tr_b16 v[92:93], v12 offset:192
ds_read_b64_tr_b16 v[94:95], v12 offset:5312
ds_read_b64_tr_b16 v[96:97], v11 offset:256
ds_read_b64_tr_b16 v[98:99], v11 offset:5376
s_waitcnt lgkmcnt(15)
s_add_u32 s36, s34, 0
buffer_store_dwordx4 v[64:67], v5, s[8:11], s36 offen sc1
s_waitcnt lgkmcnt(14)
s_add_u32 s36, s34, 18432
buffer_store_dwordx4 v[68:71], v5, s[8:11], s36 offen sc1
s_waitcnt lgkmcnt(12)
s_add_u32 s36, s34, 36864
buffer_store_dwordx4 v[72:75], v5, s[8:11], s36 offen sc1
s_waitcnt lgkmcnt(10)
s_add_u32 s36, s34, 55296
buffer_store_dwordx4 v[76:79], v5, s[8:11], s36 offen sc1
s_waitcnt lgkmcnt(8)
s_add_u32 s36, s34, 73728
buffer_store_dwordx4 v[80:83], v5, s[8:11], s36 offen sc1
s_waitcnt lgkmcnt(6)
s_add_u32 s36, s34, 92160
buffer_store_dwordx4 v[84:87], v5, s[8:11], s36 offen sc1
s_waitcnt lgkmcnt(4)
s_add_u32 s36, s34, 110592
buffer_store_dwordx4 v[88:91], v5, s[8:11], s36 offen sc1
s_waitcnt lgkmcnt(2)
s_add_u32 s36, s34, 129024
buffer_store_dwordx4 v[92:95], v5, s[8:11], s36 offen sc1
s_waitcnt lgkmcnt(0)
s_add_u32 s36, s34, 147456
buffer_store_dwordx4 v[96:99], v5, s[8:11], s36 offen sc1
s_cmp_ge_u32 s22, 2
s_cbranch_scc1 u2o_12
s_add_u32 s56, s55, 4
s_mul_hi_u32 s57, s56, 238609295
s_mul_i32 s58, s57, 18
s_sub_u32 s58, s56, s58
s_lshr_b32 s59, s57, 2
s_and_b32 s57, s57, 3
s_add_u32 s53, s54, 10240
v_and_b32 v7, 3, v1
v_lshrrev_b32 v11, 2, v1
v_mul_u32_u24 v11, 320, v11
v_lshl_add_u32 v11, v7, 4, v11
v_add_u32 v11, s53, v11
s_and_b32 s37, s57, 1
s_lshl_b32 s38, s37, 3
s_cmp_eq_u32 s37, 0
s_cselect_b32 s39, 8, 64
v_add_u32 v12, s39, v11
v_add_u32 v11, s38, v11
s_lshl_b32 s33, s59, 2
s_add_u32 s33, s33, s57
s_mul_i32 s33, s33, 165888
s_lshl_b32 s34, s58, 10
s_add_u32 s34, s34, s33
s_add_u32 s34, s34, 15269888
ds_read_b64_tr_b16 v[100:101], v11 offset:0
ds_read_b64_tr_b16 v[102:103], v11 offset:5120
ds_read_b64_tr_b16 v[104:105], v12 offset:0
ds_read_b64_tr_b16 v[106:107], v12 offset:5120
ds_read_b64_tr_b16 v[108:109], v11 offset:64
ds_read_b64_tr_b16 v[110:111], v11 offset:5184
ds_read_b64_tr_b16 v[112:113], v12 offset:64
ds_read_b64_tr_b16 v[114:115], v12 offset:5184
ds_read_b64_tr_b16 v[116:117], v11 offset:128
ds_read_b64_tr_b16 v[118:119], v11 offset:5248
ds_read_b64_tr_b16 v[120:121], v12 offset:128
ds_read_b64_tr_b16 v[122:123], v12 offset:5248
ds_read_b64_tr_b16 v[124:125], v11 offset:192
ds_read_b64_tr_b16 v[126:127], v11 offset:5312
ds_read_b64_tr_b16 v[128:129], v12 offset:192
ds_read_b64_tr_b16 v[130:131], v12 offset:5312
ds_read_b64_tr_b16 v[132:133], v11 offset:256
ds_read_b64_tr_b16 v[134:135], v11 offset:5376
s_waitcnt lgkmcnt(15)
s_add_u32 s36, s34, 0
buffer_store_dwordx4 v[100:103], v5, s[8:11], s36 offen sc1
s_waitcnt lgkmcnt(14)
s_add_u32 s36, s34, 18432
buffer_store_dwordx4 v[104:107], v5, s[8:11], s36 offen sc1
s_waitcnt lgkmcnt(12)
s_add_u32 s36, s34, 36864
buffer_store_dwordx4 v[108:111], v5, s[8:11], s36 offen sc1
s_waitcnt lgkmcnt(10)
s_add_u32 s36, s34, 55296
buffer_store_dwordx4 v[112:115], v5, s[8:11], s36 offen sc1
s_waitcnt lgkmcnt(8)
s_add_u32 s36, s34, 73728
buffer_store_dwordx4 v[116:119], v5, s[8:11], s36 offen sc1
s_waitcnt lgkmcnt(6)
s_add_u32 s36, s34, 92160
buffer_store_dwordx4 v[120:123], v5, s[8:11], s36 offen sc1
s_waitcnt lgkmcnt(4)
s_add_u32 s36, s34, 110592
buffer_store_dwordx4 v[124:127], v5, s[8:11], s36 offen sc1
s_waitcnt lgkmcnt(2)
s_add_u32 s36, s34, 129024
buffer_store_dwordx4 v[128:131], v5, s[8:11], s36 offen sc1
s_waitcnt lgkmcnt(0)
s_add_u32 s36, s34, 147456
buffer_store_dwordx4 v[132:135], v5, s[8:11], s36 offen sc1
u2o_12:
s_lshl_b32 s52, s23, 2
s_add_u32 s52, s52, 39848192
s_waitcnt vmcnt(0) lgkmcnt(0)
s_barrier
s_cmp_lg_u32 s22, 0
s_cbranch_scc1 sig_13
v_mov_b32 v14, s96
v_mov_b32 v15, 0
s_mov_b64 exec, 1
buffer_store_dword v14, v15, s[8:11], s52 offen sc1
s_mov_b64 exec, -1
sig_13:
s_branch P4_start
k1_kernel_end:
s_lshl_b32 s52, s2, 2
s_add_u32 s52, s52, 39845888
s_waitcnt vmcnt(0) lgkmcnt(0)
s_barrier
s_cmp_lg_u32 s22, 0
s_cbranch_scc1 sig_14
v_mov_b32 v14, s96
v_mov_b32 v15, 0
s_mov_b64 exec, 1
buffer_store_dword v14, v15, s[8:11], s52 offen sc1
s_mov_b64 exec, -1
sig_14:
v_mov_b32 v14, 153600
ds_read_b32 v14, v14
s_waitcnt lgkmcnt(0)
v_readfirstlane_b32 s96, v14
s_branch P3_gen
s_nop 7
s_nop 7
P3_gen:
v_lshrrev_b32 v2, 6, v0
v_and_b32 v1, 63, v0
s_nop 0
v_readfirstlane_b32 s22, v2
v_and_b32 v3, 15, v1
v_lshrrev_b32 v4, 4, v1
s_and_b32 s23, s2, 31
s_lshr_b32 s24, s2, 5
s_lshr_b32 s25, s22, 1
s_lshl_b32 s27, s23, 1
s_add_u32 s27, s27, s25
s_mul_i32 s32, s24, 3
s_add_u32 s32, s32, s22
v_cvt_f32_u32 v72, v3
v_cvt_f32_u32 v73, v4
v_mul_f32 v73, 4.0, v73
v_cvt_f32_u32 v74, s27
v_fmamk_f32 v75, v72, 0x42800000, v74
v_mul_f32 v75, 0x3a000000, v75
v_mul_f32 v76, v75, v73
v_mov_b32 v78, v76
v_fmamk_f32 v79, v75, 0x3f800000, v76
v_fmamk_f32 v80, v75, 0x40000000, v76
v_fmamk_f32 v81, v75, 0x40400000, v76
v_cos_f32 v82, v78
v_sin_f32 v83, v78
v_cos_f32 v84, v79
v_sin_f32 v85, v79
v_cos_f32 v86, v80
v_sin_f32 v87, v80
v_cos_f32 v88, v81
v_sin_f32 v89, v81
v_cvt_pk_bf16_f32 v102, v82, -v83
v_cvt_pk_bf16_f32 v103, v83, v82
v_accvgpr_write_b32 a144, v102
v_accvgpr_write_b32 a148, v103
v_cvt_pk_bf16_f32 v102, v84, -v85
v_cvt_pk_bf16_f32 v103, v85, v84
v_accvgpr_write_b32 a145, v102
v_accvgpr_write_b32 a149, v103
v_cvt_pk_bf16_f32 v102, v86, -v87
v_cvt_pk_bf16_f32 v103, v87, v86
v_accvgpr_write_b32 a146, v102
v_accvgpr_write_b32 a150, v103
v_cvt_pk_bf16_f32 v102, v88, -v89
v_cvt_pk_bf16_f32 v103, v89, v88
v_accvgpr_write_b32 a147, v102
v_accvgpr_write_b32 a151, v103
v_fmamk_f32 v78, v75, 0x41800000, v76
v_fmamk_f32 v79, v75, 0x41880000, v76
v_fmamk_f32 v80, v75, 0x41900000, v76
v_fmamk_f32 v81, v75, 0x41980000, v76
v_cos_f32 v82, v78
v_sin_f32 v83, v78
v_cos_f32 v84, v79
v_sin_f32 v85, v79
v_cos_f32 v86, v80
v_sin_f32 v87, v80
v_cos_f32 v88, v81
v_sin_f32 v89, v81
v_cvt_pk_bf16_f32 v102, v82, -v83
v_cvt_pk_bf16_f32 v103, v83, v82
v_accvgpr_write_b32 a152, v102
v_accvgpr_write_b32 a156, v103
v_cvt_pk_bf16_f32 v102, v84, -v85
v_cvt_pk_bf16_f32 v103, v85, v84
v_accvgpr_write_b32 a153, v102
v_accvgpr_write_b32 a157, v103
v_cvt_pk_bf16_f32 v102, v86, -v87
v_cvt_pk_bf16_f32 v103, v87, v86
v_accvgpr_write_b32 a154, v102
v_accvgpr_write_b32 a158, v103
v_cvt_pk_bf16_f32 v102, v88, -v89
v_cvt_pk_bf16_f32 v103, v89, v88
v_accvgpr_write_b32 a155, v102
v_accvgpr_write_b32 a159, v103
v_fmamk_f32 v75, v72, 0x42800000, v74
v_add_f32 v75, 0x44800000, v75
v_mul_f32 v75, 0x3a000000, v75
v_mul_f32 v76, v75, v73
v_mov_b32 v78, v76
v_fmamk_f32 v79, v75, 0x3f800000, v76
v_fmamk_f32 v80, v75, 0x40000000, v76
v_fmamk_f32 v81, v75, 0x40400000, v76
v_cos_f32 v82, v78
v_sin_f32 v83, v78
v_cos_f32 v84, v79
v_sin_f32 v85, v79
v_cos_f32 v86, v80
v_sin_f32 v87, v80
v_cos_f32 v88, v81
v_sin_f32 v89, v81
v_cvt_pk_bf16_f32 v102, v82, -v83
v_cvt_pk_bf16_f32 v103, v83, v82
v_accvgpr_write_b32 a160, v102
v_accvgpr_write_b32 a164, v103
v_cvt_pk_bf16_f32 v102, v84, -v85
v_cvt_pk_bf16_f32 v103, v85, v84
v_accvgpr_write_b32 a161, v102
v_accvgpr_write_b32 a165, v103
v_cvt_pk_bf16_f32 v102, v86, -v87
v_cvt_pk_bf16_f32 v103, v87, v86
v_accvgpr_write_b32 a162, v102
v_accvgpr_write_b32 a166, v103
v_cvt_pk_bf16_f32 v102, v88, -v89
v_cvt_pk_bf16_f32 v103, v89, v88
v_accvgpr_write_b32 a163, v102
v_accvgpr_write_b32 a167, v103
v_fmamk_f32 v78, v75, 0x41800000, v76
v_fmamk_f32 v79, v75, 0x41880000, v76
v_fmamk_f32 v80, v75, 0x41900000, v76
v_fmamk_f32 v81, v75, 0x41980000, v76
v_cos_f32 v82, v78
v_sin_f32 v83, v78
v_cos_f32 v84, v79
v_sin_f32 v85, v79
v_cos_f32 v86, v80
v_sin_f32 v87, v80
v_cos_f32 v88, v81
v_sin_f32 v89, v81
v_cvt_pk_bf16_f32 v102, v82, -v83
v_cvt_pk_bf16_f32 v103, v83, v82
v_accvgpr_write_b32 a168, v102
v_accvgpr_write_b32 a172, v103
v_cvt_pk_bf16_f32 v102, v84, -v85
v_cvt_pk_bf16_f32 v103, v85, v84
v_accvgpr_write_b32 a169, v102
v_accvgpr_write_b32 a173, v103
v_cvt_pk_bf16_f32 v102, v86, -v87
v_cvt_pk_bf16_f32 v103, v87, v86
v_accvgpr_write_b32 a170, v102
v_accvgpr_write_b32 a174, v103
v_cvt_pk_bf16_f32 v102, v88, -v89
v_cvt_pk_bf16_f32 v103, v89, v88
v_accvgpr_write_b32 a171, v102
v_accvgpr_write_b32 a175, v103
s_cmp_eq_u32 s22, 3
s_cbranch_scc1 p3ga_done
p3ga_done:
s_cmp_lt_u32 s2, 144
s_cbranch_scc0 P3_genB
P2_start:
s_load_dwordx2 s[4:5], s[0:1], 80
v_lshrrev_b32 v2, 6, v0
v_and_b32 v1, 63, v0
s_nop 0
v_readfirstlane_b32 s22, v2
v_lshlrev_b32 v5, 4, v1
v_and_b32 v3, 31, v1
v_lshrrev_b32 v4, 5, v1
s_lshr_b32 s35, s22, 1
s_and_b32 s36, s22, 1
s_lshl_b32 s23, s2, 1
s_add_u32 s23, s23, s35
v_mul_u32_u24 v6, 147456, v4
v_lshl_add_u32 v6, v3, 2, v6
s_lshl_b32 s24, s23, 7
v_lshlrev_b32 v7, 9, v4
v_lshl_add_u32 v7, v3, 2, v7
v_and_b32 v13, 3, v3
v_lshl_add_u32 v13, v4, 2, v13
v_mul_u32_u24 v13, 36864, v13
v_lshrrev_b32 v14, 2, v3
v_lshl_add_u32 v13, v14, 4, v13
s_mov_b32 s44, 0x55555555
s_mov_b32 s45, 0x55555555
s_mov_b32 s46, 0x33333333
s_mov_b32 s47, 0x33333333
s_lshl_b32 s25, s23, 13
s_lshl_b32 s26, s36, 12
s_add_u32 s25, s25, s26
s_add_u32 s25, s25, 7340032
s_lshl_b32 s26, s36, 14
v_add_u32 v9, s26, v5
s_lshl_b32 s26, s35, 13
s_lshl_b32 s27, s36, 12
s_add_u32 s26, s26, s27
s_add_u32 s26, s26, 32768
v_add_u32 v10, s26, v5
v_xor_b32 v11, 4096, v10
s_lshr_b32 s29, s22, 1
s_and_b32 s30, s22, 1
s_lshl_b32 s31, s29, 5
v_add_u32 v236, s31, v3
v_cvt_f32_u32 v236, v236
v_mul_f32 v236, 0x3c800000, v236
s_lshl_b32 s32, s30, 5
v_lshl_add_u32 v237, v4, 2, s32
v_cvt_f32_u32 v237, v237
v_mul_f32 v237, v236, v237
s_lshl_b32 s33, s29, 14
s_lshl_b32 s34, s30, 12
s_add_u32 s33, s33, s34
v_add_u32 v8, s33, v5
v_mov_b32 v238, v237
v_fmamk_f32 v239, v236, 0x3f800000, v237
v_fmamk_f32 v240, v236, 0x40000000, v237
v_fmamk_f32 v241, v236, 0x40400000, v237
v_cos_f32 v242, v238
v_sin_f32 v243, v238
v_cos_f32 v244, v239
v_sin_f32 v245, v239
v_cos_f32 v246, v240
v_sin_f32 v247, v240
v_cos_f32 v248, v241
v_sin_f32 v249, v241
v_cvt_pk_bf16_f32 v80, v242, v243
v_cvt_pk_bf16_f32 v84, -v243, v242
v_cvt_pk_bf16_f32 v81, v244, v245
v_cvt_pk_bf16_f32 v85, -v245, v244
v_cvt_pk_bf16_f32 v82, v246, v247
v_cvt_pk_bf16_f32 v86, -v247, v246
v_cvt_pk_bf16_f32 v83, v248, v249
v_cvt_pk_bf16_f32 v87, -v249, v248
ds_write_b128 v8, v[80:83] offset:0
ds_write_b128 v8, v[84:87] offset:8192
v_fmamk_f32 v238, v236, 0x41000000, v237
v_fmamk_f32 v239, v236, 0x41100000, v237
v_fmamk_f32 v240, v236, 0x41200000, v237
v_fmamk_f32 v241, v236, 0x41300000, v237
v_cos_f32 v242, v238
v_sin_f32 v243, v238
v_cos_f32 v244, v239
v_sin_f32 v245, v239
v_cos_f32 v246, v240
v_sin_f32 v247, v240
v_cos_f32 v248, v241
v_sin_f32 v249, v241
v_cvt_pk_bf16_f32 v88, v242, v243
v_cvt_pk_bf16_f32 v92, -v243, v242
v_cvt_pk_bf16_f32 v89, v244, v245
v_cvt_pk_bf16_f32 v93, -v245, v244
v_cvt_pk_bf16_f32 v90, v246, v247
v_cvt_pk_bf16_f32 v94, -v247, v246
v_cvt_pk_bf16_f32 v91, v248, v249
v_cvt_pk_bf16_f32 v95, -v249, v248
ds_write_b128 v8, v[88:91] offset:1024
ds_write_b128 v8, v[92:95] offset:9216
v_fmamk_f32 v238, v236, 0x41800000, v237
v_fmamk_f32 v239, v236, 0x41880000, v237
v_fmamk_f32 v240, v236, 0x41900000, v237
v_fmamk_f32 v241, v236, 0x41980000, v237
v_cos_f32 v242, v238
v_sin_f32 v243, v238
v_cos_f32 v244, v239
v_sin_f32 v245, v239
v_cos_f32 v246, v240
v_sin_f32 v247, v240
v_cos_f32 v248, v241
v_sin_f32 v249, v241
v_cvt_pk_bf16_f32 v80, v242, v243
v_cvt_pk_bf16_f32 v84, -v243, v242
v_cvt_pk_bf16_f32 v81, v244, v245
v_cvt_pk_bf16_f32 v85, -v245, v244
v_cvt_pk_bf16_f32 v82, v246, v247
v_cvt_pk_bf16_f32 v86, -v247, v246
v_cvt_pk_bf16_f32 v83, v248, v249
v_cvt_pk_bf16_f32 v87, -v249, v248
ds_write_b128 v8, v[80:83] offset:2048
ds_write_b128 v8, v[84:87] offset:10240
v_fmamk_f32 v238, v236, 0x41c00000, v237
v_fmamk_f32 v239, v236, 0x41c80000, v237
v_fmamk_f32 v240, v236, 0x41d00000, v237
v_fmamk_f32 v241, v236, 0x41d80000, v237
v_cos_f32 v242, v238
v_sin_f32 v243, v238
v_cos_f32 v244, v239
v_sin_f32 v245, v239
v_cos_f32 v246, v240
v_sin_f32 v247, v240
v_cos_f32 v248, v241
v_sin_f32 v249, v241
v_cvt_pk_bf16_f32 v88, v242, v243
v_cvt_pk_bf16_f32 v92, -v243, v242
v_cvt_pk_bf16_f32 v89, v244, v245
v_cvt_pk_bf16_f32 v93, -v245, v244
v_cvt_pk_bf16_f32 v90, v246, v247
v_cvt_pk_bf16_f32 v94, -v247, v246
v_cvt_pk_bf16_f32 v91, v248, v249
v_cvt_pk_bf16_f32 v95, -v249, v248
ds_write_b128 v8, v[88:91] offset:3072
ds_write_b128 v8, v[92:95] offset:11264
s_waitcnt lgkmcnt(0)
s_mov_b32 s8, s4
s_and_b32 s9, s5, 0xffff
s_mov_b32 s10, 39878656
s_mov_b32 s11, 0x20000
s_cmp_lg_u32 s22, 0
s_cbranch_scc1 w_15
s_mul_hi_u32 s52, s2, 178956971
s_lshl_b32 s52, s52, 7
s_add_u32 s52, s52, 39845888
v_and_b32 v238, 31, v1
v_lshlrev_b32 v238, 2, v238
v_lshlrev_b32 v239, 2, v1
s_mov_b32 s93, 39846912
s_mov_b32 s97, 0
pollm_16:
buffer_load_dword v240, v238, s[8:11], s52 offen sc1
buffer_load_dword v241, v239, s[8:11], s93 offen sc1
s_waitcnt vmcnt(0)
v_xor_b32 v240, s96, v240
v_xor_b32 v241, s96, v241
v_or_b32 v240, v240, v241
v_cmp_ne_u32 vcc, 0, v240
s_add_u32 s97, s97, 1
s_cmp_gt_u32 s97, 200000
s_cbranch_scc1 pollm_16_d
s_cmp_eq_u64 vcc, 0
s_cbranch_scc1 pollm_16_d
s_sleep 2
s_branch pollm_16
pollm_16_d:
w_15:
s_barrier
s_add_u32 s27, s24, 0
s_add_u32 s28, s27, 0
buffer_load_dword v16, v6, s[8:11], s28 offen sc1
s_add_u32 s28, s27, 36864
buffer_load_dword v17, v6, s[8:11], s28 offen sc1
s_add_u32 s28, s27, 73728
buffer_load_dword v18, v6, s[8:11], s28 offen sc1
s_add_u32 s28, s27, 110592
buffer_load_dword v19, v6, s[8:11], s28 offen sc1
s_add_u32 s28, s27, 294912
buffer_load_dword v20, v6, s[8:11], s28 offen sc1
s_add_u32 s28, s27, 331776
buffer_load_dword v21, v6, s[8:11], s28 offen sc1
s_add_u32 s28, s27, 368640
buffer_load_dword v22, v6, s[8:11], s28 offen sc1
s_add_u32 s28, s27, 405504
buffer_load_dword v23, v6, s[8:11], s28 offen sc1
s_add_u32 s28, s27, 589824
buffer_load_dword v24, v6, s[8:11], s28 offen sc1
s_add_u32 s28, s27, 626688
buffer_load_dword v25, v6, s[8:11], s28 offen sc1
s_add_u32 s28, s27, 663552
buffer_load_dword v26, v6, s[8:11], s28 offen sc1
s_add_u32 s28, s27, 700416
buffer_load_dword v27, v6, s[8:11], s28 offen sc1
s_add_u32 s28, s27, 884736
buffer_load_dword v28, v6, s[8:11], s28 offen sc1
s_add_u32 s28, s27, 921600
buffer_load_dword v29, v6, s[8:11], s28 offen sc1
s_add_u32 s28, s27, 958464
buffer_load_dword v30, v6, s[8:11], s28 offen sc1
s_add_u32 s28, s27, 995328
buffer_load_dword v31, v6, s[8:11], s28 offen sc1
s_add_u32 s28, s27, 1179648
buffer_load_dword v32, v6, s[8:11], s28 offen sc1
s_add_u32 s28, s27, 1216512
buffer_load_dword v33, v6, s[8:11], s28 offen sc1
s_add_u32 s28, s27, 1253376
buffer_load_dword v34, v6, s[8:11], s28 offen sc1
s_add_u32 s28, s27, 1290240
buffer_load_dword v35, v6, s[8:11], s28 offen sc1
s_add_u32 s28, s27, 1474560
buffer_load_dword v36, v6, s[8:11], s28 offen sc1
s_add_u32 s28, s27, 1511424
buffer_load_dword v37, v6, s[8:11], s28 offen sc1
s_add_u32 s28, s27, 1548288
buffer_load_dword v38, v6, s[8:11], s28 offen sc1
s_add_u32 s28, s27, 1585152
buffer_load_dword v39, v6, s[8:11], s28 offen sc1
s_add_u32 s28, s27, 1769472
buffer_load_dword v40, v6, s[8:11], s28 offen sc1
s_add_u32 s28, s27, 1806336
buffer_load_dword v41, v6, s[8:11], s28 offen sc1
s_add_u32 s28, s27, 1843200
buffer_load_dword v42, v6, s[8:11], s28 offen sc1
s_add_u32 s28, s27, 1880064
buffer_load_dword v43, v6, s[8:11], s28 offen sc1
s_add_u32 s28, s27, 2064384
buffer_load_dword v44, v6, s[8:11], s28 offen sc1
s_add_u32 s28, s27, 2101248
buffer_load_dword v45, v6, s[8:11], s28 offen sc1
s_add_u32 s28, s27, 2138112
buffer_load_dword v46, v6, s[8:11], s28 offen sc1
s_add_u32 s28, s27, 2174976
buffer_load_dword v47, v6, s[8:11], s28 offen sc1
buffer_load_dword v48, v7, s[8:11], s25 offen offset:0 sc1
buffer_load_dword v49, v7, s[8:11], s25 offen offset:128 sc1
buffer_load_dword v50, v7, s[8:11], s25 offen offset:256 sc1
buffer_load_dword v51, v7, s[8:11], s25 offen offset:384 sc1
buffer_load_dword v52, v7, s[8:11], s25 offen offset:1024 sc1
buffer_load_dword v53, v7, s[8:11], s25 offen offset:1152 sc1
buffer_load_dword v54, v7, s[8:11], s25 offen offset:1280 sc1
buffer_load_dword v55, v7, s[8:11], s25 offen offset:1408 sc1
buffer_load_dword v56, v7, s[8:11], s25 offen offset:2048 sc1
buffer_load_dword v57, v7, s[8:11], s25 offen offset:2176 sc1
buffer_load_dword v58, v7, s[8:11], s25 offen offset:2304 sc1
buffer_load_dword v59, v7, s[8:11], s25 offen offset:2432 sc1
buffer_load_dword v60, v7, s[8:11], s25 offen offset:3072 sc1
buffer_load_dword v61, v7, s[8:11], s25 offen offset:3200 sc1
buffer_load_dword v62, v7, s[8:11], s25 offen offset:3328 sc1
buffer_load_dword v63, v7, s[8:11], s25 offen offset:3456 sc1
s_cmp_lg_u32 s23, 0
s_cbranch_scc1 k2s_noq
s_lshl_b32 s37, s36, 12
s_add_u32 s37, s37, 9699328
buffer_load_dword v64, v7, s[8:11], s37 offen offset:0 sc1
buffer_load_dword v65, v7, s[8:11], s37 offen offset:128 sc1
buffer_load_dword v66, v7, s[8:11], s37 offen offset:256 sc1
buffer_load_dword v67, v7, s[8:11], s37 offen offset:384 sc1
buffer_load_dword v68, v7, s[8:11], s37 offen offset:1024 sc1
buffer_load_dword v69, v7, s[8:11], s37 offen offset:1152 sc1
buffer_load_dword v70, v7, s[8:11], s37 offen offset:1280 sc1
buffer_load_dword v71, v7, s[8:11], s37 offen offset:1408 sc1
buffer_load_dword v72, v7, s[8:11], s37 offen offset:2048 sc1
buffer_load_dword v73, v7, s[8:11], s37 offen offset:2176 sc1
buffer_load_dword v74, v7, s[8:11], s37 offen offset:2304 sc1
buffer_load_dword v75, v7, s[8:11], s37 offen offset:2432 sc1
buffer_load_dword v76, v7, s[8:11], s37 offen offset:3072 sc1
buffer_load_dword v77, v7, s[8:11], s37 offen offset:3200 sc1
buffer_load_dword v78, v7, s[8:11], s37 offen offset:3328 sc1
buffer_load_dword v79, v7, s[8:11], s37 offen offset:3456 sc1
k2s_noq:
ds_read_b128 v[80:83], v9 offset:0
ds_read_b128 v[84:87], v9 offset:8192
ds_read_b128 v[88:91], v9 offset:1024
ds_read_b128 v[92:95], v9 offset:9216
ds_read_b128 v[96:99], v9 offset:2048
ds_read_b128 v[100:103], v9 offset:10240
s_waitcnt vmcnt(44)
s_waitcnt lgkmcnt(5)
v_mfma_f32_32x32x16_bf16 v[112:127], v[80:83], v[16:19], 0
ds_read_b128 v[104:107], v9 offset:3072
s_waitcnt lgkmcnt(5)
v_mfma_f32_32x32x16_bf16 v[128:143], v[84:87], v[16:19], 0
ds_read_b128 v[108:111], v9 offset:11264
s_waitcnt vmcnt(40)
s_waitcnt lgkmcnt(5)
v_mfma_f32_32x32x16_bf16 v[112:127], v[88:91], v[20:23], v[112:127]
ds_read_b128 v[80:83], v9 offset:4096
s_waitcnt lgkmcnt(5)
v_mfma_f32_32x32x16_bf16 v[128:143], v[92:95], v[20:23], v[128:143]
ds_read_b128 v[84:87], v9 offset:12288
s_waitcnt vmcnt(36)
s_waitcnt lgkmcnt(5)
v_mfma_f32_32x32x16_bf16 v[112:127], v[96:99], v[24:27], v[112:127]
ds_read_b128 v[88:91], v9 offset:5120
s_waitcnt lgkmcnt(5)
v_mfma_f32_32x32x16_bf16 v[128:143], v[100:103], v[24:27], v[128:143]
ds_read_b128 v[92:95], v9 offset:13312
s_waitcnt vmcnt(32)
s_waitcnt lgkmcnt(5)
v_mfma_f32_32x32x16_bf16 v[112:127], v[104:107], v[28:31], v[112:127]
ds_read_b128 v[96:99], v9 offset:6144
s_waitcnt lgkmcnt(5)
v_mfma_f32_32x32x16_bf16 v[128:143], v[108:111], v[28:31], v[128:143]
ds_read_b128 v[100:103], v9 offset:14336
s_waitcnt vmcnt(28)
s_waitcnt lgkmcnt(5)
v_mfma_f32_32x32x16_bf16 v[112:127], v[80:83], v[32:35], v[112:127]
ds_read_b128 v[104:107], v9 offset:7168
s_waitcnt lgkmcnt(5)
v_mfma_f32_32x32x16_bf16 v[128:143], v[84:87], v[32:35], v[128:143]
ds_read_b128 v[108:111], v9 offset:15360
s_waitcnt vmcnt(24)
s_waitcnt lgkmcnt(5)
v_mfma_f32_32x32x16_bf16 v[112:127], v[88:91], v[36:39], v[112:127]
s_waitcnt lgkmcnt(4)
v_mfma_f32_32x32x16_bf16 v[128:143], v[92:95], v[36:39], v[128:143]
s_waitcnt vmcnt(20)
s_waitcnt lgkmcnt(3)
v_mfma_f32_32x32x16_bf16 v[112:127], v[96:99], v[40:43], v[112:127]
s_waitcnt lgkmcnt(2)
v_mfma_f32_32x32x16_bf16 v[128:143], v[100:103], v[40:43], v[128:143]
s_waitcnt vmcnt(16)
s_waitcnt lgkmcnt(1)
v_mfma_f32_32x32x16_bf16 v[112:127], v[104:107], v[44:47], v[112:127]
s_waitcnt lgkmcnt(0)
v_mfma_f32_32x32x16_bf16 v[128:143], v[108:111], v[44:47], v[128:143]
s_waitcnt vmcnt(0)
s_cmp_eq_u32 s2, 0
s_cbranch_scc1 k2s_k0
v_lshlrev_b32 v240, 16, v48
v_and_b32 v241, 0xffff0000, v48
s_nop 4
v_mul_f32 v242, v112, v240
v_mul_f32 v243, v112, v241
v_fma_f32 v242, -v128, v241, v242
v_fma_f32 v243, v128, v240, v243
v_cvt_pk_bf16_f32 v16, v242, -v243
v_lshlrev_b32 v244, 16, v49
v_and_b32 v245, 0xffff0000, v49
v_mul_f32 v246, v113, v244
v_mul_f32 v247, v113, v245
v_fma_f32 v246, -v129, v245, v246
v_fma_f32 v247, v129, v244, v247
v_cvt_pk_bf16_f32 v17, v246, -v247
v_lshlrev_b32 v240, 16, v50
v_and_b32 v241, 0xffff0000, v50
v_mul_f32 v242, v114, v240
v_mul_f32 v243, v114, v241
v_fma_f32 v242, -v130, v241, v242
v_fma_f32 v243, v130, v240, v243
v_cvt_pk_bf16_f32 v18, v242, -v243
v_lshlrev_b32 v244, 16, v51
v_and_b32 v245, 0xffff0000, v51
v_mul_f32 v246, v115, v244
v_mul_f32 v247, v115, v245
v_fma_f32 v246, -v131, v245, v246
v_fma_f32 v247, v131, v244, v247
v_cvt_pk_bf16_f32 v19, v246, -v247
v_lshlrev_b32 v240, 16, v52
v_and_b32 v241, 0xffff0000, v52
v_mul_f32 v242, v116, v240
v_mul_f32 v243, v116, v241
v_fma_f32 v242, -v132, v241, v242
v_fma_f32 v243, v132, v240, v243
v_cvt_pk_bf16_f32 v20, v242, -v243
v_lshlrev_b32 v244, 16, v53
v_and_b32 v245, 0xffff0000, v53
v_mul_f32 v246, v117, v244
v_mul_f32 v247, v117, v245
v_fma_f32 v246, -v133, v245, v246
v_fma_f32 v247, v133, v244, v247
v_cvt_pk_bf16_f32 v21, v246, -v247
v_lshlrev_b32 v240, 16, v54
v_and_b32 v241, 0xffff0000, v54
v_mul_f32 v242, v118, v240
v_mul_f32 v243, v118, v241
v_fma_f32 v242, -v134, v241, v242
v_fma_f32 v243, v134, v240, v243
v_cvt_pk_bf16_f32 v22, v242, -v243
v_lshlrev_b32 v244, 16, v55
v_and_b32 v245, 0xffff0000, v55
v_mul_f32 v246, v119, v244
v_mul_f32 v247, v119, v245
v_fma_f32 v246, -v135, v245, v246
v_fma_f32 v247, v135, v244, v247
v_cvt_pk_bf16_f32 v23, v246, -v247
v_lshlrev_b32 v240, 16, v56
v_and_b32 v241, 0xffff0000, v56
v_mul_f32 v242, v120, v240
v_mul_f32 v243, v120, v241
v_fma_f32 v242, -v136, v241, v242
v_fma_f32 v243, v136, v240, v243
v_cvt_pk_bf16_f32 v24, v242, -v243
v_lshlrev_b32 v244, 16, v57
v_and_b32 v245, 0xffff0000, v57
v_mul_f32 v246, v121, v244
v_mul_f32 v247, v121, v245
v_fma_f32 v246, -v137, v245, v246
v_fma_f32 v247, v137, v244, v247
v_cvt_pk_bf16_f32 v25, v246, -v247
v_lshlrev_b32 v240, 16, v58
v_and_b32 v241, 0xffff0000, v58
v_mul_f32 v242, v122, v240
v_mul_f32 v243, v122, v241
v_fma_f32 v242, -v138, v241, v242
v_fma_f32 v243, v138, v240, v243
v_cvt_pk_bf16_f32 v26, v242, -v243
v_lshlrev_b32 v244, 16, v59
v_and_b32 v245, 0xffff0000, v59
v_mul_f32 v246, v123, v244
v_mul_f32 v247, v123, v245
v_fma_f32 v246, -v139, v245, v246
v_fma_f32 v247, v139, v244, v247
v_cvt_pk_bf16_f32 v27, v246, -v247
v_lshlrev_b32 v240, 16, v60
v_and_b32 v241, 0xffff0000, v60
v_mul_f32 v242, v124, v240
v_mul_f32 v243, v124, v241
v_fma_f32 v242, -v140, v241, v242
v_fma_f32 v243, v140, v240, v243
v_cvt_pk_bf16_f32 v28, v242, -v243
v_lshlrev_b32 v244, 16, v61
v_and_b32 v245, 0xffff0000, v61
v_mul_f32 v246, v125, v244
v_mul_f32 v247, v125, v245
v_fma_f32 v246, -v141, v245, v246
v_fma_f32 v247, v141, v244, v247
v_cvt_pk_bf16_f32 v29, v246, -v247
v_lshlrev_b32 v240, 16, v62
v_and_b32 v241, 0xffff0000, v62
v_mul_f32 v242, v126, v240
v_mul_f32 v243, v126, v241
v_fma_f32 v242, -v142, v241, v242
v_fma_f32 v243, v142, v240, v243
v_cvt_pk_bf16_f32 v30, v242, -v243
v_lshlrev_b32 v244, 16, v63
v_and_b32 v245, 0xffff0000, v63
v_mul_f32 v246, v127, v244
v_mul_f32 v247, v127, v245
v_fma_f32 v246, -v143, v245, v246
v_fma_f32 v247, v143, v244, v247
v_cvt_pk_bf16_f32 v31, v246, -v247
k2s_xchg:
ds_write_b128 v10, v[16:19] offset:0
ds_write_b128 v10, v[20:23] offset:1024
ds_write_b128 v10, v[24:27] offset:2048
ds_write_b128 v10, v[28:31] offset:3072
s_waitcnt lgkmcnt(0)
s_barrier
ds_read_b128 v[32:35], v11 offset:0
ds_read_b128 v[36:39], v11 offset:1024
ds_read_b128 v[40:43], v11 offset:2048
ds_read_b128 v[44:47], v11 offset:3072
s_cmp_eq_u32 s36, 0
s_cbranch_scc0 k2s_inv1
ds_read_b128 v[80:83], v9 offset:0
ds_read_b128 v[84:87], v9 offset:8192
ds_read_b128 v[88:91], v9 offset:1024
ds_read_b128 v[92:95], v9 offset:9216
ds_read_b128 v[96:99], v9 offset:2048
ds_read_b128 v[100:103], v9 offset:10240
s_waitcnt lgkmcnt(5)
v_mfma_f32_32x32x16_bf16 v[144:159], v[80:83], v[16:19], 0
ds_read_b128 v[104:107], v9 offset:3072
s_waitcnt lgkmcnt(5)
v_mfma_f32_32x32x16_bf16 v[160:175], v[84:87], v[16:19], 0
ds_read_b128 v[108:111], v9 offset:11264
s_waitcnt lgkmcnt(5)
v_mfma_f32_32x32x16_bf16 v[144:159], v[88:91], v[20:23], v[144:159]
ds_read_b128 v[80:83], v9 offset:4096
s_waitcnt lgkmcnt(5)
v_mfma_f32_32x32x16_bf16 v[160:175], v[92:95], v[20:23], v[160:175]
ds_read_b128 v[84:87], v9 offset:12288
s_waitcnt lgkmcnt(5)
v_mfma_f32_32x32x16_bf16 v[144:159], v[96:99], v[24:27], v[144:159]
ds_read_b128 v[88:91], v9 offset:5120
s_waitcnt lgkmcnt(5)
v_mfma_f32_32x32x16_bf16 v[160:175], v[100:103], v[24:27], v[160:175]
ds_read_b128 v[92:95], v9 offset:13312
s_waitcnt lgkmcnt(5)
v_mfma_f32_32x32x16_bf16 v[144:159], v[104:107], v[28:31], v[144:159]
ds_read_b128 v[96:99], v9 offset:6144
s_waitcnt lgkmcnt(5)
v_mfma_f32_32x32x16_bf16 v[160:175], v[108:111], v[28:31], v[160:175]
ds_read_b128 v[100:103], v9 offset:14336
s_waitcnt lgkmcnt(5)
v_mfma_f32_32x32x16_bf16 v[144:159], v[80:83], v[32:35], v[144:159]
ds_read_b128 v[104:107], v9 offset:7168
s_waitcnt lgkmcnt(5)
v_mfma_f32_32x32x16_bf16 v[160:175], v[84:87], v[32:35], v[160:175]
ds_read_b128 v[108:111], v9 offset:15360
s_waitcnt lgkmcnt(5)
v_mfma_f32_32x32x16_bf16 v[144:159], v[88:91], v[36:39], v[144:159]
s_waitcnt lgkmcnt(4)
v_mfma_f32_32x32x16_bf16 v[160:175], v[92:95], v[36:39], v[160:175]
s_waitcnt lgkmcnt(3)
v_mfma_f32_32x32x16_bf16 v[144:159], v[96:99], v[40:43], v[144:159]
s_waitcnt lgkmcnt(2)
v_mfma_f32_32x32x16_bf16 v[160:175], v[100:103], v[40:43], v[160:175]
s_waitcnt lgkmcnt(1)
v_mfma_f32_32x32x16_bf16 v[144:159], v[104:107], v[44:47], v[144:159]
s_waitcnt lgkmcnt(0)
v_mfma_f32_32x32x16_bf16 v[160:175], v[108:111], v[44:47], v[160:175]
s_branch k2s_out
k2s_inv1:
ds_read_b128 v[80:83], v9 offset:4096
ds_read_b128 v[84:87], v9 offset:12288
ds_read_b128 v[88:91], v9 offset:5120
ds_read_b128 v[92:95], v9 offset:13312
ds_read_b128 v[96:99], v9 offset:6144
ds_read_b128 v[100:103], v9 offset:14336
s_waitcnt lgkmcnt(5)
v_mfma_f32_32x32x16_bf16 v[144:159], v[80:83], v[16:19], 0
ds_read_b128 v[104:107], v9 offset:7168
s_waitcnt lgkmcnt(5)
v_mfma_f32_32x32x16_bf16 v[160:175], v[84:87], v[16:19], 0
ds_read_b128 v[108:111], v9 offset:15360
s_waitcnt lgkmcnt(5)
v_mfma_f32_32x32x16_bf16 v[144:159], v[88:91], v[20:23], v[144:159]
ds_read_b128 v[80:83], v9 offset:0
s_waitcnt lgkmcnt(5)
v_mfma_f32_32x32x16_bf16 v[160:175], v[92:95], v[20:23], v[160:175]
ds_read_b128 v[84:87], v9 offset:8192
s_waitcnt lgkmcnt(5)
v_mfma_f32_32x32x16_bf16 v[144:159], v[96:99], v[24:27], v[144:159]
ds_read_b128 v[88:91], v9 offset:1024
s_waitcnt lgkmcnt(5)
v_mfma_f32_32x32x16_bf16 v[160:175], v[100:103], v[24:27], v[160:175]
ds_read_b128 v[92:95], v9 offset:9216
s_waitcnt lgkmcnt(5)
v_mfma_f32_32x32x16_bf16 v[144:159], v[104:107], v[28:31], v[144:159]
ds_read_b128 v[96:99], v9 offset:2048
s_waitcnt lgkmcnt(5)
v_mfma_f32_32x32x16_bf16 v[160:175], v[108:111], v[28:31], v[160:175]
ds_read_b128 v[100:103], v9 offset:10240
s_waitcnt lgkmcnt(5)
v_mfma_f32_32x32x16_bf16 v[144:159], v[80:83], v[32:35], v[144:159]
ds_read_b128 v[104:107], v9 offset:3072
s_waitcnt lgkmcnt(5)
v_mfma_f32_32x32x16_bf16 v[160:175], v[84:87], v[32:35], v[160:175]
ds_read_b128 v[108:111], v9 offset:11264
s_waitcnt lgkmcnt(5)
v_mfma_f32_32x32x16_bf16 v[144:159], v[88:91], v[36:39], v[144:159]
s_waitcnt lgkmcnt(4)
v_mfma_f32_32x32x16_bf16 v[160:175], v[92:95], v[36:39], v[160:175]
s_waitcnt lgkmcnt(3)
v_mfma_f32_32x32x16_bf16 v[144:159], v[96:99], v[40:43], v[144:159]
s_waitcnt lgkmcnt(2)
v_mfma_f32_32x32x16_bf16 v[160:175], v[100:103], v[40:43], v[160:175]
s_waitcnt lgkmcnt(1)
v_mfma_f32_32x32x16_bf16 v[144:159], v[104:107], v[44:47], v[144:159]
s_waitcnt lgkmcnt(0)
v_mfma_f32_32x32x16_bf16 v[160:175], v[108:111], v[44:47], v[160:175]
k2s_out:
s_nop 11
v_cvt_pk_bf16_f32 v48, v144, -v160
v_cvt_pk_bf16_f32 v49, v145, -v161
v_cvt_pk_bf16_f32 v50, v146, -v162
v_cvt_pk_bf16_f32 v51, v147, -v163
v_cvt_pk_bf16_f32 v52, v148, -v164
v_cvt_pk_bf16_f32 v53, v149, -v165
v_cvt_pk_bf16_f32 v54, v150, -v166
v_cvt_pk_bf16_f32 v55, v151, -v167
v_cvt_pk_bf16_f32 v56, v152, -v168
v_cvt_pk_bf16_f32 v57, v153, -v169
v_cvt_pk_bf16_f32 v58, v154, -v170
v_cvt_pk_bf16_f32 v59, v155, -v171
v_cvt_pk_bf16_f32 v60, v156, -v172
v_cvt_pk_bf16_f32 v61, v157, -v173
v_cvt_pk_bf16_f32 v62, v158, -v174
v_cvt_pk_bf16_f32 v63, v159, -v175
s_mov_b64 vcc, s[44:45]
v_cndmask_b32_dpp v144, v49, v48, vcc quad_perm:[1,0,3,2] row_mask:0xf bank_mask:0xf
v_cndmask_b32_dpp v146, v51, v50, vcc quad_perm:[1,0,3,2] row_mask:0xf bank_mask:0xf
v_cndmask_b32_dpp v148, v53, v52, vcc quad_perm:[1,0,3,2] row_mask:0xf bank_mask:0xf
v_cndmask_b32_dpp v150, v55, v54, vcc quad_perm:[1,0,3,2] row_mask:0xf bank_mask:0xf
v_cndmask_b32_dpp v152, v57, v56, vcc quad_perm:[1,0,3,2] row_mask:0xf bank_mask:0xf
v_cndmask_b32_dpp v154, v59, v58, vcc quad_perm:[1,0,3,2] row_mask:0xf bank_mask:0xf
v_cndmask_b32_dpp v156, v61, v60, vcc quad_perm:[1,0,3,2] row_mask:0xf bank_mask:0xf
v_cndmask_b32_dpp v158, v63, v62, vcc quad_perm:[1,0,3,2] row_mask:0xf bank_mask:0xf
s_not_b64 vcc, vcc
v_cndmask_b32_dpp v145, v48, v49, vcc quad_perm:[1,0,3,2] row_mask:0xf bank_mask:0xf
v_cndmask_b32_dpp v147, v50, v51, vcc quad_perm:[1,0,3,2] row_mask:0xf bank_mask:0xf
v_cndmask_b32_dpp v149, v52, v53, vcc quad_perm:[1,0,3,2] row_mask:0xf bank_mask:0xf
v_cndmask_b32_dpp v151, v54, v55, vcc quad_perm:[1,0,3,2] row_mask:0xf bank_mask:0xf
v_cndmask_b32_dpp v153, v56, v57, vcc quad_perm:[1,0,3,2] row_mask:0xf bank_mask:0xf
v_cndmask_b32_dpp v155, v58, v59, vcc quad_perm:[1,0,3,2] row_mask:0xf bank_mask:0xf
v_cndmask_b32_dpp v157, v60, v61, vcc quad_perm:[1,0,3,2] row_mask:0xf bank_mask:0xf
v_cndmask_b32_dpp v159, v62, v63, vcc quad_perm:[1,0,3,2] row_mask:0xf bank_mask:0xf
s_mov_b64 vcc, s[46:47]
v_cndmask_b32_dpp v48, v146, v144, vcc quad_perm:[2,3,0,1] row_mask:0xf bank_mask:0xf
v_cndmask_b32_dpp v49, v147, v145, vcc quad_perm:[2,3,0,1] row_mask:0xf bank_mask:0xf
v_cndmask_b32_dpp v52, v150, v148, vcc quad_perm:[2,3,0,1] row_mask:0xf bank_mask:0xf
v_cndmask_b32_dpp v53, v151, v149, vcc quad_perm:[2,3,0,1] row_mask:0xf bank_mask:0xf
v_cndmask_b32_dpp v56, v154, v152, vcc quad_perm:[2,3,0,1] row_mask:0xf bank_mask:0xf
v_cndmask_b32_dpp v57, v155, v153, vcc quad_perm:[2,3,0,1] row_mask:0xf bank_mask:0xf
v_cndmask_b32_dpp v60, v158, v156, vcc quad_perm:[2,3,0,1] row_mask:0xf bank_mask:0xf
v_cndmask_b32_dpp v61, v159, v157, vcc quad_perm:[2,3,0,1] row_mask:0xf bank_mask:0xf
s_not_b64 vcc, vcc
v_cndmask_b32_dpp v50, v144, v146, vcc quad_perm:[2,3,0,1] row_mask:0xf bank_mask:0xf
v_cndmask_b32_dpp v51, v145, v147, vcc quad_perm:[2,3,0,1] row_mask:0xf bank_mask:0xf
v_cndmask_b32_dpp v54, v148, v150, vcc quad_perm:[2,3,0,1] row_mask:0xf bank_mask:0xf
v_cndmask_b32_dpp v55, v149, v151, vcc quad_perm:[2,3,0,1] row_mask:0xf bank_mask:0xf
v_cndmask_b32_dpp v58, v152, v154, vcc quad_perm:[2,3,0,1] row_mask:0xf bank_mask:0xf
v_cndmask_b32_dpp v59, v153, v155, vcc quad_perm:[2,3,0,1] row_mask:0xf bank_mask:0xf
v_cndmask_b32_dpp v62, v156, v158, vcc quad_perm:[2,3,0,1] row_mask:0xf bank_mask:0xf
v_cndmask_b32_dpp v63, v157, v159, vcc quad_perm:[2,3,0,1] row_mask:0xf bank_mask:0xf
s_mul_i32 s37, s36, 1179648
s_add_u32 s27, s24, s37
s_add_u32 s27, s27, 2490368
s_add_u32 s28, s27, 0
buffer_store_dwordx4 v[48:51], v13, s[8:11], s28 offen sc1
s_add_u32 s28, s27, 294912
buffer_store_dwordx4 v[52:55], v13, s[8:11], s28 offen sc1
s_add_u32 s28, s27, 589824
buffer_store_dwordx4 v[56:59], v13, s[8:11], s28 offen sc1
s_add_u32 s28, s27, 884736
buffer_store_dwordx4 v[60:63], v13, s[8:11], s28 offen sc1
s_branch k2s_end
k2s_k0:
s_cmp_lg_u32 s23, 0
s_cbranch_scc1 k2s_k0n
s_lshl_b32 s37, s36, 13
v_lshlrev_b32 v17, 2, v3
v_lshl_add_u32 v17, v4, 10, v17
v_add_u32 v17, 49152, v17
v_add_u32 v18, s37, v17
ds_write2st64_b32 v18, v112, v128 offset0:0 offset1:65
ds_write2st64_b32 v18, v113, v129 offset0:1 offset1:66
ds_write2st64_b32 v18, v114, v130 offset0:2 offset1:67
ds_write2st64_b32 v18, v115, v131 offset0:3 offset1:68
ds_write2st64_b32 v18, v116, v132 offset0:8 offset1:73
ds_write2st64_b32 v18, v117, v133 offset0:9 offset1:74
ds_write2st64_b32 v18, v118, v134 offset0:10 offset1:75
ds_write2st64_b32 v18, v119, v135 offset0:11 offset1:76
ds_write2st64_b32 v18, v120, v136 offset0:16 offset1:81
ds_write2st64_b32 v18, v121, v137 offset0:17 offset1:82
ds_write2st64_b32 v18, v122, v138 offset0:18 offset1:83
ds_write2st64_b32 v18, v123, v139 offset0:19 offset1:84
ds_write2st64_b32 v18, v124, v140 offset0:24 offset1:89
ds_write2st64_b32 v18, v125, v141 offset0:25 offset1:90
ds_write2st64_b32 v18, v126, v142 offset0:26 offset1:91
ds_write2st64_b32 v18, v127, v143 offset0:27 offset1:92
s_cmp_lg_u32 s36, 0
s_cbranch_scc1 k2s_k0c
v_cmp_eq_u32 vcc, 0, v4
s_and_saveexec_b64 s[40:41], vcc
ds_write2st64_b32 v17, v112, v128 offset0:64 offset1:129
s_mov_b64 exec, s[40:41]
k2s_k0c:
s_waitcnt lgkmcnt(0)
s_barrier
v_sub_u32 v19, 32, v3
v_and_b32 v19, 31, v19
v_lshlrev_b32 v19, 2, v19
v_add_u32 v19, 49152, v19
v_cmp_eq_u32 vcc, 0, v3
v_mov_b32 v20, 256
s_nop 0
v_cndmask_b32 v20, 0, v20, vcc
v_add_u32 v19, v19, v20
v_lshlrev_b32 v20, 10, v4
v_sub_u32 v19, v19, v20
v_subrev_u32 v19, s37, v19
ds_read2st64_b32 v[176:177], v19 offset0:63 offset1:128
ds_read2st64_b32 v[178:179], v19 offset0:62 offset1:127
ds_read2st64_b32 v[180:181], v19 offset0:61 offset1:126
ds_read2st64_b32 v[182:183], v19 offset0:60 offset1:125
ds_read2st64_b32 v[184:185], v19 offset0:55 offset1:120
ds_read2st64_b32 v[186:187], v19 offset0:54 offset1:119
ds_read2st64_b32 v[188:189], v19 offset0:53 offset1:118
ds_read2st64_b32 v[190:191], v19 offset0:52 offset1:117
ds_read2st64_b32 v[192:193], v19 offset0:47 offset1:112
ds_read2st64_b32 v[194:195], v19 offset0:46 offset1:111
ds_read2st64_b32 v[196:197], v19 offset0:45 offset1:110
ds_read2st64_b32 v[198:199], v19 offset0:44 offset1:109
ds_read2st64_b32 v[200:201], v19 offset0:39 offset1:104
ds_read2st64_b32 v[202:203], v19 offset0:38 offset1:103
ds_read2st64_b32 v[204:205], v19 offset0:37 offset1:102
ds_read2st64_b32 v[206:207], v19 offset0:36 offset1:101
s_waitcnt lgkmcnt(0)
v_lshlrev_b32 v240, 16, v48
v_and_b32 v241, 0xffff0000, v48
v_lshlrev_b32 v242, 16, v64
v_and_b32 v243, 0xffff0000, v64
v_mul_f32 v244, v112, v240
v_mul_f32 v245, v112, v241
v_fma_f32 v244, -v128, v241, v244
v_fma_f32 v245, v128, v240, v245
v_fma_f32 v244, v176, v242, v244
v_fma_f32 v245, v176, v243, v245
v_fma_f32 v244, v177, v243, v244
v_fma_f32 v245, -v177, v242, v245
v_cvt_pk_bf16_f32 v16, v244, -v245
v_lshlrev_b32 v246, 16, v49
v_and_b32 v247, 0xffff0000, v49
v_lshlrev_b32 v248, 16, v65
v_and_b32 v249, 0xffff0000, v65
v_mul_f32 v250, v113, v246
v_mul_f32 v251, v113, v247
v_fma_f32 v250, -v129, v247, v250
v_fma_f32 v251, v129, v246, v251
v_fma_f32 v250, v178, v248, v250
v_fma_f32 v251, v178, v249, v251
v_fma_f32 v250, v179, v249, v250
v_fma_f32 v251, -v179, v248, v251
v_cvt_pk_bf16_f32 v17, v250, -v251
v_lshlrev_b32 v240, 16, v50
v_and_b32 v241, 0xffff0000, v50
v_lshlrev_b32 v242, 16, v66
v_and_b32 v243, 0xffff0000, v66
v_mul_f32 v244, v114, v240
v_mul_f32 v245, v114, v241
v_fma_f32 v244, -v130, v241, v244
v_fma_f32 v245, v130, v240, v245
v_fma_f32 v244, v180, v242, v244
v_fma_f32 v245, v180, v243, v245
v_fma_f32 v244, v181, v243, v244
v_fma_f32 v245, -v181, v242, v245
v_cvt_pk_bf16_f32 v18, v244, -v245
v_lshlrev_b32 v246, 16, v51
v_and_b32 v247, 0xffff0000, v51
v_lshlrev_b32 v248, 16, v67
v_and_b32 v249, 0xffff0000, v67
v_mul_f32 v250, v115, v246
v_mul_f32 v251, v115, v247
v_fma_f32 v250, -v131, v247, v250
v_fma_f32 v251, v131, v246, v251
v_fma_f32 v250, v182, v248, v250
v_fma_f32 v251, v182, v249, v251
v_fma_f32 v250, v183, v249, v250
v_fma_f32 v251, -v183, v248, v251
v_cvt_pk_bf16_f32 v19, v250, -v251
v_lshlrev_b32 v240, 16, v52
v_and_b32 v241, 0xffff0000, v52
v_lshlrev_b32 v242, 16, v68
v_and_b32 v243, 0xffff0000, v68
v_mul_f32 v244, v116, v240
v_mul_f32 v245, v116, v241
v_fma_f32 v244, -v132, v241, v244
v_fma_f32 v245, v132, v240, v245
v_fma_f32 v244, v184, v242, v244
v_fma_f32 v245, v184, v243, v245
v_fma_f32 v244, v185, v243, v244
v_fma_f32 v245, -v185, v242, v245
v_cvt_pk_bf16_f32 v20, v244, -v245
v_lshlrev_b32 v246, 16, v53
v_and_b32 v247, 0xffff0000, v53
v_lshlrev_b32 v248, 16, v69
v_and_b32 v249, 0xffff0000, v69
v_mul_f32 v250, v117, v246
v_mul_f32 v251, v117, v247
v_fma_f32 v250, -v133, v247, v250
v_fma_f32 v251, v133, v246, v251
v_fma_f32 v250, v186, v248, v250
v_fma_f32 v251, v186, v249, v251
v_fma_f32 v250, v187, v249, v250
v_fma_f32 v251, -v187, v248, v251
v_cvt_pk_bf16_f32 v21, v250, -v251
v_lshlrev_b32 v240, 16, v54
v_and_b32 v241, 0xffff0000, v54
v_lshlrev_b32 v242, 16, v70
v_and_b32 v243, 0xffff0000, v70
v_mul_f32 v244, v118, v240
v_mul_f32 v245, v118, v241
v_fma_f32 v244, -v134, v241, v244
v_fma_f32 v245, v134, v240, v245
v_fma_f32 v244, v188, v242, v244
v_fma_f32 v245, v188, v243, v245
v_fma_f32 v244, v189, v243, v244
v_fma_f32 v245, -v189, v242, v245
v_cvt_pk_bf16_f32 v22, v244, -v245
v_lshlrev_b32 v246, 16, v55
v_and_b32 v247, 0xffff0000, v55
v_lshlrev_b32 v248, 16, v71
v_and_b32 v249, 0xffff0000, v71
v_mul_f32 v250, v119, v246
v_mul_f32 v251, v119, v247
v_fma_f32 v250, -v135, v247, v250
v_fma_f32 v251, v135, v246, v251
v_fma_f32 v250, v190, v248, v250
v_fma_f32 v251, v190, v249, v251
v_fma_f32 v250, v191, v249, v250
v_fma_f32 v251, -v191, v248, v251
v_cvt_pk_bf16_f32 v23, v250, -v251
v_lshlrev_b32 v240, 16, v56
v_and_b32 v241, 0xffff0000, v56
v_lshlrev_b32 v242, 16, v72
v_and_b32 v243, 0xffff0000, v72
v_mul_f32 v244, v120, v240
v_mul_f32 v245, v120, v241
v_fma_f32 v244, -v136, v241, v244
v_fma_f32 v245, v136, v240, v245
v_fma_f32 v244, v192, v242, v244
v_fma_f32 v245, v192, v243, v245
v_fma_f32 v244, v193, v243, v244
v_fma_f32 v245, -v193, v242, v245
v_cvt_pk_bf16_f32 v24, v244, -v245
v_lshlrev_b32 v246, 16, v57
v_and_b32 v247, 0xffff0000, v57
v_lshlrev_b32 v248, 16, v73
v_and_b32 v249, 0xffff0000, v73
v_mul_f32 v250, v121, v246
v_mul_f32 v251, v121, v247
v_fma_f32 v250, -v137, v247, v250
v_fma_f32 v251, v137, v246, v251
v_fma_f32 v250, v194, v248, v250
v_fma_f32 v251, v194, v249, v251
v_fma_f32 v250, v195, v249, v250
v_fma_f32 v251, -v195, v248, v251
v_cvt_pk_bf16_f32 v25, v250, -v251
v_lshlrev_b32 v240, 16, v58
v_and_b32 v241, 0xffff0000, v58
v_lshlrev_b32 v242, 16, v74
v_and_b32 v243, 0xffff0000, v74
v_mul_f32 v244, v122, v240
v_mul_f32 v245, v122, v241
v_fma_f32 v244, -v138, v241, v244
v_fma_f32 v245, v138, v240, v245
v_fma_f32 v244, v196, v242, v244
v_fma_f32 v245, v196, v243, v245
v_fma_f32 v244, v197, v243, v244
v_fma_f32 v245, -v197, v242, v245
v_cvt_pk_bf16_f32 v26, v244, -v245
v_lshlrev_b32 v246, 16, v59
v_and_b32 v247, 0xffff0000, v59
v_lshlrev_b32 v248, 16, v75
v_and_b32 v249, 0xffff0000, v75
v_mul_f32 v250, v123, v246
v_mul_f32 v251, v123, v247
v_fma_f32 v250, -v139, v247, v250
v_fma_f32 v251, v139, v246, v251
v_fma_f32 v250, v198, v248, v250
v_fma_f32 v251, v198, v249, v251
v_fma_f32 v250, v199, v249, v250
v_fma_f32 v251, -v199, v248, v251
v_cvt_pk_bf16_f32 v27, v250, -v251
v_lshlrev_b32 v240, 16, v60
v_and_b32 v241, 0xffff0000, v60
v_lshlrev_b32 v242, 16, v76
v_and_b32 v243, 0xffff0000, v76
v_mul_f32 v244, v124, v240
v_mul_f32 v245, v124, v241
v_fma_f32 v244, -v140, v241, v244
v_fma_f32 v245, v140, v240, v245
v_fma_f32 v244, v200, v242, v244
v_fma_f32 v245, v200, v243, v245
v_fma_f32 v244, v201, v243, v244
v_fma_f32 v245, -v201, v242, v245
v_cvt_pk_bf16_f32 v28, v244, -v245
v_lshlrev_b32 v246, 16, v61
v_and_b32 v247, 0xffff0000, v61
v_lshlrev_b32 v248, 16, v77
v_and_b32 v249, 0xffff0000, v77
v_mul_f32 v250, v125, v246
v_mul_f32 v251, v125, v247
v_fma_f32 v250, -v141, v247, v250
v_fma_f32 v251, v141, v246, v251
v_fma_f32 v250, v202, v248, v250
v_fma_f32 v251, v202, v249, v251
v_fma_f32 v250, v203, v249, v250
v_fma_f32 v251, -v203, v248, v251
v_cvt_pk_bf16_f32 v29, v250, -v251
v_lshlrev_b32 v240, 16, v62
v_and_b32 v241, 0xffff0000, v62
v_lshlrev_b32 v242, 16, v78
v_and_b32 v243, 0xffff0000, v78
v_mul_f32 v244, v126, v240
v_mul_f32 v245, v126, v241
v_fma_f32 v244, -v142, v241, v244
v_fma_f32 v245, v142, v240, v245
v_fma_f32 v244, v204, v242, v244
v_fma_f32 v245, v204, v243, v245
v_fma_f32 v244, v205, v243, v244
v_fma_f32 v245, -v205, v242, v245
v_cvt_pk_bf16_f32 v30, v244, -v245
v_lshlrev_b32 v246, 16, v63
v_and_b32 v247, 0xffff0000, v63
v_lshlrev_b32 v248, 16, v79
v_and_b32 v249, 0xffff0000, v79
v_mul_f32 v250, v127, v246
v_mul_f32 v251, v127, v247
v_fma_f32 v250, -v143, v247, v250
v_fma_f32 v251, v143, v246, v251
v_fma_f32 v250, v206, v248, v250
v_fma_f32 v251, v206, v249, v251
v_fma_f32 v250, v207, v249, v250
v_fma_f32 v251, -v207, v248, v251
v_cvt_pk_bf16_f32 v31, v250, -v251
s_nop 1
s_branch k2s_xchg
k2s_k0n:
s_barrier
v_lshlrev_b32 v240, 16, v48
v_and_b32 v241, 0xffff0000, v48
v_mul_f32 v242, v112, v240
v_mul_f32 v243, v112, v241
v_fma_f32 v242, -v128, v241, v242
v_fma_f32 v243, v128, v240, v243
v_cvt_pk_bf16_f32 v16, v242, -v243
v_lshlrev_b32 v244, 16, v49
v_and_b32 v245, 0xffff0000, v49
v_mul_f32 v246, v113, v244
v_mul_f32 v247, v113, v245
v_fma_f32 v246, -v129, v245, v246
v_fma_f32 v247, v129, v244, v247
v_cvt_pk_bf16_f32 v17, v246, -v247
v_lshlrev_b32 v240, 16, v50
v_and_b32 v241, 0xffff0000, v50
v_mul_f32 v242, v114, v240
v_mul_f32 v243, v114, v241
v_fma_f32 v242, -v130, v241, v242
v_fma_f32 v243, v130, v240, v243
v_cvt_pk_bf16_f32 v18, v242, -v243
v_lshlrev_b32 v244, 16, v51
v_and_b32 v245, 0xffff0000, v51
v_mul_f32 v246, v115, v244
v_mul_f32 v247, v115, v245
v_fma_f32 v246, -v131, v245, v246
v_fma_f32 v247, v131, v244, v247
v_cvt_pk_bf16_f32 v19, v246, -v247
v_lshlrev_b32 v240, 16, v52
v_and_b32 v241, 0xffff0000, v52
v_mul_f32 v242, v116, v240
v_mul_f32 v243, v116, v241
v_fma_f32 v242, -v132, v241, v242
v_fma_f32 v243, v132, v240, v243
v_cvt_pk_bf16_f32 v20, v242, -v243
v_lshlrev_b32 v244, 16, v53
v_and_b32 v245, 0xffff0000, v53
v_mul_f32 v246, v117, v244
v_mul_f32 v247, v117, v245
v_fma_f32 v246, -v133, v245, v246
v_fma_f32 v247, v133, v244, v247
v_cvt_pk_bf16_f32 v21, v246, -v247
v_lshlrev_b32 v240, 16, v54
v_and_b32 v241, 0xffff0000, v54
v_mul_f32 v242, v118, v240
v_mul_f32 v243, v118, v241
v_fma_f32 v242, -v134, v241, v242
v_fma_f32 v243, v134, v240, v243
v_cvt_pk_bf16_f32 v22, v242, -v243
v_lshlrev_b32 v244, 16, v55
v_and_b32 v245, 0xffff0000, v55
v_mul_f32 v246, v119, v244
v_mul_f32 v247, v119, v245
v_fma_f32 v246, -v135, v245, v246
v_fma_f32 v247, v135, v244, v247
v_cvt_pk_bf16_f32 v23, v246, -v247
v_lshlrev_b32 v240, 16, v56
v_and_b32 v241, 0xffff0000, v56
v_mul_f32 v242, v120, v240
v_mul_f32 v243, v120, v241
v_fma_f32 v242, -v136, v241, v242
v_fma_f32 v243, v136, v240, v243
v_cvt_pk_bf16_f32 v24, v242, -v243
v_lshlrev_b32 v244, 16, v57
v_and_b32 v245, 0xffff0000, v57
v_mul_f32 v246, v121, v244
v_mul_f32 v247, v121, v245
v_fma_f32 v246, -v137, v245, v246
v_fma_f32 v247, v137, v244, v247
v_cvt_pk_bf16_f32 v25, v246, -v247
v_lshlrev_b32 v240, 16, v58
v_and_b32 v241, 0xffff0000, v58
v_mul_f32 v242, v122, v240
v_mul_f32 v243, v122, v241
v_fma_f32 v242, -v138, v241, v242
v_fma_f32 v243, v138, v240, v243
v_cvt_pk_bf16_f32 v26, v242, -v243
v_lshlrev_b32 v244, 16, v59
v_and_b32 v245, 0xffff0000, v59
v_mul_f32 v246, v123, v244
v_mul_f32 v247, v123, v245
v_fma_f32 v246, -v139, v245, v246
v_fma_f32 v247, v139, v244, v247
v_cvt_pk_bf16_f32 v27, v246, -v247
v_lshlrev_b32 v240, 16, v60
v_and_b32 v241, 0xffff0000, v60
v_mul_f32 v242, v124, v240
v_mul_f32 v243, v124, v241
v_fma_f32 v242, -v140, v241, v242
v_fma_f32 v243, v140, v240, v243
v_cvt_pk_bf16_f32 v28, v242, -v243
v_lshlrev_b32 v244, 16, v61
v_and_b32 v245, 0xffff0000, v61
v_mul_f32 v246, v125, v244
v_mul_f32 v247, v125, v245
v_fma_f32 v246, -v141, v245, v246
v_fma_f32 v247, v141, v244, v247
v_cvt_pk_bf16_f32 v29, v246, -v247
v_lshlrev_b32 v240, 16, v62
v_and_b32 v241, 0xffff0000, v62
v_mul_f32 v242, v126, v240
v_mul_f32 v243, v126, v241
v_fma_f32 v242, -v142, v241, v242
v_fma_f32 v243, v142, v240, v243
v_cvt_pk_bf16_f32 v30, v242, -v243
v_lshlrev_b32 v244, 16, v63
v_and_b32 v245, 0xffff0000, v63
v_mul_f32 v246, v127, v244
v_mul_f32 v247, v127, v245
v_fma_f32 v246, -v143, v245, v246
v_fma_f32 v247, v143, v244, v247
v_cvt_pk_bf16_f32 v31, v246, -v247
s_nop 1
s_branch k2s_xchg
k2s_end:
s_lshl_b32 s52, s2, 2
s_add_u32 s52, s52, 39849984
s_waitcnt vmcnt(0) lgkmcnt(0)
s_barrier
s_cmp_lg_u32 s22, 0
s_cbranch_scc1 sig_17
v_mov_b32 v10, s96
v_and_b32 v11, 63, v0
v_mul_u32_u24 v11, 1024, v11
s_mov_b64 exec, 255
buffer_store_dword v10, v11, s[8:11], s52 offen sc1
s_mov_b64 exec, -1
sig_17:
s_branch P3_genB
s_nop 7
s_nop 7
P3_genB:
v_lshrrev_b32 v2, 6, v0
v_and_b32 v1, 63, v0
s_nop 0
v_readfirstlane_b32 s22, v2
v_and_b32 v3, 15, v1
v_lshrrev_b32 v4, 4, v1
s_and_b32 s23, s2, 31
s_lshr_b32 s24, s2, 5
s_lshr_b32 s25, s22, 1
s_lshl_b32 s27, s23, 1
s_add_u32 s27, s27, s25
s_mul_i32 s32, s24, 3
s_add_u32 s32, s32, s22
v_cvt_f32_u32 v72, v3
v_cvt_f32_u32 v73, v4
v_mul_f32 v73, 4.0, v73
v_cvt_f32_u32 v74, s27
s_cmp_eq_u32 s22, 3
s_cbranch_scc1 p3gb_done
s_lshl_b32 s36, s32, 5
s_add_u32 s36, s36, 0
v_lshrrev_b32 v78, 2, v3
v_lshlrev_b32 v78, 3, v78
v_and_b32 v79, 3, v3
v_add3_u32 v78, v78, v79, s36
v_cvt_f32_u32 v78, v78
v_mul_f32 v78, 0x3ae38e39, v78
v_cos_f32 v80, v78
v_sin_f32 v81, v78
v_mul_f32 v79, 0x41800000, v78
v_fract_f32 v79, v79
v_cos_f32 v82, v79
v_sin_f32 v83, v79
v_mul_f32 v79, v78, v73
v_fract_f32 v79, v79
v_cos_f32 v84, v79
v_sin_f32 v85, v79
v_add_f32 v86, v80, v80
v_mul_f32 v84, 0x35e38e39, v84
v_mul_f32 v85, 0x35e38e39, v85
v_pk_mul_f32 v[94:95], v[84:85], v[80:81] op_sel:[0,0] op_sel_hi:[1,0]
v_pk_fma_f32 v[88:89], v[84:85], v[80:81], v[94:95] op_sel:[1,1,0] op_sel_hi:[0,1,1] neg_lo:[1,0,0]
v_pk_fma_f32 v[90:91], v[88:89], v[86:87], v[84:85] op_sel:[0,0,0] op_sel_hi:[1,0,1] neg_lo:[0,0,1] neg_hi:[0,0,1]
v_pk_fma_f32 v[92:93], v[90:91], v[86:87], v[88:89] op_sel:[0,0,0] op_sel_hi:[1,0,1] neg_lo:[0,0,1] neg_hi:[0,0,1]
v_cvt_pk_bf16_f32 v98, v84, -v85
v_cvt_pk_bf16_f32 v99, v88, -v89
v_cvt_pk_bf16_f32 v100, v90, -v91
v_cvt_pk_bf16_f32 v101, v92, -v93
v_and_b32 v94, 1, v3
v_lshlrev_b32 v94, 31, v94
v_or_b32 v94, 0x35643564, v94
v_cmp_eq_u32 vcc, 0, v4
s_nop 1
v_cndmask_b32 v98, v98, v94, vcc
v_accvgpr_write_b32 a0, v98
v_accvgpr_write_b32 a1, v99
v_accvgpr_write_b32 a2, v100
v_accvgpr_write_b32 a3, v101
v_pk_mul_f32 v[94:95], v[84:85], v[82:83] op_sel:[0,0] op_sel_hi:[1,0]
v_pk_fma_f32 v[84:85], v[84:85], v[82:83], v[94:95] op_sel:[1,1,0] op_sel_hi:[0,1,1] neg_lo:[1,0,0]
v_pk_mul_f32 v[94:95], v[84:85], v[80:81] op_sel:[0,0] op_sel_hi:[1,0]
v_pk_fma_f32 v[88:89], v[84:85], v[80:81], v[94:95] op_sel:[1,1,0] op_sel_hi:[0,1,1] neg_lo:[1,0,0]
v_pk_fma_f32 v[90:91], v[88:89], v[86:87], v[84:85] op_sel:[0,0,0] op_sel_hi:[1,0,1] neg_lo:[0,0,1] neg_hi:[0,0,1]
v_pk_fma_f32 v[92:93], v[90:91], v[86:87], v[88:89] op_sel:[0,0,0] op_sel_hi:[1,0,1] neg_lo:[0,0,1] neg_hi:[0,0,1]
v_cvt_pk_bf16_f32 v98, v84, -v85
v_cvt_pk_bf16_f32 v99, v88, -v89
v_cvt_pk_bf16_f32 v100, v90, -v91
v_cvt_pk_bf16_f32 v101, v92, -v93
v_accvgpr_write_b32 a4, v98
v_accvgpr_write_b32 a5, v99
v_accvgpr_write_b32 a6, v100
v_accvgpr_write_b32 a7, v101
v_pk_mul_f32 v[94:95], v[84:85], v[82:83] op_sel:[0,0] op_sel_hi:[1,0]
v_pk_fma_f32 v[84:85], v[84:85], v[82:83], v[94:95] op_sel:[1,1,0] op_sel_hi:[0,1,1] neg_lo:[1,0,0]
v_pk_mul_f32 v[94:95], v[84:85], v[80:81] op_sel:[0,0] op_sel_hi:[1,0]
v_pk_fma_f32 v[88:89], v[84:85], v[80:81], v[94:95] op_sel:[1,1,0] op_sel_hi:[0,1,1] neg_lo:[1,0,0]
v_pk_fma_f32 v[90:91], v[88:89], v[86:87], v[84:85] op_sel:[0,0,0] op_sel_hi:[1,0,1] neg_lo:[0,0,1] neg_hi:[0,0,1]
v_pk_fma_f32 v[92:93], v[90:91], v[86:87], v[88:89] op_sel:[0,0,0] op_sel_hi:[1,0,1] neg_lo:[0,0,1] neg_hi:[0,0,1]
v_cvt_pk_bf16_f32 v98, v84, -v85
v_cvt_pk_bf16_f32 v99, v88, -v89
v_cvt_pk_bf16_f32 v100, v90, -v91
v_cvt_pk_bf16_f32 v101, v92, -v93
v_accvgpr_write_b32 a8, v98
v_accvgpr_write_b32 a9, v99
v_accvgpr_write_b32 a10, v100
v_accvgpr_write_b32 a11, v101
v_pk_mul_f32 v[94:95], v[84:85], v[82:83] op_sel:[0,0] op_sel_hi:[1,0]
v_pk_fma_f32 v[84:85], v[84:85], v[82:83], v[94:95] op_sel:[1,1,0] op_sel_hi:[0,1,1] neg_lo:[1,0,0]
v_pk_mul_f32 v[94:95], v[84:85], v[80:81] op_sel:[0,0] op_sel_hi:[1,0]
v_pk_fma_f32 v[88:89], v[84:85], v[80:81], v[94:95] op_sel:[1,1,0] op_sel_hi:[0,1,1] neg_lo:[1,0,0]
v_pk_fma_f32 v[90:91], v[88:89], v[86:87], v[84:85] op_sel:[0,0,0] op_sel_hi:[1,0,1] neg_lo:[0,0,1] neg_hi:[0,0,1]
v_pk_fma_f32 v[92:93], v[90:91], v[86:87], v[88:89] op_sel:[0,0,0] op_sel_hi:[1,0,1] neg_lo:[0,0,1] neg_hi:[0,0,1]
v_cvt_pk_bf16_f32 v98, v84, -v85
v_cvt_pk_bf16_f32 v99, v88, -v89
v_cvt_pk_bf16_f32 v100, v90, -v91
v_cvt_pk_bf16_f32 v101, v92, -v93
v_accvgpr_write_b32 a12, v98
v_accvgpr_write_b32 a13, v99
v_accvgpr_write_b32 a14, v100
v_accvgpr_write_b32 a15, v101
v_pk_mul_f32 v[94:95], v[84:85], v[82:83] op_sel:[0,0] op_sel_hi:[1,0]
v_pk_fma_f32 v[84:85], v[84:85], v[82:83], v[94:95] op_sel:[1,1,0] op_sel_hi:[0,1,1] neg_lo:[1,0,0]
v_pk_mul_f32 v[94:95], v[84:85], v[80:81] op_sel:[0,0] op_sel_hi:[1,0]
v_pk_fma_f32 v[88:89], v[84:85], v[80:81], v[94:95] op_sel:[1,1,0] op_sel_hi:[0,1,1] neg_lo:[1,0,0]
v_pk_fma_f32 v[90:91], v[88:89], v[86:87], v[84:85] op_sel:[0,0,0] op_sel_hi:[1,0,1] neg_lo:[0,0,1] neg_hi:[0,0,1]
v_pk_fma_f32 v[92:93], v[90:91], v[86:87], v[88:89] op_sel:[0,0,0] op_sel_hi:[1,0,1] neg_lo:[0,0,1] neg_hi:[0,0,1]
v_cvt_pk_bf16_f32 v98, v84, -v85
v_cvt_pk_bf16_f32 v99, v88, -v89
v_cvt_pk_bf16_f32 v100, v90, -v91
v_cvt_pk_bf16_f32 v101, v92, -v93
v_accvgpr_write_b32 a16, v98
v_accvgpr_write_b32 a17, v99
v_accvgpr_write_b32 a18, v100
v_accvgpr_write_b32 a19, v101
v_pk_mul_f32 v[94:95], v[84:85], v[82:83] op_sel:[0,0] op_sel_hi:[1,0]
v_pk_fma_f32 v[84:85], v[84:85], v[82:83], v[94:95] op_sel:[1,1,0] op_sel_hi:[0,1,1] neg_lo:[1,0,0]
v_pk_mul_f32 v[94:95], v[84:85], v[80:81] op_sel:[0,0] op_sel_hi:[1,0]
v_pk_fma_f32 v[88:89], v[84:85], v[80:81], v[94:95] op_sel:[1,1,0] op_sel_hi:[0,1,1] neg_lo:[1,0,0]
v_pk_fma_f32 v[90:91], v[88:89], v[86:87], v[84:85] op_sel:[0,0,0] op_sel_hi:[1,0,1] neg_lo:[0,0,1] neg_hi:[0,0,1]
v_pk_fma_f32 v[92:93], v[90:91], v[86:87], v[88:89] op_sel:[0,0,0] op_sel_hi:[1,0,1] neg_lo:[0,0,1] neg_hi:[0,0,1]
v_cvt_pk_bf16_f32 v98, v84, -v85
v_cvt_pk_bf16_f32 v99, v88, -v89
v_cvt_pk_bf16_f32 v100, v90, -v91
v_cvt_pk_bf16_f32 v101, v92, -v93
v_accvgpr_write_b32 a20, v98
v_accvgpr_write_b32 a21, v99
v_accvgpr_write_b32 a22, v100
v_accvgpr_write_b32 a23, v101
v_pk_mul_f32 v[94:95], v[84:85], v[82:83] op_sel:[0,0] op_sel_hi:[1,0]
v_pk_fma_f32 v[84:85], v[84:85], v[82:83], v[94:95] op_sel:[1,1,0] op_sel_hi:[0,1,1] neg_lo:[1,0,0]
v_pk_mul_f32 v[94:95], v[84:85], v[80:81] op_sel:[0,0] op_sel_hi:[1,0]
v_pk_fma_f32 v[88:89], v[84:85], v[80:81], v[94:95] op_sel:[1,1,0] op_sel_hi:[0,1,1] neg_lo:[1,0,0]
v_pk_fma_f32 v[90:91], v[88:89], v[86:87], v[84:85] op_sel:[0,0,0] op_sel_hi:[1,0,1] neg_lo:[0,0,1] neg_hi:[0,0,1]
v_pk_fma_f32 v[92:93], v[90:91], v[86:87], v[88:89] op_sel:[0,0,0] op_sel_hi:[1,0,1] neg_lo:[0,0,1] neg_hi:[0,0,1]
v_cvt_pk_bf16_f32 v98, v84, -v85
v_cvt_pk_bf16_f32 v99, v88, -v89
v_cvt_pk_bf16_f32 v100, v90, -v91
v_cvt_pk_bf16_f32 v101, v92, -v93
v_accvgpr_write_b32 a24, v98
v_accvgpr_write_b32 a25, v99
v_accvgpr_write_b32 a26, v100
v_accvgpr_write_b32 a27, v101
v_pk_mul_f32 v[94:95], v[84:85], v[82:83] op_sel:[0,0] op_sel_hi:[1,0]
v_pk_fma_f32 v[84:85], v[84:85], v[82:83], v[94:95] op_sel:[1,1,0] op_sel_hi:[0,1,1] neg_lo:[1,0,0]
v_pk_mul_f32 v[94:95], v[84:85], v[80:81] op_sel:[0,0] op_sel_hi:[1,0]
v_pk_fma_f32 v[88:89], v[84:85], v[80:81], v[94:95] op_sel:[1,1,0] op_sel_hi:[0,1,1] neg_lo:[1,0,0]
v_pk_fma_f32 v[90:91], v[88:89], v[86:87], v[84:85] op_sel:[0,0,0] op_sel_hi:[1,0,1] neg_lo:[0,0,1] neg_hi:[0,0,1]
v_pk_fma_f32 v[92:93], v[90:91], v[86:87], v[88:89] op_sel:[0,0,0] op_sel_hi:[1,0,1] neg_lo:[0,0,1] neg_hi:[0,0,1]
v_cvt_pk_bf16_f32 v98, v84, -v85
v_cvt_pk_bf16_f32 v99, v88, -v89
v_cvt_pk_bf16_f32 v100, v90, -v91
v_cvt_pk_bf16_f32 v101, v92, -v93
v_accvgpr_write_b32 a28, v98
v_accvgpr_write_b32 a29, v99
v_accvgpr_write_b32 a30, v100
v_accvgpr_write_b32 a31, v101
v_pk_mul_f32 v[94:95], v[84:85], v[82:83] op_sel:[0,0] op_sel_hi:[1,0]
v_pk_fma_f32 v[84:85], v[84:85], v[82:83], v[94:95] op_sel:[1,1,0] op_sel_hi:[0,1,1] neg_lo:[1,0,0]
v_pk_mul_f32 v[94:95], v[84:85], v[80:81] op_sel:[0,0] op_sel_hi:[1,0]
v_pk_fma_f32 v[88:89], v[84:85], v[80:81], v[94:95] op_sel:[1,1,0] op_sel_hi:[0,1,1] neg_lo:[1,0,0]
v_pk_fma_f32 v[90:91], v[88:89], v[86:87], v[84:85] op_sel:[0,0,0] op_sel_hi:[1,0,1] neg_lo:[0,0,1] neg_hi:[0,0,1]
v_pk_fma_f32 v[92:93], v[90:91], v[86:87], v[88:89] op_sel:[0,0,0] op_sel_hi:[1,0,1] neg_lo:[0,0,1] neg_hi:[0,0,1]
v_cvt_pk_bf16_f32 v98, v84, -v85
v_cvt_pk_bf16_f32 v99, v88, -v89
v_cvt_pk_bf16_f32 v100, v90, -v91
v_cvt_pk_bf16_f32 v101, v92, -v93
v_accvgpr_write_b32 a32, v98
v_accvgpr_write_b32 a33, v99
v_accvgpr_write_b32 a34, v100
v_accvgpr_write_b32 a35, v101
v_pk_mul_f32 v[94:95], v[84:85], v[82:83] op_sel:[0,0] op_sel_hi:[1,0]
v_pk_fma_f32 v[84:85], v[84:85], v[82:83], v[94:95] op_sel:[1,1,0] op_sel_hi:[0,1,1] neg_lo:[1,0,0]
v_pk_mul_f32 v[94:95], v[84:85], v[80:81] op_sel:[0,0] op_sel_hi:[1,0]
v_pk_fma_f32 v[88:89], v[84:85], v[80:81], v[94:95] op_sel:[1,1,0] op_sel_hi:[0,1,1] neg_lo:[1,0,0]
v_pk_fma_f32 v[90:91], v[88:89], v[86:87], v[84:85] op_sel:[0,0,0] op_sel_hi:[1,0,1] neg_lo:[0,0,1] neg_hi:[0,0,1]
v_pk_fma_f32 v[92:93], v[90:91], v[86:87], v[88:89] op_sel:[0,0,0] op_sel_hi:[1,0,1] neg_lo:[0,0,1] neg_hi:[0,0,1]
v_cvt_pk_bf16_f32 v98, v84, -v85
v_cvt_pk_bf16_f32 v99, v88, -v89
v_cvt_pk_bf16_f32 v100, v90, -v91
v_cvt_pk_bf16_f32 v101, v92, -v93
v_accvgpr_write_b32 a36, v98
v_accvgpr_write_b32 a37, v99
v_accvgpr_write_b32 a38, v100
v_accvgpr_write_b32 a39, v101
v_pk_mul_f32 v[94:95], v[84:85], v[82:83] op_sel:[0,0] op_sel_hi:[1,0]
v_pk_fma_f32 v[84:85], v[84:85], v[82:83], v[94:95] op_sel:[1,1,0] op_sel_hi:[0,1,1] neg_lo:[1,0,0]
v_pk_mul_f32 v[94:95], v[84:85], v[80:81] op_sel:[0,0] op_sel_hi:[1,0]
v_pk_fma_f32 v[88:89], v[84:85], v[80:81], v[94:95] op_sel:[1,1,0] op_sel_hi:[0,1,1] neg_lo:[1,0,0]
v_pk_fma_f32 v[90:91], v[88:89], v[86:87], v[84:85] op_sel:[0,0,0] op_sel_hi:[1,0,1] neg_lo:[0,0,1] neg_hi:[0,0,1]
v_pk_fma_f32 v[92:93], v[90:91], v[86:87], v[88:89] op_sel:[0,0,0] op_sel_hi:[1,0,1] neg_lo:[0,0,1] neg_hi:[0,0,1]
v_cvt_pk_bf16_f32 v98, v84, -v85
v_cvt_pk_bf16_f32 v99, v88, -v89
v_cvt_pk_bf16_f32 v100, v90, -v91
v_cvt_pk_bf16_f32 v101, v92, -v93
v_accvgpr_write_b32 a40, v98
v_accvgpr_write_b32 a41, v99
v_accvgpr_write_b32 a42, v100
v_accvgpr_write_b32 a43, v101
v_pk_mul_f32 v[94:95], v[84:85], v[82:83] op_sel:[0,0] op_sel_hi:[1,0]
v_pk_fma_f32 v[84:85], v[84:85], v[82:83], v[94:95] op_sel:[1,1,0] op_sel_hi:[0,1,1] neg_lo:[1,0,0]
v_pk_mul_f32 v[94:95], v[84:85], v[80:81] op_sel:[0,0] op_sel_hi:[1,0]
v_pk_fma_f32 v[88:89], v[84:85], v[80:81], v[94:95] op_sel:[1,1,0] op_sel_hi:[0,1,1] neg_lo:[1,0,0]
v_pk_fma_f32 v[90:91], v[88:89], v[86:87], v[84:85] op_sel:[0,0,0] op_sel_hi:[1,0,1] neg_lo:[0,0,1] neg_hi:[0,0,1]
v_pk_fma_f32 v[92:93], v[90:91], v[86:87], v[88:89] op_sel:[0,0,0] op_sel_hi:[1,0,1] neg_lo:[0,0,1] neg_hi:[0,0,1]
v_cvt_pk_bf16_f32 v98, v84, -v85
v_cvt_pk_bf16_f32 v99, v88, -v89
v_cvt_pk_bf16_f32 v100, v90, -v91
v_cvt_pk_bf16_f32 v101, v92, -v93
v_accvgpr_write_b32 a44, v98
v_accvgpr_write_b32 a45, v99
v_accvgpr_write_b32 a46, v100
v_accvgpr_write_b32 a47, v101
v_pk_mul_f32 v[94:95], v[84:85], v[82:83] op_sel:[0,0] op_sel_hi:[1,0]
v_pk_fma_f32 v[84:85], v[84:85], v[82:83], v[94:95] op_sel:[1,1,0] op_sel_hi:[0,1,1] neg_lo:[1,0,0]
v_pk_mul_f32 v[94:95], v[84:85], v[80:81] op_sel:[0,0] op_sel_hi:[1,0]
v_pk_fma_f32 v[88:89], v[84:85], v[80:81], v[94:95] op_sel:[1,1,0] op_sel_hi:[0,1,1] neg_lo:[1,0,0]
v_pk_fma_f32 v[90:91], v[88:89], v[86:87], v[84:85] op_sel:[0,0,0] op_sel_hi:[1,0,1] neg_lo:[0,0,1] neg_hi:[0,0,1]
v_pk_fma_f32 v[92:93], v[90:91], v[86:87], v[88:89] op_sel:[0,0,0] op_sel_hi:[1,0,1] neg_lo:[0,0,1] neg_hi:[0,0,1]
v_cvt_pk_bf16_f32 v98, v84, -v85
v_cvt_pk_bf16_f32 v99, v88, -v89
v_cvt_pk_bf16_f32 v100, v90, -v91
v_cvt_pk_bf16_f32 v101, v92, -v93
v_accvgpr_write_b32 a48, v98
v_accvgpr_write_b32 a49, v99
v_accvgpr_write_b32 a50, v100
v_accvgpr_write_b32 a51, v101
v_pk_mul_f32 v[94:95], v[84:85], v[82:83] op_sel:[0,0] op_sel_hi:[1,0]
v_pk_fma_f32 v[84:85], v[84:85], v[82:83], v[94:95] op_sel:[1,1,0] op_sel_hi:[0,1,1] neg_lo:[1,0,0]
v_pk_mul_f32 v[94:95], v[84:85], v[80:81] op_sel:[0,0] op_sel_hi:[1,0]
v_pk_fma_f32 v[88:89], v[84:85], v[80:81], v[94:95] op_sel:[1,1,0] op_sel_hi:[0,1,1] neg_lo:[1,0,0]
v_pk_fma_f32 v[90:91], v[88:89], v[86:87], v[84:85] op_sel:[0,0,0] op_sel_hi:[1,0,1] neg_lo:[0,0,1] neg_hi:[0,0,1]
v_pk_fma_f32 v[92:93], v[90:91], v[86:87], v[88:89] op_sel:[0,0,0] op_sel_hi:[1,0,1] neg_lo:[0,0,1] neg_hi:[0,0,1]
v_cvt_pk_bf16_f32 v98, v84, -v85
v_cvt_pk_bf16_f32 v99, v88, -v89
v_cvt_pk_bf16_f32 v100, v90, -v91
v_cvt_pk_bf16_f32 v101, v92, -v93
v_accvgpr_write_b32 a52, v98
v_accvgpr_write_b32 a53, v99
v_accvgpr_write_b32 a54, v100
v_accvgpr_write_b32 a55, v101
v_pk_mul_f32 v[94:95], v[84:85], v[82:83] op_sel:[0,0] op_sel_hi:[1,0]
v_pk_fma_f32 v[84:85], v[84:85], v[82:83], v[94:95] op_sel:[1,1,0] op_sel_hi:[0,1,1] neg_lo:[1,0,0]
v_pk_mul_f32 v[94:95], v[84:85], v[80:81] op_sel:[0,0] op_sel_hi:[1,0]
v_pk_fma_f32 v[88:89], v[84:85], v[80:81], v[94:95] op_sel:[1,1,0] op_sel_hi:[0,1,1] neg_lo:[1,0,0]
v_pk_fma_f32 v[90:91], v[88:89], v[86:87], v[84:85] op_sel:[0,0,0] op_sel_hi:[1,0,1] neg_lo:[0,0,1] neg_hi:[0,0,1]
v_pk_fma_f32 v[92:93], v[90:91], v[86:87], v[88:89] op_sel:[0,0,0] op_sel_hi:[1,0,1] neg_lo:[0,0,1] neg_hi:[0,0,1]
v_cvt_pk_bf16_f32 v98, v84, -v85
v_cvt_pk_bf16_f32 v99, v88, -v89
v_cvt_pk_bf16_f32 v100, v90, -v91
v_cvt_pk_bf16_f32 v101, v92, -v93
v_accvgpr_write_b32 a56, v98
v_accvgpr_write_b32 a57, v99
v_accvgpr_write_b32 a58, v100
v_accvgpr_write_b32 a59, v101
v_pk_mul_f32 v[94:95], v[84:85], v[82:83] op_sel:[0,0] op_sel_hi:[1,0]
v_pk_fma_f32 v[84:85], v[84:85], v[82:83], v[94:95] op_sel:[1,1,0] op_sel_hi:[0,1,1] neg_lo:[1,0,0]
v_pk_mul_f32 v[94:95], v[84:85], v[80:81] op_sel:[0,0] op_sel_hi:[1,0]
v_pk_fma_f32 v[88:89], v[84:85], v[80:81], v[94:95] op_sel:[1,1,0] op_sel_hi:[0,1,1] neg_lo:[1,0,0]
v_pk_fma_f32 v[90:91], v[88:89], v[86:87], v[84:85] op_sel:[0,0,0] op_sel_hi:[1,0,1] neg_lo:[0,0,1] neg_hi:[0,0,1]
v_pk_fma_f32 v[92:93], v[90:91], v[86:87], v[88:89] op_sel:[0,0,0] op_sel_hi:[1,0,1] neg_lo:[0,0,1] neg_hi:[0,0,1]
v_cvt_pk_bf16_f32 v98, v84, -v85
v_cvt_pk_bf16_f32 v99, v88, -v89
v_cvt_pk_bf16_f32 v100, v90, -v91
v_cvt_pk_bf16_f32 v101, v92, -v93
v_accvgpr_write_b32 a60, v98
v_accvgpr_write_b32 a61, v99
v_accvgpr_write_b32 a62, v100
v_accvgpr_write_b32 a63, v101
v_pk_mul_f32 v[94:95], v[84:85], v[82:83] op_sel:[0,0] op_sel_hi:[1,0]
v_pk_fma_f32 v[84:85], v[84:85], v[82:83], v[94:95] op_sel:[1,1,0] op_sel_hi:[0,1,1] neg_lo:[1,0,0]
v_pk_mul_f32 v[94:95], v[84:85], v[80:81] op_sel:[0,0] op_sel_hi:[1,0]
v_pk_fma_f32 v[88:89], v[84:85], v[80:81], v[94:95] op_sel:[1,1,0] op_sel_hi:[0,1,1] neg_lo:[1,0,0]
v_pk_fma_f32 v[90:91], v[88:89], v[86:87], v[84:85] op_sel:[0,0,0] op_sel_hi:[1,0,1] neg_lo:[0,0,1] neg_hi:[0,0,1]
v_pk_fma_f32 v[92:93], v[90:91], v[86:87], v[88:89] op_sel:[0,0,0] op_sel_hi:[1,0,1] neg_lo:[0,0,1] neg_hi:[0,0,1]
v_cvt_pk_bf16_f32 v98, v84, -v85
v_cvt_pk_bf16_f32 v99, v88, -v89
v_cvt_pk_bf16_f32 v100, v90, -v91
v_cvt_pk_bf16_f32 v101, v92, -v93
v_accvgpr_write_b32 a64, v98
v_accvgpr_write_b32 a65, v99
v_accvgpr_write_b32 a66, v100
v_accvgpr_write_b32 a67, v101
v_pk_mul_f32 v[94:95], v[84:85], v[82:83] op_sel:[0,0] op_sel_hi:[1,0]
v_pk_fma_f32 v[84:85], v[84:85], v[82:83], v[94:95] op_sel:[1,1,0] op_sel_hi:[0,1,1] neg_lo:[1,0,0]
v_pk_mul_f32 v[94:95], v[84:85], v[80:81] op_sel:[0,0] op_sel_hi:[1,0]
v_pk_fma_f32 v[88:89], v[84:85], v[80:81], v[94:95] op_sel:[1,1,0] op_sel_hi:[0,1,1] neg_lo:[1,0,0]
v_pk_fma_f32 v[90:91], v[88:89], v[86:87], v[84:85] op_sel:[0,0,0] op_sel_hi:[1,0,1] neg_lo:[0,0,1] neg_hi:[0,0,1]
v_pk_fma_f32 v[92:93], v[90:91], v[86:87], v[88:89] op_sel:[0,0,0] op_sel_hi:[1,0,1] neg_lo:[0,0,1] neg_hi:[0,0,1]
v_cvt_pk_bf16_f32 v98, v84, -v85
v_cvt_pk_bf16_f32 v99, v88, -v89
v_cvt_pk_bf16_f32 v100, v90, -v91
v_cvt_pk_bf16_f32 v101, v92, -v93
v_accvgpr_write_b32 a68, v98
v_accvgpr_write_b32 a69, v99
v_accvgpr_write_b32 a70, v100
v_accvgpr_write_b32 a71, v101
s_lshl_b32 s36, s32, 5
s_add_u32 s36, s36, 4
v_lshrrev_b32 v78, 2, v3
v_lshlrev_b32 v78, 3, v78
v_and_b32 v79, 3, v3
v_add3_u32 v78, v78, v79, s36
v_cvt_f32_u32 v78, v78
v_mul_f32 v78, 0x3ae38e39, v78
v_cos_f32 v80, v78
v_sin_f32 v81, v78
v_mul_f32 v79, 0x41800000, v78
v_fract_f32 v79, v79
v_cos_f32 v82, v79
v_sin_f32 v83, v79
v_mul_f32 v79, v78, v73
v_fract_f32 v79, v79
v_cos_f32 v84, v79
v_sin_f32 v85, v79
v_add_f32 v86, v80, v80
v_mul_f32 v84, 0x35e38e39, v84
v_mul_f32 v85, 0x35e38e39, v85
v_pk_mul_f32 v[94:95], v[84:85], v[80:81] op_sel:[0,0] op_sel_hi:[1,0]
v_pk_fma_f32 v[88:89], v[84:85], v[80:81], v[94:95] op_sel:[1,1,0] op_sel_hi:[0,1,1] neg_lo:[1,0,0]
v_pk_fma_f32 v[90:91], v[88:89], v[86:87], v[84:85] op_sel:[0,0,0] op_sel_hi:[1,0,1] neg_lo:[0,0,1] neg_hi:[0,0,1]
v_pk_fma_f32 v[92:93], v[90:91], v[86:87], v[88:89] op_sel:[0,0,0] op_sel_hi:[1,0,1] neg_lo:[0,0,1] neg_hi:[0,0,1]
v_cvt_pk_bf16_f32 v98, v84, -v85
v_cvt_pk_bf16_f32 v99, v88, -v89
v_cvt_pk_bf16_f32 v100, v90, -v91
v_cvt_pk_bf16_f32 v101, v92, -v93
v_and_b32 v94, 1, v3
v_lshlrev_b32 v94, 31, v94
v_or_b32 v94, 0x35643564, v94
v_cmp_eq_u32 vcc, 0, v4
s_nop 1
v_cndmask_b32 v98, v98, v94, vcc
v_accvgpr_write_b32 a72, v98
v_accvgpr_write_b32 a73, v99
v_accvgpr_write_b32 a74, v100
v_accvgpr_write_b32 a75, v101
v_pk_mul_f32 v[94:95], v[84:85], v[82:83] op_sel:[0,0] op_sel_hi:[1,0]
v_pk_fma_f32 v[84:85], v[84:85], v[82:83], v[94:95] op_sel:[1,1,0] op_sel_hi:[0,1,1] neg_lo:[1,0,0]
v_pk_mul_f32 v[94:95], v[84:85], v[80:81] op_sel:[0,0] op_sel_hi:[1,0]
v_pk_fma_f32 v[88:89], v[84:85], v[80:81], v[94:95] op_sel:[1,1,0] op_sel_hi:[0,1,1] neg_lo:[1,0,0]
v_pk_fma_f32 v[90:91], v[88:89], v[86:87], v[84:85] op_sel:[0,0,0] op_sel_hi:[1,0,1] neg_lo:[0,0,1] neg_hi:[0,0,1]
v_pk_fma_f32 v[92:93], v[90:91], v[86:87], v[88:89] op_sel:[0,0,0] op_sel_hi:[1,0,1] neg_lo:[0,0,1] neg_hi:[0,0,1]
v_cvt_pk_bf16_f32 v98, v84, -v85
v_cvt_pk_bf16_f32 v99, v88, -v89
v_cvt_pk_bf16_f32 v100, v90, -v91
v_cvt_pk_bf16_f32 v101, v92, -v93
v_accvgpr_write_b32 a76, v98
v_accvgpr_write_b32 a77, v99
v_accvgpr_write_b32 a78, v100
v_accvgpr_write_b32 a79, v101
v_pk_mul_f32 v[94:95], v[84:85], v[82:83] op_sel:[0,0] op_sel_hi:[1,0]
v_pk_fma_f32 v[84:85], v[84:85], v[82:83], v[94:95] op_sel:[1,1,0] op_sel_hi:[0,1,1] neg_lo:[1,0,0]
v_pk_mul_f32 v[94:95], v[84:85], v[80:81] op_sel:[0,0] op_sel_hi:[1,0]
v_pk_fma_f32 v[88:89], v[84:85], v[80:81], v[94:95] op_sel:[1,1,0] op_sel_hi:[0,1,1] neg_lo:[1,0,0]
v_pk_fma_f32 v[90:91], v[88:89], v[86:87], v[84:85] op_sel:[0,0,0] op_sel_hi:[1,0,1] neg_lo:[0,0,1] neg_hi:[0,0,1]
v_pk_fma_f32 v[92:93], v[90:91], v[86:87], v[88:89] op_sel:[0,0,0] op_sel_hi:[1,0,1] neg_lo:[0,0,1] neg_hi:[0,0,1]
v_cvt_pk_bf16_f32 v98, v84, -v85
v_cvt_pk_bf16_f32 v99, v88, -v89
v_cvt_pk_bf16_f32 v100, v90, -v91
v_cvt_pk_bf16_f32 v101, v92, -v93
v_accvgpr_write_b32 a80, v98
v_accvgpr_write_b32 a81, v99
v_accvgpr_write_b32 a82, v100
v_accvgpr_write_b32 a83, v101
v_pk_mul_f32 v[94:95], v[84:85], v[82:83] op_sel:[0,0] op_sel_hi:[1,0]
v_pk_fma_f32 v[84:85], v[84:85], v[82:83], v[94:95] op_sel:[1,1,0] op_sel_hi:[0,1,1] neg_lo:[1,0,0]
v_pk_mul_f32 v[94:95], v[84:85], v[80:81] op_sel:[0,0] op_sel_hi:[1,0]
v_pk_fma_f32 v[88:89], v[84:85], v[80:81], v[94:95] op_sel:[1,1,0] op_sel_hi:[0,1,1] neg_lo:[1,0,0]
v_pk_fma_f32 v[90:91], v[88:89], v[86:87], v[84:85] op_sel:[0,0,0] op_sel_hi:[1,0,1] neg_lo:[0,0,1] neg_hi:[0,0,1]
v_pk_fma_f32 v[92:93], v[90:91], v[86:87], v[88:89] op_sel:[0,0,0] op_sel_hi:[1,0,1] neg_lo:[0,0,1] neg_hi:[0,0,1]
v_cvt_pk_bf16_f32 v98, v84, -v85
v_cvt_pk_bf16_f32 v99, v88, -v89
v_cvt_pk_bf16_f32 v100, v90, -v91
v_cvt_pk_bf16_f32 v101, v92, -v93
v_accvgpr_write_b32 a84, v98
v_accvgpr_write_b32 a85, v99
v_accvgpr_write_b32 a86, v100
v_accvgpr_write_b32 a87, v101
v_pk_mul_f32 v[94:95], v[84:85], v[82:83] op_sel:[0,0] op_sel_hi:[1,0]
v_pk_fma_f32 v[84:85], v[84:85], v[82:83], v[94:95] op_sel:[1,1,0] op_sel_hi:[0,1,1] neg_lo:[1,0,0]
v_pk_mul_f32 v[94:95], v[84:85], v[80:81] op_sel:[0,0] op_sel_hi:[1,0]
v_pk_fma_f32 v[88:89], v[84:85], v[80:81], v[94:95] op_sel:[1,1,0] op_sel_hi:[0,1,1] neg_lo:[1,0,0]
v_pk_fma_f32 v[90:91], v[88:89], v[86:87], v[84:85] op_sel:[0,0,0] op_sel_hi:[1,0,1] neg_lo:[0,0,1] neg_hi:[0,0,1]
v_pk_fma_f32 v[92:93], v[90:91], v[86:87], v[88:89] op_sel:[0,0,0] op_sel_hi:[1,0,1] neg_lo:[0,0,1] neg_hi:[0,0,1]
v_cvt_pk_bf16_f32 v98, v84, -v85
v_cvt_pk_bf16_f32 v99, v88, -v89
v_cvt_pk_bf16_f32 v100, v90, -v91
v_cvt_pk_bf16_f32 v101, v92, -v93
v_accvgpr_write_b32 a88, v98
v_accvgpr_write_b32 a89, v99
v_accvgpr_write_b32 a90, v100
v_accvgpr_write_b32 a91, v101
v_pk_mul_f32 v[94:95], v[84:85], v[82:83] op_sel:[0,0] op_sel_hi:[1,0]
v_pk_fma_f32 v[84:85], v[84:85], v[82:83], v[94:95] op_sel:[1,1,0] op_sel_hi:[0,1,1] neg_lo:[1,0,0]
v_pk_mul_f32 v[94:95], v[84:85], v[80:81] op_sel:[0,0] op_sel_hi:[1,0]
v_pk_fma_f32 v[88:89], v[84:85], v[80:81], v[94:95] op_sel:[1,1,0] op_sel_hi:[0,1,1] neg_lo:[1,0,0]
v_pk_fma_f32 v[90:91], v[88:89], v[86:87], v[84:85] op_sel:[0,0,0] op_sel_hi:[1,0,1] neg_lo:[0,0,1] neg_hi:[0,0,1]
v_pk_fma_f32 v[92:93], v[90:91], v[86:87], v[88:89] op_sel:[0,0,0] op_sel_hi:[1,0,1] neg_lo:[0,0,1] neg_hi:[0,0,1]
v_cvt_pk_bf16_f32 v98, v84, -v85
v_cvt_pk_bf16_f32 v99, v88, -v89
v_cvt_pk_bf16_f32 v100, v90, -v91
v_cvt_pk_bf16_f32 v101, v92, -v93
v_accvgpr_write_b32 a92, v98
v_accvgpr_write_b32 a93, v99
v_accvgpr_write_b32 a94, v100
v_accvgpr_write_b32 a95, v101
v_pk_mul_f32 v[94:95], v[84:85], v[82:83] op_sel:[0,0] op_sel_hi:[1,0]
v_pk_fma_f32 v[84:85], v[84:85], v[82:83], v[94:95] op_sel:[1,1,0] op_sel_hi:[0,1,1] neg_lo:[1,0,0]
v_pk_mul_f32 v[94:95], v[84:85], v[80:81] op_sel:[0,0] op_sel_hi:[1,0]
v_pk_fma_f32 v[88:89], v[84:85], v[80:81], v[94:95] op_sel:[1,1,0] op_sel_hi:[0,1,1] neg_lo:[1,0,0]
v_pk_fma_f32 v[90:91], v[88:89], v[86:87], v[84:85] op_sel:[0,0,0] op_sel_hi:[1,0,1] neg_lo:[0,0,1] neg_hi:[0,0,1]
v_pk_fma_f32 v[92:93], v[90:91], v[86:87], v[88:89] op_sel:[0,0,0] op_sel_hi:[1,0,1] neg_lo:[0,0,1] neg_hi:[0,0,1]
v_cvt_pk_bf16_f32 v98, v84, -v85
v_cvt_pk_bf16_f32 v99, v88, -v89
v_cvt_pk_bf16_f32 v100, v90, -v91
v_cvt_pk_bf16_f32 v101, v92, -v93
v_accvgpr_write_b32 a96, v98
v_accvgpr_write_b32 a97, v99
v_accvgpr_write_b32 a98, v100
v_accvgpr_write_b32 a99, v101
v_pk_mul_f32 v[94:95], v[84:85], v[82:83] op_sel:[0,0] op_sel_hi:[1,0]
v_pk_fma_f32 v[84:85], v[84:85], v[82:83], v[94:95] op_sel:[1,1,0] op_sel_hi:[0,1,1] neg_lo:[1,0,0]
v_pk_mul_f32 v[94:95], v[84:85], v[80:81] op_sel:[0,0] op_sel_hi:[1,0]
v_pk_fma_f32 v[88:89], v[84:85], v[80:81], v[94:95] op_sel:[1,1,0] op_sel_hi:[0,1,1] neg_lo:[1,0,0]
v_pk_fma_f32 v[90:91], v[88:89], v[86:87], v[84:85] op_sel:[0,0,0] op_sel_hi:[1,0,1] neg_lo:[0,0,1] neg_hi:[0,0,1]
v_pk_fma_f32 v[92:93], v[90:91], v[86:87], v[88:89] op_sel:[0,0,0] op_sel_hi:[1,0,1] neg_lo:[0,0,1] neg_hi:[0,0,1]
v_cvt_pk_bf16_f32 v98, v84, -v85
v_cvt_pk_bf16_f32 v99, v88, -v89
v_cvt_pk_bf16_f32 v100, v90, -v91
v_cvt_pk_bf16_f32 v101, v92, -v93
v_accvgpr_write_b32 a100, v98
v_accvgpr_write_b32 a101, v99
v_accvgpr_write_b32 a102, v100
v_accvgpr_write_b32 a103, v101
v_pk_mul_f32 v[94:95], v[84:85], v[82:83] op_sel:[0,0] op_sel_hi:[1,0]
v_pk_fma_f32 v[84:85], v[84:85], v[82:83], v[94:95] op_sel:[1,1,0] op_sel_hi:[0,1,1] neg_lo:[1,0,0]
v_pk_mul_f32 v[94:95], v[84:85], v[80:81] op_sel:[0,0] op_sel_hi:[1,0]
v_pk_fma_f32 v[88:89], v[84:85], v[80:81], v[94:95] op_sel:[1,1,0] op_sel_hi:[0,1,1] neg_lo:[1,0,0]
v_pk_fma_f32 v[90:91], v[88:89], v[86:87], v[84:85] op_sel:[0,0,0] op_sel_hi:[1,0,1] neg_lo:[0,0,1] neg_hi:[0,0,1]
v_pk_fma_f32 v[92:93], v[90:91], v[86:87], v[88:89] op_sel:[0,0,0] op_sel_hi:[1,0,1] neg_lo:[0,0,1] neg_hi:[0,0,1]
v_cvt_pk_bf16_f32 v98, v84, -v85
v_cvt_pk_bf16_f32 v99, v88, -v89
v_cvt_pk_bf16_f32 v100, v90, -v91
v_cvt_pk_bf16_f32 v101, v92, -v93
v_accvgpr_write_b32 a104, v98
v_accvgpr_write_b32 a105, v99
v_accvgpr_write_b32 a106, v100
v_accvgpr_write_b32 a107, v101
v_pk_mul_f32 v[94:95], v[84:85], v[82:83] op_sel:[0,0] op_sel_hi:[1,0]
v_pk_fma_f32 v[84:85], v[84:85], v[82:83], v[94:95] op_sel:[1,1,0] op_sel_hi:[0,1,1] neg_lo:[1,0,0]
v_pk_mul_f32 v[94:95], v[84:85], v[80:81] op_sel:[0,0] op_sel_hi:[1,0]
v_pk_fma_f32 v[88:89], v[84:85], v[80:81], v[94:95] op_sel:[1,1,0] op_sel_hi:[0,1,1] neg_lo:[1,0,0]
v_pk_fma_f32 v[90:91], v[88:89], v[86:87], v[84:85] op_sel:[0,0,0] op_sel_hi:[1,0,1] neg_lo:[0,0,1] neg_hi:[0,0,1]
v_pk_fma_f32 v[92:93], v[90:91], v[86:87], v[88:89] op_sel:[0,0,0] op_sel_hi:[1,0,1] neg_lo:[0,0,1] neg_hi:[0,0,1]
v_cvt_pk_bf16_f32 v98, v84, -v85
v_cvt_pk_bf16_f32 v99, v88, -v89
v_cvt_pk_bf16_f32 v100, v90, -v91
v_cvt_pk_bf16_f32 v101, v92, -v93
v_accvgpr_write_b32 a108, v98
v_accvgpr_write_b32 a109, v99
v_accvgpr_write_b32 a110, v100
v_accvgpr_write_b32 a111, v101
v_pk_mul_f32 v[94:95], v[84:85], v[82:83] op_sel:[0,0] op_sel_hi:[1,0]
v_pk_fma_f32 v[84:85], v[84:85], v[82:83], v[94:95] op_sel:[1,1,0] op_sel_hi:[0,1,1] neg_lo:[1,0,0]
v_pk_mul_f32 v[94:95], v[84:85], v[80:81] op_sel:[0,0] op_sel_hi:[1,0]
v_pk_fma_f32 v[88:89], v[84:85], v[80:81], v[94:95] op_sel:[1,1,0] op_sel_hi:[0,1,1] neg_lo:[1,0,0]
v_pk_fma_f32 v[90:91], v[88:89], v[86:87], v[84:85] op_sel:[0,0,0] op_sel_hi:[1,0,1] neg_lo:[0,0,1] neg_hi:[0,0,1]
v_pk_fma_f32 v[92:93], v[90:91], v[86:87], v[88:89] op_sel:[0,0,0] op_sel_hi:[1,0,1] neg_lo:[0,0,1] neg_hi:[0,0,1]
v_cvt_pk_bf16_f32 v98, v84, -v85
v_cvt_pk_bf16_f32 v99, v88, -v89
v_cvt_pk_bf16_f32 v100, v90, -v91
v_cvt_pk_bf16_f32 v101, v92, -v93
v_accvgpr_write_b32 a112, v98
v_accvgpr_write_b32 a113, v99
v_accvgpr_write_b32 a114, v100
v_accvgpr_write_b32 a115, v101
v_pk_mul_f32 v[94:95], v[84:85], v[82:83] op_sel:[0,0] op_sel_hi:[1,0]
v_pk_fma_f32 v[84:85], v[84:85], v[82:83], v[94:95] op_sel:[1,1,0] op_sel_hi:[0,1,1] neg_lo:[1,0,0]
v_pk_mul_f32 v[94:95], v[84:85], v[80:81] op_sel:[0,0] op_sel_hi:[1,0]
v_pk_fma_f32 v[88:89], v[84:85], v[80:81], v[94:95] op_sel:[1,1,0] op_sel_hi:[0,1,1] neg_lo:[1,0,0]
v_pk_fma_f32 v[90:91], v[88:89], v[86:87], v[84:85] op_sel:[0,0,0] op_sel_hi:[1,0,1] neg_lo:[0,0,1] neg_hi:[0,0,1]
v_pk_fma_f32 v[92:93], v[90:91], v[86:87], v[88:89] op_sel:[0,0,0] op_sel_hi:[1,0,1] neg_lo:[0,0,1] neg_hi:[0,0,1]
v_cvt_pk_bf16_f32 v98, v84, -v85
v_cvt_pk_bf16_f32 v99, v88, -v89
v_cvt_pk_bf16_f32 v100, v90, -v91
v_cvt_pk_bf16_f32 v101, v92, -v93
v_accvgpr_write_b32 a116, v98
v_accvgpr_write_b32 a117, v99
v_accvgpr_write_b32 a118, v100
v_accvgpr_write_b32 a119, v101
v_pk_mul_f32 v[94:95], v[84:85], v[82:83] op_sel:[0,0] op_sel_hi:[1,0]
v_pk_fma_f32 v[84:85], v[84:85], v[82:83], v[94:95] op_sel:[1,1,0] op_sel_hi:[0,1,1] neg_lo:[1,0,0]
v_pk_mul_f32 v[94:95], v[84:85], v[80:81] op_sel:[0,0] op_sel_hi:[1,0]
v_pk_fma_f32 v[88:89], v[84:85], v[80:81], v[94:95] op_sel:[1,1,0] op_sel_hi:[0,1,1] neg_lo:[1,0,0]
v_pk_fma_f32 v[90:91], v[88:89], v[86:87], v[84:85] op_sel:[0,0,0] op_sel_hi:[1,0,1] neg_lo:[0,0,1] neg_hi:[0,0,1]
v_pk_fma_f32 v[92:93], v[90:91], v[86:87], v[88:89] op_sel:[0,0,0] op_sel_hi:[1,0,1] neg_lo:[0,0,1] neg_hi:[0,0,1]
v_cvt_pk_bf16_f32 v98, v84, -v85
v_cvt_pk_bf16_f32 v99, v88, -v89
v_cvt_pk_bf16_f32 v100, v90, -v91
v_cvt_pk_bf16_f32 v101, v92, -v93
v_accvgpr_write_b32 a120, v98
v_accvgpr_write_b32 a121, v99
v_accvgpr_write_b32 a122, v100
v_accvgpr_write_b32 a123, v101
v_pk_mul_f32 v[94:95], v[84:85], v[82:83] op_sel:[0,0] op_sel_hi:[1,0]
v_pk_fma_f32 v[84:85], v[84:85], v[82:83], v[94:95] op_sel:[1,1,0] op_sel_hi:[0,1,1] neg_lo:[1,0,0]
v_pk_mul_f32 v[94:95], v[84:85], v[80:81] op_sel:[0,0] op_sel_hi:[1,0]
v_pk_fma_f32 v[88:89], v[84:85], v[80:81], v[94:95] op_sel:[1,1,0] op_sel_hi:[0,1,1] neg_lo:[1,0,0]
v_pk_fma_f32 v[90:91], v[88:89], v[86:87], v[84:85] op_sel:[0,0,0] op_sel_hi:[1,0,1] neg_lo:[0,0,1] neg_hi:[0,0,1]
v_pk_fma_f32 v[92:93], v[90:91], v[86:87], v[88:89] op_sel:[0,0,0] op_sel_hi:[1,0,1] neg_lo:[0,0,1] neg_hi:[0,0,1]
v_cvt_pk_bf16_f32 v98, v84, -v85
v_cvt_pk_bf16_f32 v99, v88, -v89
v_cvt_pk_bf16_f32 v100, v90, -v91
v_cvt_pk_bf16_f32 v101, v92, -v93
v_accvgpr_write_b32 a124, v98
v_accvgpr_write_b32 a125, v99
v_accvgpr_write_b32 a126, v100
v_accvgpr_write_b32 a127, v101
v_pk_mul_f32 v[94:95], v[84:85], v[82:83] op_sel:[0,0] op_sel_hi:[1,0]
v_pk_fma_f32 v[84:85], v[84:85], v[82:83], v[94:95] op_sel:[1,1,0] op_sel_hi:[0,1,1] neg_lo:[1,0,0]
v_pk_mul_f32 v[94:95], v[84:85], v[80:81] op_sel:[0,0] op_sel_hi:[1,0]
v_pk_fma_f32 v[88:89], v[84:85], v[80:81], v[94:95] op_sel:[1,1,0] op_sel_hi:[0,1,1] neg_lo:[1,0,0]
v_pk_fma_f32 v[90:91], v[88:89], v[86:87], v[84:85] op_sel:[0,0,0] op_sel_hi:[1,0,1] neg_lo:[0,0,1] neg_hi:[0,0,1]
v_pk_fma_f32 v[92:93], v[90:91], v[86:87], v[88:89] op_sel:[0,0,0] op_sel_hi:[1,0,1] neg_lo:[0,0,1] neg_hi:[0,0,1]
v_cvt_pk_bf16_f32 v98, v84, -v85
v_cvt_pk_bf16_f32 v99, v88, -v89
v_cvt_pk_bf16_f32 v100, v90, -v91
v_cvt_pk_bf16_f32 v101, v92, -v93
v_accvgpr_write_b32 a128, v98
v_accvgpr_write_b32 a129, v99
v_accvgpr_write_b32 a130, v100
v_accvgpr_write_b32 a131, v101
v_pk_mul_f32 v[94:95], v[84:85], v[82:83] op_sel:[0,0] op_sel_hi:[1,0]
v_pk_fma_f32 v[84:85], v[84:85], v[82:83], v[94:95] op_sel:[1,1,0] op_sel_hi:[0,1,1] neg_lo:[1,0,0]
v_pk_mul_f32 v[94:95], v[84:85], v[80:81] op_sel:[0,0] op_sel_hi:[1,0]
v_pk_fma_f32 v[88:89], v[84:85], v[80:81], v[94:95] op_sel:[1,1,0] op_sel_hi:[0,1,1] neg_lo:[1,0,0]
v_pk_fma_f32 v[90:91], v[88:89], v[86:87], v[84:85] op_sel:[0,0,0] op_sel_hi:[1,0,1] neg_lo:[0,0,1] neg_hi:[0,0,1]
v_pk_fma_f32 v[92:93], v[90:91], v[86:87], v[88:89] op_sel:[0,0,0] op_sel_hi:[1,0,1] neg_lo:[0,0,1] neg_hi:[0,0,1]
v_cvt_pk_bf16_f32 v98, v84, -v85
v_cvt_pk_bf16_f32 v99, v88, -v89
v_cvt_pk_bf16_f32 v100, v90, -v91
v_cvt_pk_bf16_f32 v101, v92, -v93
v_accvgpr_write_b32 a132, v98
v_accvgpr_write_b32 a133, v99
v_accvgpr_write_b32 a134, v100
v_accvgpr_write_b32 a135, v101
v_pk_mul_f32 v[94:95], v[84:85], v[82:83] op_sel:[0,0] op_sel_hi:[1,0]
v_pk_fma_f32 v[84:85], v[84:85], v[82:83], v[94:95] op_sel:[1,1,0] op_sel_hi:[0,1,1] neg_lo:[1,0,0]
v_pk_mul_f32 v[94:95], v[84:85], v[80:81] op_sel:[0,0] op_sel_hi:[1,0]
v_pk_fma_f32 v[88:89], v[84:85], v[80:81], v[94:95] op_sel:[1,1,0] op_sel_hi:[0,1,1] neg_lo:[1,0,0]
v_pk_fma_f32 v[90:91], v[88:89], v[86:87], v[84:85] op_sel:[0,0,0] op_sel_hi:[1,0,1] neg_lo:[0,0,1] neg_hi:[0,0,1]
v_pk_fma_f32 v[92:93], v[90:91], v[86:87], v[88:89] op_sel:[0,0,0] op_sel_hi:[1,0,1] neg_lo:[0,0,1] neg_hi:[0,0,1]
v_cvt_pk_bf16_f32 v98, v84, -v85
v_cvt_pk_bf16_f32 v99, v88, -v89
v_cvt_pk_bf16_f32 v100, v90, -v91
v_cvt_pk_bf16_f32 v101, v92, -v93
v_accvgpr_write_b32 a136, v98
v_accvgpr_write_b32 a137, v99
v_accvgpr_write_b32 a138, v100
v_accvgpr_write_b32 a139, v101
v_pk_mul_f32 v[94:95], v[84:85], v[82:83] op_sel:[0,0] op_sel_hi:[1,0]
v_pk_fma_f32 v[84:85], v[84:85], v[82:83], v[94:95] op_sel:[1,1,0] op_sel_hi:[0,1,1] neg_lo:[1,0,0]
v_pk_mul_f32 v[94:95], v[84:85], v[80:81] op_sel:[0,0] op_sel_hi:[1,0]
v_pk_fma_f32 v[88:89], v[84:85], v[80:81], v[94:95] op_sel:[1,1,0] op_sel_hi:[0,1,1] neg_lo:[1,0,0]
v_pk_fma_f32 v[90:91], v[88:89], v[86:87], v[84:85] op_sel:[0,0,0] op_sel_hi:[1,0,1] neg_lo:[0,0,1] neg_hi:[0,0,1]
v_pk_fma_f32 v[92:93], v[90:91], v[86:87], v[88:89] op_sel:[0,0,0] op_sel_hi:[1,0,1] neg_lo:[0,0,1] neg_hi:[0,0,1]
v_cvt_pk_bf16_f32 v98, v84, -v85
v_cvt_pk_bf16_f32 v99, v88, -v89
v_cvt_pk_bf16_f32 v100, v90, -v91
v_cvt_pk_bf16_f32 v101, v92, -v93
v_accvgpr_write_b32 a140, v98
v_accvgpr_write_b32 a141, v99
v_accvgpr_write_b32 a142, v100
v_accvgpr_write_b32 a143, v101
p3gb_done:
s_cmp_lt_u32 s2, 144
s_cbranch_scc1 P3_start
s_load_dwordx2 s[4:5], s[0:1], 80
s_load_dwordx2 s[40:41], s[0:1], 48
v_lshrrev_b32 v2, 6, v0
v_and_b32 v1, 63, v0
s_nop 0
v_readfirstlane_b32 s22, v2
v_lshlrev_b32 v5, 4, v1
s_sub_u32 s55, s2, 144
s_lshl_b32 s55, s55, 2
s_add_u32 s55, s55, s22
s_add_u32 s55, s55, 384
s_mul_hi_u32 s57, s55, 238609295
s_mul_i32 s58, s57, 18
s_sub_u32 s58, s55, s58
s_lshr_b32 s59, s57, 2
s_and_b32 s57, s57, 3
s_mul_i32 s53, s22, 10240
v_add_u32 v6, 0, v1
v_mul_u32_u24 v7, 3277, v6
v_lshrrev_b32 v7, 16, v7
v_mul_u32_u24 v8, 20, v7
v_sub_u32 v8, v6, v8
v_lshlrev_b32 v8, 4, v8
v_cmp_le_u32 vcc, 16, v7
v_mov_b32 v10, 128
s_nop 0
v_cndmask_b32 v10, 0, v10, vcc
v_add_u32 v10, v10, v7
v_mul_u32_u24 v10, 1152, v10
v_add_u32 v16, v10, v8
v_add_u32 v6, 64, v1
v_mul_u32_u24 v7, 3277, v6
v_lshrrev_b32 v7, 16, v7
v_mul_u32_u24 v8, 20, v7
v_sub_u32 v8, v6, v8
v_lshlrev_b32 v8, 4, v8
v_cmp_le_u32 vcc, 16, v7
v_mov_b32 v10, 128
s_nop 0
v_cndmask_b32 v10, 0, v10, vcc
v_add_u32 v10, v10, v7
v_mul_u32_u24 v10, 1152, v10
v_add_u32 v17, v10, v8
v_add_u32 v6, 128, v1
v_mul_u32_u24 v7, 3277, v6
v_lshrrev_b32 v7, 16, v7
v_mul_u32_u24 v8, 20, v7
v_sub_u32 v8, v6, v8
v_lshlrev_b32 v8, 4, v8
v_cmp_le_u32 vcc, 16, v7
v_mov_b32 v10, 128
s_nop 0
v_cndmask_b32 v10, 0, v10, vcc
v_add_u32 v10, v10, v7
v_mul_u32_u24 v10, 1152, v10
v_add_u32 v18, v10, v8
v_add_u32 v6, 192, v1
v_mul_u32_u24 v7, 3277, v6
v_lshrrev_b32 v7, 16, v7
v_mul_u32_u24 v8, 20, v7
v_sub_u32 v8, v6, v8
v_lshlrev_b32 v8, 4, v8
v_cmp_le_u32 vcc, 16, v7
v_mov_b32 v10, 128
s_nop 0
v_cndmask_b32 v10, 0, v10, vcc
v_add_u32 v10, v10, v7
v_mul_u32_u24 v10, 1152, v10
v_add_u32 v19, v10, v8
v_add_u32 v6, 256, v1
v_mul_u32_u24 v7, 3277, v6
v_lshrrev_b32 v7, 16, v7
v_mul_u32_u24 v8, 20, v7
v_sub_u32 v8, v6, v8
v_lshlrev_b32 v8, 4, v8
v_cmp_le_u32 vcc, 16, v7
v_mov_b32 v10, 128
s_nop 0
v_cndmask_b32 v10, 0, v10, vcc
v_add_u32 v10, v10, v7
v_mul_u32_u24 v10, 1152, v10
v_add_u32 v20, v10, v8
v_add_u32 v6, 320, v1
v_mul_u32_u24 v7, 3277, v6
v_lshrrev_b32 v7, 16, v7
v_mul_u32_u24 v8, 20, v7
v_sub_u32 v8, v6, v8
v_lshlrev_b32 v8, 4, v8
v_cmp_le_u32 vcc, 16, v7
v_mov_b32 v10, 128
s_nop 0
v_cndmask_b32 v10, 0, v10, vcc
v_add_u32 v10, v10, v7
v_mul_u32_u24 v10, 1152, v10
v_add_u32 v21, v10, v8
v_add_u32 v6, 384, v1
v_mul_u32_u24 v7, 3277, v6
v_lshrrev_b32 v7, 16, v7
v_mul_u32_u24 v8, 20, v7
v_sub_u32 v8, v6, v8
v_lshlrev_b32 v8, 4, v8
v_cmp_le_u32 vcc, 16, v7
v_mov_b32 v10, 128
s_nop 0
v_cndmask_b32 v10, 0, v10, vcc
v_add_u32 v10, v10, v7
v_mul_u32_u24 v10, 1152, v10
v_add_u32 v22, v10, v8
v_add_u32 v6, 448, v1
v_mul_u32_u24 v7, 3277, v6
v_lshrrev_b32 v7, 16, v7
v_mul_u32_u24 v8, 20, v7
v_sub_u32 v8, v6, v8
v_lshlrev_b32 v8, 4, v8
v_cmp_le_u32 vcc, 16, v7
v_mov_b32 v10, 128
s_nop 0
v_cndmask_b32 v10, 0, v10, vcc
v_add_u32 v10, v10, v7
v_mul_u32_u24 v10, 1152, v10
v_add_u32 v23, v10, v8
v_add_u32 v6, 512, v1
v_mul_u32_u24 v7, 3277, v6
v_lshrrev_b32 v7, 16, v7
v_mul_u32_u24 v8, 20, v7
v_sub_u32 v8, v6, v8
v_lshlrev_b32 v8, 4, v8
v_cmp_le_u32 vcc, 16, v7
v_mov_b32 v10, 128
s_nop 0
v_cndmask_b32 v10, 0, v10, vcc
v_add_u32 v10, v10, v7
v_mul_u32_u24 v10, 1152, v10
v_add_u32 v24, v10, v8
v_add_u32 v6, 576, v1
v_mul_u32_u24 v7, 3277, v6
v_lshrrev_b32 v7, 16, v7
v_mul_u32_u24 v8, 20, v7
v_sub_u32 v8, v6, v8
v_lshlrev_b32 v8, 4, v8
v_cmp_le_u32 vcc, 16, v7
v_mov_b32 v10, 128
s_nop 0
v_cndmask_b32 v10, 0, v10, vcc
v_add_u32 v10, v10, v7
v_mul_u32_u24 v10, 1152, v10
v_add_u32 v25, v10, v8
s_waitcnt lgkmcnt(0)
s_mov_b32 s8, s4
s_and_b32 s9, s5, 0xffff
s_mov_b32 s10, 39878656
s_mov_b32 s11, 0x20000
s_mov_b32 s36, s40
s_and_b32 s37, s41, 0xffff
s_mov_b32 s38, 5308416
s_mov_b32 s39, 0x20000
s_and_b32 s28, s58, 1
s_mul_i32 s28, s28, 288
s_lshr_b32 s29, s58, 1
s_lshl_b32 s29, s29, 4
s_add_u32 s28, s28, s29
s_mul_i32 s29, s59, 576
s_add_u32 s28, s28, s29
s_mul_i32 s28, s28, 1152
s_mul_i32 s29, s57, 9
s_lshr_b32 s29, s29, 1
s_lshl_b32 s29, s29, 6
s_add_u32 s28, s28, s29
s_add_u32 m0, s53, 0
s_nop 0
buffer_load_dwordx4 v16, s[36:39], s28 offen lds
s_add_u32 m0, s53, 1024
s_nop 0
buffer_load_dwordx4 v17, s[36:39], s28 offen lds
s_add_u32 m0, s53, 2048
s_nop 0
buffer_load_dwordx4 v18, s[36:39], s28 offen lds
s_add_u32 m0, s53, 3072
s_nop 0
buffer_load_dwordx4 v19, s[36:39], s28 offen lds
s_add_u32 m0, s53, 4096
s_nop 0
buffer_load_dwordx4 v20, s[36:39], s28 offen lds
s_add_u32 m0, s53, 5120
s_nop 0
buffer_load_dwordx4 v21, s[36:39], s28 offen lds
s_add_u32 m0, s53, 6144
s_nop 0
buffer_load_dwordx4 v22, s[36:39], s28 offen lds
s_add_u32 m0, s53, 7168
s_nop 0
buffer_load_dwordx4 v23, s[36:39], s28 offen lds
s_add_u32 m0, s53, 8192
s_nop 0
buffer_load_dwordx4 v24, s[36:39], s28 offen lds
s_add_u32 m0, s53, 9216
s_nop 0
buffer_load_dwordx4 v25, s[36:39], s28 offen lds
s_waitcnt vmcnt(0)
v_and_b32 v7, 3, v1
v_lshrrev_b32 v11, 2, v1
v_mul_u32_u24 v11, 320, v11
v_lshl_add_u32 v11, v7, 4, v11
v_add_u32 v11, s53, v11
s_and_b32 s37, s57, 1
s_lshl_b32 s38, s37, 3
s_cmp_eq_u32 s37, 0
s_cselect_b32 s39, 8, 64
v_add_u32 v12, s39, v11
v_add_u32 v11, s38, v11
s_lshl_b32 s33, s59, 2
s_add_u32 s33, s33, s57
s_mul_i32 s33, s33, 165888
s_lshl_b32 s34, s58, 10
s_add_u32 s34, s34, s33
s_add_u32 s34, s34, 15269888
ds_read_b64_tr_b16 v[48:49], v11 offset:0
ds_read_b64_tr_b16 v[50:51], v11 offset:5120
ds_read_b64_tr_b16 v[52:53], v12 offset:0
ds_read_b64_tr_b16 v[54:55], v12 offset:5120
ds_read_b64_tr_b16 v[56:57], v11 offset:64
ds_read_b64_tr_b16 v[58:59], v11 offset:5184
ds_read_b64_tr_b16 v[60:61], v12 offset:64
ds_read_b64_tr_b16 v[62:63], v12 offset:5184
ds_read_b64_tr_b16 v[64:65], v11 offset:128
ds_read_b64_tr_b16 v[66:67], v11 offset:5248
ds_read_b64_tr_b16 v[68:69], v12 offset:128
ds_read_b64_tr_b16 v[70:71], v12 offset:5248
ds_read_b64_tr_b16 v[72:73], v11 offset:192
ds_read_b64_tr_b16 v[74:75], v11 offset:5312
ds_read_b64_tr_b16 v[76:77], v12 offset:192
ds_read_b64_tr_b16 v[78:79], v12 offset:5312
ds_read_b64_tr_b16 v[80:81], v11 offset:256
ds_read_b64_tr_b16 v[82:83], v11 offset:5376
s_waitcnt lgkmcnt(15)
s_add_u32 s36, s34, 0
buffer_store_dwordx4 v[48:51], v5, s[8:11], s36 offen sc1
s_waitcnt lgkmcnt(14)
s_add_u32 s36, s34, 18432
buffer_store_dwordx4 v[52:55], v5, s[8:11], s36 offen sc1
s_waitcnt lgkmcnt(12)
s_add_u32 s36, s34, 36864
buffer_store_dwordx4 v[56:59], v5, s[8:11], s36 offen sc1
s_waitcnt lgkmcnt(10)
s_add_u32 s36, s34, 55296
buffer_store_dwordx4 v[60:63], v5, s[8:11], s36 offen sc1
s_waitcnt lgkmcnt(8)
s_add_u32 s36, s34, 73728
buffer_store_dwordx4 v[64:67], v5, s[8:11], s36 offen sc1
s_waitcnt lgkmcnt(6)
s_add_u32 s36, s34, 92160
buffer_store_dwordx4 v[68:71], v5, s[8:11], s36 offen sc1
s_waitcnt lgkmcnt(4)
s_add_u32 s36, s34, 110592
buffer_store_dwordx4 v[72:75], v5, s[8:11], s36 offen sc1
s_waitcnt lgkmcnt(2)
s_add_u32 s36, s34, 129024
buffer_store_dwordx4 v[76:79], v5, s[8:11], s36 offen sc1
s_waitcnt lgkmcnt(0)
s_add_u32 s36, s34, 147456
buffer_store_dwordx4 v[80:83], v5, s[8:11], s36 offen sc1
s_sub_u32 s52, s2, 144
s_lshl_b32 s52, s52, 2
s_add_u32 s52, s52, 39848448
s_waitcnt vmcnt(0) lgkmcnt(0)
s_barrier
s_cmp_lg_u32 s22, 0
s_cbranch_scc1 sig_34
v_mov_b32 v14, s96
v_mov_b32 v15, 0
s_mov_b64 exec, 1
buffer_store_dword v14, v15, s[8:11], s52 offen sc1
s_mov_b64 exec, -1
sig_34:
P3_start:
s_load_dwordx2 s[4:5], s[0:1], 80
s_load_dwordx2 s[6:7], s[0:1], 0
s_load_dwordx2 s[20:21], s[0:1], 48
s_load_dwordx2 s[52:53], s[0:1], 40
v_lshrrev_b32 v2, 6, v0
v_and_b32 v1, 63, v0
v_readfirstlane_b32 s22, v2
v_and_b32 v3, 15, v1
v_lshrrev_b32 v4, 4, v1
v_lshlrev_b32 v5, 4, v1
s_and_b32 s23, s2, 31
s_lshr_b32 s24, s2, 5
s_lshr_b32 s25, s22, 1
s_and_b32 s26, s22, 1
s_lshl_b32 s27, s23, 1
s_add_u32 s27, s27, s25
s_mul_i32 s32, s24, 3
s_add_u32 s32, s32, s22
v_and_b32 v6, 7, v3
v_xor_b32 v7, v4, v6
v_lshlrev_b32 v7, 4, v7
v_lshl_add_u32 v7, v6, 7, v7
v_lshrrev_b32 v6, 3, v3
v_lshl_add_u32 v7, v6, 10, v7
s_mul_i32 s28, s25, 36864
s_mul_i32 s29, s26, 18432
s_add_u32 s28, s28, s29
v_add_u32 v7, s28, v7
v_xor_b32 v8, 64, v7
s_mul_i32 s28, s25, 36864
s_mul_i32 s29, s26, 9216
s_add_u32 s28, s28, s29
s_add_u32 s28, s28, 73728
v_add_u32 v10, s28, v5
s_cmp_eq_u32 s22, 3
s_cbranch_scc1 k3_kernel_loader
s_waitcnt lgkmcnt(0)
s_mov_b32 s8, s4
s_and_b32 s9, s5, 0xffff
s_mov_b32 s10, 39878656
s_mov_b32 s11, 0x20000
s_mov_b32 s12, s6
s_and_b32 s13, s7, 0xffff
s_mov_b32 s14, 2359296
s_mov_b32 s15, 0x20000
v_mul_u32_u24 v9, 73728, v3
v_lshl_add_u32 v9, v4, 4, v9
s_lshl_b32 s33, s32, 6
s_mul_i32 s34, s23, 2304
s_add_u32 s33, s33, s34
v_add_u32 v11, 73728, v5
v_add_u32 v12, 110592, v5
s_add_u32 s35, s33, 0
buffer_load_dwordx4 v[240:243], v9, s[12:15], s35 offen
s_add_u32 s35, s33, 1179648
buffer_load_dwordx4 v[244:247], v9, s[12:15], s35 offen
s_add_u32 s35, s33, 1152
buffer_load_dwordx4 v[248:251], v9, s[12:15], s35 offen
s_add_u32 s35, s33, 1180800
buffer_load_dwordx4 v[252:255], v9, s[12:15], s35 offen
s_barrier
ds_read_b128 v[48:51], v7 offset:2048
ds_read_b128 v[52:55], v8 offset:2048
ds_read_b128 v[56:59], v7 offset:4096
ds_read_b128 v[60:63], v8 offset:4096
ds_read_b128 v[64:67], v7 offset:6144
ds_read_b128 v[68:71], v8 offset:6144
s_waitcnt lgkmcnt(4)
v_mfma_f32_16x16x32_bf16 v[72:75], v[48:51], a[144:147], 0
v_mfma_f32_16x16x32_bf16 v[76:79], v[48:51], a[148:151], 0
v_mfma_f32_16x16x32_bf16 v[80:83], v[48:51], a[160:163], 0
v_mfma_f32_16x16x32_bf16 v[84:87], v[48:51], a[164:167], 0
v_mfma_f32_16x16x32_bf16 v[72:75], v[52:55], a[152:155], v[72:75]
v_mfma_f32_16x16x32_bf16 v[76:79], v[52:55], a[156:159], v[76:79]
v_mfma_f32_16x16x32_bf16 v[80:83], v[52:55], a[168:171], v[80:83]
v_mfma_f32_16x16x32_bf16 v[84:87], v[52:55], a[172:175], v[84:87]
s_waitcnt lgkmcnt(2)
v_mfma_f32_16x16x32_bf16 v[88:91], v[56:59], a[144:147], 0
v_mfma_f32_16x16x32_bf16 v[92:95], v[56:59], a[148:151], 0
v_mfma_f32_16x16x32_bf16 v[96:99], v[56:59], a[160:163], 0
s_nop 1
v_cvt_pk_bf16_f32 v104, v72, v76
v_cvt_pk_bf16_f32 v105, v73, v77
v_mfma_f32_16x16x32_bf16 v[100:103], v[56:59], a[164:167], 0
v_cvt_pk_bf16_f32 v106, v74, v78
v_cvt_pk_bf16_f32 v107, v75, v79
v_mfma_f32_16x16x32_bf16 v[88:91], v[60:63], a[152:155], v[88:91]
ds_write_b128 v10, v[104:107] offset:1024
v_cvt_pk_bf16_f32 v108, v80, v84
v_mfma_f32_16x16x32_bf16 v[92:95], v[60:63], a[156:159], v[92:95]
v_cvt_pk_bf16_f32 v109, v81, v85
v_cvt_pk_bf16_f32 v110, v82, v86
v_mfma_f32_16x16x32_bf16 v[96:99], v[60:63], a[168:171], v[96:99]
v_cvt_pk_bf16_f32 v111, v83, v87
ds_write_b128 v10, v[108:111] offset:19456
v_mfma_f32_16x16x32_bf16 v[100:103], v[60:63], a[172:175], v[100:103]
s_waitcnt lgkmcnt(2)
v_mfma_f32_16x16x32_bf16 v[72:75], v[64:67], a[144:147], 0
v_mfma_f32_16x16x32_bf16 v[76:79], v[64:67], a[148:151], 0
v_mfma_f32_16x16x32_bf16 v[80:83], v[64:67], a[160:163], 0
v_cvt_pk_bf16_f32 v104, v88, v92
v_cvt_pk_bf16_f32 v105, v89, v93
v_mfma_f32_16x16x32_bf16 v[84:87], v[64:67], a[164:167], 0
v_cvt_pk_bf16_f32 v106, v90, v94
v_cvt_pk_bf16_f32 v107, v91, v95
v_mfma_f32_16x16x32_bf16 v[72:75], v[68:71], a[152:155], v[72:75]
ds_write_b128 v10, v[104:107] offset:2048
v_cvt_pk_bf16_f32 v108, v96, v100
v_mfma_f32_16x16x32_bf16 v[76:79], v[68:71], a[156:159], v[76:79]
v_cvt_pk_bf16_f32 v109, v97, v101
v_cvt_pk_bf16_f32 v110, v98, v102
v_mfma_f32_16x16x32_bf16 v[80:83], v[68:71], a[168:171], v[80:83]
v_cvt_pk_bf16_f32 v111, v99, v103
ds_write_b128 v10, v[108:111] offset:20480
v_mfma_f32_16x16x32_bf16 v[84:87], v[68:71], a[172:175], v[84:87]
s_nop 1
v_cvt_pk_bf16_f32 v104, v72, v76
v_cvt_pk_bf16_f32 v105, v73, v77
v_cvt_pk_bf16_f32 v106, v74, v78
v_cvt_pk_bf16_f32 v107, v75, v79
ds_write_b128 v10, v[104:107] offset:3072
s_nop 0
v_cvt_pk_bf16_f32 v108, v80, v84
v_cvt_pk_bf16_f32 v109, v81, v85
v_cvt_pk_bf16_f32 v110, v82, v86
v_cvt_pk_bf16_f32 v111, v83, v87
ds_write_b128 v10, v[108:111] offset:21504
s_waitcnt lgkmcnt(0)
s_barrier
ds_read_b128 v[48:51], v7 offset:8192
ds_read_b128 v[52:55], v8 offset:8192
ds_read_b128 v[56:59], v7 offset:10240
ds_read_b128 v[60:63], v8 offset:10240
ds_read_b128 v[64:67], v7 offset:12288
ds_read_b128 v[68:71], v8 offset:12288
s_waitcnt lgkmcnt(4)
v_mfma_f32_16x16x32_bf16 v[88:91], v[48:51], a[144:147], 0
v_mfma_f32_16x16x32_bf16 v[92:95], v[48:51], a[148:151], 0
v_mfma_f32_16x16x32_bf16 v[96:99], v[48:51], a[160:163], 0
v_mfma_f32_16x16x32_bf16 v[100:103], v[48:51], a[164:167], 0
v_mfma_f32_16x16x32_bf16 v[88:91], v[52:55], a[152:155], v[88:91]
v_mfma_f32_16x16x32_bf16 v[92:95], v[52:55], a[156:159], v[92:95]
v_mfma_f32_16x16x32_bf16 v[96:99], v[52:55], a[168:171], v[96:99]
v_mfma_f32_16x16x32_bf16 v[100:103], v[52:55], a[172:175], v[100:103]
s_waitcnt lgkmcnt(2)
v_mfma_f32_16x16x32_bf16 v[72:75], v[56:59], a[144:147], 0
v_mfma_f32_16x16x32_bf16 v[76:79], v[56:59], a[148:151], 0
v_mfma_f32_16x16x32_bf16 v[80:83], v[56:59], a[160:163], 0
s_nop 1
v_cvt_pk_bf16_f32 v104, v88, v92
v_cvt_pk_bf16_f32 v105, v89, v93
v_mfma_f32_16x16x32_bf16 v[84:87], v[56:59], a[164:167], 0
v_cvt_pk_bf16_f32 v106, v90, v94
v_cvt_pk_bf16_f32 v107, v91, v95
v_mfma_f32_16x16x32_bf16 v[72:75], v[60:63], a[152:155], v[72:75]
ds_write_b128 v10, v[104:107] offset:4096
v_cvt_pk_bf16_f32 v108, v96, v100
v_mfma_f32_16x16x32_bf16 v[76:79], v[60:63], a[156:159], v[76:79]
v_cvt_pk_bf16_f32 v109, v97, v101
v_cvt_pk_bf16_f32 v110, v98, v102
v_mfma_f32_16x16x32_bf16 v[80:83], v[60:63], a[168:171], v[80:83]
v_cvt_pk_bf16_f32 v111, v99, v103
ds_write_b128 v10, v[108:111] offset:22528
v_mfma_f32_16x16x32_bf16 v[84:87], v[60:63], a[172:175], v[84:87]
s_waitcnt lgkmcnt(2)
v_mfma_f32_16x16x32_bf16 v[88:91], v[64:67], a[144:147], 0
v_mfma_f32_16x16x32_bf16 v[92:95], v[64:67], a[148:151], 0
v_mfma_f32_16x16x32_bf16 v[96:99], v[64:67], a[160:163], 0
v_cvt_pk_bf16_f32 v104, v72, v76
v_cvt_pk_bf16_f32 v105, v73, v77
v_mfma_f32_16x16x32_bf16 v[100:103], v[64:67], a[164:167], 0
v_cvt_pk_bf16_f32 v106, v74, v78
v_cvt_pk_bf16_f32 v107, v75, v79
v_mfma_f32_16x16x32_bf16 v[88:91], v[68:71], a[152:155], v[88:91]
ds_write_b128 v10, v[104:107] offset:5120
v_cvt_pk_bf16_f32 v108, v80, v84
v_mfma_f32_16x16x32_bf16 v[92:95], v[68:71], a[156:159], v[92:95]
v_cvt_pk_bf16_f32 v109, v81, v85
v_cvt_pk_bf16_f32 v110, v82, v86
v_mfma_f32_16x16x32_bf16 v[96:99], v[68:71], a[168:171], v[96:99]
v_cvt_pk_bf16_f32 v111, v83, v87
ds_write_b128 v10, v[108:111] offset:23552
v_mfma_f32_16x16x32_bf16 v[100:103], v[68:71], a[172:175], v[100:103]
s_nop 1
v_cvt_pk_bf16_f32 v104, v88, v92
v_cvt_pk_bf16_f32 v105, v89, v93
v_cvt_pk_bf16_f32 v106, v90, v94
v_cvt_pk_bf16_f32 v107, v91, v95
ds_write_b128 v10, v[104:107] offset:6144
s_nop 0
v_cvt_pk_bf16_f32 v108, v96, v100
v_cvt_pk_bf16_f32 v109, v97, v101
v_cvt_pk_bf16_f32 v110, v98, v102
v_cvt_pk_bf16_f32 v111, v99, v103
ds_write_b128 v10, v[108:111] offset:24576
ds_read_b128 v[144:147], v11 offset:1024
ds_read_b128 v[148:151], v11 offset:19456
ds_read_b128 v[152:155], v12 offset:1024
ds_read_b128 v[156:159], v12 offset:19456
ds_read_b128 v[160:163], v11 offset:10240
ds_read_b128 v[164:167], v11 offset:28672
ds_read_b128 v[168:171], v12 offset:10240
ds_read_b128 v[172:175], v12 offset:28672
s_waitcnt lgkmcnt(4)
v_mfma_f32_16x16x32_bf16 v[112:115], a[4:7], v[144:147], 0
v_mfma_f32_16x16x32_bf16 v[116:119], a[4:7], v[148:151], 0
v_mfma_f32_16x16x32_bf16 v[120:123], a[4:7], v[152:155], 0
v_mfma_f32_16x16x32_bf16 v[124:127], a[4:7], v[156:159], 0
v_mfma_f32_16x16x32_bf16 v[128:131], a[76:79], v[144:147], 0
ds_read_b128 v[144:147], v11 offset:2048
v_mfma_f32_16x16x32_bf16 v[132:135], a[76:79], v[148:151], 0
ds_read_b128 v[148:151], v11 offset:20480
v_mfma_f32_16x16x32_bf16 v[136:139], a[76:79], v[152:155], 0
ds_read_b128 v[152:155], v12 offset:2048
v_mfma_f32_16x16x32_bf16 v[140:143], a[76:79], v[156:159], 0
ds_read_b128 v[156:159], v12 offset:20480
s_waitcnt lgkmcnt(4)
v_mfma_f32_16x16x32_bf16 v[112:115], a[40:43], v[160:163], v[112:115]
v_mfma_f32_16x16x32_bf16 v[116:119], a[40:43], v[164:167], v[116:119]
v_mfma_f32_16x16x32_bf16 v[120:123], a[40:43], v[168:171], v[120:123]
v_mfma_f32_16x16x32_bf16 v[124:127], a[40:43], v[172:175], v[124:127]
v_mfma_f32_16x16x32_bf16 v[128:131], a[112:115], v[160:163], v[128:131]
ds_read_b128 v[160:163], v11 offset:11264
v_mfma_f32_16x16x32_bf16 v[132:135], a[112:115], v[164:167], v[132:135]
ds_read_b128 v[164:167], v11 offset:29696
v_mfma_f32_16x16x32_bf16 v[136:139], a[112:115], v[168:171], v[136:139]
ds_read_b128 v[168:171], v12 offset:11264
v_mfma_f32_16x16x32_bf16 v[140:143], a[112:115], v[172:175], v[140:143]
ds_read_b128 v[172:175], v12 offset:29696
s_waitcnt lgkmcnt(4)
v_mfma_f32_16x16x32_bf16 v[112:115], a[8:11], v[144:147], v[112:115]
v_mfma_f32_16x16x32_bf16 v[116:119], a[8:11], v[148:151], v[116:119]
v_mfma_f32_16x16x32_bf16 v[120:123], a[8:11], v[152:155], v[120:123]
v_mfma_f32_16x16x32_bf16 v[124:127], a[8:11], v[156:159], v[124:127]
v_mfma_f32_16x16x32_bf16 v[128:131], a[80:83], v[144:147], v[128:131]
ds_read_b128 v[144:147], v11 offset:3072
v_mfma_f32_16x16x32_bf16 v[132:135], a[80:83], v[148:151], v[132:135]
ds_read_b128 v[148:151], v11 offset:21504
v_mfma_f32_16x16x32_bf16 v[136:139], a[80:83], v[152:155], v[136:139]
ds_read_b128 v[152:155], v12 offset:3072
v_mfma_f32_16x16x32_bf16 v[140:143], a[80:83], v[156:159], v[140:143]
ds_read_b128 v[156:159], v12 offset:21504
s_waitcnt lgkmcnt(4)
v_mfma_f32_16x16x32_bf16 v[112:115], a[44:47], v[160:163], v[112:115]
v_mfma_f32_16x16x32_bf16 v[116:119], a[44:47], v[164:167], v[116:119]
v_mfma_f32_16x16x32_bf16 v[120:123], a[44:47], v[168:171], v[120:123]
v_mfma_f32_16x16x32_bf16 v[124:127], a[44:47], v[172:175], v[124:127]
v_mfma_f32_16x16x32_bf16 v[128:131], a[116:119], v[160:163], v[128:131]
ds_read_b128 v[160:163], v11 offset:12288
v_mfma_f32_16x16x32_bf16 v[132:135], a[116:119], v[164:167], v[132:135]
ds_read_b128 v[164:167], v11 offset:30720
v_mfma_f32_16x16x32_bf16 v[136:139], a[116:119], v[168:171], v[136:139]
ds_read_b128 v[168:171], v12 offset:12288
v_mfma_f32_16x16x32_bf16 v[140:143], a[116:119], v[172:175], v[140:143]
ds_read_b128 v[172:175], v12 offset:30720
s_waitcnt lgkmcnt(4)
v_mfma_f32_16x16x32_bf16 v[112:115], a[12:15], v[144:147], v[112:115]
v_mfma_f32_16x16x32_bf16 v[116:119], a[12:15], v[148:151], v[116:119]
v_mfma_f32_16x16x32_bf16 v[120:123], a[12:15], v[152:155], v[120:123]
v_mfma_f32_16x16x32_bf16 v[124:127], a[12:15], v[156:159], v[124:127]
v_mfma_f32_16x16x32_bf16 v[128:131], a[84:87], v[144:147], v[128:131]
v_mfma_f32_16x16x32_bf16 v[132:135], a[84:87], v[148:151], v[132:135]
v_mfma_f32_16x16x32_bf16 v[136:139], a[84:87], v[152:155], v[136:139]
v_mfma_f32_16x16x32_bf16 v[140:143], a[84:87], v[156:159], v[140:143]
s_waitcnt lgkmcnt(0)
v_mfma_f32_16x16x32_bf16 v[112:115], a[48:51], v[160:163], v[112:115]
v_mfma_f32_16x16x32_bf16 v[116:119], a[48:51], v[164:167], v[116:119]
v_mfma_f32_16x16x32_bf16 v[120:123], a[48:51], v[168:171], v[120:123]
v_mfma_f32_16x16x32_bf16 v[124:127], a[48:51], v[172:175], v[124:127]
v_mfma_f32_16x16x32_bf16 v[128:131], a[120:123], v[160:163], v[128:131]
v_mfma_f32_16x16x32_bf16 v[132:135], a[120:123], v[164:167], v[132:135]
v_mfma_f32_16x16x32_bf16 v[136:139], a[120:123], v[168:171], v[136:139]
v_mfma_f32_16x16x32_bf16 v[140:143], a[120:123], v[172:175], v[140:143]
s_waitcnt lgkmcnt(0)
s_barrier
ds_read_b128 v[48:51], v7 offset:14336
ds_read_b128 v[52:55], v8 offset:14336
ds_read_b128 v[56:59], v7 offset:16384
ds_read_b128 v[60:63], v8 offset:16384
ds_read_b128 v[64:67], v7 offset:0
ds_read_b128 v[68:71], v8 offset:0
s_waitcnt lgkmcnt(4)
v_mfma_f32_16x16x32_bf16 v[72:75], v[48:51], a[144:147], 0
v_mfma_f32_16x16x32_bf16 v[76:79], v[48:51], a[148:151], 0
v_mfma_f32_16x16x32_bf16 v[80:83], v[48:51], a[160:163], 0
v_mfma_f32_16x16x32_bf16 v[84:87], v[48:51], a[164:167], 0
v_mfma_f32_16x16x32_bf16 v[72:75], v[52:55], a[152:155], v[72:75]
v_mfma_f32_16x16x32_bf16 v[76:79], v[52:55], a[156:159], v[76:79]
v_mfma_f32_16x16x32_bf16 v[80:83], v[52:55], a[168:171], v[80:83]
v_mfma_f32_16x16x32_bf16 v[84:87], v[52:55], a[172:175], v[84:87]
s_waitcnt lgkmcnt(2)
v_mfma_f32_16x16x32_bf16 v[88:91], v[56:59], a[144:147], 0
v_mfma_f32_16x16x32_bf16 v[92:95], v[56:59], a[148:151], 0
v_mfma_f32_16x16x32_bf16 v[96:99], v[56:59], a[160:163], 0
s_nop 1
v_cvt_pk_bf16_f32 v104, v72, v76
v_cvt_pk_bf16_f32 v105, v73, v77
v_mfma_f32_16x16x32_bf16 v[100:103], v[56:59], a[164:167], 0
v_cvt_pk_bf16_f32 v106, v74, v78
v_cvt_pk_bf16_f32 v107, v75, v79
v_mfma_f32_16x16x32_bf16 v[88:91], v[60:63], a[152:155], v[88:91]
ds_write_b128 v10, v[104:107] offset:7168
v_cvt_pk_bf16_f32 v108, v80, v84
v_mfma_f32_16x16x32_bf16 v[92:95], v[60:63], a[156:159], v[92:95]
v_cvt_pk_bf16_f32 v109, v81, v85
v_cvt_pk_bf16_f32 v110, v82, v86
v_mfma_f32_16x16x32_bf16 v[96:99], v[60:63], a[168:171], v[96:99]
v_cvt_pk_bf16_f32 v111, v83, v87
ds_write_b128 v10, v[108:111] offset:25600
v_mfma_f32_16x16x32_bf16 v[100:103], v[60:63], a[172:175], v[100:103]
s_waitcnt lgkmcnt(2)
v_mfma_f32_16x16x32_bf16 v[72:75], v[64:67], a[144:147], 0
v_mfma_f32_16x16x32_bf16 v[76:79], v[64:67], a[148:151], 0
v_mfma_f32_16x16x32_bf16 v[80:83], v[64:67], a[160:163], 0
v_cvt_pk_bf16_f32 v104, v88, v92
v_cvt_pk_bf16_f32 v105, v89, v93
v_mfma_f32_16x16x32_bf16 v[84:87], v[64:67], a[164:167], 0
v_cvt_pk_bf16_f32 v106, v90, v94
v_cvt_pk_bf16_f32 v107, v91, v95
v_mfma_f32_16x16x32_bf16 v[72:75], v[68:71], a[152:155], v[72:75]
ds_write_b128 v10, v[104:107] offset:8192
v_cvt_pk_bf16_f32 v108, v96, v100
v_mfma_f32_16x16x32_bf16 v[76:79], v[68:71], a[156:159], v[76:79]
v_cvt_pk_bf16_f32 v109, v97, v101
v_cvt_pk_bf16_f32 v110, v98, v102
v_mfma_f32_16x16x32_bf16 v[80:83], v[68:71], a[168:171], v[80:83]
v_cvt_pk_bf16_f32 v111, v99, v103
ds_write_b128 v10, v[108:111] offset:26624
v_mfma_f32_16x16x32_bf16 v[84:87], v[68:71], a[172:175], v[84:87]
s_nop 1
v_cvt_pk_bf16_f32 v104, v72, v76
v_cvt_pk_bf16_f32 v105, v73, v77
v_cvt_pk_bf16_f32 v106, v74, v78
v_cvt_pk_bf16_f32 v107, v75, v79
ds_write_b128 v10, v[104:107] offset:0
s_nop 0
v_cvt_pk_bf16_f32 v108, v80, v84
v_cvt_pk_bf16_f32 v109, v81, v85
v_cvt_pk_bf16_f32 v110, v82, v86
v_cvt_pk_bf16_f32 v111, v83, v87
ds_write_b128 v10, v[108:111] offset:18432
ds_read_b128 v[144:147], v11 offset:4096
ds_read_b128 v[148:151], v11 offset:22528
ds_read_b128 v[152:155], v12 offset:4096
ds_read_b128 v[156:159], v12 offset:22528
ds_read_b128 v[160:163], v11 offset:13312
ds_read_b128 v[164:167], v11 offset:31744
ds_read_b128 v[168:171], v12 offset:13312
ds_read_b128 v[172:175], v12 offset:31744
s_waitcnt lgkmcnt(4)
v_mfma_f32_16x16x32_bf16 v[112:115], a[16:19], v[144:147], v[112:115]
v_mfma_f32_16x16x32_bf16 v[116:119], a[16:19], v[148:151], v[116:119]
v_mfma_f32_16x16x32_bf16 v[120:123], a[16:19], v[152:155], v[120:123]
v_mfma_f32_16x16x32_bf16 v[124:127], a[16:19], v[156:159], v[124:127]
v_mfma_f32_16x16x32_bf16 v[128:131], a[88:91], v[144:147], v[128:131]
ds_read_b128 v[144:147], v11 offset:5120
v_mfma_f32_16x16x32_bf16 v[132:135], a[88:91], v[148:151], v[132:135]
ds_read_b128 v[148:151], v11 offset:23552
v_mfma_f32_16x16x32_bf16 v[136:139], a[88:91], v[152:155], v[136:139]
ds_read_b128 v[152:155], v12 offset:5120
v_mfma_f32_16x16x32_bf16 v[140:143], a[88:91], v[156:159], v[140:143]
ds_read_b128 v[156:159], v12 offset:23552
s_waitcnt lgkmcnt(4)
v_mfma_f32_16x16x32_bf16 v[112:115], a[52:55], v[160:163], v[112:115]
v_mfma_f32_16x16x32_bf16 v[116:119], a[52:55], v[164:167], v[116:119]
v_mfma_f32_16x16x32_bf16 v[120:123], a[52:55], v[168:171], v[120:123]
v_mfma_f32_16x16x32_bf16 v[124:127], a[52:55], v[172:175], v[124:127]
v_mfma_f32_16x16x32_bf16 v[128:131], a[124:127], v[160:163], v[128:131]
ds_read_b128 v[160:163], v11 offset:14336
v_mfma_f32_16x16x32_bf16 v[132:135], a[124:127], v[164:167], v[132:135]
ds_read_b128 v[164:167], v11 offset:32768
v_mfma_f32_16x16x32_bf16 v[136:139], a[124:127], v[168:171], v[136:139]
ds_read_b128 v[168:171], v12 offset:14336
v_mfma_f32_16x16x32_bf16 v[140:143], a[124:127], v[172:175], v[140:143]
ds_read_b128 v[172:175], v12 offset:32768
s_waitcnt lgkmcnt(4)
v_mfma_f32_16x16x32_bf16 v[112:115], a[20:23], v[144:147], v[112:115]
v_mfma_f32_16x16x32_bf16 v[116:119], a[20:23], v[148:151], v[116:119]
v_mfma_f32_16x16x32_bf16 v[120:123], a[20:23], v[152:155], v[120:123]
v_mfma_f32_16x16x32_bf16 v[124:127], a[20:23], v[156:159], v[124:127]
v_mfma_f32_16x16x32_bf16 v[128:131], a[92:95], v[144:147], v[128:131]
ds_read_b128 v[144:147], v11 offset:6144
v_mfma_f32_16x16x32_bf16 v[132:135], a[92:95], v[148:151], v[132:135]
ds_read_b128 v[148:151], v11 offset:24576
v_mfma_f32_16x16x32_bf16 v[136:139], a[92:95], v[152:155], v[136:139]
ds_read_b128 v[152:155], v12 offset:6144
v_mfma_f32_16x16x32_bf16 v[140:143], a[92:95], v[156:159], v[140:143]
ds_read_b128 v[156:159], v12 offset:24576
s_waitcnt lgkmcnt(4)
v_mfma_f32_16x16x32_bf16 v[112:115], a[56:59], v[160:163], v[112:115]
v_mfma_f32_16x16x32_bf16 v[116:119], a[56:59], v[164:167], v[116:119]
v_mfma_f32_16x16x32_bf16 v[120:123], a[56:59], v[168:171], v[120:123]
v_mfma_f32_16x16x32_bf16 v[124:127], a[56:59], v[172:175], v[124:127]
v_mfma_f32_16x16x32_bf16 v[128:131], a[128:131], v[160:163], v[128:131]
ds_read_b128 v[160:163], v11 offset:15360
v_mfma_f32_16x16x32_bf16 v[132:135], a[128:131], v[164:167], v[132:135]
ds_read_b128 v[164:167], v11 offset:33792
v_mfma_f32_16x16x32_bf16 v[136:139], a[128:131], v[168:171], v[136:139]
ds_read_b128 v[168:171], v12 offset:15360
v_mfma_f32_16x16x32_bf16 v[140:143], a[128:131], v[172:175], v[140:143]
ds_read_b128 v[172:175], v12 offset:33792
s_waitcnt lgkmcnt(4)
v_mfma_f32_16x16x32_bf16 v[112:115], a[24:27], v[144:147], v[112:115]
v_mfma_f32_16x16x32_bf16 v[116:119], a[24:27], v[148:151], v[116:119]
v_mfma_f32_16x16x32_bf16 v[120:123], a[24:27], v[152:155], v[120:123]
v_mfma_f32_16x16x32_bf16 v[124:127], a[24:27], v[156:159], v[124:127]
v_mfma_f32_16x16x32_bf16 v[128:131], a[96:99], v[144:147], v[128:131]
v_mfma_f32_16x16x32_bf16 v[132:135], a[96:99], v[148:151], v[132:135]
v_mfma_f32_16x16x32_bf16 v[136:139], a[96:99], v[152:155], v[136:139]
v_mfma_f32_16x16x32_bf16 v[140:143], a[96:99], v[156:159], v[140:143]
s_waitcnt lgkmcnt(0)
v_mfma_f32_16x16x32_bf16 v[112:115], a[60:63], v[160:163], v[112:115]
v_mfma_f32_16x16x32_bf16 v[116:119], a[60:63], v[164:167], v[116:119]
v_mfma_f32_16x16x32_bf16 v[120:123], a[60:63], v[168:171], v[120:123]
v_mfma_f32_16x16x32_bf16 v[124:127], a[60:63], v[172:175], v[124:127]
v_mfma_f32_16x16x32_bf16 v[128:131], a[132:135], v[160:163], v[128:131]
v_mfma_f32_16x16x32_bf16 v[132:135], a[132:135], v[164:167], v[132:135]
v_mfma_f32_16x16x32_bf16 v[136:139], a[132:135], v[168:171], v[136:139]
v_mfma_f32_16x16x32_bf16 v[140:143], a[132:135], v[172:175], v[140:143]
s_waitcnt lgkmcnt(0)
s_barrier
ds_read_b128 v[144:147], v11 offset:7168
ds_read_b128 v[148:151], v11 offset:25600
ds_read_b128 v[152:155], v12 offset:7168
ds_read_b128 v[156:159], v12 offset:25600
ds_read_b128 v[160:163], v11 offset:16384
ds_read_b128 v[164:167], v11 offset:34816
ds_read_b128 v[168:171], v12 offset:16384
ds_read_b128 v[172:175], v12 offset:34816
s_waitcnt lgkmcnt(4)
v_mfma_f32_16x16x32_bf16 v[112:115], a[28:31], v[144:147], v[112:115]
v_mfma_f32_16x16x32_bf16 v[116:119], a[28:31], v[148:151], v[116:119]
v_mfma_f32_16x16x32_bf16 v[120:123], a[28:31], v[152:155], v[120:123]
v_mfma_f32_16x16x32_bf16 v[124:127], a[28:31], v[156:159], v[124:127]
v_mfma_f32_16x16x32_bf16 v[128:131], a[100:103], v[144:147], v[128:131]
ds_read_b128 v[144:147], v11 offset:8192
v_mfma_f32_16x16x32_bf16 v[132:135], a[100:103], v[148:151], v[132:135]
ds_read_b128 v[148:151], v11 offset:26624
v_mfma_f32_16x16x32_bf16 v[136:139], a[100:103], v[152:155], v[136:139]
ds_read_b128 v[152:155], v12 offset:8192
v_mfma_f32_16x16x32_bf16 v[140:143], a[100:103], v[156:159], v[140:143]
ds_read_b128 v[156:159], v12 offset:26624
s_waitcnt lgkmcnt(4)
v_mfma_f32_16x16x32_bf16 v[112:115], a[64:67], v[160:163], v[112:115]
v_mfma_f32_16x16x32_bf16 v[116:119], a[64:67], v[164:167], v[116:119]
v_mfma_f32_16x16x32_bf16 v[120:123], a[64:67], v[168:171], v[120:123]
v_mfma_f32_16x16x32_bf16 v[124:127], a[64:67], v[172:175], v[124:127]
v_mfma_f32_16x16x32_bf16 v[128:131], a[136:139], v[160:163], v[128:131]
ds_read_b128 v[160:163], v11 offset:17408
v_mfma_f32_16x16x32_bf16 v[132:135], a[136:139], v[164:167], v[132:135]
ds_read_b128 v[164:167], v11 offset:35840
v_mfma_f32_16x16x32_bf16 v[136:139], a[136:139], v[168:171], v[136:139]
ds_read_b128 v[168:171], v12 offset:17408
v_mfma_f32_16x16x32_bf16 v[140:143], a[136:139], v[172:175], v[140:143]
ds_read_b128 v[172:175], v12 offset:35840
s_waitcnt lgkmcnt(4)
v_mfma_f32_16x16x32_bf16 v[112:115], a[32:35], v[144:147], v[112:115]
v_mfma_f32_16x16x32_bf16 v[116:119], a[32:35], v[148:151], v[116:119]
v_mfma_f32_16x16x32_bf16 v[120:123], a[32:35], v[152:155], v[120:123]
v_mfma_f32_16x16x32_bf16 v[124:127], a[32:35], v[156:159], v[124:127]
v_mfma_f32_16x16x32_bf16 v[128:131], a[104:107], v[144:147], v[128:131]
ds_read_b128 v[144:147], v11 offset:0
v_mfma_f32_16x16x32_bf16 v[132:135], a[104:107], v[148:151], v[132:135]
ds_read_b128 v[148:151], v11 offset:18432
v_mfma_f32_16x16x32_bf16 v[136:139], a[104:107], v[152:155], v[136:139]
ds_read_b128 v[152:155], v12 offset:0
v_mfma_f32_16x16x32_bf16 v[140:143], a[104:107], v[156:159], v[140:143]
ds_read_b128 v[156:159], v12 offset:18432
s_waitcnt lgkmcnt(4)
v_mfma_f32_16x16x32_bf16 v[112:115], a[68:71], v[160:163], v[112:115]
v_mfma_f32_16x16x32_bf16 v[116:119], a[68:71], v[164:167], v[116:119]
v_mfma_f32_16x16x32_bf16 v[120:123], a[68:71], v[168:171], v[120:123]
v_mfma_f32_16x16x32_bf16 v[124:127], a[68:71], v[172:175], v[124:127]
v_mfma_f32_16x16x32_bf16 v[128:131], a[140:143], v[160:163], v[128:131]
ds_read_b128 v[160:163], v11 offset:9216
v_mfma_f32_16x16x32_bf16 v[132:135], a[140:143], v[164:167], v[132:135]
ds_read_b128 v[164:167], v11 offset:27648
v_mfma_f32_16x16x32_bf16 v[136:139], a[140:143], v[168:171], v[136:139]
ds_read_b128 v[168:171], v12 offset:9216
v_mfma_f32_16x16x32_bf16 v[140:143], a[140:143], v[172:175], v[140:143]
ds_read_b128 v[172:175], v12 offset:27648
s_waitcnt lgkmcnt(4)
v_mfma_f32_16x16x32_bf16 v[112:115], a[0:3], v[144:147], v[112:115]
v_mfma_f32_16x16x32_bf16 v[116:119], a[0:3], v[148:151], v[116:119]
v_mfma_f32_16x16x32_bf16 v[120:123], a[0:3], v[152:155], v[120:123]
v_mfma_f32_16x16x32_bf16 v[124:127], a[0:3], v[156:159], v[124:127]
v_mfma_f32_16x16x32_bf16 v[128:131], a[72:75], v[144:147], v[128:131]
v_mfma_f32_16x16x32_bf16 v[132:135], a[72:75], v[148:151], v[132:135]
v_mfma_f32_16x16x32_bf16 v[136:139], a[72:75], v[152:155], v[136:139]
v_mfma_f32_16x16x32_bf16 v[140:143], a[72:75], v[156:159], v[140:143]
s_waitcnt lgkmcnt(0)
v_mfma_f32_16x16x32_bf16 v[112:115], a[36:39], v[160:163], v[112:115]
v_mfma_f32_16x16x32_bf16 v[116:119], a[36:39], v[164:167], v[116:119]
v_mfma_f32_16x16x32_bf16 v[120:123], a[36:39], v[168:171], v[120:123]
v_mfma_f32_16x16x32_bf16 v[124:127], a[36:39], v[172:175], v[124:127]
v_mfma_f32_16x16x32_bf16 v[128:131], a[108:111], v[160:163], v[128:131]
v_mfma_f32_16x16x32_bf16 v[132:135], a[108:111], v[164:167], v[132:135]
v_mfma_f32_16x16x32_bf16 v[136:139], a[108:111], v[168:171], v[136:139]
v_mfma_f32_16x16x32_bf16 v[140:143], a[108:111], v[172:175], v[140:143]
s_waitcnt vmcnt(0)
s_lshl_b32 s39, s32, 10
s_mul_i32 s40, s23, 73728
s_add_u32 s39, s39, s40
s_add_u32 s39, s39, 4980736
s_lshl_b32 s40, s22, 11
s_add_u32 s40, s40, 147456
v_lshlrev_b32 v13, 9, v4
v_lshl_add_u32 v13, v3, 3, v13
v_add_u32 v13, s40, v13
s_mov_b32 s42, 0x3f803f80
v_cvt_pk_bf16_f32 v180, v112, v113
v_cvt_pk_bf16_f32 v181, v114, v115
v_cvt_pk_bf16_f32 v182, v128, v129
v_cvt_pk_bf16_f32 v183, v130, v131
v_lshlrev_b32 v112, 16, v180
v_and_b32 v113, 0xffff0000, v180
v_lshlrev_b32 v184, 16, v240
v_and_b32 v185, 0xffff0000, v240
v_add_f32 v112, v112, v184
v_add_f32 v113, v113, v185
v_lshlrev_b32 v114, 16, v181
v_and_b32 v115, 0xffff0000, v181
v_lshlrev_b32 v184, 16, v241
v_and_b32 v185, 0xffff0000, v241
v_add_f32 v114, v114, v184
v_add_f32 v115, v115, v185
v_cvt_pk_bf16_f32 v176, v112, v113
v_cvt_pk_bf16_f32 v177, v114, v115
v_lshlrev_b32 v128, 16, v182
v_and_b32 v129, 0xffff0000, v182
v_lshlrev_b32 v184, 16, v242
v_and_b32 v185, 0xffff0000, v242
v_add_f32 v128, v128, v184
v_add_f32 v129, v129, v185
v_lshlrev_b32 v130, 16, v183
v_and_b32 v131, 0xffff0000, v183
v_lshlrev_b32 v184, 16, v243
v_and_b32 v185, 0xffff0000, v243
v_add_f32 v130, v130, v184
v_add_f32 v131, v131, v185
v_cvt_pk_bf16_f32 v178, v128, v129
v_cvt_pk_bf16_f32 v179, v130, v131
s_add_u32 s41, s39, 0
buffer_store_dwordx4 v[176:179], v5, s[8:11], s41 offen sc1
v_dot2_f32_bf16 v186, v176, s42, 0
v_dot2_f32_bf16 v187, v176, v176, 0
v_dot2_f32_bf16 v186, v177, s42, v186
v_dot2_f32_bf16 v187, v177, v177, v187
v_dot2_f32_bf16 v186, v178, s42, v186
v_dot2_f32_bf16 v187, v178, v178, v187
v_dot2_f32_bf16 v186, v179, s42, v186
v_dot2_f32_bf16 v187, v179, v179, v187
s_nop 2
ds_write_b64 v13, v[186:187] offset:0
v_cvt_pk_bf16_f32 v196, v116, v117
v_cvt_pk_bf16_f32 v197, v118, v119
v_cvt_pk_bf16_f32 v198, v132, v133
v_cvt_pk_bf16_f32 v199, v134, v135
v_lshlrev_b32 v116, 16, v196
v_and_b32 v117, 0xffff0000, v196
v_lshlrev_b32 v200, 16, v244
v_and_b32 v201, 0xffff0000, v244
v_add_f32 v116, v116, v200
v_add_f32 v117, v117, v201
v_lshlrev_b32 v118, 16, v197
v_and_b32 v119, 0xffff0000, v197
v_lshlrev_b32 v200, 16, v245
v_and_b32 v201, 0xffff0000, v245
v_add_f32 v118, v118, v200
v_add_f32 v119, v119, v201
v_cvt_pk_bf16_f32 v192, v116, v117
v_cvt_pk_bf16_f32 v193, v118, v119
v_lshlrev_b32 v132, 16, v198
v_and_b32 v133, 0xffff0000, v198
v_lshlrev_b32 v200, 16, v246
v_and_b32 v201, 0xffff0000, v246
v_add_f32 v132, v132, v200
v_add_f32 v133, v133, v201
v_lshlrev_b32 v134, 16, v199
v_and_b32 v135, 0xffff0000, v199
v_lshlrev_b32 v200, 16, v247
v_and_b32 v201, 0xffff0000, v247
v_add_f32 v134, v134, v200
v_add_f32 v135, v135, v201
v_cvt_pk_bf16_f32 v194, v132, v133
v_cvt_pk_bf16_f32 v195, v134, v135
s_add_u32 s41, s39, 18432
buffer_store_dwordx4 v[192:195], v5, s[8:11], s41 offen sc1
v_dot2_f32_bf16 v202, v192, s42, 0
v_dot2_f32_bf16 v203, v192, v192, 0
v_dot2_f32_bf16 v202, v193, s42, v202
v_dot2_f32_bf16 v203, v193, v193, v203
v_dot2_f32_bf16 v202, v194, s42, v202
v_dot2_f32_bf16 v203, v194, v194, v203
v_dot2_f32_bf16 v202, v195, s42, v202
v_dot2_f32_bf16 v203, v195, v195, v203
s_nop 2
ds_write_b64 v13, v[202:203] offset:128
v_cvt_pk_bf16_f32 v212, v120, v121
v_cvt_pk_bf16_f32 v213, v122, v123
v_cvt_pk_bf16_f32 v214, v136, v137
v_cvt_pk_bf16_f32 v215, v138, v139
v_lshlrev_b32 v120, 16, v212
v_and_b32 v121, 0xffff0000, v212
v_lshlrev_b32 v216, 16, v248
v_and_b32 v217, 0xffff0000, v248
v_add_f32 v120, v120, v216
v_add_f32 v121, v121, v217
v_lshlrev_b32 v122, 16, v213
v_and_b32 v123, 0xffff0000, v213
v_lshlrev_b32 v216, 16, v249
v_and_b32 v217, 0xffff0000, v249
v_add_f32 v122, v122, v216
v_add_f32 v123, v123, v217
v_cvt_pk_bf16_f32 v208, v120, v121
v_cvt_pk_bf16_f32 v209, v122, v123
v_lshlrev_b32 v136, 16, v214
v_and_b32 v137, 0xffff0000, v214
v_lshlrev_b32 v216, 16, v250
v_and_b32 v217, 0xffff0000, v250
v_add_f32 v136, v136, v216
v_add_f32 v137, v137, v217
v_lshlrev_b32 v138, 16, v215
v_and_b32 v139, 0xffff0000, v215
v_lshlrev_b32 v216, 16, v251
v_and_b32 v217, 0xffff0000, v251
v_add_f32 v138, v138, v216
v_add_f32 v139, v139, v217
v_cvt_pk_bf16_f32 v210, v136, v137
v_cvt_pk_bf16_f32 v211, v138, v139
s_add_u32 s41, s39, 36864
buffer_store_dwordx4 v[208:211], v5, s[8:11], s41 offen sc1
v_dot2_f32_bf16 v218, v208, s42, 0
v_dot2_f32_bf16 v219, v208, v208, 0
v_dot2_f32_bf16 v218, v209, s42, v218
v_dot2_f32_bf16 v219, v209, v209, v219
v_dot2_f32_bf16 v218, v210, s42, v218
v_dot2_f32_bf16 v219, v210, v210, v219
v_dot2_f32_bf16 v218, v211, s42, v218
v_dot2_f32_bf16 v219, v211, v211, v219
s_nop 2
ds_write_b64 v13, v[218:219] offset:256
v_cvt_pk_bf16_f32 v228, v124, v125
v_cvt_pk_bf16_f32 v229, v126, v127
v_cvt_pk_bf16_f32 v230, v140, v141
v_cvt_pk_bf16_f32 v231, v142, v143
v_lshlrev_b32 v124, 16, v228
v_and_b32 v125, 0xffff0000, v228
v_lshlrev_b32 v232, 16, v252
v_and_b32 v233, 0xffff0000, v252
v_add_f32 v124, v124, v232
v_add_f32 v125, v125, v233
v_lshlrev_b32 v126, 16, v229
v_and_b32 v127, 0xffff0000, v229
v_lshlrev_b32 v232, 16, v253
v_and_b32 v233, 0xffff0000, v253
v_add_f32 v126, v126, v232
v_add_f32 v127, v127, v233
v_cvt_pk_bf16_f32 v224, v124, v125
v_cvt_pk_bf16_f32 v225, v126, v127
v_lshlrev_b32 v140, 16, v230
v_and_b32 v141, 0xffff0000, v230
v_lshlrev_b32 v232, 16, v254
v_and_b32 v233, 0xffff0000, v254
v_add_f32 v140, v140, v232
v_add_f32 v141, v141, v233
v_lshlrev_b32 v142, 16, v231
v_and_b32 v143, 0xffff0000, v231
v_lshlrev_b32 v232, 16, v255
v_and_b32 v233, 0xffff0000, v255
v_add_f32 v142, v142, v232
v_add_f32 v143, v143, v233
v_cvt_pk_bf16_f32 v226, v140, v141
v_cvt_pk_bf16_f32 v227, v142, v143
s_add_u32 s41, s39, 55296
buffer_store_dwordx4 v[224:227], v5, s[8:11], s41 offen sc1
v_dot2_f32_bf16 v234, v224, s42, 0
v_dot2_f32_bf16 v235, v224, v224, 0
v_dot2_f32_bf16 v234, v225, s42, v234
v_dot2_f32_bf16 v235, v225, v225, v235
v_dot2_f32_bf16 v234, v226, s42, v234
v_dot2_f32_bf16 v235, v226, v226, v235
v_dot2_f32_bf16 v234, v227, s42, v234
v_dot2_f32_bf16 v235, v227, v227, v235
s_nop 2
ds_write_b64 v13, v[234:235] offset:384
s_waitcnt lgkmcnt(0)
s_barrier
s_branch k3_kernel_end
k3_kernel_loader:
v_lshrrev_b32 v9, 3, v1
v_and_b32 v11, 7, v1
v_xor_b32 v11, v11, v9
v_lshlrev_b32 v11, 4, v11
v_lshl_add_u32 v9, v9, 7, v11
s_lshl_b32 s33, s23, 1
s_mul_i32 s33, s33, 36864
s_add_u32 s33, s33, 2490368
s_waitcnt lgkmcnt(0)
s_mov_b32 s8, s4
s_and_b32 s9, s5, 0xffff
s_mov_b32 s10, 39878656
s_mov_b32 s11, 0x20000
s_and_b32 s94, s2, 7
s_mul_i32 s94, s94, 1024
s_add_u32 s94, s94, 39849984
s_add_u32 s95, s94, 256
s_add_u32 s61, s94, 512
v_max_u32 v13, 1, v1
v_lshlrev_b32 v13, 2, v13
v_lshlrev_b32 v12, 2, v1
v_and_b32 v11, 15, v1
v_lshlrev_b32 v11, 2, v11
s_mov_b32 s97, 0
pollm_18:
buffer_load_dword v14, v13, s[8:11], s94 offen sc1
buffer_load_dword v15, v12, s[8:11], s95 offen sc1
buffer_load_dword v16, v11, s[8:11], s61 offen sc1
s_waitcnt vmcnt(0)
v_xor_b32 v14, s96, v14
v_xor_b32 v15, s96, v15
v_or_b32 v14, v14, v15
v_xor_b32 v16, s96, v16
v_or_b32 v14, v14, v16
v_cmp_ne_u32 vcc, 0, v14
s_add_u32 s97, s97, 1
s_cmp_gt_u32 s97, 200000
s_cbranch_scc1 pollm_18_d
s_cmp_eq_u64 vcc, 0
s_cbranch_scc1 pollm_18_d
s_sleep 2
s_branch pollm_18
pollm_18_d:
s_add_u32 s34, s33, 2048
s_mov_b32 m0, 2048
s_nop 0
buffer_load_dwordx4 v9, s[8:11], s34 offen sc1 lds
buffer_load_dwordx4 v9, s[8:11], s34 offen offset:1024 sc1 lds
s_add_u32 s34, s33, 20480
s_mov_b32 m0, 20480
s_nop 0
buffer_load_dwordx4 v9, s[8:11], s34 offen sc1 lds
buffer_load_dwordx4 v9, s[8:11], s34 offen offset:1024 sc1 lds
s_add_u32 s34, s33, 38912
s_mov_b32 m0, 38912
s_nop 0
buffer_load_dwordx4 v9, s[8:11], s34 offen sc1 lds
buffer_load_dwordx4 v9, s[8:11], s34 offen offset:1024 sc1 lds
s_add_u32 s34, s33, 57344
s_mov_b32 m0, 57344
s_nop 0
buffer_load_dwordx4 v9, s[8:11], s34 offen sc1 lds
buffer_load_dwordx4 v9, s[8:11], s34 offen offset:1024 sc1 lds
s_add_u32 s34, s33, 4096
s_mov_b32 m0, 4096
s_nop 0
buffer_load_dwordx4 v9, s[8:11], s34 offen sc1 lds
buffer_load_dwordx4 v9, s[8:11], s34 offen offset:1024 sc1 lds
s_add_u32 s34, s33, 22528
s_mov_b32 m0, 22528
s_nop 0
buffer_load_dwordx4 v9, s[8:11], s34 offen sc1 lds
buffer_load_dwordx4 v9, s[8:11], s34 offen offset:1024 sc1 lds
s_add_u32 s34, s33, 40960
s_mov_b32 m0, 40960
s_nop 0
buffer_load_dwordx4 v9, s[8:11], s34 offen sc1 lds
buffer_load_dwordx4 v9, s[8:11], s34 offen offset:1024 sc1 lds
s_add_u32 s34, s33, 59392
s_mov_b32 m0, 59392
s_nop 0
buffer_load_dwordx4 v9, s[8:11], s34 offen sc1 lds
buffer_load_dwordx4 v9, s[8:11], s34 offen offset:1024 sc1 lds
s_add_u32 s34, s33, 6144
s_mov_b32 m0, 6144
s_nop 0
buffer_load_dwordx4 v9, s[8:11], s34 offen sc1 lds
buffer_load_dwordx4 v9, s[8:11], s34 offen offset:1024 sc1 lds
s_add_u32 s34, s33, 24576
s_mov_b32 m0, 24576
s_nop 0
buffer_load_dwordx4 v9, s[8:11], s34 offen sc1 lds
buffer_load_dwordx4 v9, s[8:11], s34 offen offset:1024 sc1 lds
s_add_u32 s34, s33, 43008
s_mov_b32 m0, 43008
s_nop 0
buffer_load_dwordx4 v9, s[8:11], s34 offen sc1 lds
buffer_load_dwordx4 v9, s[8:11], s34 offen offset:1024 sc1 lds
s_add_u32 s34, s33, 61440
s_mov_b32 m0, 61440
s_nop 0
buffer_load_dwordx4 v9, s[8:11], s34 offen sc1 lds
buffer_load_dwordx4 v9, s[8:11], s34 offen offset:1024 sc1 lds
s_add_u32 s34, s33, 8192
s_mov_b32 m0, 8192
s_nop 0
buffer_load_dwordx4 v9, s[8:11], s34 offen sc1 lds
buffer_load_dwordx4 v9, s[8:11], s34 offen offset:1024 sc1 lds
s_add_u32 s34, s33, 26624
s_mov_b32 m0, 26624
s_nop 0
buffer_load_dwordx4 v9, s[8:11], s34 offen sc1 lds
buffer_load_dwordx4 v9, s[8:11], s34 offen offset:1024 sc1 lds
s_add_u32 s34, s33, 45056
s_mov_b32 m0, 45056
s_nop 0
buffer_load_dwordx4 v9, s[8:11], s34 offen sc1 lds
buffer_load_dwordx4 v9, s[8:11], s34 offen offset:1024 sc1 lds
s_add_u32 s34, s33, 63488
s_mov_b32 m0, 63488
s_nop 0
buffer_load_dwordx4 v9, s[8:11], s34 offen sc1 lds
buffer_load_dwordx4 v9, s[8:11], s34 offen offset:1024 sc1 lds
s_add_u32 s34, s33, 10240
s_mov_b32 m0, 10240
s_nop 0
buffer_load_dwordx4 v9, s[8:11], s34 offen sc1 lds
buffer_load_dwordx4 v9, s[8:11], s34 offen offset:1024 sc1 lds
s_add_u32 s34, s33, 28672
s_mov_b32 m0, 28672
s_nop 0
buffer_load_dwordx4 v9, s[8:11], s34 offen sc1 lds
buffer_load_dwordx4 v9, s[8:11], s34 offen offset:1024 sc1 lds
s_add_u32 s34, s33, 47104
s_mov_b32 m0, 47104
s_nop 0
buffer_load_dwordx4 v9, s[8:11], s34 offen sc1 lds
buffer_load_dwordx4 v9, s[8:11], s34 offen offset:1024 sc1 lds
s_add_u32 s34, s33, 65536
s_mov_b32 m0, 65536
s_nop 0
buffer_load_dwordx4 v9, s[8:11], s34 offen sc1 lds
buffer_load_dwordx4 v9, s[8:11], s34 offen offset:1024 sc1 lds
s_add_u32 s34, s33, 12288
s_mov_b32 m0, 12288
s_nop 0
buffer_load_dwordx4 v9, s[8:11], s34 offen sc1 lds
buffer_load_dwordx4 v9, s[8:11], s34 offen offset:1024 sc1 lds
s_add_u32 s34, s33, 30720
s_mov_b32 m0, 30720
s_nop 0
buffer_load_dwordx4 v9, s[8:11], s34 offen sc1 lds
buffer_load_dwordx4 v9, s[8:11], s34 offen offset:1024 sc1 lds
s_add_u32 s34, s33, 49152
s_mov_b32 m0, 49152
s_nop 0
buffer_load_dwordx4 v9, s[8:11], s34 offen sc1 lds
buffer_load_dwordx4 v9, s[8:11], s34 offen offset:1024 sc1 lds
s_add_u32 s34, s33, 67584
s_mov_b32 m0, 67584
s_nop 0
buffer_load_dwordx4 v9, s[8:11], s34 offen sc1 lds
buffer_load_dwordx4 v9, s[8:11], s34 offen offset:1024 sc1 lds
s_add_u32 s34, s33, 14336
s_mov_b32 m0, 14336
s_nop 0
buffer_load_dwordx4 v9, s[8:11], s34 offen sc1 lds
buffer_load_dwordx4 v9, s[8:11], s34 offen offset:1024 sc1 lds
s_add_u32 s34, s33, 32768
s_mov_b32 m0, 32768
s_nop 0
buffer_load_dwordx4 v9, s[8:11], s34 offen sc1 lds
buffer_load_dwordx4 v9, s[8:11], s34 offen offset:1024 sc1 lds
s_add_u32 s34, s33, 51200
s_mov_b32 m0, 51200
s_nop 0
buffer_load_dwordx4 v9, s[8:11], s34 offen sc1 lds
buffer_load_dwordx4 v9, s[8:11], s34 offen offset:1024 sc1 lds
s_add_u32 s34, s33, 69632
s_mov_b32 m0, 69632
s_nop 0
buffer_load_dwordx4 v9, s[8:11], s34 offen sc1 lds
buffer_load_dwordx4 v9, s[8:11], s34 offen offset:1024 sc1 lds
s_add_u32 s34, s33, 16384
s_mov_b32 m0, 16384
s_nop 0
buffer_load_dwordx4 v9, s[8:11], s34 offen sc1 lds
buffer_load_dwordx4 v9, s[8:11], s34 offen offset:1024 sc1 lds
s_add_u32 s34, s33, 34816
s_mov_b32 m0, 34816
s_nop 0
buffer_load_dwordx4 v9, s[8:11], s34 offen sc1 lds
buffer_load_dwordx4 v9, s[8:11], s34 offen offset:1024 sc1 lds
s_add_u32 s34, s33, 53248
s_mov_b32 m0, 53248
s_nop 0
buffer_load_dwordx4 v9, s[8:11], s34 offen sc1 lds
buffer_load_dwordx4 v9, s[8:11], s34 offen offset:1024 sc1 lds
s_add_u32 s34, s33, 71680
s_mov_b32 m0, 71680
s_nop 0
buffer_load_dwordx4 v9, s[8:11], s34 offen sc1 lds
buffer_load_dwordx4 v9, s[8:11], s34 offen offset:1024 sc1 lds
s_waitcnt vmcnt(40)
s_barrier
ds_read_b128 v[48:51], v7 offset:2048
ds_read_b128 v[52:55], v8 offset:2048
ds_read_b128 v[56:59], v7 offset:4096
ds_read_b128 v[60:63], v8 offset:4096
ds_read_b128 v[64:67], v7 offset:6144
ds_read_b128 v[68:71], v8 offset:6144
s_waitcnt lgkmcnt(4)
v_mfma_f32_16x16x32_bf16 v[72:75], v[48:51], a[144:147], 0
v_mfma_f32_16x16x32_bf16 v[76:79], v[48:51], a[148:151], 0
v_mfma_f32_16x16x32_bf16 v[80:83], v[48:51], a[160:163], 0
v_mfma_f32_16x16x32_bf16 v[84:87], v[48:51], a[164:167], 0
v_mfma_f32_16x16x32_bf16 v[72:75], v[52:55], a[152:155], v[72:75]
v_mfma_f32_16x16x32_bf16 v[76:79], v[52:55], a[156:159], v[76:79]
v_mfma_f32_16x16x32_bf16 v[80:83], v[52:55], a[168:171], v[80:83]
v_mfma_f32_16x16x32_bf16 v[84:87], v[52:55], a[172:175], v[84:87]
s_waitcnt lgkmcnt(2)
v_mfma_f32_16x16x32_bf16 v[88:91], v[56:59], a[144:147], 0
v_mfma_f32_16x16x32_bf16 v[92:95], v[56:59], a[148:151], 0
v_mfma_f32_16x16x32_bf16 v[96:99], v[56:59], a[160:163], 0
s_nop 1
v_cvt_pk_bf16_f32 v104, v72, v76
v_cvt_pk_bf16_f32 v105, v73, v77
v_mfma_f32_16x16x32_bf16 v[100:103], v[56:59], a[164:167], 0
v_cvt_pk_bf16_f32 v106, v74, v78
v_cvt_pk_bf16_f32 v107, v75, v79
v_mfma_f32_16x16x32_bf16 v[88:91], v[60:63], a[152:155], v[88:91]
ds_write_b128 v10, v[104:107] offset:1024
v_cvt_pk_bf16_f32 v108, v80, v84
v_mfma_f32_16x16x32_bf16 v[92:95], v[60:63], a[156:159], v[92:95]
v_cvt_pk_bf16_f32 v109, v81, v85
v_cvt_pk_bf16_f32 v110, v82, v86
v_mfma_f32_16x16x32_bf16 v[96:99], v[60:63], a[168:171], v[96:99]
v_cvt_pk_bf16_f32 v111, v83, v87
ds_write_b128 v10, v[108:111] offset:19456
v_mfma_f32_16x16x32_bf16 v[100:103], v[60:63], a[172:175], v[100:103]
s_waitcnt lgkmcnt(2)
v_mfma_f32_16x16x32_bf16 v[72:75], v[64:67], a[144:147], 0
v_mfma_f32_16x16x32_bf16 v[76:79], v[64:67], a[148:151], 0
v_mfma_f32_16x16x32_bf16 v[80:83], v[64:67], a[160:163], 0
v_cvt_pk_bf16_f32 v104, v88, v92
v_cvt_pk_bf16_f32 v105, v89, v93
v_mfma_f32_16x16x32_bf16 v[84:87], v[64:67], a[164:167], 0
v_cvt_pk_bf16_f32 v106, v90, v94
v_cvt_pk_bf16_f32 v107, v91, v95
v_mfma_f32_16x16x32_bf16 v[72:75], v[68:71], a[152:155], v[72:75]
ds_write_b128 v10, v[104:107] offset:2048
v_cvt_pk_bf16_f32 v108, v96, v100
v_mfma_f32_16x16x32_bf16 v[76:79], v[68:71], a[156:159], v[76:79]
v_cvt_pk_bf16_f32 v109, v97, v101
v_cvt_pk_bf16_f32 v110, v98, v102
v_mfma_f32_16x16x32_bf16 v[80:83], v[68:71], a[168:171], v[80:83]
v_cvt_pk_bf16_f32 v111, v99, v103
ds_write_b128 v10, v[108:111] offset:20480
v_mfma_f32_16x16x32_bf16 v[84:87], v[68:71], a[172:175], v[84:87]
s_nop 1
v_cvt_pk_bf16_f32 v104, v72, v76
v_cvt_pk_bf16_f32 v105, v73, v77
v_cvt_pk_bf16_f32 v106, v74, v78
v_cvt_pk_bf16_f32 v107, v75, v79
ds_write_b128 v10, v[104:107] offset:3072
s_nop 0
v_cvt_pk_bf16_f32 v108, v80, v84
v_cvt_pk_bf16_f32 v109, v81, v85
v_cvt_pk_bf16_f32 v110, v82, v86
v_cvt_pk_bf16_f32 v111, v83, v87
ds_write_b128 v10, v[108:111] offset:21504
s_waitcnt vmcnt(16)
s_waitcnt lgkmcnt(0)
s_barrier
ds_read_b128 v[48:51], v7 offset:8192
ds_read_b128 v[52:55], v8 offset:8192
ds_read_b128 v[56:59], v7 offset:10240
ds_read_b128 v[60:63], v8 offset:10240
ds_read_b128 v[64:67], v7 offset:12288
ds_read_b128 v[68:71], v8 offset:12288
s_waitcnt lgkmcnt(4)
v_mfma_f32_16x16x32_bf16 v[88:91], v[48:51], a[144:147], 0
v_mfma_f32_16x16x32_bf16 v[92:95], v[48:51], a[148:151], 0
v_mfma_f32_16x16x32_bf16 v[96:99], v[48:51], a[160:163], 0
v_mfma_f32_16x16x32_bf16 v[100:103], v[48:51], a[164:167], 0
v_mfma_f32_16x16x32_bf16 v[88:91], v[52:55], a[152:155], v[88:91]
v_mfma_f32_16x16x32_bf16 v[92:95], v[52:55], a[156:159], v[92:95]
v_mfma_f32_16x16x32_bf16 v[96:99], v[52:55], a[168:171], v[96:99]
v_mfma_f32_16x16x32_bf16 v[100:103], v[52:55], a[172:175], v[100:103]
s_waitcnt lgkmcnt(2)
v_mfma_f32_16x16x32_bf16 v[72:75], v[56:59], a[144:147], 0
v_mfma_f32_16x16x32_bf16 v[76:79], v[56:59], a[148:151], 0
v_mfma_f32_16x16x32_bf16 v[80:83], v[56:59], a[160:163], 0
s_nop 1
v_cvt_pk_bf16_f32 v104, v88, v92
v_cvt_pk_bf16_f32 v105, v89, v93
v_mfma_f32_16x16x32_bf16 v[84:87], v[56:59], a[164:167], 0
v_cvt_pk_bf16_f32 v106, v90, v94
v_cvt_pk_bf16_f32 v107, v91, v95
v_mfma_f32_16x16x32_bf16 v[72:75], v[60:63], a[152:155], v[72:75]
ds_write_b128 v10, v[104:107] offset:4096
v_cvt_pk_bf16_f32 v108, v96, v100
v_mfma_f32_16x16x32_bf16 v[76:79], v[60:63], a[156:159], v[76:79]
v_cvt_pk_bf16_f32 v109, v97, v101
v_cvt_pk_bf16_f32 v110, v98, v102
v_mfma_f32_16x16x32_bf16 v[80:83], v[60:63], a[168:171], v[80:83]
v_cvt_pk_bf16_f32 v111, v99, v103
ds_write_b128 v10, v[108:111] offset:22528
v_mfma_f32_16x16x32_bf16 v[84:87], v[60:63], a[172:175], v[84:87]
s_waitcnt lgkmcnt(2)
v_mfma_f32_16x16x32_bf16 v[88:91], v[64:67], a[144:147], 0
v_mfma_f32_16x16x32_bf16 v[92:95], v[64:67], a[148:151], 0
v_mfma_f32_16x16x32_bf16 v[96:99], v[64:67], a[160:163], 0
v_cvt_pk_bf16_f32 v104, v72, v76
v_cvt_pk_bf16_f32 v105, v73, v77
v_mfma_f32_16x16x32_bf16 v[100:103], v[64:67], a[164:167], 0
v_cvt_pk_bf16_f32 v106, v74, v78
v_cvt_pk_bf16_f32 v107, v75, v79
v_mfma_f32_16x16x32_bf16 v[88:91], v[68:71], a[152:155], v[88:91]
ds_write_b128 v10, v[104:107] offset:5120
v_cvt_pk_bf16_f32 v108, v80, v84
v_mfma_f32_16x16x32_bf16 v[92:95], v[68:71], a[156:159], v[92:95]
v_cvt_pk_bf16_f32 v109, v81, v85
v_cvt_pk_bf16_f32 v110, v82, v86
v_mfma_f32_16x16x32_bf16 v[96:99], v[68:71], a[168:171], v[96:99]
v_cvt_pk_bf16_f32 v111, v83, v87
ds_write_b128 v10, v[108:111] offset:23552
v_mfma_f32_16x16x32_bf16 v[100:103], v[68:71], a[172:175], v[100:103]
s_nop 1
v_cvt_pk_bf16_f32 v104, v88, v92
v_cvt_pk_bf16_f32 v105, v89, v93
v_cvt_pk_bf16_f32 v106, v90, v94
v_cvt_pk_bf16_f32 v107, v91, v95
ds_write_b128 v10, v[104:107] offset:6144
s_nop 0
v_cvt_pk_bf16_f32 v108, v96, v100
v_cvt_pk_bf16_f32 v109, v97, v101
v_cvt_pk_bf16_f32 v110, v98, v102
v_cvt_pk_bf16_f32 v111, v99, v103
ds_write_b128 v10, v[108:111] offset:24576
v_mov_b32 v12, 0
s_mov_b32 s97, 0
poll_19:
buffer_load_dword v13, v12, s[8:11], s94 offen sc1
s_waitcnt vmcnt(0)
v_cmp_ne_u32 vcc, s96, v13
s_add_u32 s97, s97, 1
s_cmp_gt_u32 s97, 200000
s_cbranch_scc1 poll_19_d
s_cmp_eq_u64 vcc, 0
s_cbranch_scc1 poll_19_d
s_sleep 2
s_branch poll_19
poll_19_d:
s_add_u32 s34, s33, 0
s_mov_b32 m0, 0
s_nop 0
buffer_load_dwordx4 v9, s[8:11], s34 offen sc1 lds
buffer_load_dwordx4 v9, s[8:11], s34 offen offset:1024 sc1 lds
s_add_u32 s34, s33, 18432
s_mov_b32 m0, 18432
s_nop 0
buffer_load_dwordx4 v9, s[8:11], s34 offen sc1 lds
buffer_load_dwordx4 v9, s[8:11], s34 offen offset:1024 sc1 lds
s_add_u32 s34, s33, 36864
s_mov_b32 m0, 36864
s_nop 0
buffer_load_dwordx4 v9, s[8:11], s34 offen sc1 lds
buffer_load_dwordx4 v9, s[8:11], s34 offen offset:1024 sc1 lds
s_add_u32 s34, s33, 55296
s_mov_b32 m0, 55296
s_nop 0
buffer_load_dwordx4 v9, s[8:11], s34 offen sc1 lds
buffer_load_dwordx4 v9, s[8:11], s34 offen offset:1024 sc1 lds
s_waitcnt vmcnt(0)
s_waitcnt lgkmcnt(0)
s_barrier
ds_read_b128 v[48:51], v7 offset:14336
ds_read_b128 v[52:55], v8 offset:14336
ds_read_b128 v[56:59], v7 offset:16384
ds_read_b128 v[60:63], v8 offset:16384
ds_read_b128 v[64:67], v7 offset:0
ds_read_b128 v[68:71], v8 offset:0
s_waitcnt lgkmcnt(4)
v_mfma_f32_16x16x32_bf16 v[72:75], v[48:51], a[144:147], 0
v_mfma_f32_16x16x32_bf16 v[76:79], v[48:51], a[148:151], 0
v_mfma_f32_16x16x32_bf16 v[80:83], v[48:51], a[160:163], 0
v_mfma_f32_16x16x32_bf16 v[84:87], v[48:51], a[164:167], 0
v_mfma_f32_16x16x32_bf16 v[72:75], v[52:55], a[152:155], v[72:75]
v_mfma_f32_16x16x32_bf16 v[76:79], v[52:55], a[156:159], v[76:79]
v_mfma_f32_16x16x32_bf16 v[80:83], v[52:55], a[168:171], v[80:83]
v_mfma_f32_16x16x32_bf16 v[84:87], v[52:55], a[172:175], v[84:87]
s_waitcnt lgkmcnt(2)
v_mfma_f32_16x16x32_bf16 v[88:91], v[56:59], a[144:147], 0
v_mfma_f32_16x16x32_bf16 v[92:95], v[56:59], a[148:151], 0
v_mfma_f32_16x16x32_bf16 v[96:99], v[56:59], a[160:163], 0
s_nop 1
v_cvt_pk_bf16_f32 v104, v72, v76
v_cvt_pk_bf16_f32 v105, v73, v77
v_mfma_f32_16x16x32_bf16 v[100:103], v[56:59], a[164:167], 0
v_cvt_pk_bf16_f32 v106, v74, v78
v_cvt_pk_bf16_f32 v107, v75, v79
v_mfma_f32_16x16x32_bf16 v[88:91], v[60:63], a[152:155], v[88:91]
ds_write_b128 v10, v[104:107] offset:7168
v_cvt_pk_bf16_f32 v108, v80, v84
v_mfma_f32_16x16x32_bf16 v[92:95], v[60:63], a[156:159], v[92:95]
v_cvt_pk_bf16_f32 v109, v81, v85
v_cvt_pk_bf16_f32 v110, v82, v86
v_mfma_f32_16x16x32_bf16 v[96:99], v[60:63], a[168:171], v[96:99]
v_cvt_pk_bf16_f32 v111, v83, v87
ds_write_b128 v10, v[108:111] offset:25600
v_mfma_f32_16x16x32_bf16 v[100:103], v[60:63], a[172:175], v[100:103]
s_waitcnt lgkmcnt(2)
v_mfma_f32_16x16x32_bf16 v[72:75], v[64:67], a[144:147], 0
v_mfma_f32_16x16x32_bf16 v[76:79], v[64:67], a[148:151], 0
v_mfma_f32_16x16x32_bf16 v[80:83], v[64:67], a[160:163], 0
v_cvt_pk_bf16_f32 v104, v88, v92
v_cvt_pk_bf16_f32 v105, v89, v93
v_mfma_f32_16x16x32_bf16 v[84:87], v[64:67], a[164:167], 0
v_cvt_pk_bf16_f32 v106, v90, v94
v_cvt_pk_bf16_f32 v107, v91, v95
v_mfma_f32_16x16x32_bf16 v[72:75], v[68:71], a[152:155], v[72:75]
ds_write_b128 v10, v[104:107] offset:8192
v_cvt_pk_bf16_f32 v108, v96, v100
v_mfma_f32_16x16x32_bf16 v[76:79], v[68:71], a[156:159], v[76:79]
v_cvt_pk_bf16_f32 v109, v97, v101
v_cvt_pk_bf16_f32 v110, v98, v102
v_mfma_f32_16x16x32_bf16 v[80:83], v[68:71], a[168:171], v[80:83]
v_cvt_pk_bf16_f32 v111, v99, v103
ds_write_b128 v10, v[108:111] offset:26624
v_mfma_f32_16x16x32_bf16 v[84:87], v[68:71], a[172:175], v[84:87]
s_nop 1
v_cvt_pk_bf16_f32 v104, v72, v76
v_cvt_pk_bf16_f32 v105, v73, v77
v_cvt_pk_bf16_f32 v106, v74, v78
v_cvt_pk_bf16_f32 v107, v75, v79
ds_write_b128 v10, v[104:107] offset:0
s_nop 0
v_cvt_pk_bf16_f32 v108, v80, v84
v_cvt_pk_bf16_f32 v109, v81, v85
v_cvt_pk_bf16_f32 v110, v82, v86
v_cvt_pk_bf16_f32 v111, v83, v87
ds_write_b128 v10, v[108:111] offset:18432
s_waitcnt lgkmcnt(0)
s_barrier
s_mov_b32 s16, s52
s_and_b32 s17, s53, 0xffff
s_mov_b32 s18, 9216
s_mov_b32 s19, 0x20000
v_lshlrev_b32 v12, 2, v1
s_mov_b32 s87, 39847936
s_mov_b32 s97, 0
poll_20:
buffer_load_dword v13, v12, s[8:11], s87 offen sc1
s_waitcnt vmcnt(0)
v_cmp_ne_u32 vcc, s96, v13
s_add_u32 s97, s97, 1
s_cmp_gt_u32 s97, 200000
s_cbranch_scc1 poll_20_d
s_cmp_eq_u64 vcc, 0
s_cbranch_scc1 poll_20_d
s_sleep 2
s_branch poll_20
poll_20_d:
s_and_b32 s44, s23, 3
s_lshl_b32 s44, s44, 1
s_bfe_u32 s51, s23, 0x10002
s_add_u32 s54, s44, s51
s_xor_b32 s51, s51, 1
s_add_u32 s55, s44, s51
s_lshr_b32 s45, s23, 3
s_lshl_b32 s46, s24, 2
s_add_u32 s45, s45, s46
s_lshl_b32 s46, s45, 1
s_add_u32 s47, s45, 12
s_cmp_lt_u32 s45, 12
s_cselect_b32 s46, s46, s47
s_mul_i32 s47, s54, 36
s_add_u32 s46, s46, s47
s_mul_i32 s47, s46, 18432
s_add_u32 s47, s47, 9961472
s_sub_u32 s56, s45, 12
s_mul_i32 s56, s56, 12
s_mul_hi_u32 s57, s56, 119304648
s_mul_i32 s58, s57, 36
s_sub_u32 s56, s56, s58
s_lshl_b32 s58, s55, 2
s_add_u32 s58, s58, s57
s_mul_i32 s58, s58, 162
s_add_u32 s56, s56, s58
s_lshl_b32 s56, s56, 10
s_add_u32 s56, s56, 9961472
s_add_u32 s57, s47, 18432
s_cmp_lt_u32 s45, 12
s_cselect_b32 s56, s57, s56
s_lshl_b32 s48, s46, 5
v_lshlrev_b32 v6, 1, v3
buffer_load_ushort v160, v6, s[16:19], s48 offen offset:0
buffer_load_ushort v161, v6, s[16:19], s48 offen offset:32
s_add_u32 s59, s47, 0
buffer_load_dwordx4 v[16:19], v5, s[8:11], s59 offen offset:0 sc1
buffer_load_dwordx4 v[20:23], v5, s[8:11], s59 offen offset:1024 sc1
buffer_load_dwordx4 v[24:27], v5, s[8:11], s59 offen offset:2048 sc1
buffer_load_dwordx4 v[28:31], v5, s[8:11], s59 offen offset:3072 sc1
s_add_u32 s59, s47, 4096
buffer_load_dwordx4 v[32:35], v5, s[8:11], s59 offen offset:0 sc1
buffer_load_dwordx4 v[36:39], v5, s[8:11], s59 offen offset:1024 sc1
buffer_load_dwordx4 v[40:43], v5, s[8:11], s59 offen offset:2048 sc1
buffer_load_dwordx4 v[44:47], v5, s[8:11], s59 offen offset:3072 sc1
s_add_u32 s59, s47, 8192
buffer_load_dwordx4 v[48:51], v5, s[8:11], s59 offen offset:0 sc1
buffer_load_dwordx4 v[52:55], v5, s[8:11], s59 offen offset:1024 sc1
buffer_load_dwordx4 v[56:59], v5, s[8:11], s59 offen offset:2048 sc1
buffer_load_dwordx4 v[60:63], v5, s[8:11], s59 offen offset:3072 sc1
s_add_u32 s59, s47, 12288
buffer_load_dwordx4 v[64:67], v5, s[8:11], s59 offen offset:0 sc1
buffer_load_dwordx4 v[68:71], v5, s[8:11], s59 offen offset:1024 sc1
buffer_load_dwordx4 v[72:75], v5, s[8:11], s59 offen offset:2048 sc1
buffer_load_dwordx4 v[76:79], v5, s[8:11], s59 offen offset:3072 sc1
s_add_u32 s59, s47, 16384
buffer_load_dwordx4 v[80:83], v5, s[8:11], s59 offen offset:0 sc1
buffer_load_dwordx4 v[84:87], v5, s[8:11], s59 offen offset:1024 sc1
s_add_u32 s59, s56, 0
buffer_load_dwordx4 v[88:91], v5, s[8:11], s59 offen offset:0 sc1
buffer_load_dwordx4 v[92:95], v5, s[8:11], s59 offen offset:1024 sc1
buffer_load_dwordx4 v[96:99], v5, s[8:11], s59 offen offset:2048 sc1
buffer_load_dwordx4 v[100:103], v5, s[8:11], s59 offen offset:3072 sc1
s_add_u32 s59, s56, 4096
buffer_load_dwordx4 v[104:107], v5, s[8:11], s59 offen offset:0 sc1
buffer_load_dwordx4 v[108:111], v5, s[8:11], s59 offen offset:1024 sc1
buffer_load_dwordx4 v[112:115], v5, s[8:11], s59 offen offset:2048 sc1
buffer_load_dwordx4 v[116:119], v5, s[8:11], s59 offen offset:3072 sc1
s_add_u32 s59, s56, 8192
buffer_load_dwordx4 v[120:123], v5, s[8:11], s59 offen offset:0 sc1
buffer_load_dwordx4 v[124:127], v5, s[8:11], s59 offen offset:1024 sc1
buffer_load_dwordx4 v[128:131], v5, s[8:11], s59 offen offset:2048 sc1
buffer_load_dwordx4 v[132:135], v5, s[8:11], s59 offen offset:3072 sc1
s_add_u32 s59, s56, 12288
buffer_load_dwordx4 v[136:139], v5, s[8:11], s59 offen offset:0 sc1
buffer_load_dwordx4 v[140:143], v5, s[8:11], s59 offen offset:1024 sc1
buffer_load_dwordx4 v[144:147], v5, s[8:11], s59 offen offset:2048 sc1
buffer_load_dwordx4 v[148:151], v5, s[8:11], s59 offen offset:3072 sc1
s_add_u32 s59, s56, 16384
buffer_load_dwordx4 v[152:155], v5, s[8:11], s59 offen offset:0 sc1
buffer_load_dwordx4 v[156:159], v5, s[8:11], s59 offen offset:1024 sc1
s_mov_b32 s49, 0x3f803f80
v_lshrrev_b32 v8, 2, v3
v_lshlrev_b32 v8, 5, v8
v_and_b32 v9, 3, v3
v_lshl_add_u32 v8, v9, 2, v8
v_mov_b32 v9, 0x7fffff00
v_cmp_gt_u32 vcc, 16, v1
s_nop 1
v_cndmask_b32 v8, v9, v8, vcc
s_lshl_b32 s50, s46, 7
s_add_u32 s50, s50, 9895936
v_lshlrev_b32 v13, 3, v1
v_add_u32 v13, 147456, v13
s_mul_i32 s43, s23, 6
s_add_u32 s43, s43, s24
s_lshl_b32 s43, s43, 9
s_add_u32 s43, s43, 9764864
v_lshlrev_b32 v14, 3, v1
s_barrier
ds_read_b64 v[180:181], v13 offset:0
ds_read_b64 v[182:183], v13 offset:512
ds_read_b64 v[184:185], v13 offset:1024
ds_read_b64 v[186:187], v13 offset:1536
ds_read_b64 v[188:189], v13 offset:2048
ds_read_b64 v[190:191], v13 offset:2560
ds_read_b64 v[192:193], v13 offset:3072
ds_read_b64 v[194:195], v13 offset:3584
ds_read_b64 v[196:197], v13 offset:4096
ds_read_b64 v[198:199], v13 offset:4608
ds_read_b64 v[200:201], v13 offset:5120
ds_read_b64 v[202:203], v13 offset:5632
s_waitcnt lgkmcnt(0)
v_add_f32 v180, v180, v182
v_add_f32 v181, v181, v183
v_add_f32 v180, v180, v184
v_add_f32 v181, v181, v185
v_add_f32 v180, v180, v186
v_add_f32 v181, v181, v187
v_add_f32 v180, v180, v188
v_add_f32 v181, v181, v189
v_add_f32 v180, v180, v190
v_add_f32 v181, v181, v191
v_add_f32 v180, v180, v192
v_add_f32 v181, v181, v193
v_add_f32 v180, v180, v194
v_add_f32 v181, v181, v195
v_add_f32 v180, v180, v196
v_add_f32 v181, v181, v197
v_add_f32 v180, v180, v198
v_add_f32 v181, v181, v199
v_add_f32 v180, v180, v200
v_add_f32 v181, v181, v201
v_add_f32 v180, v180, v202
v_add_f32 v181, v181, v203
buffer_store_dwordx2 v[180:181], v14, s[8:11], s43 offen sc1
s_waitcnt vmcnt(0) lgkmcnt(0)
s_barrier
v_mov_b32 v164, 0
v_mov_b32 v165, 0
v_mov_b32 v166, 0
v_mov_b32 v167, 0
v_dot2_f32_bf16 v164, v16, s49, v164
v_dot2_f32_bf16 v165, v17, s49, v165
v_dot2_f32_bf16 v166, v18, s49, v166
v_dot2_f32_bf16 v167, v19, s49, v167
v_dot2_f32_bf16 v164, v20, s49, v164
v_dot2_f32_bf16 v165, v21, s49, v165
v_dot2_f32_bf16 v166, v22, s49, v166
v_dot2_f32_bf16 v167, v23, s49, v167
v_dot2_f32_bf16 v164, v24, s49, v164
v_dot2_f32_bf16 v165, v25, s49, v165
v_dot2_f32_bf16 v166, v26, s49, v166
v_dot2_f32_bf16 v167, v27, s49, v167
v_dot2_f32_bf16 v164, v28, s49, v164
v_dot2_f32_bf16 v165, v29, s49, v165
v_dot2_f32_bf16 v166, v30, s49, v166
v_dot2_f32_bf16 v167, v31, s49, v167
v_dot2_f32_bf16 v164, v32, s49, v164
v_dot2_f32_bf16 v165, v33, s49, v165
v_dot2_f32_bf16 v166, v34, s49, v166
v_dot2_f32_bf16 v167, v35, s49, v167
v_dot2_f32_bf16 v164, v36, s49, v164
v_dot2_f32_bf16 v165, v37, s49, v165
v_dot2_f32_bf16 v166, v38, s49, v166
v_dot2_f32_bf16 v167, v39, s49, v167
v_dot2_f32_bf16 v164, v40, s49, v164
v_dot2_f32_bf16 v165, v41, s49, v165
v_dot2_f32_bf16 v166, v42, s49, v166
v_dot2_f32_bf16 v167, v43, s49, v167
v_dot2_f32_bf16 v164, v44, s49, v164
v_dot2_f32_bf16 v165, v45, s49, v165
v_dot2_f32_bf16 v166, v46, s49, v166
v_dot2_f32_bf16 v167, v47, s49, v167
v_dot2_f32_bf16 v164, v48, s49, v164
v_dot2_f32_bf16 v165, v49, s49, v165
v_dot2_f32_bf16 v166, v50, s49, v166
v_dot2_f32_bf16 v167, v51, s49, v167
v_dot2_f32_bf16 v164, v52, s49, v164
v_dot2_f32_bf16 v165, v53, s49, v165
v_dot2_f32_bf16 v166, v54, s49, v166
v_dot2_f32_bf16 v167, v55, s49, v167
v_dot2_f32_bf16 v164, v56, s49, v164
v_dot2_f32_bf16 v165, v57, s49, v165
v_dot2_f32_bf16 v166, v58, s49, v166
v_dot2_f32_bf16 v167, v59, s49, v167
v_dot2_f32_bf16 v164, v60, s49, v164
v_dot2_f32_bf16 v165, v61, s49, v165
v_dot2_f32_bf16 v166, v62, s49, v166
v_dot2_f32_bf16 v167, v63, s49, v167
v_dot2_f32_bf16 v164, v64, s49, v164
v_dot2_f32_bf16 v165, v65, s49, v165
v_dot2_f32_bf16 v166, v66, s49, v166
v_dot2_f32_bf16 v167, v67, s49, v167
v_dot2_f32_bf16 v164, v68, s49, v164
v_dot2_f32_bf16 v165, v69, s49, v165
v_dot2_f32_bf16 v166, v70, s49, v166
v_dot2_f32_bf16 v167, v71, s49, v167
v_dot2_f32_bf16 v164, v72, s49, v164
v_dot2_f32_bf16 v165, v73, s49, v165
v_dot2_f32_bf16 v166, v74, s49, v166
v_dot2_f32_bf16 v167, v75, s49, v167
v_dot2_f32_bf16 v164, v76, s49, v164
v_dot2_f32_bf16 v165, v77, s49, v165
v_dot2_f32_bf16 v166, v78, s49, v166
v_dot2_f32_bf16 v167, v79, s49, v167
v_dot2_f32_bf16 v164, v80, s49, v164
v_dot2_f32_bf16 v165, v81, s49, v165
v_dot2_f32_bf16 v166, v82, s49, v166
v_dot2_f32_bf16 v167, v83, s49, v167
v_dot2_f32_bf16 v164, v84, s49, v164
v_dot2_f32_bf16 v165, v85, s49, v165
v_dot2_f32_bf16 v166, v86, s49, v166
v_dot2_f32_bf16 v167, v87, s49, v167
s_nop 0
v_add_f32 v164, v164, v165
s_nop 0
v_add_f32 v166, v166, v167
v_add_f32 v164, v164, v166
v_mov_b32 v165, v164
s_nop 1
v_permlane32_swap_b32 v164, v165
v_add_f32 v164, v164, v165
v_mov_b32 v165, v164
s_nop 1
v_permlane16_swap_b32 v164, v165
v_add_f32 v164, v164, v165
v_lshlrev_b32 v168, 16, v160
v_mov_b32 v172, v164
buffer_store_dword v168, v8, s[8:11], s50 offen offset:0 sc1
buffer_store_dword v172, v8, s[8:11], s50 offen offset:16 sc1
s_cmp_ge_u32 s45, 12
s_cbranch_scc1 k3_kernel_csend
v_mov_b32 v164, 0
v_mov_b32 v165, 0
v_mov_b32 v166, 0
v_mov_b32 v167, 0
v_dot2_f32_bf16 v164, v88, s49, v164
v_dot2_f32_bf16 v165, v89, s49, v165
v_dot2_f32_bf16 v166, v90, s49, v166
v_dot2_f32_bf16 v167, v91, s49, v167
v_dot2_f32_bf16 v164, v92, s49, v164
v_dot2_f32_bf16 v165, v93, s49, v165
v_dot2_f32_bf16 v166, v94, s49, v166
v_dot2_f32_bf16 v167, v95, s49, v167
v_dot2_f32_bf16 v164, v96, s49, v164
v_dot2_f32_bf16 v165, v97, s49, v165
v_dot2_f32_bf16 v166, v98, s49, v166
v_dot2_f32_bf16 v167, v99, s49, v167
v_dot2_f32_bf16 v164, v100, s49, v164
v_dot2_f32_bf16 v165, v101, s49, v165
v_dot2_f32_bf16 v166, v102, s49, v166
v_dot2_f32_bf16 v167, v103, s49, v167
v_dot2_f32_bf16 v164, v104, s49, v164
v_dot2_f32_bf16 v165, v105, s49, v165
v_dot2_f32_bf16 v166, v106, s49, v166
v_dot2_f32_bf16 v167, v107, s49, v167
v_dot2_f32_bf16 v164, v108, s49, v164
v_dot2_f32_bf16 v165, v109, s49, v165
v_dot2_f32_bf16 v166, v110, s49, v166
v_dot2_f32_bf16 v167, v111, s49, v167
v_dot2_f32_bf16 v164, v112, s49, v164
v_dot2_f32_bf16 v165, v113, s49, v165
v_dot2_f32_bf16 v166, v114, s49, v166
v_dot2_f32_bf16 v167, v115, s49, v167
v_dot2_f32_bf16 v164, v116, s49, v164
v_dot2_f32_bf16 v165, v117, s49, v165
v_dot2_f32_bf16 v166, v118, s49, v166
v_dot2_f32_bf16 v167, v119, s49, v167
v_dot2_f32_bf16 v164, v120, s49, v164
v_dot2_f32_bf16 v165, v121, s49, v165
v_dot2_f32_bf16 v166, v122, s49, v166
v_dot2_f32_bf16 v167, v123, s49, v167
v_dot2_f32_bf16 v164, v124, s49, v164
v_dot2_f32_bf16 v165, v125, s49, v165
v_dot2_f32_bf16 v166, v126, s49, v166
v_dot2_f32_bf16 v167, v127, s49, v167
v_dot2_f32_bf16 v164, v128, s49, v164
v_dot2_f32_bf16 v165, v129, s49, v165
v_dot2_f32_bf16 v166, v130, s49, v166
v_dot2_f32_bf16 v167, v131, s49, v167
v_dot2_f32_bf16 v164, v132, s49, v164
v_dot2_f32_bf16 v165, v133, s49, v165
v_dot2_f32_bf16 v166, v134, s49, v166
v_dot2_f32_bf16 v167, v135, s49, v167
v_dot2_f32_bf16 v164, v136, s49, v164
v_dot2_f32_bf16 v165, v137, s49, v165
v_dot2_f32_bf16 v166, v138, s49, v166
v_dot2_f32_bf16 v167, v139, s49, v167
v_dot2_f32_bf16 v164, v140, s49, v164
v_dot2_f32_bf16 v165, v141, s49, v165
v_dot2_f32_bf16 v166, v142, s49, v166
v_dot2_f32_bf16 v167, v143, s49, v167
v_dot2_f32_bf16 v164, v144, s49, v164
v_dot2_f32_bf16 v165, v145, s49, v165
v_dot2_f32_bf16 v166, v146, s49, v166
v_dot2_f32_bf16 v167, v147, s49, v167
v_dot2_f32_bf16 v164, v148, s49, v164
v_dot2_f32_bf16 v165, v149, s49, v165
v_dot2_f32_bf16 v166, v150, s49, v166
v_dot2_f32_bf16 v167, v151, s49, v167
v_dot2_f32_bf16 v164, v152, s49, v164
v_dot2_f32_bf16 v165, v153, s49, v165
v_dot2_f32_bf16 v166, v154, s49, v166
v_dot2_f32_bf16 v167, v155, s49, v167
v_dot2_f32_bf16 v164, v156, s49, v164
v_dot2_f32_bf16 v165, v157, s49, v165
v_dot2_f32_bf16 v166, v158, s49, v166
v_dot2_f32_bf16 v167, v159, s49, v167
s_nop 0
v_add_f32 v164, v164, v165
s_nop 0
v_add_f32 v166, v166, v167
v_add_f32 v164, v164, v166
v_mov_b32 v165, v164
s_nop 1
v_permlane32_swap_b32 v164, v165
v_add_f32 v164, v164, v165
v_mov_b32 v165, v164
s_nop 1
v_permlane16_swap_b32 v164, v165
v_add_f32 v164, v164, v165
v_lshlrev_b32 v169, 16, v161
v_mov_b32 v173, v164
buffer_store_dword v169, v8, s[8:11], s50 offen offset:128 sc1
buffer_store_dword v173, v8, s[8:11], s50 offen offset:144 sc1
k3_kernel_csend:
s_waitcnt vmcnt(0)
s_lshl_b32 s52, s2, 2
s_add_u32 s52, s52, 39866368
v_mov_b32 v12, s96
v_and_b32 v13, 63, v0
v_mul_u32_u24 v13, 1024, v13
s_mov_b64 exec, 255
buffer_store_dword v12, v13, s[8:11], s52 offen sc1
s_mov_b64 exec, -1
s_branch P4_start
k3_kernel_end:
s_lshl_b32 s52, s2, 2
s_add_u32 s52, s52, 39858176
s_waitcnt vmcnt(0) lgkmcnt(0)
s_barrier
s_cmp_lg_u32 s22, 0
s_cbranch_scc1 sig_21
v_mov_b32 v12, s96
v_and_b32 v13, 63, v0
v_mul_u32_u24 v13, 1024, v13
s_mov_b64 exec, 255
buffer_store_dword v12, v13, s[8:11], s52 offen sc1
s_mov_b64 exec, -1
sig_21:
s_branch P4_start
s_nop 7
s_nop 7
P4_start:
s_load_dwordx2 s[4:5], s[0:1], 80
v_lshrrev_b32 v2, 6, v0
v_and_b32 v11, 63, v0
v_readfirstlane_b32 s12, v2
v_lshlrev_b32 v1, 4, v11
s_and_b32 s14, s2, 3
s_lshl_b32 s14, s14, 1
s_lshr_b32 s13, s2, 3
s_and_b32 s15, s13, 1
s_add_u32 s14, s14, s15
s_lshr_b32 s13, s13, 1
s_bfe_u32 s15, s2, 0x10002
s_lshl_b32 s15, s15, 4
s_add_u32 s13, s13, s15
s_mul_i32 s15, s13, 73728
s_mul_i32 s16, s12, 18432
s_add_u32 s17, s15, s16
s_add_u32 s17, s17, 4980736
s_mov_b32 s18, s16
s_lshl_b32 s19, s14, 2
s_add_u32 s19, s19, s12
s_mul_i32 s20, s19, 165888
s_add_u32 s21, s20, 9961472
s_add_u32 s22, s20, 15269888
s_mul_i32 s23, s19, 1152
s_add_u32 s23, s23, 9895936
v_lshrrev_b32 v10, 4, v11
v_lshlrev_b32 v10, 5, v10
s_mul_i32 s24, s13, 3072
s_add_u32 s24, s24, 9764864
v_lshlrev_b32 v2, 3, v11
s_mul_i32 s25, s14, 2359296
s_add_u32 s25, s25, s15
s_add_u32 s25, s25, s16
s_add_u32 s25, s25, 20578304
v_mov_b32 v3, v1
v_add_u32 v4, 36864, v1
s_lshr_b32 s26, s12, 1
s_lshl_b32 s26, s26, 12
s_and_b32 s27, s12, 1
s_lshl_b32 s27, s27, 3
s_add_u32 s26, s26, s27
s_add_u32 s26, s26, 73728
v_add_u32 v5, s26, v1
v_add_u32 v6, 32768, v5
v_add_u32 v7, 73728, v1
v_add_u32 v8, 36864, v7
v_mov_b32 v9, 0xbdd2d3e8
s_waitcnt lgkmcnt(0)
s_mov_b32 s8, s4
s_and_b32 s9, s5, 0xffff
s_mov_b32 s10, 39878656
s_mov_b32 s11, 0x20000
s_cmp_lt_u32 s2, 192
s_cbranch_scc1 w_23
s_cmp_lg_u32 s12, 0
s_cbranch_scc1 w_23_b
v_lshlrev_b32 v12, 2, v11
s_mov_b32 s87, 39847936
s_mov_b32 s97, 0
poll_24:
buffer_load_dword v13, v12, s[8:11], s87 offen sc1
s_waitcnt vmcnt(0)
v_cmp_ne_u32 vcc, s96, v13
s_add_u32 s97, s97, 1
s_cmp_gt_u32 s97, 200000
s_cbranch_scc1 poll_24_d
s_cmp_eq_u64 vcc, 0
s_cbranch_scc1 poll_24_d
s_sleep 2
s_branch poll_24
poll_24_d:
w_23_b:
s_barrier
w_23:
s_add_u32 s28, s21, 0
buffer_load_dwordx4 v[20:23], v1, s[8:11], s28 offen offset:0
s_add_u32 s28, s21, 16384
buffer_load_dwordx4 v[24:27], v1, s[8:11], s28 offen offset:2048
s_add_u32 s28, s21, 0
buffer_load_dwordx4 v[28:31], v1, s[8:11], s28 offen offset:1024
s_add_u32 s28, s21, 16384
buffer_load_dwordx4 v[32:35], v1, s[8:11], s28 offen offset:3072
s_add_u32 s28, s21, 0
buffer_load_dwordx4 v[36:39], v1, s[8:11], s28 offen offset:2048
s_add_u32 s28, s21, 20480
buffer_load_dwordx4 v[40:43], v1, s[8:11], s28 offen offset:0
s_add_u32 s28, s21, 0
buffer_load_dwordx4 v[44:47], v1, s[8:11], s28 offen offset:3072
s_add_u32 s28, s21, 20480
buffer_load_dwordx4 v[48:51], v1, s[8:11], s28 offen offset:1024
s_add_u32 s28, s21, 4096
buffer_load_dwordx4 v[52:55], v1, s[8:11], s28 offen offset:0
s_add_u32 s28, s21, 20480
buffer_load_dwordx4 v[56:59], v1, s[8:11], s28 offen offset:2048
s_add_u32 s28, s21, 4096
buffer_load_dwordx4 v[60:63], v1, s[8:11], s28 offen offset:1024
s_add_u32 s28, s21, 20480
buffer_load_dwordx4 v[64:67], v1, s[8:11], s28 offen offset:3072
s_add_u32 s28, s21, 4096
buffer_load_dwordx4 v[68:71], v1, s[8:11], s28 offen offset:2048
s_add_u32 s28, s21, 24576
buffer_load_dwordx4 v[72:75], v1, s[8:11], s28 offen offset:0
s_cmp_lg_u32 s12, 0
s_cbranch_scc1 w_22
v_min_u32 v14, 5, v11
v_lshlrev_b32 v12, 5, v14
v_add_u32 v12, s13, v12
v_lshlrev_b32 v12, 2, v12
s_and_b32 s52, s2, 7
s_mul_i32 s52, s52, 1024
s_add_u32 s52, s52, 39858176
s_mov_b32 s97, 0
poll_25:
buffer_load_dword v13, v12, s[8:11], s52 offen sc1
s_waitcnt vmcnt(0)
v_cmp_ne_u32 vcc, s96, v13
s_add_u32 s97, s97, 1
s_cmp_gt_u32 s97, 200000
s_cbranch_scc1 poll_25_d
s_cmp_eq_u64 vcc, 0
s_cbranch_scc1 poll_25_d
s_sleep 2
s_branch poll_25
poll_25_d:
w_22:
s_waitcnt vmcnt(0)
s_barrier
s_add_u32 m0, s18, 0
s_add_u32 s30, s17, 0
buffer_load_dwordx4 v1, s[8:11], s30 offen offset:0 sc1 lds
buffer_load_dwordx4 v1, s[8:11], s30 offen offset:1024 sc1 lds
buffer_load_dwordx4 v1, s[8:11], s30 offen offset:2048 sc1 lds
buffer_load_dwordx4 v1, s[8:11], s30 offen offset:3072 sc1 lds
s_add_u32 m0, s18, 4096
s_add_u32 s30, s17, 4096
buffer_load_dwordx4 v1, s[8:11], s30 offen offset:0 sc1 lds
buffer_load_dwordx4 v1, s[8:11], s30 offen offset:1024 sc1 lds
buffer_load_dwordx4 v1, s[8:11], s30 offen offset:2048 sc1 lds
buffer_load_dwordx4 v1, s[8:11], s30 offen offset:3072 sc1 lds
s_waitcnt vmcnt(5)
s_barrier
ds_read_b128 a[0:3], v3 offset:0
ds_read_b128 a[4:7], v3 offset:18432
ds_read_b128 a[8:11], v4 offset:0
ds_read_b128 a[12:15], v4 offset:18432
ds_read_b128 a[16:19], v3 offset:1024
ds_read_b128 a[20:23], v3 offset:19456
ds_read_b128 a[24:27], v4 offset:1024
ds_read_b128 a[28:31], v4 offset:19456
s_waitcnt lgkmcnt(4)
v_mfma_f32_16x16x32_bf16 v[108:111], v[20:23], a[0:3], 0
s_add_u32 m0, s18, 8192
s_add_u32 s30, s17, 8192
buffer_load_dwordx4 v1, s[8:11], s30 offen offset:0 sc1 lds
v_mfma_f32_16x16x32_bf16 v[112:115], v[20:23], a[4:7], 0
v_mfma_f32_16x16x32_bf16 v[116:119], v[20:23], a[8:11], 0
buffer_load_dwordx4 v1, s[8:11], s30 offen offset:1024 sc1 lds
v_mfma_f32_16x16x32_bf16 v[120:123], v[20:23], a[12:15], 0
s_add_u32 s28, s21, 4096
buffer_load_dwordx4 v[20:23], v1, s[8:11], s28 offen offset:3072
v_mfma_f32_16x16x32_bf16 v[124:127], v[24:27], a[0:3], 0
buffer_load_dwordx4 v1, s[8:11], s30 offen offset:2048 sc1 lds
ds_read_b128 a[32:35], v3 offset:2048
v_mfma_f32_16x16x32_bf16 v[128:131], v[24:27], a[4:7], 0
ds_read_b128 a[36:39], v3 offset:20480
v_mfma_f32_16x16x32_bf16 v[132:135], v[24:27], a[8:11], 0
buffer_load_dwordx4 v1, s[8:11], s30 offen offset:3072 sc1 lds
ds_read_b128 a[40:43], v4 offset:2048
v_mfma_f32_16x16x32_bf16 v[136:139], v[24:27], a[12:15], 0
s_add_u32 s28, s21, 24576
buffer_load_dwordx4 v[24:27], v1, s[8:11], s28 offen offset:1024
ds_read_b128 a[44:47], v4 offset:20480
s_waitcnt lgkmcnt(4)
v_mfma_f32_16x16x32_bf16 v[108:111], v[28:31], a[16:19], v[108:111]
s_add_u32 m0, s18, 12288
s_add_u32 s30, s17, 12288
buffer_load_dwordx4 v1, s[8:11], s30 offen offset:0 sc1 lds
v_mfma_f32_16x16x32_bf16 v[112:115], v[28:31], a[20:23], v[112:115]
v_mfma_f32_16x16x32_bf16 v[116:119], v[28:31], a[24:27], v[116:119]
buffer_load_dwordx4 v1, s[8:11], s30 offen offset:1024 sc1 lds
buffer_load_dwordx2 v[204:205], v2, s[8:11], s24 offen offset:0 sc1
buffer_load_dwordx2 v[206:207], v2, s[8:11], s24 offen offset:512 sc1
buffer_load_dwordx2 v[208:209], v2, s[8:11], s24 offen offset:1024 sc1
buffer_load_dwordx2 v[210:211], v2, s[8:11], s24 offen offset:1536 sc1
buffer_load_dwordx2 v[212:213], v2, s[8:11], s24 offen offset:2048 sc1
buffer_load_dwordx2 v[214:215], v2, s[8:11], s24 offen offset:2560 sc1
v_mfma_f32_16x16x32_bf16 v[120:123], v[28:31], a[28:31], v[120:123]
s_add_u32 s28, s21, 8192
buffer_load_dwordx4 v[28:31], v1, s[8:11], s28 offen offset:0
v_mfma_f32_16x16x32_bf16 v[124:127], v[32:35], a[16:19], v[124:127]
buffer_load_dwordx4 v1, s[8:11], s30 offen offset:2048 sc1 lds
s_waitcnt vmcnt(18)
s_barrier
ds_read_b128 a[48:51], v3 offset:3072
v_mfma_f32_16x16x32_bf16 v[128:131], v[32:35], a[20:23], v[128:131]
ds_read_b128 a[52:55], v3 offset:21504
v_mfma_f32_16x16x32_bf16 v[132:135], v[32:35], a[24:27], v[132:135]
buffer_load_dwordx4 v1, s[8:11], s30 offen offset:3072 sc1 lds
ds_read_b128 a[56:59], v4 offset:3072
v_mfma_f32_16x16x32_bf16 v[136:139], v[32:35], a[28:31], v[136:139]
s_add_u32 s28, s21, 24576
buffer_load_dwordx4 v[32:35], v1, s[8:11], s28 offen offset:2048
ds_read_b128 a[60:63], v4 offset:21504
s_waitcnt lgkmcnt(4)
v_mfma_f32_16x16x32_bf16 v[108:111], v[36:39], a[32:35], v[108:111]
s_add_u32 m0, s18, 16384
s_add_u32 s30, s17, 16384
buffer_load_dwordx4 v1, s[8:11], s30 offen offset:0 sc1 lds
v_mfma_f32_16x16x32_bf16 v[112:115], v[36:39], a[36:39], v[112:115]
v_mfma_f32_16x16x32_bf16 v[116:119], v[36:39], a[40:43], v[116:119]
buffer_load_dwordx4 v1, s[8:11], s30 offen offset:1024 sc1 lds
v_mfma_f32_16x16x32_bf16 v[120:123], v[36:39], a[44:47], v[120:123]
s_add_u32 s28, s21, 8192
buffer_load_dwordx4 v[36:39], v1, s[8:11], s28 offen offset:1024
v_mfma_f32_16x16x32_bf16 v[124:127], v[40:43], a[32:35], v[124:127]
ds_read_b128 a[64:67], v3 offset:4096
v_mfma_f32_16x16x32_bf16 v[128:131], v[40:43], a[36:39], v[128:131]
ds_read_b128 a[68:71], v3 offset:22528
v_mfma_f32_16x16x32_bf16 v[132:135], v[40:43], a[40:43], v[132:135]
ds_read_b128 a[72:75], v4 offset:4096
v_mfma_f32_16x16x32_bf16 v[136:139], v[40:43], a[44:47], v[136:139]
s_add_u32 s28, s21, 24576
buffer_load_dwordx4 v[40:43], v1, s[8:11], s28 offen offset:3072
ds_read_b128 a[76:79], v4 offset:22528
s_lshr_b32 s52, s14, 1
s_and_b32 s53, s14, 1
s_lshl_b32 s53, s53, 2
s_add_u32 s52, s52, s53
v_and_b32 v250, 63, v0
v_min_u32 v250, 23, v250
v_and_b32 v251, 3, v250
v_lshlrev_b32 v251, 3, v251
v_add_u32 v251, s52, v251
v_lshrrev_b32 v250, 2, v250
v_lshl_add_u32 v250, v250, 5, v251
v_lshlrev_b32 v250, 2, v250
s_and_b32 s93, s2, 7
s_mul_i32 s93, s93, 1024
s_add_u32 s93, s93, 39866368
buffer_load_dword v251, v250, s[8:11], s93 offen sc1
s_waitcnt lgkmcnt(4)
v_mfma_f32_16x16x32_bf16 v[108:111], v[44:47], a[48:51], v[108:111]
v_mfma_f32_16x16x32_bf16 v[112:115], v[44:47], a[52:55], v[112:115]
v_mfma_f32_16x16x32_bf16 v[116:119], v[44:47], a[56:59], v[116:119]
v_mfma_f32_16x16x32_bf16 v[120:123], v[44:47], a[60:63], v[120:123]
s_add_u32 s28, s21, 8192
buffer_load_dwordx4 v[44:47], v1, s[8:11], s28 offen offset:2048
v_mfma_f32_16x16x32_bf16 v[124:127], v[48:51], a[48:51], v[124:127]
ds_read_b128 a[80:83], v3 offset:5120
v_mfma_f32_16x16x32_bf16 v[128:131], v[48:51], a[52:55], v[128:131]
ds_read_b128 a[84:87], v3 offset:23552
v_mfma_f32_16x16x32_bf16 v[132:135], v[48:51], a[56:59], v[132:135]
ds_read_b128 a[88:91], v4 offset:5120
v_mfma_f32_16x16x32_bf16 v[136:139], v[48:51], a[60:63], v[136:139]
s_add_u32 s28, s21, 28672
buffer_load_dwordx4 v[48:51], v1, s[8:11], s28 offen offset:0
ds_read_b128 a[92:95], v4 offset:23552
s_waitcnt lgkmcnt(4)
v_mfma_f32_16x16x32_bf16 v[108:111], v[52:55], a[64:67], v[108:111]
v_mfma_f32_16x16x32_bf16 v[112:115], v[52:55], a[68:71], v[112:115]
v_mfma_f32_16x16x32_bf16 v[116:119], v[52:55], a[72:75], v[116:119]
v_mfma_f32_16x16x32_bf16 v[120:123], v[52:55], a[76:79], v[120:123]
s_add_u32 s28, s21, 8192
buffer_load_dwordx4 v[52:55], v1, s[8:11], s28 offen offset:3072
v_mfma_f32_16x16x32_bf16 v[124:127], v[56:59], a[64:67], v[124:127]
s_waitcnt vmcnt(25)
s_barrier
ds_read_b128 a[96:99], v3 offset:6144
v_mfma_f32_16x16x32_bf16 v[128:131], v[56:59], a[68:71], v[128:131]
ds_read_b128 a[100:103], v3 offset:24576
v_mfma_f32_16x16x32_bf16 v[132:135], v[56:59], a[72:75], v[132:135]
ds_read_b128 a[104:107], v4 offset:6144
v_mfma_f32_16x16x32_bf16 v[136:139], v[56:59], a[76:79], v[136:139]
s_add_u32 s28, s21, 28672
buffer_load_dwordx4 v[56:59], v1, s[8:11], s28 offen offset:1024
ds_read_b128 a[108:111], v4 offset:24576
s_waitcnt lgkmcnt(4)
v_mfma_f32_16x16x32_bf16 v[108:111], v[60:63], a[80:83], v[108:111]
s_waitcnt vmcnt(13)
v_add_f32 v204, v204, v206
v_mfma_f32_16x16x32_bf16 v[112:115], v[60:63], a[84:87], v[112:115]
v_add_f32 v205, v205, v207
v_mfma_f32_16x16x32_bf16 v[116:119], v[60:63], a[88:91], v[116:119]
v_add_f32 v204, v204, v208
v_add_f32 v205, v205, v209
v_mfma_f32_16x16x32_bf16 v[120:123], v[60:63], a[92:95], v[120:123]
s_add_u32 s28, s21, 12288
buffer_load_dwordx4 v[60:63], v1, s[8:11], s28 offen offset:0
v_add_f32 v204, v204, v210
v_mfma_f32_16x16x32_bf16 v[124:127], v[64:67], a[80:83], v[124:127]
ds_read_b128 a[112:115], v3 offset:7168
v_add_f32 v205, v205, v211
v_add_f32 v204, v204, v212
v_mfma_f32_16x16x32_bf16 v[128:131], v[64:67], a[84:87], v[128:131]
ds_read_b128 a[116:119], v3 offset:25600
v_add_f32 v205, v205, v213
v_add_f32 v204, v204, v214
v_mfma_f32_16x16x32_bf16 v[132:135], v[64:67], a[88:91], v[132:135]
ds_read_b128 a[120:123], v4 offset:7168
v_add_f32 v205, v205, v215
v_mfma_f32_16x16x32_bf16 v[136:139], v[64:67], a[92:95], v[136:139]
s_add_u32 s28, s21, 28672
buffer_load_dwordx4 v[64:67], v1, s[8:11], s28 offen offset:2048
ds_read_b128 a[124:127], v4 offset:25600
v_mul_f32 v204, 0x3ae38e39, v204
v_mul_f32 v205, 0x3ae38e39, v205
s_waitcnt lgkmcnt(4)
v_mfma_f32_16x16x32_bf16 v[108:111], v[68:71], a[96:99], v[108:111]
v_fma_f32 v205, -v204, v204, v205
v_mfma_f32_16x16x32_bf16 v[112:115], v[68:71], a[100:103], v[112:115]
v_max_f32 v205, 0, v205
v_cvt_pk_bf16_f32 v206, v204, v205
v_mfma_f32_16x16x32_bf16 v[116:119], v[68:71], a[104:107], v[116:119]
v_lshlrev_b32 v207, 16, v206
v_and_b32 v208, 0xffff0000, v206
v_mfma_f32_16x16x32_bf16 v[120:123], v[68:71], a[108:111], v[120:123]
s_add_u32 s28, s21, 12288
buffer_load_dwordx4 v[68:71], v1, s[8:11], s28 offen offset:1024
v_add_f32 v208, 0x3727c5ac, v208
v_mfma_f32_16x16x32_bf16 v[124:127], v[72:75], a[96:99], v[124:127]
ds_read_b128 a[128:131], v3 offset:8192
v_cvt_pk_bf16_f32 v208, v208, v208
v_and_b32 v208, 0xffff0000, v208
v_mfma_f32_16x16x32_bf16 v[128:131], v[72:75], a[100:103], v[128:131]
ds_read_b128 a[132:135], v3 offset:26624
v_sqrt_f32 v208, v208
v_mfma_f32_16x16x32_bf16 v[132:135], v[72:75], a[104:107], v[132:135]
ds_read_b128 a[136:139], v4 offset:8192
v_cvt_pk_bf16_f32 v208, v208, v208
v_and_b32 v208, 0xffff0000, v208
v_mfma_f32_16x16x32_bf16 v[136:139], v[72:75], a[108:111], v[136:139]
s_add_u32 s28, s21, 28672
buffer_load_dwordx4 v[72:75], v1, s[8:11], s28 offen offset:3072
ds_read_b128 a[140:143], v4 offset:26624
v_rcp_f32 v208, v208
s_nop 0
v_mul_f32 v207, v207, v208
s_waitcnt lgkmcnt(4)
v_mfma_f32_16x16x32_bf16 v[108:111], v[20:23], a[112:115], v[108:111]
v_sub_f32 v207, 0, v207
v_mfma_f32_16x16x32_bf16 v[112:115], v[20:23], a[116:119], v[112:115]
v_and_b32 v209, 15, v0
v_lshlrev_b32 v209, 2, v209
v_mfma_f32_16x16x32_bf16 v[116:119], v[20:23], a[120:123], v[116:119]
v_add_u32 v210, 0, v209
v_mfma_f32_16x16x32_bf16 v[120:123], v[20:23], a[124:127], v[120:123]
s_add_u32 s28, s21, 12288
buffer_load_dwordx4 v[20:23], v1, s[8:11], s28 offen offset:2048
v_add_u32 v211, 64, v209
v_add_u32 v212, 128, v209
v_mfma_f32_16x16x32_bf16 v[124:127], v[24:27], a[112:115], v[124:127]
s_barrier
ds_read_b128 a[144:147], v3 offset:9216
v_add_u32 v213, 192, v209
ds_bpermute_b32 v12, v210, v208
v_mfma_f32_16x16x32_bf16 v[128:131], v[24:27], a[116:119], v[128:131]
ds_read_b128 a[148:151], v3 offset:27648
ds_bpermute_b32 v16, v210, v207
v_mfma_f32_16x16x32_bf16 v[132:135], v[24:27], a[120:123], v[132:135]
ds_read_b128 a[152:155], v4 offset:9216
ds_bpermute_b32 v13, v211, v208
ds_bpermute_b32 v17, v211, v207
v_mfma_f32_16x16x32_bf16 v[136:139], v[24:27], a[124:127], v[136:139]
s_add_u32 s28, s21, 32768
buffer_load_dwordx4 v[24:27], v1, s[8:11], s28 offen offset:0
ds_read_b128 a[156:159], v4 offset:27648
ds_bpermute_b32 v14, v212, v208
s_waitcnt vmcnt(18)
s_waitcnt lgkmcnt(9)
v_mfma_f32_16x16x32_bf16 v[108:111], v[28:31], a[128:131], v[108:111]
ds_bpermute_b32 v18, v212, v207
ds_bpermute_b32 v15, v213, v208
v_mfma_f32_16x16x32_bf16 v[112:115], v[28:31], a[132:135], v[112:115]
ds_bpermute_b32 v19, v213, v207
v_mfma_f32_16x16x32_bf16 v[116:119], v[28:31], a[136:139], v[116:119]
v_mfma_f32_16x16x32_bf16 v[120:123], v[28:31], a[140:143], v[120:123]
s_add_u32 s28, s21, 12288
buffer_load_dwordx4 v[28:31], v1, s[8:11], s28 offen offset:3072
s_waitcnt vmcnt(16)
v_mfma_f32_16x16x32_bf16 v[124:127], v[32:35], a[128:131], v[124:127]
ds_read_b128 a[160:163], v3 offset:10240
v_mfma_f32_16x16x32_bf16 v[128:131], v[32:35], a[132:135], v[128:131]
ds_read_b128 a[164:167], v3 offset:28672
v_mfma_f32_16x16x32_bf16 v[132:135], v[32:35], a[136:139], v[132:135]
ds_read_b128 a[168:171], v4 offset:10240
v_mfma_f32_16x16x32_bf16 v[136:139], v[32:35], a[140:143], v[136:139]
s_add_u32 s28, s21, 32768
buffer_load_dwordx4 v[32:35], v1, s[8:11], s28 offen offset:1024
ds_read_b128 a[172:175], v4 offset:28672
s_waitcnt vmcnt(11)
s_waitcnt lgkmcnt(8)
v_mfma_f32_16x16x32_bf16 v[108:111], v[36:39], a[144:147], v[108:111]
v_mfma_f32_16x16x32_bf16 v[112:115], v[36:39], a[148:151], v[112:115]
v_mfma_f32_16x16x32_bf16 v[116:119], v[36:39], a[152:155], v[116:119]
v_mfma_f32_16x16x32_bf16 v[120:123], v[36:39], a[156:159], v[120:123]
s_add_u32 s28, s21, 16384
buffer_load_dwordx4 v[36:39], v1, s[8:11], s28 offen offset:0
v_mfma_f32_16x16x32_bf16 v[124:127], v[40:43], a[144:147], v[124:127]
ds_read_b128 a[176:179], v3 offset:11264
v_mfma_f32_16x16x32_bf16 v[128:131], v[40:43], a[148:151], v[128:131]
ds_read_b128 a[180:183], v3 offset:29696
v_mfma_f32_16x16x32_bf16 v[132:135], v[40:43], a[152:155], v[132:135]
ds_read_b128 a[184:187], v4 offset:11264
v_mfma_f32_16x16x32_bf16 v[136:139], v[40:43], a[156:159], v[136:139]
s_add_u32 s28, s21, 32768
buffer_load_dwordx4 v[40:43], v1, s[8:11], s28 offen offset:2048
ds_read_b128 a[188:191], v4 offset:29696
s_waitcnt lgkmcnt(4)
v_mfma_f32_16x16x32_bf16 v[108:111], v[44:47], a[160:163], v[108:111]
v_mfma_f32_16x16x32_bf16 v[112:115], v[44:47], a[164:167], v[112:115]
v_mfma_f32_16x16x32_bf16 v[116:119], v[44:47], a[168:171], v[116:119]
v_mfma_f32_16x16x32_bf16 v[120:123], v[44:47], a[172:175], v[120:123]
s_add_u32 s28, s21, 16384
buffer_load_dwordx4 v[44:47], v1, s[8:11], s28 offen offset:1024
s_waitcnt vmcnt(11)
v_mfma_f32_16x16x32_bf16 v[124:127], v[48:51], a[160:163], v[124:127]
s_barrier
ds_read_b128 a[192:195], v3 offset:12288
v_mfma_f32_16x16x32_bf16 v[128:131], v[48:51], a[164:167], v[128:131]
ds_read_b128 a[196:199], v3 offset:30720
v_mfma_f32_16x16x32_bf16 v[132:135], v[48:51], a[168:171], v[132:135]
ds_read_b128 a[200:203], v4 offset:12288
v_mfma_f32_16x16x32_bf16 v[136:139], v[48:51], a[172:175], v[136:139]
s_add_u32 s28, s21, 32768
buffer_load_dwordx4 v[48:51], v1, s[8:11], s28 offen offset:3072
ds_read_b128 a[204:207], v4 offset:30720
v_cmp_ne_u32 vcc, s96, v251
s_nop 1
s_cmp_eq_u64 vcc, 0
s_cbranch_scc1 bcok_26
s_mov_b32 s97, 0
poll_27:
buffer_load_dword v251, v250, s[8:11], s93 offen sc1
s_waitcnt vmcnt(0)
v_cmp_ne_u32 vcc, s96, v251
s_add_u32 s97, s97, 1
s_cmp_gt_u32 s97, 200000
s_cbranch_scc1 poll_27_d
s_cmp_eq_u64 vcc, 0
s_cbranch_scc1 poll_27_d
s_sleep 2
s_branch poll_27
poll_27_d:
bcok_26:
buffer_load_dwordx4 v[220:223], v10, s[8:11], s23 offen offset:0 sc1
buffer_load_dwordx4 v[224:227], v10, s[8:11], s23 offen offset:16 sc1
buffer_load_dwordx4 v[228:231], v10, s[8:11], s23 offen offset:128 sc1
buffer_load_dwordx4 v[232:235], v10, s[8:11], s23 offen offset:144 sc1
s_waitcnt lgkmcnt(4)
v_mfma_f32_16x16x32_bf16 v[108:111], v[52:55], a[176:179], v[108:111]
v_mfma_f32_16x16x32_bf16 v[112:115], v[52:55], a[180:183], v[112:115]
v_mfma_f32_16x16x32_bf16 v[116:119], v[52:55], a[184:187], v[116:119]
v_mfma_f32_16x16x32_bf16 v[120:123], v[52:55], a[188:191], v[120:123]
s_add_u32 s28, s21, 36864
buffer_load_dwordx4 v[52:55], v1, s[8:11], s28 offen offset:0
v_mfma_f32_16x16x32_bf16 v[124:127], v[56:59], a[176:179], v[124:127]
ds_read_b128 a[208:211], v3 offset:13312
v_mfma_f32_16x16x32_bf16 v[128:131], v[56:59], a[180:183], v[128:131]
ds_read_b128 a[212:215], v3 offset:31744
v_mfma_f32_16x16x32_bf16 v[132:135], v[56:59], a[184:187], v[132:135]
ds_read_b128 a[216:219], v4 offset:13312
v_mfma_f32_16x16x32_bf16 v[136:139], v[56:59], a[188:191], v[136:139]
buffer_load_dwordx4 v[56:59], v1, s[8:11], s28 offen offset:1024
ds_read_b128 a[220:223], v4 offset:31744
s_waitcnt vmcnt(15)
s_waitcnt lgkmcnt(4)
v_mfma_f32_16x16x32_bf16 v[108:111], v[60:63], a[192:195], v[108:111]
v_mfma_f32_16x16x32_bf16 v[112:115], v[60:63], a[196:199], v[112:115]
v_mfma_f32_16x16x32_bf16 v[116:119], v[60:63], a[200:203], v[116:119]
v_mfma_f32_16x16x32_bf16 v[120:123], v[60:63], a[204:207], v[120:123]
buffer_load_dwordx4 v[60:63], v1, s[8:11], s28 offen offset:2048
v_mfma_f32_16x16x32_bf16 v[124:127], v[64:67], a[192:195], v[124:127]
ds_read_b128 a[224:227], v3 offset:14336
v_mfma_f32_16x16x32_bf16 v[128:131], v[64:67], a[196:199], v[128:131]
ds_read_b128 a[228:231], v3 offset:32768
v_mfma_f32_16x16x32_bf16 v[132:135], v[64:67], a[200:203], v[132:135]
ds_read_b128 a[232:235], v4 offset:14336
v_mfma_f32_16x16x32_bf16 v[136:139], v[64:67], a[204:207], v[136:139]
buffer_load_dwordx4 v[64:67], v1, s[8:11], s28 offen offset:3072
ds_read_b128 a[236:239], v4 offset:32768
s_waitcnt lgkmcnt(4)
v_mfma_f32_16x16x32_bf16 v[108:111], v[68:71], a[208:211], v[108:111]
v_mfma_f32_16x16x32_bf16 v[112:115], v[68:71], a[212:215], v[112:115]
v_mfma_f32_16x16x32_bf16 v[116:119], v[68:71], a[216:219], v[116:119]
v_mfma_f32_16x16x32_bf16 v[120:123], v[68:71], a[220:223], v[120:123]
s_add_u32 s28, s21, 40960
buffer_load_dwordx4 v[68:71], v1, s[8:11], s28 offen offset:0
s_waitcnt vmcnt(15)
v_mfma_f32_16x16x32_bf16 v[124:127], v[72:75], a[208:211], v[124:127]
s_barrier
ds_read_b128 a[240:243], v3 offset:15360
v_mfma_f32_16x16x32_bf16 v[128:131], v[72:75], a[212:215], v[128:131]
ds_read_b128 a[244:247], v3 offset:33792
v_mfma_f32_16x16x32_bf16 v[132:135], v[72:75], a[216:219], v[132:135]
ds_read_b128 a[248:251], v4 offset:15360
v_mfma_f32_16x16x32_bf16 v[136:139], v[72:75], a[220:223], v[136:139]
buffer_load_dwordx4 v[72:75], v1, s[8:11], s28 offen offset:1024
ds_read_b128 a[252:255], v4 offset:33792
s_waitcnt lgkmcnt(4)
v_mfma_f32_16x16x32_bf16 v[108:111], v[20:23], a[224:227], v[108:111]
v_mfma_f32_16x16x32_bf16 v[112:115], v[20:23], a[228:231], v[112:115]
v_mfma_f32_16x16x32_bf16 v[116:119], v[20:23], a[232:235], v[116:119]
v_mfma_f32_16x16x32_bf16 v[120:123], v[20:23], a[236:239], v[120:123]
buffer_load_dwordx4 v[20:23], v1, s[8:11], s28 offen offset:2048
v_mfma_f32_16x16x32_bf16 v[124:127], v[24:27], a[224:227], v[124:127]
ds_read_b128 v[76:79], v3 offset:16384
v_mfma_f32_16x16x32_bf16 v[128:131], v[24:27], a[228:231], v[128:131]
ds_read_b128 v[80:83], v3 offset:34816
v_mfma_f32_16x16x32_bf16 v[132:135], v[24:27], a[232:235], v[132:135]
ds_read_b128 v[84:87], v4 offset:16384
v_mfma_f32_16x16x32_bf16 v[136:139], v[24:27], a[236:239], v[136:139]
buffer_load_dwordx4 v[24:27], v1, s[8:11], s28 offen offset:3072
ds_read_b128 v[88:91], v4 offset:34816
s_waitcnt vmcnt(15)
s_waitcnt lgkmcnt(4)
v_mfma_f32_16x16x32_bf16 v[108:111], v[28:31], a[240:243], v[108:111]
v_mfma_f32_16x16x32_bf16 v[112:115], v[28:31], a[244:247], v[112:115]
v_mfma_f32_16x16x32_bf16 v[116:119], v[28:31], a[248:251], v[116:119]
v_mfma_f32_16x16x32_bf16 v[120:123], v[28:31], a[252:255], v[120:123]
s_add_u32 s28, s21, 45056
buffer_load_dwordx4 v[28:31], v1, s[8:11], s28 offen offset:0
v_mfma_f32_16x16x32_bf16 v[124:127], v[32:35], a[240:243], v[124:127]
ds_read_b128 v[92:95], v3 offset:17408
v_mfma_f32_16x16x32_bf16 v[128:131], v[32:35], a[244:247], v[128:131]
ds_read_b128 v[96:99], v3 offset:35840
v_mfma_f32_16x16x32_bf16 v[132:135], v[32:35], a[248:251], v[132:135]
ds_read_b128 v[100:103], v4 offset:17408
v_mfma_f32_16x16x32_bf16 v[136:139], v[32:35], a[252:255], v[136:139]
buffer_load_dwordx4 v[32:35], v1, s[8:11], s28 offen offset:1024
ds_read_b128 v[104:107], v4 offset:35840
s_waitcnt lgkmcnt(4)
v_mfma_f32_16x16x32_bf16 v[108:111], v[36:39], v[76:79], v[108:111]
v_mfma_f32_16x16x32_bf16 v[112:115], v[36:39], v[80:83], v[112:115]
v_mfma_f32_16x16x32_bf16 v[116:119], v[36:39], v[84:87], v[116:119]
v_mfma_f32_16x16x32_bf16 v[120:123], v[36:39], v[88:91], v[120:123]
buffer_load_dwordx4 v[36:39], v1, s[8:11], s28 offen offset:2048
s_waitcnt vmcnt(15)
v_mfma_f32_16x16x32_bf16 v[124:127], v[40:43], v[76:79], v[124:127]
v_mfma_f32_16x16x32_bf16 v[128:131], v[40:43], v[80:83], v[128:131]
v_mfma_f32_16x16x32_bf16 v[132:135], v[40:43], v[84:87], v[132:135]
v_mfma_f32_16x16x32_bf16 v[136:139], v[40:43], v[88:91], v[136:139]
buffer_load_dwordx4 v[40:43], v1, s[8:11], s28 offen offset:3072
s_waitcnt lgkmcnt(0)
v_mfma_f32_16x16x32_bf16 v[108:111], v[44:47], v[92:95], v[108:111]
v_mfma_f32_16x16x32_bf16 v[112:115], v[44:47], v[96:99], v[112:115]
v_mfma_f32_16x16x32_bf16 v[116:119], v[44:47], v[100:103], v[116:119]
v_mfma_f32_16x16x32_bf16 v[120:123], v[44:47], v[104:107], v[120:123]
s_add_u32 s28, s21, 49152
buffer_load_dwordx4 v[44:47], v1, s[8:11], s28 offen offset:0
v_mfma_f32_16x16x32_bf16 v[124:127], v[48:51], v[92:95], v[124:127]
v_mfma_f32_16x16x32_bf16 v[128:131], v[48:51], v[96:99], v[128:131]
s_waitcnt vmcnt(15)
v_mfma_f32_16x16x32_bf16 v[132:135], v[48:51], v[100:103], v[132:135]
v_fma_f32 v240, v16, v224, v220
v_fma_f32 v241, v16, v225, v221
v_mfma_f32_16x16x32_bf16 v[136:139], v[48:51], v[104:107], v[136:139]
buffer_load_dwordx4 v[48:51], v1, s[8:11], s28 offen offset:1024
v_fma_f32 v242, v16, v226, v222
s_waitcnt vmcnt(11)
v_mfma_f32_16x16x32_bf16 v[140:143], v[52:55], a[0:3], 0
v_fma_f32 v243, v16, v227, v223
v_fma_f32 v236, v108, v12, v240
v_mfma_f32_16x16x32_bf16 v[144:147], v[52:55], a[4:7], 0
v_fma_f32 v237, v109, v12, v241
v_fma_f32 v238, v110, v12, v242
v_mfma_f32_16x16x32_bf16 v[148:151], v[52:55], a[8:11], 0
v_fma_f32 v239, v111, v12, v243
v_mfma_f32_16x16x32_bf16 v[152:155], v[52:55], a[12:15], 0
buffer_load_dwordx4 v[52:55], v1, s[8:11], s28 offen offset:2048
v_mul_f32 v240, v236, v236
v_mul_f32 v241, v237, v237
v_mfma_f32_16x16x32_bf16 v[140:143], v[56:59], a[16:19], v[140:143]
v_mul_f32 v242, v238, v238
v_mfma_f32_16x16x32_bf16 v[144:147], v[56:59], a[20:23], v[144:147]
v_mul_f32 v243, v239, v239
v_fmaak_f32 v240, v240, v9, 0xc0135761
v_mfma_f32_16x16x32_bf16 v[148:151], v[56:59], a[24:27], v[148:151]
v_fmaak_f32 v241, v241, v9, 0xc0135761
v_fmaak_f32 v242, v242, v9, 0xc0135761
v_mfma_f32_16x16x32_bf16 v[152:155], v[56:59], a[28:31], v[152:155]
buffer_load_dwordx4 v[56:59], v1, s[8:11], s28 offen offset:3072
v_fmaak_f32 v243, v243, v9, 0xc0135761
v_mfma_f32_16x16x32_bf16 v[140:143], v[60:63], a[32:35], v[140:143]
v_mul_f32 v240, v236, v240
v_mul_f32 v241, v237, v241
v_mfma_f32_16x16x32_bf16 v[144:147], v[60:63], a[36:39], v[144:147]
v_mul_f32 v242, v238, v242
v_mfma_f32_16x16x32_bf16 v[148:151], v[60:63], a[40:43], v[148:151]
v_mul_f32 v243, v239, v243
v_exp_f32 v240, v240
v_mfma_f32_16x16x32_bf16 v[152:155], v[60:63], a[44:47], v[152:155]
s_add_u32 s28, s21, 53248
buffer_load_dwordx4 v[60:63], v1, s[8:11], s28 offen offset:0
v_exp_f32 v241, v241
v_exp_f32 v242, v242
s_waitcnt vmcnt(11)
v_mfma_f32_16x16x32_bf16 v[140:143], v[64:67], a[48:51], v[140:143]
v_exp_f32 v243, v243
v_mfma_f32_16x16x32_bf16 v[144:147], v[64:67], a[52:55], v[144:147]
v_add_f32 v240, 1.0, v240
v_add_f32 v241, 1.0, v241
v_mfma_f32_16x16x32_bf16 v[148:151], v[64:67], a[56:59], v[148:151]
v_add_f32 v242, 1.0, v242
v_mfma_f32_16x16x32_bf16 v[152:155], v[64:67], a[60:63], v[152:155]
buffer_load_dwordx4 v[64:67], v1, s[8:11], s28 offen offset:1024
v_add_f32 v243, 1.0, v243
v_rcp_f32 v240, v240
v_mfma_f32_16x16x32_bf16 v[140:143], v[68:71], a[64:67], v[140:143]
v_rcp_f32 v241, v241
v_rcp_f32 v242, v242
v_mfma_f32_16x16x32_bf16 v[144:147], v[68:71], a[68:71], v[144:147]
v_rcp_f32 v243, v243
v_mfma_f32_16x16x32_bf16 v[148:151], v[68:71], a[72:75], v[148:151]
v_mul_f32 v236, v236, v240
v_mul_f32 v237, v237, v241
v_mfma_f32_16x16x32_bf16 v[152:155], v[68:71], a[76:79], v[152:155]
buffer_load_dwordx4 v[68:71], v1, s[8:11], s28 offen offset:2048
v_mul_f32 v238, v238, v242
v_mfma_f32_16x16x32_bf16 v[140:143], v[72:75], a[80:83], v[140:143]
v_mul_f32 v239, v239, v243
v_cvt_pk_bf16_f32 v244, v236, v237
v_mfma_f32_16x16x32_bf16 v[144:147], v[72:75], a[84:87], v[144:147]
v_cvt_pk_bf16_f32 v245, v238, v239
ds_write_b64 v5, v[244:245] offset:0
v_mfma_f32_16x16x32_bf16 v[148:151], v[72:75], a[88:91], v[148:151]
v_fma_f32 v240, v17, v224, v220
v_mfma_f32_16x16x32_bf16 v[152:155], v[72:75], a[92:95], v[152:155]
buffer_load_dwordx4 v[72:75], v1, s[8:11], s28 offen offset:3072
v_fma_f32 v241, v17, v225, v221
v_fma_f32 v242, v17, v226, v222
s_waitcnt vmcnt(11)
v_mfma_f32_16x16x32_bf16 v[140:143], v[20:23], a[96:99], v[140:143]
v_fma_f32 v243, v17, v227, v223
v_mfma_f32_16x16x32_bf16 v[144:147], v[20:23], a[100:103], v[144:147]
v_fma_f32 v236, v112, v13, v240
v_fma_f32 v237, v113, v13, v241
v_mfma_f32_16x16x32_bf16 v[148:151], v[20:23], a[104:107], v[148:151]
v_fma_f32 v238, v114, v13, v242
v_fma_f32 v239, v115, v13, v243
v_mfma_f32_16x16x32_bf16 v[152:155], v[20:23], a[108:111], v[152:155]
s_add_u32 s28, s21, 57344
buffer_load_dwordx4 v[20:23], v1, s[8:11], s28 offen offset:0
v_mul_f32 v240, v236, v236
v_mfma_f32_16x16x32_bf16 v[140:143], v[24:27], a[112:115], v[140:143]
v_mul_f32 v241, v237, v237
v_mul_f32 v242, v238, v238
v_mfma_f32_16x16x32_bf16 v[144:147], v[24:27], a[116:119], v[144:147]
v_mul_f32 v243, v239, v239
v_mfma_f32_16x16x32_bf16 v[148:151], v[24:27], a[120:123], v[148:151]
v_fmaak_f32 v240, v240, v9, 0xc0135761
v_fmaak_f32 v241, v241, v9, 0xc0135761
v_mfma_f32_16x16x32_bf16 v[152:155], v[24:27], a[124:127], v[152:155]
buffer_load_dwordx4 v[24:27], v1, s[8:11], s28 offen offset:1024
v_fmaak_f32 v242, v242, v9, 0xc0135761
v_fmaak_f32 v243, v243, v9, 0xc0135761
v_mfma_f32_16x16x32_bf16 v[140:143], v[28:31], a[128:131], v[140:143]
v_mul_f32 v240, v236, v240
v_mfma_f32_16x16x32_bf16 v[144:147], v[28:31], a[132:135], v[144:147]
v_mul_f32 v241, v237, v241
v_mul_f32 v242, v238, v242
v_mfma_f32_16x16x32_bf16 v[148:151], v[28:31], a[136:139], v[148:151]
v_mul_f32 v243, v239, v243
v_mfma_f32_16x16x32_bf16 v[152:155], v[28:31], a[140:143], v[152:155]
buffer_load_dwordx4 v[28:31], v1, s[8:11], s28 offen offset:2048
v_exp_f32 v240, v240
v_exp_f32 v241, v241
s_waitcnt vmcnt(11)
v_mfma_f32_16x16x32_bf16 v[140:143], v[32:35], a[144:147], v[140:143]
v_exp_f32 v242, v242
v_exp_f32 v243, v243
v_mfma_f32_16x16x32_bf16 v[144:147], v[32:35], a[148:151], v[144:147]
v_add_f32 v240, 1.0, v240
v_mfma_f32_16x16x32_bf16 v[148:151], v[32:35], a[152:155], v[148:151]
v_add_f32 v241, 1.0, v241
v_add_f32 v242, 1.0, v242
v_mfma_f32_16x16x32_bf16 v[152:155], v[32:35], a[156:159], v[152:155]
buffer_load_dwordx4 v[32:35], v1, s[8:11], s28 offen offset:3072
v_add_f32 v243, 1.0, v243
v_mfma_f32_16x16x32_bf16 v[140:143], v[36:39], a[160:163], v[140:143]
v_rcp_f32 v240, v240
v_rcp_f32 v241, v241
v_mfma_f32_16x16x32_bf16 v[144:147], v[36:39], a[164:167], v[144:147]
v_rcp_f32 v242, v242
v_rcp_f32 v243, v243
v_mfma_f32_16x16x32_bf16 v[148:151], v[36:39], a[168:171], v[148:151]
v_mul_f32 v236, v236, v240
v_mfma_f32_16x16x32_bf16 v[152:155], v[36:39], a[172:175], v[152:155]
s_add_u32 s28, s21, 61440
buffer_load_dwordx4 v[36:39], v1, s[8:11], s28 offen offset:0
v_mul_f32 v237, v237, v241
v_mul_f32 v238, v238, v242
v_mfma_f32_16x16x32_bf16 v[140:143], v[40:43], a[176:179], v[140:143]
v_mul_f32 v239, v239, v243
v_mfma_f32_16x16x32_bf16 v[144:147], v[40:43], a[180:183], v[144:147]
v_cvt_pk_bf16_f32 v246, v236, v237
v_cvt_pk_bf16_f32 v247, v238, v239
v_mfma_f32_16x16x32_bf16 v[148:151], v[40:43], a[184:187], v[148:151]
ds_write_b64 v5, v[246:247] offset:1024
v_fma_f32 v240, v18, v224, v220
v_mfma_f32_16x16x32_bf16 v[152:155], v[40:43], a[188:191], v[152:155]
buffer_load_dwordx4 v[40:43], v1, s[8:11], s28 offen offset:1024
v_fma_f32 v241, v18, v225, v221
s_waitcnt vmcnt(11)
v_mfma_f32_16x16x32_bf16 v[140:143], v[44:47], a[192:195], v[140:143]
v_fma_f32 v242, v18, v226, v222
v_fma_f32 v243, v18, v227, v223
v_mfma_f32_16x16x32_bf16 v[144:147], v[44:47], a[196:199], v[144:147]
v_fma_f32 v236, v116, v14, v240
v_mfma_f32_16x16x32_bf16 v[148:151], v[44:47], a[200:203], v[148:151]
v_fma_f32 v237, v117, v14, v241
v_fma_f32 v238, v118, v14, v242
v_mfma_f32_16x16x32_bf16 v[152:155], v[44:47], a[204:207], v[152:155]
buffer_load_dwordx4 v[44:47], v1, s[8:11], s28 offen offset:2048
v_fma_f32 v239, v119, v14, v243
v_mul_f32 v240, v236, v236
v_mfma_f32_16x16x32_bf16 v[140:143], v[48:51], a[208:211], v[140:143]
v_mul_f32 v241, v237, v237
v_mfma_f32_16x16x32_bf16 v[144:147], v[48:51], a[212:215], v[144:147]
v_mul_f32 v242, v238, v238
v_mul_f32 v243, v239, v239
v_mfma_f32_16x16x32_bf16 v[148:151], v[48:51], a[216:219], v[148:151]
v_fmaak_f32 v240, v240, v9, 0xc0135761
v_mfma_f32_16x16x32_bf16 v[152:155], v[48:51], a[220:223], v[152:155]
buffer_load_dwordx4 v[48:51], v1, s[8:11], s28 offen offset:3072
v_fmaak_f32 v241, v241, v9, 0xc0135761
v_fmaak_f32 v242, v242, v9, 0xc0135761
v_mfma_f32_16x16x32_bf16 v[140:143], v[52:55], a[224:227], v[140:143]
v_fmaak_f32 v243, v243, v9, 0xc0135761
v_mul_f32 v240, v236, v240
v_mfma_f32_16x16x32_bf16 v[144:147], v[52:55], a[228:231], v[144:147]
v_mul_f32 v241, v237, v241
v_mfma_f32_16x16x32_bf16 v[148:151], v[52:55], a[232:235], v[148:151]
v_mul_f32 v242, v238, v242
v_mul_f32 v243, v239, v243
v_mfma_f32_16x16x32_bf16 v[152:155], v[52:55], a[236:239], v[152:155]
s_add_u32 s28, s21, 65536
buffer_load_dwordx4 v[52:55], v1, s[8:11], s28 offen offset:0
v_exp_f32 v240, v240
s_waitcnt vmcnt(11)
v_mfma_f32_16x16x32_bf16 v[140:143], v[56:59], a[240:243], v[140:143]
v_exp_f32 v241, v241
v_exp_f32 v242, v242
v_mfma_f32_16x16x32_bf16 v[144:147], v[56:59], a[244:247], v[144:147]
v_exp_f32 v243, v243
v_add_f32 v240, 1.0, v240
v_mfma_f32_16x16x32_bf16 v[148:151], v[56:59], a[248:251], v[148:151]
v_add_f32 v241, 1.0, v241
v_mfma_f32_16x16x32_bf16 v[152:155], v[56:59], a[252:255], v[152:155]
buffer_load_dwordx4 v[56:59], v1, s[8:11], s28 offen offset:1024
v_add_f32 v242, 1.0, v242
v_add_f32 v243, 1.0, v243
v_mfma_f32_16x16x32_bf16 v[140:143], v[60:63], v[76:79], v[140:143]
v_rcp_f32 v240, v240
v_mfma_f32_16x16x32_bf16 v[144:147], v[60:63], v[80:83], v[144:147]
v_rcp_f32 v241, v241
v_rcp_f32 v242, v242
v_mfma_f32_16x16x32_bf16 v[148:151], v[60:63], v[84:87], v[148:151]
v_rcp_f32 v243, v243
v_mul_f32 v236, v236, v240
v_mfma_f32_16x16x32_bf16 v[152:155], v[60:63], v[88:91], v[152:155]
buffer_load_dwordx4 v[60:63], v1, s[8:11], s28 offen offset:2048
v_mul_f32 v237, v237, v241
v_mfma_f32_16x16x32_bf16 v[140:143], v[64:67], v[92:95], v[140:143]
v_mul_f32 v238, v238, v242
v_mul_f32 v239, v239, v243
v_mfma_f32_16x16x32_bf16 v[144:147], v[64:67], v[96:99], v[144:147]
v_cvt_pk_bf16_f32 v244, v236, v237
v_mfma_f32_16x16x32_bf16 v[148:151], v[64:67], v[100:103], v[148:151]
v_cvt_pk_bf16_f32 v245, v238, v239
ds_write_b64 v5, v[244:245] offset:2048
v_mfma_f32_16x16x32_bf16 v[152:155], v[64:67], v[104:107], v[152:155]
buffer_load_dwordx4 v[64:67], v1, s[8:11], s28 offen offset:3072
v_fma_f32 v240, v19, v224, v220
v_fma_f32 v241, v19, v225, v221
s_waitcnt vmcnt(11)
v_mfma_f32_16x16x32_bf16 v[156:159], v[68:71], a[0:3], 0
v_fma_f32 v242, v19, v226, v222
v_mfma_f32_16x16x32_bf16 v[160:163], v[68:71], a[4:7], 0
v_fma_f32 v243, v19, v227, v223
v_fma_f32 v236, v120, v15, v240
v_mfma_f32_16x16x32_bf16 v[164:167], v[68:71], a[8:11], 0
v_fma_f32 v237, v121, v15, v241
v_mfma_f32_16x16x32_bf16 v[168:171], v[68:71], a[12:15], 0
s_add_u32 s28, s21, 69632
buffer_load_dwordx4 v[68:71], v1, s[8:11], s28 offen offset:0
v_fma_f32 v238, v122, v15, v242
v_fma_f32 v239, v123, v15, v243
v_mfma_f32_16x16x32_bf16 v[156:159], v[72:75], a[16:19], v[156:159]
v_mul_f32 v240, v236, v236
v_mul_f32 v241, v237, v237
v_mfma_f32_16x16x32_bf16 v[160:163], v[72:75], a[20:23], v[160:163]
v_mul_f32 v242, v238, v238
v_mfma_f32_16x16x32_bf16 v[164:167], v[72:75], a[24:27], v[164:167]
v_mul_f32 v243, v239, v239
v_fmaak_f32 v240, v240, v9, 0xc0135761
v_mfma_f32_16x16x32_bf16 v[168:171], v[72:75], a[28:31], v[168:171]
buffer_load_dwordx4 v[72:75], v1, s[8:11], s28 offen offset:1024
v_fmaak_f32 v241, v241, v9, 0xc0135761
v_mfma_f32_16x16x32_bf16 v[156:159], v[20:23], a[32:35], v[156:159]
v_fmaak_f32 v242, v242, v9, 0xc0135761
v_fmaak_f32 v243, v243, v9, 0xc0135761
v_mfma_f32_16x16x32_bf16 v[160:163], v[20:23], a[36:39], v[160:163]
v_mul_f32 v240, v236, v240
v_mul_f32 v241, v237, v241
v_mfma_f32_16x16x32_bf16 v[164:167], v[20:23], a[40:43], v[164:167]
v_mul_f32 v242, v238, v242
v_mfma_f32_16x16x32_bf16 v[168:171], v[20:23], a[44:47], v[168:171]
buffer_load_dwordx4 v[20:23], v1, s[8:11], s28 offen offset:2048
v_mul_f32 v243, v239, v243
v_exp_f32 v240, v240
s_waitcnt vmcnt(11)
v_mfma_f32_16x16x32_bf16 v[156:159], v[24:27], a[48:51], v[156:159]
v_exp_f32 v241, v241
v_mfma_f32_16x16x32_bf16 v[160:163], v[24:27], a[52:55], v[160:163]
v_exp_f32 v242, v242
v_exp_f32 v243, v243
v_mfma_f32_16x16x32_bf16 v[164:167], v[24:27], a[56:59], v[164:167]
v_add_f32 v240, 1.0, v240
v_add_f32 v241, 1.0, v241
v_mfma_f32_16x16x32_bf16 v[168:171], v[24:27], a[60:63], v[168:171]
buffer_load_dwordx4 v[24:27], v1, s[8:11], s28 offen offset:3072
v_add_f32 v242, 1.0, v242
v_mfma_f32_16x16x32_bf16 v[156:159], v[28:31], a[64:67], v[156:159]
v_add_f32 v243, 1.0, v243
v_rcp_f32 v240, v240
v_mfma_f32_16x16x32_bf16 v[160:163], v[28:31], a[68:71], v[160:163]
v_rcp_f32 v241, v241
v_mfma_f32_16x16x32_bf16 v[164:167], v[28:31], a[72:75], v[164:167]
v_rcp_f32 v242, v242
v_rcp_f32 v243, v243
v_mfma_f32_16x16x32_bf16 v[168:171], v[28:31], a[76:79], v[168:171]
s_add_u32 s28, s21, 73728
buffer_load_dwordx4 v[28:31], v1, s[8:11], s28 offen offset:0
v_mul_f32 v236, v236, v240
v_mul_f32 v237, v237, v241
v_mfma_f32_16x16x32_bf16 v[156:159], v[32:35], a[80:83], v[156:159]
v_mul_f32 v238, v238, v242
v_mfma_f32_16x16x32_bf16 v[160:163], v[32:35], a[84:87], v[160:163]
v_mul_f32 v239, v239, v243
v_cvt_pk_bf16_f32 v246, v236, v237
v_mfma_f32_16x16x32_bf16 v[164:167], v[32:35], a[88:91], v[164:167]
v_cvt_pk_bf16_f32 v247, v238, v239
v_mfma_f32_16x16x32_bf16 v[168:171], v[32:35], a[92:95], v[168:171]
buffer_load_dwordx4 v[32:35], v1, s[8:11], s28 offen offset:1024
ds_write_b64 v5, v[246:247] offset:3072
buffer_load_dwordx4 v[220:223], v10, s[8:11], s23 offen offset:256 sc1
buffer_load_dwordx4 v[224:227], v10, s[8:11], s23 offen offset:272 sc1
s_waitcnt vmcnt(13)
v_mfma_f32_16x16x32_bf16 v[156:159], v[36:39], a[96:99], v[156:159]
v_fma_f32 v240, v16, v232, v228
v_fma_f32 v241, v16, v233, v229
v_mfma_f32_16x16x32_bf16 v[160:163], v[36:39], a[100:103], v[160:163]
v_fma_f32 v242, v16, v234, v230
v_mfma_f32_16x16x32_bf16 v[164:167], v[36:39], a[104:107], v[164:167]
v_fma_f32 v243, v16, v235, v231
v_fma_f32 v236, v124, v12, v240
v_mfma_f32_16x16x32_bf16 v[168:171], v[36:39], a[108:111], v[168:171]
buffer_load_dwordx4 v[36:39], v1, s[8:11], s28 offen offset:2048
v_fma_f32 v237, v125, v12, v241
v_mfma_f32_16x16x32_bf16 v[156:159], v[40:43], a[112:115], v[156:159]
v_fma_f32 v238, v126, v12, v242
v_fma_f32 v239, v127, v12, v243
v_mfma_f32_16x16x32_bf16 v[160:163], v[40:43], a[116:119], v[160:163]
v_mul_f32 v240, v236, v236
v_mul_f32 v241, v237, v237
v_mfma_f32_16x16x32_bf16 v[164:167], v[40:43], a[120:123], v[164:167]
v_mul_f32 v242, v238, v238
v_mfma_f32_16x16x32_bf16 v[168:171], v[40:43], a[124:127], v[168:171]
buffer_load_dwordx4 v[40:43], v1, s[8:11], s28 offen offset:3072
v_mul_f32 v243, v239, v239
v_fmaak_f32 v240, v240, v9, 0xc0135761
v_mfma_f32_16x16x32_bf16 v[156:159], v[44:47], a[128:131], v[156:159]
v_fmaak_f32 v241, v241, v9, 0xc0135761
v_mfma_f32_16x16x32_bf16 v[160:163], v[44:47], a[132:135], v[160:163]
v_fmaak_f32 v242, v242, v9, 0xc0135761
v_fmaak_f32 v243, v243, v9, 0xc0135761
v_mfma_f32_16x16x32_bf16 v[164:167], v[44:47], a[136:139], v[164:167]
v_mul_f32 v240, v236, v240
v_mul_f32 v241, v237, v241
v_mfma_f32_16x16x32_bf16 v[168:171], v[44:47], a[140:143], v[168:171]
s_add_u32 s28, s21, 77824
buffer_load_dwordx4 v[44:47], v1, s[8:11], s28 offen offset:0
v_mul_f32 v242, v238, v242
s_waitcnt vmcnt(13)
v_mfma_f32_16x16x32_bf16 v[156:159], v[48:51], a[144:147], v[156:159]
v_mul_f32 v243, v239, v243
v_exp_f32 v240, v240
v_mfma_f32_16x16x32_bf16 v[160:163], v[48:51], a[148:151], v[160:163]
v_exp_f32 v241, v241
v_mfma_f32_16x16x32_bf16 v[164:167], v[48:51], a[152:155], v[164:167]
v_exp_f32 v242, v242
v_exp_f32 v243, v243
v_mfma_f32_16x16x32_bf16 v[168:171], v[48:51], a[156:159], v[168:171]
buffer_load_dwordx4 v[48:51], v1, s[8:11], s28 offen offset:1024
v_add_f32 v240, 1.0, v240
v_add_f32 v241, 1.0, v241
v_mfma_f32_16x16x32_bf16 v[156:159], v[52:55], a[160:163], v[156:159]
v_add_f32 v242, 1.0, v242
v_mfma_f32_16x16x32_bf16 v[160:163], v[52:55], a[164:167], v[160:163]
v_add_f32 v243, 1.0, v243
v_rcp_f32 v240, v240
v_mfma_f32_16x16x32_bf16 v[164:167], v[52:55], a[168:171], v[164:167]
v_rcp_f32 v241, v241
v_mfma_f32_16x16x32_bf16 v[168:171], v[52:55], a[172:175], v[168:171]
buffer_load_dwordx4 v[52:55], v1, s[8:11], s28 offen offset:2048
v_rcp_f32 v242, v242
v_rcp_f32 v243, v243
v_mfma_f32_16x16x32_bf16 v[156:159], v[56:59], a[176:179], v[156:159]
v_mul_f32 v236, v236, v240
v_mul_f32 v237, v237, v241
v_mfma_f32_16x16x32_bf16 v[160:163], v[56:59], a[180:183], v[160:163]
v_mul_f32 v238, v238, v242
v_mfma_f32_16x16x32_bf16 v[164:167], v[56:59], a[184:187], v[164:167]
v_mul_f32 v239, v239, v243
v_cvt_pk_bf16_f32 v244, v236, v237
v_mfma_f32_16x16x32_bf16 v[168:171], v[56:59], a[188:191], v[168:171]
buffer_load_dwordx4 v[56:59], v1, s[8:11], s28 offen offset:3072
v_cvt_pk_bf16_f32 v245, v238, v239
s_waitcnt vmcnt(13)
v_mfma_f32_16x16x32_bf16 v[156:159], v[60:63], a[192:195], v[156:159]
ds_write_b64 v5, v[244:245] offset:8192
v_fma_f32 v240, v17, v232, v228
v_mfma_f32_16x16x32_bf16 v[160:163], v[60:63], a[196:199], v[160:163]
v_fma_f32 v241, v17, v233, v229
v_fma_f32 v242, v17, v234, v230
v_mfma_f32_16x16x32_bf16 v[164:167], v[60:63], a[200:203], v[164:167]
v_fma_f32 v243, v17, v235, v231
v_mfma_f32_16x16x32_bf16 v[168:171], v[60:63], a[204:207], v[168:171]
s_add_u32 s28, s21, 81920
buffer_load_dwordx4 v[60:63], v1, s[8:11], s28 offen offset:0
v_fma_f32 v236, v128, v13, v240
v_fma_f32 v237, v129, v13, v241
v_mfma_f32_16x16x32_bf16 v[156:159], v[64:67], a[208:211], v[156:159]
v_fma_f32 v238, v130, v13, v242
v_mfma_f32_16x16x32_bf16 v[160:163], v[64:67], a[212:215], v[160:163]
v_fma_f32 v239, v131, v13, v243
v_mul_f32 v240, v236, v236
v_mfma_f32_16x16x32_bf16 v[164:167], v[64:67], a[216:219], v[164:167]
v_mul_f32 v241, v237, v237
v_mul_f32 v242, v238, v238
v_mfma_f32_16x16x32_bf16 v[168:171], v[64:67], a[220:223], v[168:171]
buffer_load_dwordx4 v[64:67], v1, s[8:11], s28 offen offset:1024
v_mul_f32 v243, v239, v239
v_mfma_f32_16x16x32_bf16 v[156:159], v[68:71], a[224:227], v[156:159]
v_fmaak_f32 v240, v240, v9, 0xc0135761
v_fmaak_f32 v241, v241, v9, 0xc0135761
v_mfma_f32_16x16x32_bf16 v[160:163], v[68:71], a[228:231], v[160:163]
v_fmaak_f32 v242, v242, v9, 0xc0135761
v_mfma_f32_16x16x32_bf16 v[164:167], v[68:71], a[232:235], v[164:167]
v_fmaak_f32 v243, v243, v9, 0xc0135761
v_mul_f32 v240, v236, v240
v_mfma_f32_16x16x32_bf16 v[168:171], v[68:71], a[236:239], v[168:171]
buffer_load_dwordx4 v[68:71], v1, s[8:11], s28 offen offset:2048
v_mul_f32 v241, v237, v241
v_mul_f32 v242, v238, v242
s_waitcnt vmcnt(13)
v_mfma_f32_16x16x32_bf16 v[156:159], v[72:75], a[240:243], v[156:159]
v_mul_f32 v243, v239, v243
v_mfma_f32_16x16x32_bf16 v[160:163], v[72:75], a[244:247], v[160:163]
v_exp_f32 v240, v240
v_exp_f32 v241, v241
v_mfma_f32_16x16x32_bf16 v[164:167], v[72:75], a[248:251], v[164:167]
v_exp_f32 v242, v242
v_mfma_f32_16x16x32_bf16 v[168:171], v[72:75], a[252:255], v[168:171]
buffer_load_dwordx4 v[72:75], v1, s[8:11], s28 offen offset:3072
v_exp_f32 v243, v243
v_add_f32 v240, 1.0, v240
v_mfma_f32_16x16x32_bf16 v[156:159], v[20:23], v[76:79], v[156:159]
v_add_f32 v241, 1.0, v241
v_add_f32 v242, 1.0, v242
v_mfma_f32_16x16x32_bf16 v[160:163], v[20:23], v[80:83], v[160:163]
v_add_f32 v243, 1.0, v243
v_mfma_f32_16x16x32_bf16 v[164:167], v[20:23], v[84:87], v[164:167]
v_rcp_f32 v240, v240
v_rcp_f32 v241, v241
v_mfma_f32_16x16x32_bf16 v[168:171], v[20:23], v[88:91], v[168:171]
s_add_u32 s28, s21, 86016
buffer_load_dwordx4 v[20:23], v1, s[8:11], s28 offen offset:0
v_rcp_f32 v242, v242
v_mfma_f32_16x16x32_bf16 v[156:159], v[24:27], v[92:95], v[156:159]
v_rcp_f32 v243, v243
v_mul_f32 v236, v236, v240
v_mfma_f32_16x16x32_bf16 v[160:163], v[24:27], v[96:99], v[160:163]
v_mul_f32 v237, v237, v241
v_mul_f32 v238, v238, v242
v_mfma_f32_16x16x32_bf16 v[164:167], v[24:27], v[100:103], v[164:167]
v_mul_f32 v239, v239, v243
v_mfma_f32_16x16x32_bf16 v[168:171], v[24:27], v[104:107], v[168:171]
buffer_load_dwordx4 v[24:27], v1, s[8:11], s28 offen offset:1024
v_cvt_pk_bf16_f32 v246, v236, v237
v_cvt_pk_bf16_f32 v247, v238, v239
s_waitcnt vmcnt(11)
v_mfma_f32_16x16x32_bf16 v[172:175], v[28:31], a[0:3], 0
ds_write_b64 v5, v[246:247] offset:9216
v_mfma_f32_16x16x32_bf16 v[176:179], v[28:31], a[4:7], 0
v_fma_f32 v240, v18, v232, v228
v_fma_f32 v241, v18, v233, v229
v_mfma_f32_16x16x32_bf16 v[180:183], v[28:31], a[8:11], 0
v_fma_f32 v242, v18, v234, v230
v_fma_f32 v243, v18, v235, v231
v_mfma_f32_16x16x32_bf16 v[184:187], v[28:31], a[12:15], 0
buffer_load_dwordx4 v[28:31], v1, s[8:11], s28 offen offset:2048
v_fma_f32 v236, v132, v14, v240
v_mfma_f32_16x16x32_bf16 v[172:175], v[32:35], a[16:19], v[172:175]
v_fma_f32 v237, v133, v14, v241
v_fma_f32 v238, v134, v14, v242
v_mfma_f32_16x16x32_bf16 v[176:179], v[32:35], a[20:23], v[176:179]
v_fma_f32 v239, v135, v14, v243
v_mfma_f32_16x16x32_bf16 v[180:183], v[32:35], a[24:27], v[180:183]
v_mul_f32 v240, v236, v236
v_mul_f32 v241, v237, v237
v_mfma_f32_16x16x32_bf16 v[184:187], v[32:35], a[28:31], v[184:187]
buffer_load_dwordx4 v[32:35], v1, s[8:11], s28 offen offset:3072
v_mul_f32 v242, v238, v238
v_mul_f32 v243, v239, v239
v_mfma_f32_16x16x32_bf16 v[172:175], v[36:39], a[32:35], v[172:175]
v_fmaak_f32 v240, v240, v9, 0xc0135761
v_mfma_f32_16x16x32_bf16 v[176:179], v[36:39], a[36:39], v[176:179]
v_fmaak_f32 v241, v241, v9, 0xc0135761
v_fmaak_f32 v242, v242, v9, 0xc0135761
v_mfma_f32_16x16x32_bf16 v[180:183], v[36:39], a[40:43], v[180:183]
v_fmaak_f32 v243, v243, v9, 0xc0135761
v_mfma_f32_16x16x32_bf16 v[184:187], v[36:39], a[44:47], v[184:187]
s_add_u32 s28, s21, 90112
buffer_load_dwordx4 v[36:39], v1, s[8:11], s28 offen offset:0
v_mul_f32 v240, v236, v240
v_mul_f32 v241, v237, v241
s_waitcnt vmcnt(11)
v_mfma_f32_16x16x32_bf16 v[172:175], v[40:43], a[48:51], v[172:175]
v_mul_f32 v242, v238, v242
v_mul_f32 v243, v239, v243
v_mfma_f32_16x16x32_bf16 v[176:179], v[40:43], a[52:55], v[176:179]
v_exp_f32 v240, v240
v_mfma_f32_16x16x32_bf16 v[180:183], v[40:43], a[56:59], v[180:183]
v_exp_f32 v241, v241
v_exp_f32 v242, v242
v_mfma_f32_16x16x32_bf16 v[184:187], v[40:43], a[60:63], v[184:187]
buffer_load_dwordx4 v[40:43], v1, s[8:11], s28 offen offset:1024
v_exp_f32 v243, v243
v_mfma_f32_16x16x32_bf16 v[172:175], v[44:47], a[64:67], v[172:175]
v_add_f32 v240, 1.0, v240
v_add_f32 v241, 1.0, v241
v_mfma_f32_16x16x32_bf16 v[176:179], v[44:47], a[68:71], v[176:179]
v_add_f32 v242, 1.0, v242
v_add_f32 v243, 1.0, v243
v_mfma_f32_16x16x32_bf16 v[180:183], v[44:47], a[72:75], v[180:183]
v_rcp_f32 v240, v240
v_mfma_f32_16x16x32_bf16 v[184:187], v[44:47], a[76:79], v[184:187]
buffer_load_dwordx4 v[44:47], v1, s[8:11], s28 offen offset:2048
v_rcp_f32 v241, v241
v_rcp_f32 v242, v242
v_mfma_f32_16x16x32_bf16 v[172:175], v[48:51], a[80:83], v[172:175]
v_rcp_f32 v243, v243
v_mfma_f32_16x16x32_bf16 v[176:179], v[48:51], a[84:87], v[176:179]
v_mul_f32 v236, v236, v240
v_mul_f32 v237, v237, v241
v_mfma_f32_16x16x32_bf16 v[180:183], v[48:51], a[88:91], v[180:183]
v_mul_f32 v238, v238, v242
v_mul_f32 v239, v239, v243
v_mfma_f32_16x16x32_bf16 v[184:187], v[48:51], a[92:95], v[184:187]
buffer_load_dwordx4 v[48:51], v1, s[8:11], s28 offen offset:3072
v_cvt_pk_bf16_f32 v244, v236, v237
s_waitcnt vmcnt(11)
v_mfma_f32_16x16x32_bf16 v[172:175], v[52:55], a[96:99], v[172:175]
v_cvt_pk_bf16_f32 v245, v238, v239
ds_write_b64 v5, v[244:245] offset:10240
v_mfma_f32_16x16x32_bf16 v[176:179], v[52:55], a[100:103], v[176:179]
v_fma_f32 v240, v19, v232, v228
v_mfma_f32_16x16x32_bf16 v[180:183], v[52:55], a[104:107], v[180:183]
v_fma_f32 v241, v19, v233, v229
v_fma_f32 v242, v19, v234, v230
v_mfma_f32_16x16x32_bf16 v[184:187], v[52:55], a[108:111], v[184:187]
s_add_u32 s28, s21, 94208
buffer_load_dwordx4 v[52:55], v1, s[8:11], s28 offen offset:0
v_fma_f32 v243, v19, v235, v231
v_fma_f32 v236, v136, v15, v240
v_mfma_f32_16x16x32_bf16 v[172:175], v[56:59], a[112:115], v[172:175]
v_fma_f32 v237, v137, v15, v241
v_mfma_f32_16x16x32_bf16 v[176:179], v[56:59], a[116:119], v[176:179]
v_fma_f32 v238, v138, v15, v242
v_fma_f32 v239, v139, v15, v243
v_mfma_f32_16x16x32_bf16 v[180:183], v[56:59], a[120:123], v[180:183]
v_mul_f32 v240, v236, v236
v_mfma_f32_16x16x32_bf16 v[184:187], v[56:59], a[124:127], v[184:187]
buffer_load_dwordx4 v[56:59], v1, s[8:11], s28 offen offset:1024
v_mul_f32 v241, v237, v237
v_mul_f32 v242, v238, v238
v_mfma_f32_16x16x32_bf16 v[172:175], v[60:63], a[128:131], v[172:175]
v_mul_f32 v243, v239, v239
v_fmaak_f32 v240, v240, v9, 0xc0135761
v_mfma_f32_16x16x32_bf16 v[176:179], v[60:63], a[132:135], v[176:179]
v_fmaak_f32 v241, v241, v9, 0xc0135761
v_mfma_f32_16x16x32_bf16 v[180:183], v[60:63], a[136:139], v[180:183]
v_fmaak_f32 v242, v242, v9, 0xc0135761
v_fmaak_f32 v243, v243, v9, 0xc0135761
v_mfma_f32_16x16x32_bf16 v[184:187], v[60:63], a[140:143], v[184:187]
buffer_load_dwordx4 v[60:63], v1, s[8:11], s28 offen offset:2048
v_mul_f32 v240, v236, v240
s_waitcnt vmcnt(11)
v_mfma_f32_16x16x32_bf16 v[172:175], v[64:67], a[144:147], v[172:175]
v_mul_f32 v241, v237, v241
v_mul_f32 v242, v238, v242
v_mfma_f32_16x16x32_bf16 v[176:179], v[64:67], a[148:151], v[176:179]
v_mul_f32 v243, v239, v243
v_exp_f32 v240, v240
v_mfma_f32_16x16x32_bf16 v[180:183], v[64:67], a[152:155], v[180:183]
v_exp_f32 v241, v241
v_mfma_f32_16x16x32_bf16 v[184:187], v[64:67], a[156:159], v[184:187]
buffer_load_dwordx4 v[64:67], v1, s[8:11], s28 offen offset:3072
v_exp_f32 v242, v242
v_exp_f32 v243, v243
v_mfma_f32_16x16x32_bf16 v[172:175], v[68:71], a[160:163], v[172:175]
v_add_f32 v240, 1.0, v240
v_mfma_f32_16x16x32_bf16 v[176:179], v[68:71], a[164:167], v[176:179]
v_add_f32 v241, 1.0, v241
v_add_f32 v242, 1.0, v242
v_mfma_f32_16x16x32_bf16 v[180:183], v[68:71], a[168:171], v[180:183]
v_add_f32 v243, 1.0, v243
v_rcp_f32 v240, v240
v_mfma_f32_16x16x32_bf16 v[184:187], v[68:71], a[172:175], v[184:187]
s_add_u32 s28, s21, 98304
buffer_load_dwordx4 v[68:71], v1, s[8:11], s28 offen offset:0
v_rcp_f32 v241, v241
v_mfma_f32_16x16x32_bf16 v[172:175], v[72:75], a[176:179], v[172:175]
v_rcp_f32 v242, v242
v_rcp_f32 v243, v243
v_mfma_f32_16x16x32_bf16 v[176:179], v[72:75], a[180:183], v[176:179]
v_mul_f32 v236, v236, v240
v_mfma_f32_16x16x32_bf16 v[180:183], v[72:75], a[184:187], v[180:183]
v_mul_f32 v237, v237, v241
v_mul_f32 v238, v238, v242
v_mfma_f32_16x16x32_bf16 v[184:187], v[72:75], a[188:191], v[184:187]
buffer_load_dwordx4 v[72:75], v1, s[8:11], s28 offen offset:1024
v_mul_f32 v239, v239, v243
v_cvt_pk_bf16_f32 v246, v236, v237
s_waitcnt vmcnt(11)
v_mfma_f32_16x16x32_bf16 v[172:175], v[20:23], a[192:195], v[172:175]
v_cvt_pk_bf16_f32 v247, v238, v239
v_mfma_f32_16x16x32_bf16 v[176:179], v[20:23], a[196:199], v[176:179]
ds_write_b64 v5, v[246:247] offset:11264
buffer_load_dwordx4 v[228:231], v10, s[8:11], s23 offen offset:384 sc1
buffer_load_dwordx4 v[232:235], v10, s[8:11], s23 offen offset:400 sc1
v_mfma_f32_16x16x32_bf16 v[180:183], v[20:23], a[200:203], v[180:183]
v_fma_f32 v240, v16, v224, v220
v_mfma_f32_16x16x32_bf16 v[184:187], v[20:23], a[204:207], v[184:187]
buffer_load_dwordx4 v[20:23], v1, s[8:11], s28 offen offset:2048
v_fma_f32 v241, v16, v225, v221
v_fma_f32 v242, v16, v226, v222
v_mfma_f32_16x16x32_bf16 v[172:175], v[24:27], a[208:211], v[172:175]
v_fma_f32 v243, v16, v227, v223
v_fma_f32 v236, v140, v12, v240
v_mfma_f32_16x16x32_bf16 v[176:179], v[24:27], a[212:215], v[176:179]
v_fma_f32 v237, v141, v12, v241
v_mfma_f32_16x16x32_bf16 v[180:183], v[24:27], a[216:219], v[180:183]
v_fma_f32 v238, v142, v12, v242
v_fma_f32 v239, v143, v12, v243
v_mfma_f32_16x16x32_bf16 v[184:187], v[24:27], a[220:223], v[184:187]
buffer_load_dwordx4 v[24:27], v1, s[8:11], s28 offen offset:3072
v_mul_f32 v240, v236, v236
v_mfma_f32_16x16x32_bf16 v[172:175], v[28:31], a[224:227], v[172:175]
v_mul_f32 v241, v237, v237
v_mul_f32 v242, v238, v238
v_mfma_f32_16x16x32_bf16 v[176:179], v[28:31], a[228:231], v[176:179]
v_mul_f32 v243, v239, v239
v_fmaak_f32 v240, v240, v9, 0xc0135761
v_mfma_f32_16x16x32_bf16 v[180:183], v[28:31], a[232:235], v[180:183]
v_fmaak_f32 v241, v241, v9, 0xc0135761
v_mfma_f32_16x16x32_bf16 v[184:187], v[28:31], a[236:239], v[184:187]
s_add_u32 s28, s21, 102400
buffer_load_dwordx4 v[28:31], v1, s[8:11], s28 offen offset:0
v_fmaak_f32 v242, v242, v9, 0xc0135761
v_fmaak_f32 v243, v243, v9, 0xc0135761
s_waitcnt vmcnt(13)
v_mfma_f32_16x16x32_bf16 v[172:175], v[32:35], a[240:243], v[172:175]
v_mul_f32 v240, v236, v240
v_mfma_f32_16x16x32_bf16 v[176:179], v[32:35], a[244:247], v[176:179]
v_mul_f32 v241, v237, v241
v_mul_f32 v242, v238, v242
v_mfma_f32_16x16x32_bf16 v[180:183], v[32:35], a[248:251], v[180:183]
v_mul_f32 v243, v239, v243
v_exp_f32 v240, v240
v_mfma_f32_16x16x32_bf16 v[184:187], v[32:35], a[252:255], v[184:187]
buffer_load_dwordx4 v[32:35], v1, s[8:11], s28 offen offset:1024
v_exp_f32 v241, v241
v_mfma_f32_16x16x32_bf16 v[172:175], v[36:39], v[76:79], v[172:175]
v_exp_f32 v242, v242
v_exp_f32 v243, v243
v_mfma_f32_16x16x32_bf16 v[176:179], v[36:39], v[80:83], v[176:179]
v_add_f32 v240, 1.0, v240
v_mfma_f32_16x16x32_bf16 v[180:183], v[36:39], v[84:87], v[180:183]
v_add_f32 v241, 1.0, v241
v_add_f32 v242, 1.0, v242
v_mfma_f32_16x16x32_bf16 v[184:187], v[36:39], v[88:91], v[184:187]
buffer_load_dwordx4 v[36:39], v1, s[8:11], s28 offen offset:2048
v_add_f32 v243, 1.0, v243
v_rcp_f32 v240, v240
v_mfma_f32_16x16x32_bf16 v[172:175], v[40:43], v[92:95], v[172:175]
v_rcp_f32 v241, v241
v_mfma_f32_16x16x32_bf16 v[176:179], v[40:43], v[96:99], v[176:179]
v_rcp_f32 v242, v242
v_rcp_f32 v243, v243
v_mfma_f32_16x16x32_bf16 v[180:183], v[40:43], v[100:103], v[180:183]
v_mul_f32 v236, v236, v240
v_mfma_f32_16x16x32_bf16 v[184:187], v[40:43], v[104:107], v[184:187]
buffer_load_dwordx4 v[40:43], v1, s[8:11], s28 offen offset:3072
v_mul_f32 v237, v237, v241
v_mul_f32 v238, v238, v242
v_and_b32 v248, 63, v0
v_lshlrev_b32 v248, 2, v248
s_mov_b32 s92, 39848192
buffer_load_dword v249, v248, s[8:11], s92 offen sc1
v_min_u32 v254, 188, v248
buffer_load_dword v252, v254, s[8:11], s92 offen offset:256 sc1
s_waitcnt vmcnt(15)
v_mfma_f32_16x16x32_bf16 v[188:191], v[44:47], a[0:3], 0
v_mul_f32 v239, v239, v243
v_cvt_pk_bf16_f32 v244, v236, v237
v_mfma_f32_16x16x32_bf16 v[192:195], v[44:47], a[4:7], 0
v_cvt_pk_bf16_f32 v245, v238, v239
v_mfma_f32_16x16x32_bf16 v[196:199], v[44:47], a[8:11], 0
ds_write_b64 v5, v[244:245] offset:16384
v_fma_f32 v240, v17, v224, v220
v_mfma_f32_16x16x32_bf16 v[200:203], v[44:47], a[12:15], 0
s_add_u32 s28, s21, 106496
buffer_load_dwordx4 v[44:47], v1, s[8:11], s28 offen offset:0
v_fma_f32 v241, v17, v225, v221
v_mfma_f32_16x16x32_bf16 v[188:191], v[48:51], a[16:19], v[188:191]
v_fma_f32 v242, v17, v226, v222
v_fma_f32 v243, v17, v227, v223
v_mfma_f32_16x16x32_bf16 v[192:195], v[48:51], a[20:23], v[192:195]
v_fma_f32 v236, v144, v13, v240
v_fma_f32 v237, v145, v13, v241
v_mfma_f32_16x16x32_bf16 v[196:199], v[48:51], a[24:27], v[196:199]
v_fma_f32 v238, v146, v13, v242
v_mfma_f32_16x16x32_bf16 v[200:203], v[48:51], a[28:31], v[200:203]
buffer_load_dwordx4 v[48:51], v1, s[8:11], s28 offen offset:1024
v_fma_f32 v239, v147, v13, v243
v_mul_f32 v240, v236, v236
v_mfma_f32_16x16x32_bf16 v[188:191], v[52:55], a[32:35], v[188:191]
v_mul_f32 v241, v237, v237
v_mfma_f32_16x16x32_bf16 v[192:195], v[52:55], a[36:39], v[192:195]
v_mul_f32 v242, v238, v238
v_mul_f32 v243, v239, v239
v_mfma_f32_16x16x32_bf16 v[196:199], v[52:55], a[40:43], v[196:199]
v_fmaak_f32 v240, v240, v9, 0xc0135761
v_fmaak_f32 v241, v241, v9, 0xc0135761
v_mfma_f32_16x16x32_bf16 v[200:203], v[52:55], a[44:47], v[200:203]
buffer_load_dwordx4 v[52:55], v1, s[8:11], s28 offen offset:2048
v_fmaak_f32 v242, v242, v9, 0xc0135761
s_waitcnt vmcnt(15)
v_mfma_f32_16x16x32_bf16 v[188:191], v[56:59], a[48:51], v[188:191]
v_fmaak_f32 v243, v243, v9, 0xc0135761
v_mul_f32 v240, v236, v240
v_mfma_f32_16x16x32_bf16 v[192:195], v[56:59], a[52:55], v[192:195]
v_mul_f32 v241, v237, v241
v_mfma_f32_16x16x32_bf16 v[196:199], v[56:59], a[56:59], v[196:199]
v_mul_f32 v242, v238, v242
v_mul_f32 v243, v239, v243
v_mfma_f32_16x16x32_bf16 v[200:203], v[56:59], a[60:63], v[200:203]
buffer_load_dwordx4 v[56:59], v1, s[8:11], s28 offen offset:3072
v_exp_f32 v240, v240
v_exp_f32 v241, v241
v_mfma_f32_16x16x32_bf16 v[188:191], v[60:63], a[64:67], v[188:191]
v_exp_f32 v242, v242
v_mfma_f32_16x16x32_bf16 v[192:195], v[60:63], a[68:71], v[192:195]
v_exp_f32 v243, v243
v_add_f32 v240, 1.0, v240
v_mfma_f32_16x16x32_bf16 v[196:199], v[60:63], a[72:75], v[196:199]
v_add_f32 v241, 1.0, v241
v_mfma_f32_16x16x32_bf16 v[200:203], v[60:63], a[76:79], v[200:203]
s_add_u32 s28, s21, 110592
buffer_load_dwordx4 v[60:63], v1, s[8:11], s28 offen offset:0
v_add_f32 v242, 1.0, v242
v_add_f32 v243, 1.0, v243
v_mfma_f32_16x16x32_bf16 v[188:191], v[64:67], a[80:83], v[188:191]
v_rcp_f32 v240, v240
v_rcp_f32 v241, v241
v_mfma_f32_16x16x32_bf16 v[192:195], v[64:67], a[84:87], v[192:195]
v_rcp_f32 v242, v242
v_mfma_f32_16x16x32_bf16 v[196:199], v[64:67], a[88:91], v[196:199]
v_rcp_f32 v243, v243
v_mul_f32 v236, v236, v240
v_mfma_f32_16x16x32_bf16 v[200:203], v[64:67], a[92:95], v[200:203]
buffer_load_dwordx4 v[64:67], v1, s[8:11], s28 offen offset:1024
v_mul_f32 v237, v237, v241
s_waitcnt vmcnt(13)
v_mfma_f32_16x16x32_bf16 v[188:191], v[68:71], a[96:99], v[188:191]
v_mul_f32 v238, v238, v242
v_mul_f32 v239, v239, v243
v_mfma_f32_16x16x32_bf16 v[192:195], v[68:71], a[100:103], v[192:195]
v_cvt_pk_bf16_f32 v246, v236, v237
v_cvt_pk_bf16_f32 v247, v238, v239
v_mfma_f32_16x16x32_bf16 v[196:199], v[68:71], a[104:107], v[196:199]
ds_write_b64 v5, v[246:247] offset:17408
v_mfma_f32_16x16x32_bf16 v[200:203], v[68:71], a[108:111], v[200:203]
buffer_load_dwordx4 v[68:71], v1, s[8:11], s28 offen offset:2048
v_fma_f32 v240, v18, v224, v220
v_fma_f32 v241, v18, v225, v221
v_mfma_f32_16x16x32_bf16 v[188:191], v[72:75], a[112:115], v[188:191]
v_fma_f32 v242, v18, v226, v222
v_mfma_f32_16x16x32_bf16 v[192:195], v[72:75], a[116:119], v[192:195]
v_fma_f32 v243, v18, v227, v223
v_fma_f32 v236, v148, v14, v240
v_mfma_f32_16x16x32_bf16 v[196:199], v[72:75], a[120:123], v[196:199]
v_fma_f32 v237, v149, v14, v241
v_fma_f32 v238, v150, v14, v242
v_mfma_f32_16x16x32_bf16 v[200:203], v[72:75], a[124:127], v[200:203]
buffer_load_dwordx4 v[72:75], v1, s[8:11], s28 offen offset:3072
v_fma_f32 v239, v151, v14, v243
v_mfma_f32_16x16x32_bf16 v[188:191], v[20:23], a[128:131], v[188:191]
v_mul_f32 v240, v236, v236
v_mul_f32 v241, v237, v237
v_mfma_f32_16x16x32_bf16 v[192:195], v[20:23], a[132:135], v[192:195]
v_mul_f32 v242, v238, v238
v_mfma_f32_16x16x32_bf16 v[196:199], v[20:23], a[136:139], v[196:199]
v_mul_f32 v243, v239, v239
v_fmaak_f32 v240, v240, v9, 0xc0135761
v_mfma_f32_16x16x32_bf16 v[200:203], v[20:23], a[140:143], v[200:203]
s_add_u32 s28, s21, 114688
buffer_load_dwordx4 v[20:23], v1, s[8:11], s28 offen offset:0
v_fmaak_f32 v241, v241, v9, 0xc0135761
v_fmaak_f32 v242, v242, v9, 0xc0135761
s_waitcnt vmcnt(13)
v_mfma_f32_16x16x32_bf16 v[188:191], v[24:27], a[144:147], v[188:191]
v_fmaak_f32 v243, v243, v9, 0xc0135761
v_mfma_f32_16x16x32_bf16 v[192:195], v[24:27], a[148:151], v[192:195]
v_mul_f32 v240, v236, v240
v_mul_f32 v241, v237, v241
v_mfma_f32_16x16x32_bf16 v[196:199], v[24:27], a[152:155], v[196:199]
v_mul_f32 v242, v238, v242
v_mfma_f32_16x16x32_bf16 v[200:203], v[24:27], a[156:159], v[200:203]
buffer_load_dwordx4 v[24:27], v1, s[8:11], s28 offen offset:1024
v_mul_f32 v243, v239, v243
v_exp_f32 v240, v240
v_mfma_f32_16x16x32_bf16 v[188:191], v[28:31], a[160:163], v[188:191]
v_exp_f32 v241, v241
v_exp_f32 v242, v242
v_mfma_f32_16x16x32_bf16 v[192:195], v[28:31], a[164:167], v[192:195]
v_exp_f32 v243, v243
v_mfma_f32_16x16x32_bf16 v[196:199], v[28:31], a[168:171], v[196:199]
v_add_f32 v240, 1.0, v240
v_add_f32 v241, 1.0, v241
v_mfma_f32_16x16x32_bf16 v[200:203], v[28:31], a[172:175], v[200:203]
buffer_load_dwordx4 v[28:31], v1, s[8:11], s28 offen offset:2048
v_add_f32 v242, 1.0, v242
v_mfma_f32_16x16x32_bf16 v[188:191], v[32:35], a[176:179], v[188:191]
v_add_f32 v243, 1.0, v243
v_rcp_f32 v240, v240
v_mfma_f32_16x16x32_bf16 v[192:195], v[32:35], a[180:183], v[192:195]
v_rcp_f32 v241, v241
v_rcp_f32 v242, v242
v_mfma_f32_16x16x32_bf16 v[196:199], v[32:35], a[184:187], v[196:199]
v_rcp_f32 v243, v243
v_mfma_f32_16x16x32_bf16 v[200:203], v[32:35], a[188:191], v[200:203]
buffer_load_dwordx4 v[32:35], v1, s[8:11], s28 offen offset:3072
v_mul_f32 v236, v236, v240
v_mul_f32 v237, v237, v241
s_waitcnt vmcnt(11)
v_mfma_f32_16x16x32_bf16 v[188:191], v[36:39], a[192:195], v[188:191]
v_mul_f32 v238, v238, v242
v_mfma_f32_16x16x32_bf16 v[192:195], v[36:39], a[196:199], v[192:195]
v_mul_f32 v239, v239, v243
v_cvt_pk_bf16_f32 v244, v236, v237
v_mfma_f32_16x16x32_bf16 v[196:199], v[36:39], a[200:203], v[196:199]
v_cvt_pk_bf16_f32 v245, v238, v239
ds_write_b64 v5, v[244:245] offset:18432
v_mfma_f32_16x16x32_bf16 v[200:203], v[36:39], a[204:207], v[200:203]
s_add_u32 s28, s21, 118784
buffer_load_dwordx4 v[36:39], v1, s[8:11], s28 offen offset:0
v_fma_f32 v240, v19, v224, v220
v_mfma_f32_16x16x32_bf16 v[188:191], v[40:43], a[208:211], v[188:191]
v_fma_f32 v241, v19, v225, v221
v_fma_f32 v242, v19, v226, v222
v_mfma_f32_16x16x32_bf16 v[192:195], v[40:43], a[212:215], v[192:195]
v_fma_f32 v243, v19, v227, v223
v_mfma_f32_16x16x32_bf16 v[196:199], v[40:43], a[216:219], v[196:199]
v_fma_f32 v236, v152, v15, v240
v_fma_f32 v237, v153, v15, v241
v_mfma_f32_16x16x32_bf16 v[200:203], v[40:43], a[220:223], v[200:203]
buffer_load_dwordx4 v[40:43], v1, s[8:11], s28 offen offset:1024
v_fma_f32 v238, v154, v15, v242
v_fma_f32 v239, v155, v15, v243
v_mfma_f32_16x16x32_bf16 v[188:191], v[44:47], a[224:227], v[188:191]
v_mul_f32 v240, v236, v236
v_mfma_f32_16x16x32_bf16 v[192:195], v[44:47], a[228:231], v[192:195]
v_mul_f32 v241, v237, v237
v_mul_f32 v242, v238, v238
v_mfma_f32_16x16x32_bf16 v[196:199], v[44:47], a[232:235], v[196:199]
v_mul_f32 v243, v239, v239
v_mfma_f32_16x16x32_bf16 v[200:203], v[44:47], a[236:239], v[200:203]
buffer_load_dwordx4 v[44:47], v1, s[8:11], s28 offen offset:2048
v_fmaak_f32 v240, v240, v9, 0xc0135761
v_fmaak_f32 v241, v241, v9, 0xc0135761
s_waitcnt vmcnt(11)
v_mfma_f32_16x16x32_bf16 v[188:191], v[48:51], a[240:243], v[188:191]
v_fmaak_f32 v242, v242, v9, 0xc0135761
v_fmaak_f32 v243, v243, v9, 0xc0135761
v_mfma_f32_16x16x32_bf16 v[192:195], v[48:51], a[244:247], v[192:195]
v_mul_f32 v240, v236, v240
v_mfma_f32_16x16x32_bf16 v[196:199], v[48:51], a[248:251], v[196:199]
v_mul_f32 v241, v237, v241
v_mul_f32 v242, v238, v242
v_mfma_f32_16x16x32_bf16 v[200:203], v[48:51], a[252:255], v[200:203]
buffer_load_dwordx4 v[48:51], v1, s[8:11], s28 offen offset:3072
v_mul_f32 v243, v239, v243
v_mfma_f32_16x16x32_bf16 v[188:191], v[52:55], v[76:79], v[188:191]
v_exp_f32 v240, v240
v_exp_f32 v241, v241
v_mfma_f32_16x16x32_bf16 v[192:195], v[52:55], v[80:83], v[192:195]
v_exp_f32 v242, v242
v_exp_f32 v243, v243
v_mfma_f32_16x16x32_bf16 v[196:199], v[52:55], v[84:87], v[196:199]
v_add_f32 v240, 1.0, v240
v_mfma_f32_16x16x32_bf16 v[200:203], v[52:55], v[88:91], v[200:203]
s_add_u32 s28, s21, 122880
buffer_load_dwordx4 v[52:55], v1, s[8:11], s28 offen offset:0
v_add_f32 v241, 1.0, v241
v_add_f32 v242, 1.0, v242
v_mfma_f32_16x16x32_bf16 v[188:191], v[56:59], v[92:95], v[188:191]
v_add_f32 v243, 1.0, v243
v_mfma_f32_16x16x32_bf16 v[192:195], v[56:59], v[96:99], v[192:195]
v_rcp_f32 v240, v240
v_rcp_f32 v241, v241
v_mfma_f32_16x16x32_bf16 v[196:199], v[56:59], v[100:103], v[196:199]
v_rcp_f32 v242, v242
v_rcp_f32 v243, v243
v_mfma_f32_16x16x32_bf16 v[200:203], v[56:59], v[104:107], v[200:203]
buffer_load_dwordx4 v[56:59], v1, s[8:11], s28 offen offset:1024
v_mul_f32 v236, v236, v240
s_waitcnt vmcnt(11)
v_mfma_f32_16x16x32_bf16 v[204:207], v[60:63], a[0:3], 0
v_mul_f32 v237, v237, v241
v_mul_f32 v238, v238, v242
v_mfma_f32_16x16x32_bf16 v[208:211], v[60:63], a[4:7], 0
v_mul_f32 v239, v239, v243
v_mfma_f32_16x16x32_bf16 v[212:215], v[60:63], a[8:11], 0
v_cvt_pk_bf16_f32 v246, v236, v237
v_cvt_pk_bf16_f32 v247, v238, v239
v_mfma_f32_16x16x32_bf16 v[216:219], v[60:63], a[12:15], 0
buffer_load_dwordx4 v[60:63], v1, s[8:11], s28 offen offset:2048
ds_write_b64 v5, v[246:247] offset:19456
buffer_load_dwordx4 v[220:223], v10, s[8:11], s23 offen offset:512 sc1
buffer_load_dwordx4 v[224:227], v10, s[8:11], s23 offen offset:528 sc1
v_mfma_f32_16x16x32_bf16 v[204:207], v[64:67], a[16:19], v[204:207]
v_fma_f32 v240, v16, v232, v228
v_mfma_f32_16x16x32_bf16 v[208:211], v[64:67], a[20:23], v[208:211]
v_fma_f32 v241, v16, v233, v229
v_fma_f32 v242, v16, v234, v230
v_mfma_f32_16x16x32_bf16 v[212:215], v[64:67], a[24:27], v[212:215]
v_fma_f32 v243, v16, v235, v231
v_mfma_f32_16x16x32_bf16 v[216:219], v[64:67], a[28:31], v[216:219]
buffer_load_dwordx4 v[64:67], v1, s[8:11], s28 offen offset:3072
v_fma_f32 v236, v156, v12, v240
v_fma_f32 v237, v157, v12, v241
v_mfma_f32_16x16x32_bf16 v[204:207], v[68:71], a[32:35], v[204:207]
v_fma_f32 v238, v158, v12, v242
v_fma_f32 v239, v159, v12, v243
v_mfma_f32_16x16x32_bf16 v[208:211], v[68:71], a[36:39], v[208:211]
v_mul_f32 v240, v236, v236
v_mfma_f32_16x16x32_bf16 v[212:215], v[68:71], a[40:43], v[212:215]
v_mul_f32 v241, v237, v237
v_mul_f32 v242, v238, v238
v_mfma_f32_16x16x32_bf16 v[216:219], v[68:71], a[44:47], v[216:219]
s_add_u32 s28, s21, 126976
buffer_load_dwordx4 v[68:71], v1, s[8:11], s28 offen offset:0
v_mul_f32 v243, v239, v239
s_waitcnt vmcnt(13)
v_mfma_f32_16x16x32_bf16 v[204:207], v[72:75], a[48:51], v[204:207]
v_fmaak_f32 v240, v240, v9, 0xc0135761
v_fmaak_f32 v241, v241, v9, 0xc0135761
v_mfma_f32_16x16x32_bf16 v[208:211], v[72:75], a[52:55], v[208:211]
v_fmaak_f32 v242, v242, v9, 0xc0135761
v_fmaak_f32 v243, v243, v9, 0xc0135761
v_mfma_f32_16x16x32_bf16 v[212:215], v[72:75], a[56:59], v[212:215]
v_mul_f32 v240, v236, v240
v_mfma_f32_16x16x32_bf16 v[216:219], v[72:75], a[60:63], v[216:219]
buffer_load_dwordx4 v[72:75], v1, s[8:11], s28 offen offset:1024
v_mul_f32 v241, v237, v241
v_mul_f32 v242, v238, v242
v_mfma_f32_16x16x32_bf16 v[204:207], v[20:23], a[64:67], v[204:207]
v_mul_f32 v243, v239, v243
v_mfma_f32_16x16x32_bf16 v[208:211], v[20:23], a[68:71], v[208:211]
v_exp_f32 v240, v240
v_exp_f32 v241, v241
v_mfma_f32_16x16x32_bf16 v[212:215], v[20:23], a[72:75], v[212:215]
v_exp_f32 v242, v242
v_exp_f32 v243, v243
v_mfma_f32_16x16x32_bf16 v[216:219], v[20:23], a[76:79], v[216:219]
buffer_load_dwordx4 v[20:23], v1, s[8:11], s28 offen offset:2048
v_add_f32 v240, 1.0, v240
v_mfma_f32_16x16x32_bf16 v[204:207], v[24:27], a[80:83], v[204:207]
v_add_f32 v241, 1.0, v241
v_add_f32 v242, 1.0, v242
v_mfma_f32_16x16x32_bf16 v[208:211], v[24:27], a[84:87], v[208:211]
v_add_f32 v243, 1.0, v243
v_mfma_f32_16x16x32_bf16 v[212:215], v[24:27], a[88:91], v[212:215]
v_rcp_f32 v240, v240
v_rcp_f32 v241, v241
v_mfma_f32_16x16x32_bf16 v[216:219], v[24:27], a[92:95], v[216:219]
buffer_load_dwordx4 v[24:27], v1, s[8:11], s28 offen offset:3072
v_rcp_f32 v242, v242
v_rcp_f32 v243, v243
s_waitcnt vmcnt(13)
v_mfma_f32_16x16x32_bf16 v[204:207], v[28:31], a[96:99], v[204:207]
v_mul_f32 v236, v236, v240
v_mfma_f32_16x16x32_bf16 v[208:211], v[28:31], a[100:103], v[208:211]
v_mul_f32 v237, v237, v241
v_mul_f32 v238, v238, v242
v_mfma_f32_16x16x32_bf16 v[212:215], v[28:31], a[104:107], v[212:215]
v_mul_f32 v239, v239, v243
v_mfma_f32_16x16x32_bf16 v[216:219], v[28:31], a[108:111], v[216:219]
s_add_u32 s28, s21, 131072
buffer_load_dwordx4 v[28:31], v1, s[8:11], s28 offen offset:0
v_cvt_pk_bf16_f32 v244, v236, v237
v_cvt_pk_bf16_f32 v245, v238, v239
v_mfma_f32_16x16x32_bf16 v[204:207], v[32:35], a[112:115], v[204:207]
ds_write_b64 v5, v[244:245] offset:24576
v_fma_f32 v240, v17, v232, v228
v_mfma_f32_16x16x32_bf16 v[208:211], v[32:35], a[116:119], v[208:211]
v_fma_f32 v241, v17, v233, v229
v_mfma_f32_16x16x32_bf16 v[212:215], v[32:35], a[120:123], v[212:215]
v_fma_f32 v242, v17, v234, v230
v_fma_f32 v243, v17, v235, v231
v_mfma_f32_16x16x32_bf16 v[216:219], v[32:35], a[124:127], v[216:219]
buffer_load_dwordx4 v[32:35], v1, s[8:11], s28 offen offset:1024
v_fma_f32 v236, v160, v13, v240
v_mfma_f32_16x16x32_bf16 v[204:207], v[36:39], a[128:131], v[204:207]
v_fma_f32 v237, v161, v13, v241
v_fma_f32 v238, v162, v13, v242
v_mfma_f32_16x16x32_bf16 v[208:211], v[36:39], a[132:135], v[208:211]
v_fma_f32 v239, v163, v13, v243
v_mul_f32 v240, v236, v236
v_mfma_f32_16x16x32_bf16 v[212:215], v[36:39], a[136:139], v[212:215]
v_mul_f32 v241, v237, v237
v_mfma_f32_16x16x32_bf16 v[216:219], v[36:39], a[140:143], v[216:219]
buffer_load_dwordx4 v[36:39], v1, s[8:11], s28 offen offset:2048
v_mul_f32 v242, v238, v238
v_mul_f32 v243, v239, v239
s_waitcnt vmcnt(13)
v_mfma_f32_16x16x32_bf16 v[204:207], v[40:43], a[144:147], v[204:207]
v_fmaak_f32 v240, v240, v9, 0xc0135761
v_mfma_f32_16x16x32_bf16 v[208:211], v[40:43], a[148:151], v[208:211]
v_fmaak_f32 v241, v241, v9, 0xc0135761
v_fmaak_f32 v242, v242, v9, 0xc0135761
v_mfma_f32_16x16x32_bf16 v[212:215], v[40:43], a[152:155], v[212:215]
v_fmaak_f32 v243, v243, v9, 0xc0135761
v_mul_f32 v240, v236, v240
v_mfma_f32_16x16x32_bf16 v[216:219], v[40:43], a[156:159], v[216:219]
buffer_load_dwordx4 v[40:43], v1, s[8:11], s28 offen offset:3072
v_mul_f32 v241, v237, v241
v_mfma_f32_16x16x32_bf16 v[204:207], v[44:47], a[160:163], v[204:207]
v_mul_f32 v242, v238, v242
v_mul_f32 v243, v239, v243
v_mfma_f32_16x16x32_bf16 v[208:211], v[44:47], a[164:167], v[208:211]
v_exp_f32 v240, v240
v_mfma_f32_16x16x32_bf16 v[212:215], v[44:47], a[168:171], v[212:215]
v_exp_f32 v241, v241
v_exp_f32 v242, v242
v_mfma_f32_16x16x32_bf16 v[216:219], v[44:47], a[172:175], v[216:219]
s_add_u32 s28, s21, 135168
buffer_load_dwordx4 v[44:47], v1, s[8:11], s28 offen offset:0
v_exp_f32 v243, v243
v_add_f32 v240, 1.0, v240
v_mfma_f32_16x16x32_bf16 v[204:207], v[48:51], a[176:179], v[204:207]
v_add_f32 v241, 1.0, v241
v_mfma_f32_16x16x32_bf16 v[208:211], v[48:51], a[180:183], v[208:211]
v_add_f32 v242, 1.0, v242
v_add_f32 v243, 1.0, v243
v_mfma_f32_16x16x32_bf16 v[212:215], v[48:51], a[184:187], v[212:215]
v_rcp_f32 v240, v240
v_mfma_f32_16x16x32_bf16 v[216:219], v[48:51], a[188:191], v[216:219]
buffer_load_dwordx4 v[48:51], v1, s[8:11], s28 offen offset:1024
v_rcp_f32 v241, v241
v_rcp_f32 v242, v242
s_waitcnt vmcnt(13)
v_mfma_f32_16x16x32_bf16 v[204:207], v[52:55], a[192:195], v[204:207]
v_rcp_f32 v243, v243
v_mul_f32 v236, v236, v240
v_mfma_f32_16x16x32_bf16 v[208:211], v[52:55], a[196:199], v[208:211]
v_mul_f32 v237, v237, v241
v_mfma_f32_16x16x32_bf16 v[212:215], v[52:55], a[200:203], v[212:215]
v_mul_f32 v238, v238, v242
v_mul_f32 v239, v239, v243
v_mfma_f32_16x16x32_bf16 v[216:219], v[52:55], a[204:207], v[216:219]
buffer_load_dwordx4 v[52:55], v1, s[8:11], s28 offen offset:2048
v_cvt_pk_bf16_f32 v246, v236, v237
v_mfma_f32_16x16x32_bf16 v[204:207], v[56:59], a[208:211], v[204:207]
v_cvt_pk_bf16_f32 v247, v238, v239
ds_write_b64 v5, v[246:247] offset:25600
v_mfma_f32_16x16x32_bf16 v[208:211], v[56:59], a[212:215], v[208:211]
v_fma_f32 v240, v18, v232, v228
v_fma_f32 v241, v18, v233, v229
v_mfma_f32_16x16x32_bf16 v[212:215], v[56:59], a[216:219], v[212:215]
v_fma_f32 v242, v18, v234, v230
v_mfma_f32_16x16x32_bf16 v[216:219], v[56:59], a[220:223], v[216:219]
buffer_load_dwordx4 v[56:59], v1, s[8:11], s28 offen offset:3072
v_fma_f32 v243, v18, v235, v231
v_fma_f32 v236, v164, v14, v240
v_mfma_f32_16x16x32_bf16 v[204:207], v[60:63], a[224:227], v[204:207]
v_fma_f32 v237, v165, v14, v241
v_mfma_f32_16x16x32_bf16 v[208:211], v[60:63], a[228:231], v[208:211]
v_fma_f32 v238, v166, v14, v242
v_fma_f32 v239, v167, v14, v243
v_mfma_f32_16x16x32_bf16 v[212:215], v[60:63], a[232:235], v[212:215]
v_mul_f32 v240, v236, v236
v_mul_f32 v241, v237, v237
v_mfma_f32_16x16x32_bf16 v[216:219], v[60:63], a[236:239], v[216:219]
s_add_u32 s28, s21, 139264
buffer_load_dwordx4 v[60:63], v1, s[8:11], s28 offen offset:0
v_mul_f32 v242, v238, v238
s_waitcnt vmcnt(11)
v_mfma_f32_16x16x32_bf16 v[204:207], v[64:67], a[240:243], v[204:207]
v_mul_f32 v243, v239, v239
v_fmaak_f32 v240, v240, v9, 0xc0135761
v_mfma_f32_16x16x32_bf16 v[208:211], v[64:67], a[244:247], v[208:211]
v_fmaak_f32 v241, v241, v9, 0xc0135761
v_mfma_f32_16x16x32_bf16 v[212:215], v[64:67], a[248:251], v[212:215]
v_fmaak_f32 v242, v242, v9, 0xc0135761
v_fmaak_f32 v243, v243, v9, 0xc0135761
v_mfma_f32_16x16x32_bf16 v[216:219], v[64:67], a[252:255], v[216:219]
buffer_load_dwordx4 v[64:67], v1, s[8:11], s28 offen offset:1024
v_mul_f32 v240, v236, v240
v_mul_f32 v241, v237, v241
v_mfma_f32_16x16x32_bf16 v[204:207], v[68:71], v[76:79], v[204:207]
v_mul_f32 v242, v238, v242
v_mfma_f32_16x16x32_bf16 v[208:211], v[68:71], v[80:83], v[208:211]
v_mul_f32 v243, v239, v243
v_exp_f32 v240, v240
v_mfma_f32_16x16x32_bf16 v[212:215], v[68:71], v[84:87], v[212:215]
v_exp_f32 v241, v241
v_mfma_f32_16x16x32_bf16 v[216:219], v[68:71], v[88:91], v[216:219]
buffer_load_dwordx4 v[68:71], v1, s[8:11], s28 offen offset:2048
v_exp_f32 v242, v242
v_exp_f32 v243, v243
v_mfma_f32_16x16x32_bf16 v[204:207], v[72:75], v[92:95], v[204:207]
v_add_f32 v240, 1.0, v240
v_add_f32 v241, 1.0, v241
v_mfma_f32_16x16x32_bf16 v[208:211], v[72:75], v[96:99], v[208:211]
v_add_f32 v242, 1.0, v242
v_mfma_f32_16x16x32_bf16 v[212:215], v[72:75], v[100:103], v[212:215]
v_add_f32 v243, 1.0, v243
v_rcp_f32 v240, v240
v_mfma_f32_16x16x32_bf16 v[216:219], v[72:75], v[104:107], v[216:219]
buffer_load_dwordx4 v[72:75], v1, s[8:11], s28 offen offset:3072
v_rcp_f32 v241, v241
s_waitcnt vmcnt(11)
v_mfma_f32_16x16x32_bf16 v[108:111], v[20:23], a[0:3], 0
v_rcp_f32 v242, v242
v_rcp_f32 v243, v243
v_mfma_f32_16x16x32_bf16 v[112:115], v[20:23], a[4:7], 0
v_mul_f32 v236, v236, v240
v_mul_f32 v237, v237, v241
v_mfma_f32_16x16x32_bf16 v[116:119], v[20:23], a[8:11], 0
v_mul_f32 v238, v238, v242
v_mfma_f32_16x16x32_bf16 v[120:123], v[20:23], a[12:15], 0
s_add_u32 s28, s21, 143360
buffer_load_dwordx4 v[20:23], v1, s[8:11], s28 offen offset:0
v_mul_f32 v239, v239, v243
v_cvt_pk_bf16_f32 v244, v236, v237
v_mfma_f32_16x16x32_bf16 v[108:111], v[24:27], a[16:19], v[108:111]
v_cvt_pk_bf16_f32 v245, v238, v239
v_mfma_f32_16x16x32_bf16 v[112:115], v[24:27], a[20:23], v[112:115]
ds_write_b64 v5, v[244:245] offset:26624
v_fma_f32 v240, v19, v232, v228
v_mfma_f32_16x16x32_bf16 v[116:119], v[24:27], a[24:27], v[116:119]
v_fma_f32 v241, v19, v233, v229
v_fma_f32 v242, v19, v234, v230
v_mfma_f32_16x16x32_bf16 v[120:123], v[24:27], a[28:31], v[120:123]
buffer_load_dwordx4 v[24:27], v1, s[8:11], s28 offen offset:1024
v_fma_f32 v243, v19, v235, v231
v_mfma_f32_16x16x32_bf16 v[108:111], v[28:31], a[32:35], v[108:111]
v_fma_f32 v236, v168, v15, v240
v_fma_f32 v237, v169, v15, v241
v_mfma_f32_16x16x32_bf16 v[112:115], v[28:31], a[36:39], v[112:115]
v_fma_f32 v238, v170, v15, v242
v_mfma_f32_16x16x32_bf16 v[116:119], v[28:31], a[40:43], v[116:119]
v_fma_f32 v239, v171, v15, v243
v_mul_f32 v240, v236, v236
v_mfma_f32_16x16x32_bf16 v[120:123], v[28:31], a[44:47], v[120:123]
buffer_load_dwordx4 v[28:31], v1, s[8:11], s28 offen offset:2048
v_mul_f32 v241, v237, v237
v_mul_f32 v242, v238, v238
s_waitcnt vmcnt(11)
v_mfma_f32_16x16x32_bf16 v[108:111], v[32:35], a[48:51], v[108:111]
v_mul_f32 v243, v239, v239
v_mfma_f32_16x16x32_bf16 v[112:115], v[32:35], a[52:55], v[112:115]
v_fmaak_f32 v240, v240, v9, 0xc0135761
v_fmaak_f32 v241, v241, v9, 0xc0135761
v_mfma_f32_16x16x32_bf16 v[116:119], v[32:35], a[56:59], v[116:119]
v_fmaak_f32 v242, v242, v9, 0xc0135761
v_mfma_f32_16x16x32_bf16 v[120:123], v[32:35], a[60:63], v[120:123]
buffer_load_dwordx4 v[32:35], v1, s[8:11], s28 offen offset:3072
v_fmaak_f32 v243, v243, v9, 0xc0135761
v_mul_f32 v240, v236, v240
v_mfma_f32_16x16x32_bf16 v[108:111], v[36:39], a[64:67], v[108:111]
v_mul_f32 v241, v237, v241
v_mul_f32 v242, v238, v242
v_mfma_f32_16x16x32_bf16 v[112:115], v[36:39], a[68:71], v[112:115]
v_mul_f32 v243, v239, v243
v_mfma_f32_16x16x32_bf16 v[116:119], v[36:39], a[72:75], v[116:119]
v_exp_f32 v240, v240
v_exp_f32 v241, v241
v_mfma_f32_16x16x32_bf16 v[120:123], v[36:39], a[76:79], v[120:123]
s_add_u32 s28, s21, 147456
buffer_load_dwordx4 v[36:39], v1, s[8:11], s28 offen offset:0
v_exp_f32 v242, v242
v_mfma_f32_16x16x32_bf16 v[108:111], v[40:43], a[80:83], v[108:111]
v_exp_f32 v243, v243
v_add_f32 v240, 1.0, v240
v_mfma_f32_16x16x32_bf16 v[112:115], v[40:43], a[84:87], v[112:115]
v_add_f32 v241, 1.0, v241
v_add_f32 v242, 1.0, v242
v_mfma_f32_16x16x32_bf16 v[116:119], v[40:43], a[88:91], v[116:119]
v_add_f32 v243, 1.0, v243
v_mfma_f32_16x16x32_bf16 v[120:123], v[40:43], a[92:95], v[120:123]
buffer_load_dwordx4 v[40:43], v1, s[8:11], s28 offen offset:1024
v_rcp_f32 v240, v240
v_rcp_f32 v241, v241
s_waitcnt vmcnt(11)
v_mfma_f32_16x16x32_bf16 v[108:111], v[44:47], a[96:99], v[108:111]
v_rcp_f32 v242, v242
v_mfma_f32_16x16x32_bf16 v[112:115], v[44:47], a[100:103], v[112:115]
v_rcp_f32 v243, v243
v_mul_f32 v236, v236, v240
v_mfma_f32_16x16x32_bf16 v[116:119], v[44:47], a[104:107], v[116:119]
v_mul_f32 v237, v237, v241
v_mul_f32 v238, v238, v242
v_mfma_f32_16x16x32_bf16 v[120:123], v[44:47], a[108:111], v[120:123]
buffer_load_dwordx4 v[44:47], v1, s[8:11], s28 offen offset:2048
v_mul_f32 v239, v239, v243
v_mfma_f32_16x16x32_bf16 v[108:111], v[48:51], a[112:115], v[108:111]
v_cvt_pk_bf16_f32 v246, v236, v237
v_cvt_pk_bf16_f32 v247, v238, v239
v_mfma_f32_16x16x32_bf16 v[112:115], v[48:51], a[116:119], v[112:115]
ds_write_b64 v5, v[246:247] offset:27648
v_mfma_f32_16x16x32_bf16 v[116:119], v[48:51], a[120:123], v[116:119]
buffer_load_dwordx4 v[228:231], v10, s[8:11], s23 offen offset:640 sc1
buffer_load_dwordx4 v[232:235], v10, s[8:11], s23 offen offset:656 sc1
v_fma_f32 v240, v16, v224, v220
v_mfma_f32_16x16x32_bf16 v[120:123], v[48:51], a[124:127], v[120:123]
buffer_load_dwordx4 v[48:51], v1, s[8:11], s28 offen offset:3072
v_fma_f32 v241, v16, v225, v221
v_fma_f32 v242, v16, v226, v222
v_mfma_f32_16x16x32_bf16 v[108:111], v[52:55], a[128:131], v[108:111]
v_fma_f32 v243, v16, v227, v223
v_mfma_f32_16x16x32_bf16 v[112:115], v[52:55], a[132:135], v[112:115]
v_fma_f32 v236, v172, v12, v240
v_fma_f32 v237, v173, v12, v241
v_mfma_f32_16x16x32_bf16 v[116:119], v[52:55], a[136:139], v[116:119]
v_fma_f32 v238, v174, v12, v242
v_mfma_f32_16x16x32_bf16 v[120:123], v[52:55], a[140:143], v[120:123]
s_add_u32 s28, s21, 151552
buffer_load_dwordx4 v[52:55], v1, s[8:11], s28 offen offset:0
v_fma_f32 v239, v175, v12, v243
v_mul_f32 v240, v236, v236
s_waitcnt vmcnt(13)
v_mfma_f32_16x16x32_bf16 v[108:111], v[56:59], a[144:147], v[108:111]
v_mul_f32 v241, v237, v237
v_mul_f32 v242, v238, v238
v_mfma_f32_16x16x32_bf16 v[112:115], v[56:59], a[148:151], v[112:115]
v_mul_f32 v243, v239, v239
v_mfma_f32_16x16x32_bf16 v[116:119], v[56:59], a[152:155], v[116:119]
v_fmaak_f32 v240, v240, v9, 0xc0135761
v_fmaak_f32 v241, v241, v9, 0xc0135761
v_mfma_f32_16x16x32_bf16 v[120:123], v[56:59], a[156:159], v[120:123]
buffer_load_dwordx4 v[56:59], v1, s[8:11], s28 offen offset:1024
v_fmaak_f32 v242, v242, v9, 0xc0135761
v_mfma_f32_16x16x32_bf16 v[108:111], v[60:63], a[160:163], v[108:111]
v_fmaak_f32 v243, v243, v9, 0xc0135761
v_mul_f32 v240, v236, v240
v_mfma_f32_16x16x32_bf16 v[112:115], v[60:63], a[164:167], v[112:115]
v_mul_f32 v241, v237, v241
v_mul_f32 v242, v238, v242
v_mfma_f32_16x16x32_bf16 v[116:119], v[60:63], a[168:171], v[116:119]
v_mul_f32 v243, v239, v243
v_mfma_f32_16x16x32_bf16 v[120:123], v[60:63], a[172:175], v[120:123]
buffer_load_dwordx4 v[60:63], v1, s[8:11], s28 offen offset:2048
v_exp_f32 v240, v240
v_exp_f32 v241, v241
v_mfma_f32_16x16x32_bf16 v[108:111], v[64:67], a[176:179], v[108:111]
v_exp_f32 v242, v242
v_mfma_f32_16x16x32_bf16 v[112:115], v[64:67], a[180:183], v[112:115]
v_exp_f32 v243, v243
v_add_f32 v240, 1.0, v240
v_mfma_f32_16x16x32_bf16 v[116:119], v[64:67], a[184:187], v[116:119]
v_add_f32 v241, 1.0, v241
v_add_f32 v242, 1.0, v242
v_mfma_f32_16x16x32_bf16 v[120:123], v[64:67], a[188:191], v[120:123]
buffer_load_dwordx4 v[64:67], v1, s[8:11], s28 offen offset:3072
v_add_f32 v243, 1.0, v243
s_waitcnt vmcnt(13)
v_mfma_f32_16x16x32_bf16 v[108:111], v[68:71], a[192:195], v[108:111]
v_rcp_f32 v240, v240
v_rcp_f32 v241, v241
v_mfma_f32_16x16x32_bf16 v[112:115], v[68:71], a[196:199], v[112:115]
v_rcp_f32 v242, v242
v_mfma_f32_16x16x32_bf16 v[116:119], v[68:71], a[200:203], v[116:119]
v_rcp_f32 v243, v243
v_mul_f32 v236, v236, v240
v_mfma_f32_16x16x32_bf16 v[120:123], v[68:71], a[204:207], v[120:123]
s_add_u32 s28, s21, 155648
buffer_load_dwordx4 v[68:71], v1, s[8:11], s28 offen offset:0
v_mul_f32 v237, v237, v241
v_mul_f32 v238, v238, v242
v_mfma_f32_16x16x32_bf16 v[108:111], v[72:75], a[208:211], v[108:111]
v_mul_f32 v239, v239, v243
v_mfma_f32_16x16x32_bf16 v[112:115], v[72:75], a[212:215], v[112:115]
v_cvt_pk_bf16_f32 v244, v236, v237
v_cvt_pk_bf16_f32 v245, v238, v239
v_mfma_f32_16x16x32_bf16 v[116:119], v[72:75], a[216:219], v[116:119]
ds_write_b64 v6, v[244:245] offset:0
v_mfma_f32_16x16x32_bf16 v[120:123], v[72:75], a[220:223], v[120:123]
buffer_load_dwordx4 v[72:75], v1, s[8:11], s28 offen offset:1024
v_fma_f32 v240, v17, v224, v220
v_fma_f32 v241, v17, v225, v221
v_mfma_f32_16x16x32_bf16 v[108:111], v[20:23], a[224:227], v[108:111]
v_fma_f32 v242, v17, v226, v222
v_fma_f32 v243, v17, v227, v223
v_mfma_f32_16x16x32_bf16 v[112:115], v[20:23], a[228:231], v[112:115]
v_fma_f32 v236, v176, v13, v240
v_mfma_f32_16x16x32_bf16 v[116:119], v[20:23], a[232:235], v[116:119]
v_fma_f32 v237, v177, v13, v241
v_fma_f32 v238, v178, v13, v242
v_mfma_f32_16x16x32_bf16 v[120:123], v[20:23], a[236:239], v[120:123]
buffer_load_dwordx4 v[20:23], v1, s[8:11], s28 offen offset:2048
v_fma_f32 v239, v179, v13, v243
s_waitcnt vmcnt(13)
v_mfma_f32_16x16x32_bf16 v[108:111], v[24:27], a[240:243], v[108:111]
v_mul_f32 v240, v236, v236
v_mul_f32 v241, v237, v237
v_mfma_f32_16x16x32_bf16 v[112:115], v[24:27], a[244:247], v[112:115]
v_mul_f32 v242, v238, v238
v_mul_f32 v243, v239, v239
v_mfma_f32_16x16x32_bf16 v[116:119], v[24:27], a[248:251], v[116:119]
v_fmaak_f32 v240, v240, v9, 0xc0135761
v_mfma_f32_16x16x32_bf16 v[120:123], v[24:27], a[252:255], v[120:123]
buffer_load_dwordx4 v[24:27], v1, s[8:11], s28 offen offset:3072
v_fmaak_f32 v241, v241, v9, 0xc0135761
v_fmaak_f32 v242, v242, v9, 0xc0135761
v_mfma_f32_16x16x32_bf16 v[108:111], v[28:31], v[76:79], v[108:111]
v_fmaak_f32 v243, v243, v9, 0xc0135761
v_mfma_f32_16x16x32_bf16 v[112:115], v[28:31], v[80:83], v[112:115]
v_mul_f32 v240, v236, v240
v_mul_f32 v241, v237, v241
v_mfma_f32_16x16x32_bf16 v[116:119], v[28:31], v[84:87], v[116:119]
v_mul_f32 v242, v238, v242
v_mul_f32 v243, v239, v243
v_mfma_f32_16x16x32_bf16 v[120:123], v[28:31], v[88:91], v[120:123]
s_add_u32 s28, s21, 159744
buffer_load_dwordx4 v[28:31], v1, s[8:11], s28 offen offset:0
v_exp_f32 v240, v240
v_mfma_f32_16x16x32_bf16 v[108:111], v[32:35], v[92:95], v[108:111]
v_exp_f32 v241, v241
v_exp_f32 v242, v242
v_mfma_f32_16x16x32_bf16 v[112:115], v[32:35], v[96:99], v[112:115]
v_exp_f32 v243, v243
v_mfma_f32_16x16x32_bf16 v[116:119], v[32:35], v[100:103], v[116:119]
v_add_f32 v240, 1.0, v240
v_add_f32 v241, 1.0, v241
v_mfma_f32_16x16x32_bf16 v[120:123], v[32:35], v[104:107], v[120:123]
buffer_load_dwordx4 v[32:35], v1, s[8:11], s28 offen offset:1024
v_add_f32 v242, 1.0, v242
v_add_f32 v243, 1.0, v243
s_waitcnt vmcnt(13)
v_mfma_f32_16x16x32_bf16 v[124:127], v[36:39], a[0:3], 0
v_rcp_f32 v240, v240
v_mfma_f32_16x16x32_bf16 v[128:131], v[36:39], a[4:7], 0
v_rcp_f32 v241, v241
v_rcp_f32 v242, v242
v_mfma_f32_16x16x32_bf16 v[132:135], v[36:39], a[8:11], 0
v_rcp_f32 v243, v243
v_mfma_f32_16x16x32_bf16 v[136:139], v[36:39], a[12:15], 0
buffer_load_dwordx4 v[36:39], v1, s[8:11], s28 offen offset:2048
v_mul_f32 v236, v236, v240
v_mul_f32 v237, v237, v241
v_mfma_f32_16x16x32_bf16 v[124:127], v[40:43], a[16:19], v[124:127]
v_mul_f32 v238, v238, v242
v_mul_f32 v239, v239, v243
v_mfma_f32_16x16x32_bf16 v[128:131], v[40:43], a[20:23], v[128:131]
v_cvt_pk_bf16_f32 v246, v236, v237
v_mfma_f32_16x16x32_bf16 v[132:135], v[40:43], a[24:27], v[132:135]
v_cvt_pk_bf16_f32 v247, v238, v239
ds_write_b64 v6, v[246:247] offset:1024
v_mfma_f32_16x16x32_bf16 v[136:139], v[40:43], a[28:31], v[136:139]
buffer_load_dwordx4 v[40:43], v1, s[8:11], s28 offen offset:3072
v_fma_f32 v240, v18, v224, v220
v_mfma_f32_16x16x32_bf16 v[124:127], v[44:47], a[32:35], v[124:127]
v_fma_f32 v241, v18, v225, v221
v_fma_f32 v242, v18, v226, v222
v_mfma_f32_16x16x32_bf16 v[128:131], v[44:47], a[36:39], v[128:131]
v_fma_f32 v243, v18, v227, v223
v_fma_f32 v236, v180, v14, v240
v_mfma_f32_16x16x32_bf16 v[132:135], v[44:47], a[40:43], v[132:135]
v_fma_f32 v237, v181, v14, v241
v_mfma_f32_16x16x32_bf16 v[136:139], v[44:47], a[44:47], v[136:139]
s_add_u32 s28, s21, 163840
buffer_load_dwordx4 v[44:47], v1, s[8:11], s28 offen offset:0
v_fma_f32 v238, v182, v14, v242
v_fma_f32 v239, v183, v14, v243
s_waitcnt vmcnt(11)
v_mfma_f32_16x16x32_bf16 v[124:127], v[48:51], a[48:51], v[124:127]
v_mul_f32 v240, v236, v236
v_mfma_f32_16x16x32_bf16 v[128:131], v[48:51], a[52:55], v[128:131]
v_mul_f32 v241, v237, v237
v_mul_f32 v242, v238, v238
v_mfma_f32_16x16x32_bf16 v[132:135], v[48:51], a[56:59], v[132:135]
v_mul_f32 v243, v239, v239
v_fmaak_f32 v240, v240, v9, 0xc0135761
v_mfma_f32_16x16x32_bf16 v[136:139], v[48:51], a[60:63], v[136:139]
buffer_load_dwordx4 v[48:51], v1, s[8:11], s28 offen offset:1024
v_fmaak_f32 v241, v241, v9, 0xc0135761
v_mfma_f32_16x16x32_bf16 v[124:127], v[52:55], a[64:67], v[124:127]
v_fmaak_f32 v242, v242, v9, 0xc0135761
v_fmaak_f32 v243, v243, v9, 0xc0135761
v_mfma_f32_16x16x32_bf16 v[128:131], v[52:55], a[68:71], v[128:131]
v_mul_f32 v240, v236, v240
v_mfma_f32_16x16x32_bf16 v[132:135], v[52:55], a[72:75], v[132:135]
v_mul_f32 v241, v237, v241
v_mul_f32 v242, v238, v242
v_mfma_f32_16x16x32_bf16 v[136:139], v[52:55], a[76:79], v[136:139]
v_xor_b32 v249, s96, v249
v_xor_b32 v252, s96, v252
v_or_b32 v249, v249, v252
v_cmp_ne_u32 vcc, 0, v249
s_nop 1
s_cmp_eq_u64 vcc, 0
s_cbranch_scc1 w2ok_28
s_mov_b32 s87, 39848192
s_mov_b32 s97, 0
poll_29:
buffer_load_dword v249, v248, s[8:11], s87 offen sc1
s_waitcnt vmcnt(0)
v_cmp_ne_u32 vcc, s96, v249
s_add_u32 s97, s97, 1
s_cmp_gt_u32 s97, 200000
s_cbranch_scc1 poll_29_d
s_cmp_eq_u64 vcc, 0
s_cbranch_scc1 poll_29_d
s_sleep 2
s_branch poll_29
poll_29_d:
s_mov_b32 s87, 39848448
s_mov_b32 s97, 0
poll_30:
buffer_load_dword v249, v254, s[8:11], s87 offen sc1
s_waitcnt vmcnt(0)
v_cmp_ne_u32 vcc, s96, v249
s_add_u32 s97, s97, 1
s_cmp_gt_u32 s97, 200000
s_cbranch_scc1 poll_30_d
s_cmp_eq_u64 vcc, 0
s_cbranch_scc1 poll_30_d
s_sleep 2
s_branch poll_30
poll_30_d:
w2ok_28:
s_add_u32 s29, s22, 0
buffer_load_dwordx4 v[52:55], v1, s[8:11], s29 offen offset:0
v_mul_f32 v243, v239, v243
v_exp_f32 v240, v240
v_mfma_f32_16x16x32_bf16 v[124:127], v[56:59], a[80:83], v[124:127]
v_exp_f32 v241, v241
v_mfma_f32_16x16x32_bf16 v[128:131], v[56:59], a[84:87], v[128:131]
v_exp_f32 v242, v242
v_exp_f32 v243, v243
v_mfma_f32_16x16x32_bf16 v[132:135], v[56:59], a[88:91], v[132:135]
v_add_f32 v240, 1.0, v240
v_mfma_f32_16x16x32_bf16 v[136:139], v[56:59], a[92:95], v[136:139]
buffer_load_dwordx4 v[56:59], v1, s[8:11], s29 offen offset:1024
v_add_f32 v241, 1.0, v241
v_add_f32 v242, 1.0, v242
s_waitcnt vmcnt(11)
v_mfma_f32_16x16x32_bf16 v[124:127], v[60:63], a[96:99], v[124:127]
v_add_f32 v243, 1.0, v243
v_rcp_f32 v240, v240
v_mfma_f32_16x16x32_bf16 v[128:131], v[60:63], a[100:103], v[128:131]
v_rcp_f32 v241, v241
v_mfma_f32_16x16x32_bf16 v[132:135], v[60:63], a[104:107], v[132:135]
v_rcp_f32 v242, v242
v_rcp_f32 v243, v243
v_mfma_f32_16x16x32_bf16 v[136:139], v[60:63], a[108:111], v[136:139]
buffer_load_dwordx4 v[60:63], v1, s[8:11], s29 offen offset:2048
v_mul_f32 v236, v236, v240
v_mfma_f32_16x16x32_bf16 v[124:127], v[64:67], a[112:115], v[124:127]
v_mul_f32 v237, v237, v241
v_mul_f32 v238, v238, v242
v_mfma_f32_16x16x32_bf16 v[128:131], v[64:67], a[116:119], v[128:131]
v_mul_f32 v239, v239, v243
v_cvt_pk_bf16_f32 v244, v236, v237
v_mfma_f32_16x16x32_bf16 v[132:135], v[64:67], a[120:123], v[132:135]
v_cvt_pk_bf16_f32 v245, v238, v239
v_mfma_f32_16x16x32_bf16 v[136:139], v[64:67], a[124:127], v[136:139]
buffer_load_dwordx4 v[64:67], v1, s[8:11], s29 offen offset:3072
ds_write_b64 v6, v[244:245] offset:2048
v_fma_f32 v240, v19, v224, v220
v_mfma_f32_16x16x32_bf16 v[124:127], v[68:71], a[128:131], v[124:127]
v_fma_f32 v241, v19, v225, v221
v_mfma_f32_16x16x32_bf16 v[128:131], v[68:71], a[132:135], v[128:131]
v_fma_f32 v242, v19, v226, v222
v_fma_f32 v243, v19, v227, v223
v_mfma_f32_16x16x32_bf16 v[132:135], v[68:71], a[136:139], v[132:135]
v_fma_f32 v236, v184, v15, v240
v_fma_f32 v237, v185, v15, v241
v_mfma_f32_16x16x32_bf16 v[136:139], v[68:71], a[140:143], v[136:139]
s_add_u32 s29, s22, 4096
buffer_load_dwordx4 v[68:71], v1, s[8:11], s29 offen offset:0
v_fma_f32 v238, v186, v15, v242
s_waitcnt vmcnt(11)
v_mfma_f32_16x16x32_bf16 v[124:127], v[72:75], a[144:147], v[124:127]
v_fma_f32 v239, v187, v15, v243
v_mul_f32 v240, v236, v236
v_mfma_f32_16x16x32_bf16 v[128:131], v[72:75], a[148:151], v[128:131]
v_mul_f32 v241, v237, v237
v_mfma_f32_16x16x32_bf16 v[132:135], v[72:75], a[152:155], v[132:135]
v_mul_f32 v242, v238, v238
v_mul_f32 v243, v239, v239
v_mfma_f32_16x16x32_bf16 v[136:139], v[72:75], a[156:159], v[136:139]
buffer_load_dwordx4 v[72:75], v1, s[8:11], s29 offen offset:1024
v_fmaak_f32 v240, v240, v9, 0xc0135761
v_fmaak_f32 v241, v241, v9, 0xc0135761
v_mfma_f32_16x16x32_bf16 v[124:127], v[20:23], a[160:163], v[124:127]
v_fmaak_f32 v242, v242, v9, 0xc0135761
v_mfma_f32_16x16x32_bf16 v[128:131], v[20:23], a[164:167], v[128:131]
v_fmaak_f32 v243, v243, v9, 0xc0135761
v_mul_f32 v240, v236, v240
v_mfma_f32_16x16x32_bf16 v[132:135], v[20:23], a[168:171], v[132:135]
v_mul_f32 v241, v237, v241
v_mfma_f32_16x16x32_bf16 v[136:139], v[20:23], a[172:175], v[136:139]
buffer_load_dwordx4 v[20:23], v1, s[8:11], s29 offen offset:2048
v_mul_f32 v242, v238, v242
v_mul_f32 v243, v239, v243
v_mfma_f32_16x16x32_bf16 v[124:127], v[24:27], a[176:179], v[124:127]
v_exp_f32 v240, v240
v_exp_f32 v241, v241
v_mfma_f32_16x16x32_bf16 v[128:131], v[24:27], a[180:183], v[128:131]
v_exp_f32 v242, v242
v_mfma_f32_16x16x32_bf16 v[132:135], v[24:27], a[184:187], v[132:135]
v_exp_f32 v243, v243
v_add_f32 v240, 1.0, v240
v_mfma_f32_16x16x32_bf16 v[136:139], v[24:27], a[188:191], v[136:139]
buffer_load_dwordx4 v[24:27], v1, s[8:11], s29 offen offset:3072
v_add_f32 v241, 1.0, v241
s_waitcnt vmcnt(11)
v_mfma_f32_16x16x32_bf16 v[124:127], v[28:31], a[192:195], v[124:127]
v_add_f32 v242, 1.0, v242
v_add_f32 v243, 1.0, v243
v_mfma_f32_16x16x32_bf16 v[128:131], v[28:31], a[196:199], v[128:131]
v_rcp_f32 v240, v240
v_rcp_f32 v241, v241
v_mfma_f32_16x16x32_bf16 v[132:135], v[28:31], a[200:203], v[132:135]
v_rcp_f32 v242, v242
v_mfma_f32_16x16x32_bf16 v[136:139], v[28:31], a[204:207], v[136:139]
s_add_u32 s29, s22, 8192
buffer_load_dwordx4 v[28:31], v1, s[8:11], s29 offen offset:0
v_rcp_f32 v243, v243
v_mul_f32 v236, v236, v240
v_mfma_f32_16x16x32_bf16 v[124:127], v[32:35], a[208:211], v[124:127]
v_mul_f32 v237, v237, v241
v_mfma_f32_16x16x32_bf16 v[128:131], v[32:35], a[212:215], v[128:131]
v_mul_f32 v238, v238, v242
v_mul_f32 v239, v239, v243
v_mfma_f32_16x16x32_bf16 v[132:135], v[32:35], a[216:219], v[132:135]
v_cvt_pk_bf16_f32 v246, v236, v237
v_cvt_pk_bf16_f32 v247, v238, v239
v_mfma_f32_16x16x32_bf16 v[136:139], v[32:35], a[220:223], v[136:139]
buffer_load_dwordx4 v[32:35], v1, s[8:11], s29 offen offset:1024
ds_write_b64 v6, v[246:247] offset:3072
v_mfma_f32_16x16x32_bf16 v[124:127], v[36:39], a[224:227], v[124:127]
buffer_load_dwordx4 v[220:223], v10, s[8:11], s23 offen offset:768 sc1
buffer_load_dwordx4 v[224:227], v10, s[8:11], s23 offen offset:784 sc1
v_fma_f32 v240, v16, v232, v228
v_mfma_f32_16x16x32_bf16 v[128:131], v[36:39], a[228:231], v[128:131]
v_fma_f32 v241, v16, v233, v229
v_mfma_f32_16x16x32_bf16 v[132:135], v[36:39], a[232:235], v[132:135]
v_fma_f32 v242, v16, v234, v230
v_fma_f32 v243, v16, v235, v231
v_mfma_f32_16x16x32_bf16 v[136:139], v[36:39], a[236:239], v[136:139]
s_add_u32 s29, s22, 16384
buffer_load_dwordx4 v[36:39], v1, s[8:11], s29 offen offset:2048
v_fma_f32 v236, v188, v12, v240
v_fma_f32 v237, v189, v12, v241
s_waitcnt vmcnt(13)
v_mfma_f32_16x16x32_bf16 v[124:127], v[40:43], a[240:243], v[124:127]
s_waitcnt lgkmcnt(0)
s_barrier
ds_read_b128 a[0:3], v7 offset:0
v_fma_f32 v238, v190, v12, v242
v_mfma_f32_16x16x32_bf16 v[128:131], v[40:43], a[244:247], v[128:131]
ds_read_b128 a[4:7], v7 offset:1024
v_fma_f32 v239, v191, v12, v243
v_mul_f32 v240, v236, v236
v_mfma_f32_16x16x32_bf16 v[132:135], v[40:43], a[248:251], v[132:135]
ds_read_b128 a[8:11], v7 offset:2048
v_mul_f32 v241, v237, v237
v_mfma_f32_16x16x32_bf16 v[136:139], v[40:43], a[252:255], v[136:139]
buffer_load_dwordx4 v[40:43], v1, s[8:11], s29 offen offset:3072
ds_read_b128 a[12:15], v7 offset:3072
v_mul_f32 v242, v238, v238
v_mul_f32 v243, v239, v239
v_mfma_f32_16x16x32_bf16 v[124:127], v[44:47], v[76:79], v[124:127]
ds_read_b128 a[16:19], v7 offset:4096
v_fmaak_f32 v240, v240, v9, 0xc0135761
v_fmaak_f32 v241, v241, v9, 0xc0135761
v_mfma_f32_16x16x32_bf16 v[128:131], v[44:47], v[80:83], v[128:131]
ds_read_b128 a[20:23], v7 offset:5120
v_fmaak_f32 v242, v242, v9, 0xc0135761
v_mfma_f32_16x16x32_bf16 v[132:135], v[44:47], v[84:87], v[132:135]
ds_read_b128 a[24:27], v7 offset:6144
v_fmaak_f32 v243, v243, v9, 0xc0135761
v_mul_f32 v240, v236, v240
v_mfma_f32_16x16x32_bf16 v[136:139], v[44:47], v[88:91], v[136:139]
s_add_u32 s29, s22, 20480
buffer_load_dwordx4 v[44:47], v1, s[8:11], s29 offen offset:0
ds_read_b128 a[28:31], v7 offset:7168
v_mul_f32 v241, v237, v241
v_mfma_f32_16x16x32_bf16 v[124:127], v[48:51], v[92:95], v[124:127]
ds_read_b128 a[32:35], v7 offset:8192
v_mul_f32 v242, v238, v242
v_mul_f32 v243, v239, v243
v_mfma_f32_16x16x32_bf16 v[128:131], v[48:51], v[96:99], v[128:131]
ds_read_b128 a[36:39], v7 offset:9216
v_exp_f32 v240, v240
v_exp_f32 v241, v241
v_mfma_f32_16x16x32_bf16 v[132:135], v[48:51], v[100:103], v[132:135]
ds_read_b128 a[40:43], v7 offset:10240
v_exp_f32 v242, v242
v_mfma_f32_16x16x32_bf16 v[136:139], v[48:51], v[104:107], v[136:139]
buffer_load_dwordx4 v[48:51], v1, s[8:11], s29 offen offset:1024
ds_read_b128 a[44:47], v7 offset:11264
v_exp_f32 v243, v243
v_add_f32 v240, 1.0, v240
s_waitcnt vmcnt(13)
s_waitcnt lgkmcnt(8)
v_mfma_f32_16x16x32_bf16 v[140:143], v[52:55], a[0:3], 0
ds_read_b128 a[48:51], v7 offset:12288
v_add_f32 v241, 1.0, v241
v_mfma_f32_16x16x32_bf16 v[144:147], v[52:55], a[4:7], 0
ds_read_b128 a[52:55], v7 offset:13312
v_add_f32 v242, 1.0, v242
v_add_f32 v243, 1.0, v243
v_mfma_f32_16x16x32_bf16 v[148:151], v[52:55], a[8:11], 0
ds_read_b128 a[56:59], v7 offset:14336
v_rcp_f32 v240, v240
v_rcp_f32 v241, v241
v_mfma_f32_16x16x32_bf16 v[152:155], v[52:55], a[12:15], 0
buffer_load_dwordx4 v[52:55], v1, s[8:11], s29 offen offset:2048
ds_read_b128 a[60:63], v7 offset:15360
v_rcp_f32 v242, v242
s_waitcnt lgkmcnt(8)
v_mfma_f32_16x16x32_bf16 v[140:143], v[56:59], a[16:19], v[140:143]
ds_read_b128 a[64:67], v7 offset:16384
v_rcp_f32 v243, v243
v_mul_f32 v236, v236, v240
v_mfma_f32_16x16x32_bf16 v[144:147], v[56:59], a[20:23], v[144:147]
ds_read_b128 a[68:71], v7 offset:17408
v_mul_f32 v237, v237, v241
v_mfma_f32_16x16x32_bf16 v[148:151], v[56:59], a[24:27], v[148:151]
ds_read_b128 a[72:75], v7 offset:18432
v_mul_f32 v238, v238, v242
v_mul_f32 v239, v239, v243
v_mfma_f32_16x16x32_bf16 v[152:155], v[56:59], a[28:31], v[152:155]
buffer_load_dwordx4 v[56:59], v1, s[8:11], s29 offen offset:3072
ds_read_b128 a[76:79], v7 offset:19456
v_cvt_pk_bf16_f32 v244, v236, v237
v_cvt_pk_bf16_f32 v245, v238, v239
s_waitcnt lgkmcnt(8)
v_mfma_f32_16x16x32_bf16 v[140:143], v[60:63], a[32:35], v[140:143]
ds_read_b128 a[80:83], v7 offset:20480
ds_write_b64 v6, v[244:245] offset:8192
v_mfma_f32_16x16x32_bf16 v[144:147], v[60:63], a[36:39], v[144:147]
ds_read_b128 a[84:87], v7 offset:21504
v_fma_f32 v240, v17, v232, v228
v_fma_f32 v241, v17, v233, v229
v_mfma_f32_16x16x32_bf16 v[148:151], v[60:63], a[40:43], v[148:151]
ds_read_b128 a[88:91], v7 offset:22528
v_fma_f32 v242, v17, v234, v230
v_mfma_f32_16x16x32_bf16 v[152:155], v[60:63], a[44:47], v[152:155]
s_add_u32 s29, s22, 24576
buffer_load_dwordx4 v[60:63], v1, s[8:11], s29 offen offset:0
ds_read_b128 a[92:95], v7 offset:23552
v_fma_f32 v243, v17, v235, v231
v_fma_f32 v236, v192, v13, v240
s_waitcnt vmcnt(13)
s_waitcnt lgkmcnt(9)
v_mfma_f32_16x16x32_bf16 v[140:143], v[64:67], a[48:51], v[140:143]
ds_read_b128 a[96:99], v7 offset:24576
v_fma_f32 v237, v193, v13, v241
v_fma_f32 v238, v194, v13, v242
v_mfma_f32_16x16x32_bf16 v[144:147], v[64:67], a[52:55], v[144:147]
ds_read_b128 a[100:103], v7 offset:25600
v_fma_f32 v239, v195, v13, v243
v_mfma_f32_16x16x32_bf16 v[148:151], v[64:67], a[56:59], v[148:151]
ds_read_b128 a[104:107], v7 offset:26624
v_mul_f32 v240, v236, v236
v_mul_f32 v241, v237, v237
v_mfma_f32_16x16x32_bf16 v[152:155], v[64:67], a[60:63], v[152:155]
buffer_load_dwordx4 v[64:67], v1, s[8:11], s29 offen offset:1024
ds_read_b128 a[108:111], v7 offset:27648
v_mul_f32 v242, v238, v238
s_waitcnt lgkmcnt(9)
v_mfma_f32_16x16x32_bf16 v[140:143], v[68:71], a[64:67], v[140:143]
ds_read_b128 a[112:115], v7 offset:28672
v_mul_f32 v243, v239, v239
v_fmaak_f32 v240, v240, v9, 0xc0135761
v_mfma_f32_16x16x32_bf16 v[144:147], v[68:71], a[68:71], v[144:147]
ds_read_b128 a[116:119], v7 offset:29696
v_fmaak_f32 v241, v241, v9, 0xc0135761
v_fmaak_f32 v242, v242, v9, 0xc0135761
v_mfma_f32_16x16x32_bf16 v[148:151], v[68:71], a[72:75], v[148:151]
ds_read_b128 a[120:123], v7 offset:30720
v_fmaak_f32 v243, v243, v9, 0xc0135761
v_mfma_f32_16x16x32_bf16 v[152:155], v[68:71], a[76:79], v[152:155]
buffer_load_dwordx4 v[68:71], v1, s[8:11], s29 offen offset:2048
ds_read_b128 a[124:127], v7 offset:31744
v_mul_f32 v240, v236, v240
v_mul_f32 v241, v237, v241
s_waitcnt lgkmcnt(8)
v_mfma_f32_16x16x32_bf16 v[140:143], v[72:75], a[80:83], v[140:143]
ds_read_b128 a[128:131], v7 offset:32768
v_mul_f32 v242, v238, v242
v_mfma_f32_16x16x32_bf16 v[144:147], v[72:75], a[84:87], v[144:147]
ds_read_b128 a[132:135], v7 offset:33792
v_mul_f32 v243, v239, v243
v_exp_f32 v240, v240
v_mfma_f32_16x16x32_bf16 v[148:151], v[72:75], a[88:91], v[148:151]
ds_read_b128 a[136:139], v7 offset:34816
v_exp_f32 v241, v241
v_exp_f32 v242, v242
v_mfma_f32_16x16x32_bf16 v[152:155], v[72:75], a[92:95], v[152:155]
buffer_load_dwordx4 v[72:75], v1, s[8:11], s29 offen offset:3072
ds_read_b128 a[140:143], v7 offset:35840
v_exp_f32 v243, v243
s_waitcnt vmcnt(13)
s_waitcnt lgkmcnt(8)
v_mfma_f32_16x16x32_bf16 v[140:143], v[20:23], a[96:99], v[140:143]
ds_read_b128 a[144:147], v8 offset:0
v_add_f32 v240, 1.0, v240
v_add_f32 v241, 1.0, v241
v_mfma_f32_16x16x32_bf16 v[144:147], v[20:23], a[100:103], v[144:147]
ds_read_b128 a[148:151], v8 offset:1024
v_add_f32 v242, 1.0, v242
v_mfma_f32_16x16x32_bf16 v[148:151], v[20:23], a[104:107], v[148:151]
ds_read_b128 a[152:155], v8 offset:2048
v_add_f32 v243, 1.0, v243
v_rcp_f32 v240, v240
v_mfma_f32_16x16x32_bf16 v[152:155], v[20:23], a[108:111], v[152:155]
s_add_u32 s29, s22, 36864
buffer_load_dwordx4 v[20:23], v1, s[8:11], s29 offen offset:0
ds_read_b128 a[156:159], v8 offset:3072
v_rcp_f32 v241, v241
v_rcp_f32 v242, v242
s_waitcnt lgkmcnt(8)
v_mfma_f32_16x16x32_bf16 v[140:143], v[24:27], a[112:115], v[140:143]
v_rcp_f32 v243, v243
v_mfma_f32_16x16x32_bf16 v[144:147], v[24:27], a[116:119], v[144:147]
v_mul_f32 v236, v236, v240
v_mul_f32 v237, v237, v241
v_mfma_f32_16x16x32_bf16 v[148:151], v[24:27], a[120:123], v[148:151]
v_mul_f32 v238, v238, v242
v_mfma_f32_16x16x32_bf16 v[152:155], v[24:27], a[124:127], v[152:155]
buffer_load_dwordx4 v[24:27], v1, s[8:11], s29 offen offset:1024
v_mul_f32 v239, v239, v243
v_cvt_pk_bf16_f32 v246, v236, v237
s_waitcnt lgkmcnt(4)
v_mfma_f32_16x16x32_bf16 v[140:143], v[28:31], a[128:131], v[140:143]
v_cvt_pk_bf16_f32 v247, v238, v239
ds_write_b64 v6, v[246:247] offset:9216
v_mfma_f32_16x16x32_bf16 v[144:147], v[28:31], a[132:135], v[144:147]
v_fma_f32 v240, v18, v232, v228
v_mfma_f32_16x16x32_bf16 v[148:151], v[28:31], a[136:139], v[148:151]
v_fma_f32 v241, v18, v233, v229
v_fma_f32 v242, v18, v234, v230
v_mfma_f32_16x16x32_bf16 v[152:155], v[28:31], a[140:143], v[152:155]
buffer_load_dwordx4 v[28:31], v1, s[8:11], s29 offen offset:2048
v_fma_f32 v243, v18, v235, v231
s_waitcnt vmcnt(11)
s_waitcnt lgkmcnt(1)
v_mfma_f32_16x16x32_bf16 v[140:143], v[32:35], a[144:147], v[140:143]
v_fma_f32 v236, v196, v14, v240
v_fma_f32 v237, v197, v14, v241
v_mfma_f32_16x16x32_bf16 v[144:147], v[32:35], a[148:151], v[144:147]
v_fma_f32 v238, v198, v14, v242
v_fma_f32 v239, v199, v14, v243
v_mfma_f32_16x16x32_bf16 v[148:151], v[32:35], a[152:155], v[148:151]
v_mul_f32 v240, v236, v236
v_mfma_f32_16x16x32_bf16 v[152:155], v[32:35], a[156:159], v[152:155]
buffer_load_dwordx4 v[32:35], v1, s[8:11], s29 offen offset:3072
v_mul_f32 v241, v237, v237
v_mul_f32 v242, v238, v238
v_mfma_f32_16x16x32_bf16 v[156:159], v[36:39], a[0:3], 0
v_mul_f32 v243, v239, v239
v_mfma_f32_16x16x32_bf16 v[160:163], v[36:39], a[4:7], 0
v_fmaak_f32 v240, v240, v9, 0xc0135761
v_fmaak_f32 v241, v241, v9, 0xc0135761
v_mfma_f32_16x16x32_bf16 v[164:167], v[36:39], a[8:11], 0
v_fmaak_f32 v242, v242, v9, 0xc0135761
v_fmaak_f32 v243, v243, v9, 0xc0135761
v_mfma_f32_16x16x32_bf16 v[168:171], v[36:39], a[12:15], 0
s_add_u32 s29, s22, 8192
buffer_load_dwordx4 v[36:39], v1, s[8:11], s29 offen offset:2048
v_mul_f32 v240, v236, v240
v_mfma_f32_16x16x32_bf16 v[156:159], v[40:43], a[16:19], v[156:159]
v_mul_f32 v241, v237, v241
v_mul_f32 v242, v238, v242
v_mfma_f32_16x16x32_bf16 v[160:163], v[40:43], a[20:23], v[160:163]
v_mul_f32 v243, v239, v243
v_mfma_f32_16x16x32_bf16 v[164:167], v[40:43], a[24:27], v[164:167]
v_exp_f32 v240, v240
v_exp_f32 v241, v241
v_mfma_f32_16x16x32_bf16 v[168:171], v[40:43], a[28:31], v[168:171]
buffer_load_dwordx4 v[40:43], v1, s[8:11], s29 offen offset:3072
v_exp_f32 v242, v242
v_exp_f32 v243, v243
s_waitcnt vmcnt(11)
v_mfma_f32_16x16x32_bf16 v[156:159], v[44:47], a[32:35], v[156:159]
v_add_f32 v240, 1.0, v240
v_mfma_f32_16x16x32_bf16 v[160:163], v[44:47], a[36:39], v[160:163]
v_add_f32 v241, 1.0, v241
v_add_f32 v242, 1.0, v242
v_mfma_f32_16x16x32_bf16 v[164:167], v[44:47], a[40:43], v[164:167]
v_add_f32 v243, 1.0, v243
v_mfma_f32_16x16x32_bf16 v[168:171], v[44:47], a[44:47], v[168:171]
s_add_u32 s29, s22, 28672
buffer_load_dwordx4 v[44:47], v1, s[8:11], s29 offen offset:0
v_rcp_f32 v240, v240
v_rcp_f32 v241, v241
v_mfma_f32_16x16x32_bf16 v[156:159], v[48:51], a[48:51], v[156:159]
v_rcp_f32 v242, v242
v_rcp_f32 v243, v243
v_mfma_f32_16x16x32_bf16 v[160:163], v[48:51], a[52:55], v[160:163]
v_mul_f32 v236, v236, v240
v_mfma_f32_16x16x32_bf16 v[164:167], v[48:51], a[56:59], v[164:167]
v_mul_f32 v237, v237, v241
v_mul_f32 v238, v238, v242
v_mfma_f32_16x16x32_bf16 v[168:171], v[48:51], a[60:63], v[168:171]
buffer_load_dwordx4 v[48:51], v1, s[8:11], s29 offen offset:1024
v_mul_f32 v239, v239, v243
v_mfma_f32_16x16x32_bf16 v[156:159], v[52:55], a[64:67], v[156:159]
v_cvt_pk_bf16_f32 v244, v236, v237
v_cvt_pk_bf16_f32 v245, v238, v239
v_mfma_f32_16x16x32_bf16 v[160:163], v[52:55], a[68:71], v[160:163]
ds_write_b64 v6, v[244:245] offset:10240
v_fma_f32 v240, v19, v232, v228
v_mfma_f32_16x16x32_bf16 v[164:167], v[52:55], a[72:75], v[164:167]
v_fma_f32 v241, v19, v233, v229
v_mfma_f32_16x16x32_bf16 v[168:171], v[52:55], a[76:79], v[168:171]
s_add_u32 s29, s22, 40960
buffer_load_dwordx4 v[52:55], v1, s[8:11], s29 offen offset:0
v_fma_f32 v242, v19, v234, v230
v_fma_f32 v243, v19, v235, v231
s_waitcnt vmcnt(11)
v_mfma_f32_16x16x32_bf16 v[156:159], v[56:59], a[80:83], v[156:159]
v_fma_f32 v236, v200, v15, v240
v_mfma_f32_16x16x32_bf16 v[160:163], v[56:59], a[84:87], v[160:163]
v_fma_f32 v237, v201, v15, v241
v_fma_f32 v238, v202, v15, v242
v_mfma_f32_16x16x32_bf16 v[164:167], v[56:59], a[88:91], v[164:167]
v_fma_f32 v239, v203, v15, v243
v_mul_f32 v240, v236, v236
v_mfma_f32_16x16x32_bf16 v[168:171], v[56:59], a[92:95], v[168:171]
buffer_load_dwordx4 v[56:59], v1, s[8:11], s29 offen offset:1024
v_mul_f32 v241, v237, v237
v_mfma_f32_16x16x32_bf16 v[156:159], v[60:63], a[96:99], v[156:159]
v_mul_f32 v242, v238, v238
v_mul_f32 v243, v239, v239
v_mfma_f32_16x16x32_bf16 v[160:163], v[60:63], a[100:103], v[160:163]
v_fmaak_f32 v240, v240, v9, 0xc0135761
v_mfma_f32_16x16x32_bf16 v[164:167], v[60:63], a[104:107], v[164:167]
v_fmaak_f32 v241, v241, v9, 0xc0135761
v_fmaak_f32 v242, v242, v9, 0xc0135761
v_mfma_f32_16x16x32_bf16 v[168:171], v[60:63], a[108:111], v[168:171]
buffer_load_dwordx4 v[60:63], v1, s[8:11], s29 offen offset:2048
v_fmaak_f32 v243, v243, v9, 0xc0135761
v_mul_f32 v240, v236, v240
v_mfma_f32_16x16x32_bf16 v[156:159], v[64:67], a[112:115], v[156:159]
v_mul_f32 v241, v237, v241
v_mfma_f32_16x16x32_bf16 v[160:163], v[64:67], a[116:119], v[160:163]
v_mul_f32 v242, v238, v242
v_mul_f32 v243, v239, v243
v_mfma_f32_16x16x32_bf16 v[164:167], v[64:67], a[120:123], v[164:167]
v_exp_f32 v240, v240
v_mfma_f32_16x16x32_bf16 v[168:171], v[64:67], a[124:127], v[168:171]
buffer_load_dwordx4 v[64:67], v1, s[8:11], s29 offen offset:3072
v_exp_f32 v241, v241
v_exp_f32 v242, v242
s_waitcnt vmcnt(11)
v_mfma_f32_16x16x32_bf16 v[156:159], v[68:71], a[128:131], v[156:159]
v_exp_f32 v243, v243
v_add_f32 v240, 1.0, v240
v_mfma_f32_16x16x32_bf16 v[160:163], v[68:71], a[132:135], v[160:163]
v_add_f32 v241, 1.0, v241
v_mfma_f32_16x16x32_bf16 v[164:167], v[68:71], a[136:139], v[164:167]
v_add_f32 v242, 1.0, v242
v_add_f32 v243, 1.0, v243
v_mfma_f32_16x16x32_bf16 v[168:171], v[68:71], a[140:143], v[168:171]
s_add_u32 s29, s22, 45056
buffer_load_dwordx4 v[68:71], v1, s[8:11], s29 offen offset:0
v_rcp_f32 v240, v240
v_mfma_f32_16x16x32_bf16 v[156:159], v[72:75], a[144:147], v[156:159]
v_rcp_f32 v241, v241
v_rcp_f32 v242, v242
v_mfma_f32_16x16x32_bf16 v[160:163], v[72:75], a[148:151], v[160:163]
v_rcp_f32 v243, v243
v_mul_f32 v236, v236, v240
v_mfma_f32_16x16x32_bf16 v[164:167], v[72:75], a[152:155], v[164:167]
v_mul_f32 v237, v237, v241
v_mfma_f32_16x16x32_bf16 v[168:171], v[72:75], a[156:159], v[168:171]
buffer_load_dwordx4 v[72:75], v1, s[8:11], s29 offen offset:1024
v_mul_f32 v238, v238, v242
v_mul_f32 v239, v239, v243
v_mfma_f32_16x16x32_bf16 v[172:175], v[20:23], a[0:3], 0
v_cvt_pk_bf16_f32 v246, v236, v237
v_mfma_f32_16x16x32_bf16 v[176:179], v[20:23], a[4:7], 0
v_cvt_pk_bf16_f32 v247, v238, v239
ds_write_b64 v6, v[246:247] offset:11264
v_mfma_f32_16x16x32_bf16 v[180:183], v[20:23], a[8:11], 0
buffer_load_dwordx4 v[228:231], v10, s[8:11], s23 offen offset:896 sc1
buffer_load_dwordx4 v[232:235], v10, s[8:11], s23 offen offset:912 sc1
v_fma_f32 v240, v16, v224, v220
v_mfma_f32_16x16x32_bf16 v[184:187], v[20:23], a[12:15], 0
buffer_load_dwordx4 v[20:23], v1, s[8:11], s29 offen offset:2048
v_fma_f32 v241, v16, v225, v221
s_waitcnt vmcnt(13)
v_mfma_f32_16x16x32_bf16 v[172:175], v[24:27], a[16:19], v[172:175]
s_waitcnt lgkmcnt(0)
s_barrier
ds_read_b128 a[160:163], v8 offset:4096
v_fma_f32 v242, v16, v226, v222
v_fma_f32 v243, v16, v227, v223
v_mfma_f32_16x16x32_bf16 v[176:179], v[24:27], a[20:23], v[176:179]
ds_read_b128 a[164:167], v8 offset:5120
v_fma_f32 v236, v204, v12, v240
v_mfma_f32_16x16x32_bf16 v[180:183], v[24:27], a[24:27], v[180:183]
ds_read_b128 a[168:171], v8 offset:6144
v_fma_f32 v237, v205, v12, v241
v_fma_f32 v238, v206, v12, v242
v_mfma_f32_16x16x32_bf16 v[184:187], v[24:27], a[28:31], v[184:187]
buffer_load_dwordx4 v[24:27], v1, s[8:11], s29 offen offset:3072
ds_read_b128 a[172:175], v8 offset:7168
v_fma_f32 v239, v207, v12, v243
v_mul_f32 v240, v236, v236
v_mfma_f32_16x16x32_bf16 v[172:175], v[28:31], a[32:35], v[172:175]
ds_read_b128 a[176:179], v8 offset:8192
v_mul_f32 v241, v237, v237
v_mfma_f32_16x16x32_bf16 v[176:179], v[28:31], a[36:39], v[176:179]
ds_read_b128 a[180:183], v8 offset:9216
v_mul_f32 v242, v238, v238
v_mul_f32 v243, v239, v239
v_mfma_f32_16x16x32_bf16 v[180:183], v[28:31], a[40:43], v[180:183]
ds_read_b128 a[184:187], v8 offset:10240
v_fmaak_f32 v240, v240, v9, 0xc0135761
v_mfma_f32_16x16x32_bf16 v[184:187], v[28:31], a[44:47], v[184:187]
s_add_u32 s29, s22, 53248
buffer_load_dwordx4 v[28:31], v1, s[8:11], s29 offen offset:2048
ds_read_b128 a[188:191], v8 offset:11264
v_fmaak_f32 v241, v241, v9, 0xc0135761
v_fmaak_f32 v242, v242, v9, 0xc0135761
v_mfma_f32_16x16x32_bf16 v[172:175], v[32:35], a[48:51], v[172:175]
v_fmaak_f32 v243, v243, v9, 0xc0135761
v_mul_f32 v240, v236, v240
v_mfma_f32_16x16x32_bf16 v[176:179], v[32:35], a[52:55], v[176:179]
v_mul_f32 v241, v237, v241
v_mfma_f32_16x16x32_bf16 v[180:183], v[32:35], a[56:59], v[180:183]
v_mul_f32 v242, v238, v242
v_mul_f32 v243, v239, v243
v_mfma_f32_16x16x32_bf16 v[184:187], v[32:35], a[60:63], v[184:187]
buffer_load_dwordx4 v[32:35], v1, s[8:11], s29 offen offset:3072
v_exp_f32 v240, v240
s_waitcnt vmcnt(13)
s_waitcnt lgkmcnt(4)
v_mfma_f32_16x16x32_bf16 v[140:143], v[36:39], a[160:163], v[140:143]
v_exp_f32 v241, v241
v_exp_f32 v242, v242
v_mfma_f32_16x16x32_bf16 v[144:147], v[36:39], a[164:167], v[144:147]
v_exp_f32 v243, v243
v_add_f32 v240, 1.0, v240
v_mfma_f32_16x16x32_bf16 v[148:151], v[36:39], a[168:171], v[148:151]
v_add_f32 v241, 1.0, v241
v_mfma_f32_16x16x32_bf16 v[152:155], v[36:39], a[172:175], v[152:155]
s_add_u32 s29, s22, 57344
buffer_load_dwordx4 v[36:39], v1, s[8:11], s29 offen offset:0
v_add_f32 v242, 1.0, v242
v_add_f32 v243, 1.0, v243
s_waitcnt lgkmcnt(0)
v_mfma_f32_16x16x32_bf16 v[140:143], v[40:43], a[176:179], v[140:143]
v_rcp_f32 v240, v240
v_mfma_f32_16x16x32_bf16 v[144:147], v[40:43], a[180:183], v[144:147]
v_rcp_f32 v241, v241
v_rcp_f32 v242, v242
v_mfma_f32_16x16x32_bf16 v[148:151], v[40:43], a[184:187], v[148:151]
v_rcp_f32 v243, v243
v_mul_f32 v236, v236, v240
v_mfma_f32_16x16x32_bf16 v[152:155], v[40:43], a[188:191], v[152:155]
buffer_load_dwordx4 v[40:43], v1, s[8:11], s29 offen offset:1024
v_mul_f32 v237, v237, v241
v_mfma_f32_16x16x32_bf16 v[156:159], v[44:47], a[160:163], v[156:159]
v_mul_f32 v238, v238, v242
v_mul_f32 v239, v239, v243
v_mfma_f32_16x16x32_bf16 v[160:163], v[44:47], a[164:167], v[160:163]
v_cvt_pk_bf16_f32 v244, v236, v237
v_mfma_f32_16x16x32_bf16 v[164:167], v[44:47], a[168:171], v[164:167]
v_cvt_pk_bf16_f32 v245, v238, v239
ds_write_b64 v6, v[244:245] offset:16384
v_mfma_f32_16x16x32_bf16 v[168:171], v[44:47], a[172:175], v[168:171]
buffer_load_dwordx4 v[44:47], v1, s[8:11], s29 offen offset:2048
v_fma_f32 v240, v17, v224, v220
v_fma_f32 v241, v17, v225, v221
s_waitcnt vmcnt(13)
v_mfma_f32_16x16x32_bf16 v[156:159], v[48:51], a[176:179], v[156:159]
v_fma_f32 v242, v17, v226, v222
v_mfma_f32_16x16x32_bf16 v[160:163], v[48:51], a[180:183], v[160:163]
v_fma_f32 v243, v17, v227, v223
v_fma_f32 v236, v208, v13, v240
v_mfma_f32_16x16x32_bf16 v[164:167], v[48:51], a[184:187], v[164:167]
v_fma_f32 v237, v209, v13, v241
v_mfma_f32_16x16x32_bf16 v[168:171], v[48:51], a[188:191], v[168:171]
buffer_load_dwordx4 v[48:51], v1, s[8:11], s29 offen offset:3072
v_fma_f32 v238, v210, v13, v242
v_fma_f32 v239, v211, v13, v243
v_mfma_f32_16x16x32_bf16 v[172:175], v[52:55], a[64:67], v[172:175]
v_mul_f32 v240, v236, v236
v_mul_f32 v241, v237, v237
v_mfma_f32_16x16x32_bf16 v[176:179], v[52:55], a[68:71], v[176:179]
v_mul_f32 v242, v238, v238
v_mfma_f32_16x16x32_bf16 v[180:183], v[52:55], a[72:75], v[180:183]
v_mul_f32 v243, v239, v239
v_fmaak_f32 v240, v240, v9, 0xc0135761
v_mfma_f32_16x16x32_bf16 v[184:187], v[52:55], a[76:79], v[184:187]
s_add_u32 s29, s22, 61440
buffer_load_dwordx4 v[52:55], v1, s[8:11], s29 offen offset:0
v_fmaak_f32 v241, v241, v9, 0xc0135761
v_mfma_f32_16x16x32_bf16 v[172:175], v[56:59], a[80:83], v[172:175]
v_fmaak_f32 v242, v242, v9, 0xc0135761
v_fmaak_f32 v243, v243, v9, 0xc0135761
v_mfma_f32_16x16x32_bf16 v[176:179], v[56:59], a[84:87], v[176:179]
v_mul_f32 v240, v236, v240
v_mul_f32 v241, v237, v241
v_mfma_f32_16x16x32_bf16 v[180:183], v[56:59], a[88:91], v[180:183]
v_mul_f32 v242, v238, v242
v_mfma_f32_16x16x32_bf16 v[184:187], v[56:59], a[92:95], v[184:187]
buffer_load_dwordx4 v[56:59], v1, s[8:11], s29 offen offset:1024
v_mul_f32 v243, v239, v243
v_exp_f32 v240, v240
s_waitcnt vmcnt(13)
v_mfma_f32_16x16x32_bf16 v[172:175], v[60:63], a[96:99], v[172:175]
v_exp_f32 v241, v241
v_mfma_f32_16x16x32_bf16 v[176:179], v[60:63], a[100:103], v[176:179]
v_exp_f32 v242, v242
v_exp_f32 v243, v243
v_mfma_f32_16x16x32_bf16 v[180:183], v[60:63], a[104:107], v[180:183]
v_add_f32 v240, 1.0, v240
v_add_f32 v241, 1.0, v241
v_mfma_f32_16x16x32_bf16 v[184:187], v[60:63], a[108:111], v[184:187]
buffer_load_dwordx4 v[60:63], v1, s[8:11], s29 offen offset:2048
v_add_f32 v242, 1.0, v242
v_mfma_f32_16x16x32_bf16 v[172:175], v[64:67], a[112:115], v[172:175]
v_add_f32 v243, 1.0, v243
v_rcp_f32 v240, v240
v_mfma_f32_16x16x32_bf16 v[176:179], v[64:67], a[116:119], v[176:179]
v_rcp_f32 v241, v241
v_mfma_f32_16x16x32_bf16 v[180:183], v[64:67], a[120:123], v[180:183]
v_rcp_f32 v242, v242
v_rcp_f32 v243, v243
v_mfma_f32_16x16x32_bf16 v[184:187], v[64:67], a[124:127], v[184:187]
buffer_load_dwordx4 v[64:67], v1, s[8:11], s29 offen offset:3072
v_mul_f32 v236, v236, v240
v_mul_f32 v237, v237, v241
v_mfma_f32_16x16x32_bf16 v[172:175], v[68:71], a[128:131], v[172:175]
v_mul_f32 v238, v238, v242
v_mfma_f32_16x16x32_bf16 v[176:179], v[68:71], a[132:135], v[176:179]
v_mul_f32 v239, v239, v243
v_cvt_pk_bf16_f32 v246, v236, v237
v_mfma_f32_16x16x32_bf16 v[180:183], v[68:71], a[136:139], v[180:183]
v_cvt_pk_bf16_f32 v247, v238, v239
v_mfma_f32_16x16x32_bf16 v[184:187], v[68:71], a[140:143], v[184:187]
s_add_u32 s29, s22, 65536
buffer_load_dwordx4 v[68:71], v1, s[8:11], s29 offen offset:0
ds_write_b64 v6, v[246:247] offset:17408
v_fma_f32 v240, v18, v224, v220
s_waitcnt vmcnt(11)
v_mfma_f32_16x16x32_bf16 v[172:175], v[72:75], a[144:147], v[172:175]
v_fma_f32 v241, v18, v225, v221
v_fma_f32 v242, v18, v226, v222
v_mfma_f32_16x16x32_bf16 v[176:179], v[72:75], a[148:151], v[176:179]
v_fma_f32 v243, v18, v227, v223
v_mfma_f32_16x16x32_bf16 v[180:183], v[72:75], a[152:155], v[180:183]
v_fma_f32 v236, v212, v14, v240
v_fma_f32 v237, v213, v14, v241
v_mfma_f32_16x16x32_bf16 v[184:187], v[72:75], a[156:159], v[184:187]
buffer_load_dwordx4 v[72:75], v1, s[8:11], s29 offen offset:1024
v_fma_f32 v238, v214, v14, v242
v_mfma_f32_16x16x32_bf16 v[172:175], v[20:23], a[160:163], v[172:175]
v_fma_f32 v239, v215, v14, v243
v_mul_f32 v240, v236, v236
v_mfma_f32_16x16x32_bf16 v[176:179], v[20:23], a[164:167], v[176:179]
v_mul_f32 v241, v237, v237
v_mul_f32 v242, v238, v238
v_mfma_f32_16x16x32_bf16 v[180:183], v[20:23], a[168:171], v[180:183]
v_mul_f32 v243, v239, v239
v_mfma_f32_16x16x32_bf16 v[184:187], v[20:23], a[172:175], v[184:187]
s_add_u32 s29, s22, 73728
buffer_load_dwordx4 v[20:23], v1, s[8:11], s29 offen offset:0
v_fmaak_f32 v240, v240, v9, 0xc0135761
v_fmaak_f32 v241, v241, v9, 0xc0135761
v_mfma_f32_16x16x32_bf16 v[172:175], v[24:27], a[176:179], v[172:175]
v_fmaak_f32 v242, v242, v9, 0xc0135761
v_mfma_f32_16x16x32_bf16 v[176:179], v[24:27], a[180:183], v[176:179]
v_fmaak_f32 v243, v243, v9, 0xc0135761
v_mul_f32 v240, v236, v240
v_mfma_f32_16x16x32_bf16 v[180:183], v[24:27], a[184:187], v[180:183]
v_mul_f32 v241, v237, v241
v_mul_f32 v242, v238, v242
v_mfma_f32_16x16x32_bf16 v[184:187], v[24:27], a[188:191], v[184:187]
s_add_u32 s29, s22, 12288
buffer_load_dwordx4 v[24:27], v1, s[8:11], s29 offen offset:0
v_mul_f32 v243, v239, v243
s_waitcnt vmcnt(11)
v_mfma_f32_16x16x32_bf16 v[188:191], v[28:31], a[0:3], 0
v_exp_f32 v240, v240
v_exp_f32 v241, v241
v_mfma_f32_16x16x32_bf16 v[192:195], v[28:31], a[4:7], 0
v_exp_f32 v242, v242
v_mfma_f32_16x16x32_bf16 v[196:199], v[28:31], a[8:11], 0
v_exp_f32 v243, v243
v_add_f32 v240, 1.0, v240
v_mfma_f32_16x16x32_bf16 v[200:203], v[28:31], a[12:15], 0
buffer_load_dwordx4 v[28:31], v1, s[8:11], s29 offen offset:1024
v_add_f32 v241, 1.0, v241
v_add_f32 v242, 1.0, v242
v_mfma_f32_16x16x32_bf16 v[188:191], v[32:35], a[16:19], v[188:191]
v_add_f32 v243, 1.0, v243
v_mfma_f32_16x16x32_bf16 v[192:195], v[32:35], a[20:23], v[192:195]
v_rcp_f32 v240, v240
v_rcp_f32 v241, v241
v_mfma_f32_16x16x32_bf16 v[196:199], v[32:35], a[24:27], v[196:199]
v_rcp_f32 v242, v242
v_mfma_f32_16x16x32_bf16 v[200:203], v[32:35], a[28:31], v[200:203]
s_add_u32 s29, s22, 28672
buffer_load_dwordx4 v[32:35], v1, s[8:11], s29 offen offset:2048
v_rcp_f32 v243, v243
v_mul_f32 v236, v236, v240
v_mfma_f32_16x16x32_bf16 v[188:191], v[36:39], a[32:35], v[188:191]
v_mul_f32 v237, v237, v241
v_mul_f32 v238, v238, v242
v_mfma_f32_16x16x32_bf16 v[192:195], v[36:39], a[36:39], v[192:195]
v_mul_f32 v239, v239, v243
v_mfma_f32_16x16x32_bf16 v[196:199], v[36:39], a[40:43], v[196:199]
v_cvt_pk_bf16_f32 v244, v236, v237
v_cvt_pk_bf16_f32 v245, v238, v239
v_mfma_f32_16x16x32_bf16 v[200:203], v[36:39], a[44:47], v[200:203]
buffer_load_dwordx4 v[36:39], v1, s[8:11], s29 offen offset:3072
ds_write_b64 v6, v[244:245] offset:18432
s_waitcnt vmcnt(11)
v_mfma_f32_16x16x32_bf16 v[188:191], v[40:43], a[48:51], v[188:191]
v_fma_f32 v240, v19, v224, v220
v_fma_f32 v241, v19, v225, v221
v_mfma_f32_16x16x32_bf16 v[192:195], v[40:43], a[52:55], v[192:195]
v_fma_f32 v242, v19, v226, v222
v_fma_f32 v243, v19, v227, v223
v_mfma_f32_16x16x32_bf16 v[196:199], v[40:43], a[56:59], v[196:199]
v_fma_f32 v236, v216, v15, v240
v_mfma_f32_16x16x32_bf16 v[200:203], v[40:43], a[60:63], v[200:203]
s_add_u32 s29, s22, 49152
buffer_load_dwordx4 v[40:43], v1, s[8:11], s29 offen offset:0
v_fma_f32 v237, v217, v15, v241
v_fma_f32 v238, v218, v15, v242
v_mfma_f32_16x16x32_bf16 v[188:191], v[44:47], a[64:67], v[188:191]
v_fma_f32 v239, v219, v15, v243
v_mfma_f32_16x16x32_bf16 v[192:195], v[44:47], a[68:71], v[192:195]
v_mul_f32 v240, v236, v236
v_mul_f32 v241, v237, v237
v_mfma_f32_16x16x32_bf16 v[196:199], v[44:47], a[72:75], v[196:199]
v_mul_f32 v242, v238, v238
v_mul_f32 v243, v239, v239
v_mfma_f32_16x16x32_bf16 v[200:203], v[44:47], a[76:79], v[200:203]
buffer_load_dwordx4 v[44:47], v1, s[8:11], s29 offen offset:1024
v_fmaak_f32 v240, v240, v9, 0xc0135761
v_mfma_f32_16x16x32_bf16 v[188:191], v[48:51], a[80:83], v[188:191]
v_fmaak_f32 v241, v241, v9, 0xc0135761
v_fmaak_f32 v242, v242, v9, 0xc0135761
v_mfma_f32_16x16x32_bf16 v[192:195], v[48:51], a[84:87], v[192:195]
v_fmaak_f32 v243, v243, v9, 0xc0135761
v_mfma_f32_16x16x32_bf16 v[196:199], v[48:51], a[88:91], v[196:199]
v_mul_f32 v240, v236, v240
v_mul_f32 v241, v237, v241
v_mfma_f32_16x16x32_bf16 v[200:203], v[48:51], a[92:95], v[200:203]
s_add_u32 s29, s22, 65536
buffer_load_dwordx4 v[48:51], v1, s[8:11], s29 offen offset:2048
v_mul_f32 v242, v238, v242
v_mul_f32 v243, v239, v243
s_waitcnt vmcnt(11)
v_mfma_f32_16x16x32_bf16 v[188:191], v[52:55], a[96:99], v[188:191]
v_exp_f32 v240, v240
v_mfma_f32_16x16x32_bf16 v[192:195], v[52:55], a[100:103], v[192:195]
v_exp_f32 v241, v241
v_exp_f32 v242, v242
v_mfma_f32_16x16x32_bf16 v[196:199], v[52:55], a[104:107], v[196:199]
v_exp_f32 v243, v243
v_mfma_f32_16x16x32_bf16 v[200:203], v[52:55], a[108:111], v[200:203]
buffer_load_dwordx4 v[52:55], v1, s[8:11], s29 offen offset:3072
v_add_f32 v240, 1.0, v240
v_add_f32 v241, 1.0, v241
v_mfma_f32_16x16x32_bf16 v[188:191], v[56:59], a[112:115], v[188:191]
v_add_f32 v242, 1.0, v242
v_add_f32 v243, 1.0, v243
v_mfma_f32_16x16x32_bf16 v[192:195], v[56:59], a[116:119], v[192:195]
v_rcp_f32 v240, v240
v_mfma_f32_16x16x32_bf16 v[196:199], v[56:59], a[120:123], v[196:199]
v_rcp_f32 v241, v241
v_rcp_f32 v242, v242
v_mfma_f32_16x16x32_bf16 v[200:203], v[56:59], a[124:127], v[200:203]
s_add_u32 s29, s22, 73728
buffer_load_dwordx4 v[56:59], v1, s[8:11], s29 offen offset:1024
v_rcp_f32 v243, v243
v_mfma_f32_16x16x32_bf16 v[188:191], v[60:63], a[128:131], v[188:191]
v_mul_f32 v236, v236, v240
v_mul_f32 v237, v237, v241
v_mfma_f32_16x16x32_bf16 v[192:195], v[60:63], a[132:135], v[192:195]
v_mul_f32 v238, v238, v242
v_mul_f32 v239, v239, v243
v_mfma_f32_16x16x32_bf16 v[196:199], v[60:63], a[136:139], v[196:199]
v_cvt_pk_bf16_f32 v246, v236, v237
v_mfma_f32_16x16x32_bf16 v[200:203], v[60:63], a[140:143], v[200:203]
buffer_load_dwordx4 v[60:63], v1, s[8:11], s29 offen offset:2048
v_cvt_pk_bf16_f32 v247, v238, v239
ds_write_b64 v6, v[246:247] offset:19456
s_waitcnt vmcnt(11)
v_mfma_f32_16x16x32_bf16 v[188:191], v[64:67], a[144:147], v[188:191]
buffer_load_dwordx4 v[220:223], v10, s[8:11], s23 offen offset:1024 sc1
buffer_load_dwordx4 v[224:227], v10, s[8:11], s23 offen offset:1040 sc1
v_mfma_f32_16x16x32_bf16 v[192:195], v[64:67], a[148:151], v[192:195]
v_fma_f32 v240, v16, v232, v228
v_fma_f32 v241, v16, v233, v229
v_mfma_f32_16x16x32_bf16 v[196:199], v[64:67], a[152:155], v[196:199]
v_fma_f32 v242, v16, v234, v230
v_fma_f32 v243, v16, v235, v231
v_mfma_f32_16x16x32_bf16 v[200:203], v[64:67], a[156:159], v[200:203]
buffer_load_dwordx4 v[64:67], v1, s[8:11], s29 offen offset:3072
v_fma_f32 v236, v108, v12, v240
v_mfma_f32_16x16x32_bf16 v[188:191], v[68:71], a[160:163], v[188:191]
s_waitcnt lgkmcnt(0)
s_barrier
ds_read_b128 a[192:195], v8 offset:12288
v_fma_f32 v237, v109, v12, v241
v_fma_f32 v238, v110, v12, v242
v_mfma_f32_16x16x32_bf16 v[192:195], v[68:71], a[164:167], v[192:195]
ds_read_b128 a[196:199], v8 offset:13312
v_fma_f32 v239, v111, v12, v243
v_mfma_f32_16x16x32_bf16 v[196:199], v[68:71], a[168:171], v[196:199]
ds_read_b128 a[200:203], v8 offset:14336
v_mul_f32 v240, v236, v236
v_mul_f32 v241, v237, v237
v_mfma_f32_16x16x32_bf16 v[200:203], v[68:71], a[172:175], v[200:203]
s_add_u32 s29, s22, 77824
buffer_load_dwordx4 v[68:71], v1, s[8:11], s29 offen offset:0
ds_read_b128 a[204:207], v8 offset:15360
v_mul_f32 v242, v238, v238
v_mul_f32 v243, v239, v239
v_mfma_f32_16x16x32_bf16 v[188:191], v[72:75], a[176:179], v[188:191]
ds_read_b128 a[208:211], v8 offset:16384
v_fmaak_f32 v240, v240, v9, 0xc0135761
v_mfma_f32_16x16x32_bf16 v[192:195], v[72:75], a[180:183], v[192:195]
ds_read_b128 a[212:215], v8 offset:17408
v_fmaak_f32 v241, v241, v9, 0xc0135761
v_fmaak_f32 v242, v242, v9, 0xc0135761
v_mfma_f32_16x16x32_bf16 v[196:199], v[72:75], a[184:187], v[196:199]
ds_read_b128 a[216:219], v8 offset:18432
v_fmaak_f32 v243, v243, v9, 0xc0135761
v_mfma_f32_16x16x32_bf16 v[200:203], v[72:75], a[188:191], v[200:203]
buffer_load_dwordx4 v[72:75], v1, s[8:11], s29 offen offset:1024
ds_read_b128 a[220:223], v8 offset:19456
v_mul_f32 v240, v236, v240
v_mul_f32 v241, v237, v241
s_waitcnt vmcnt(13)
v_mfma_f32_16x16x32_bf16 v[204:207], v[20:23], a[0:3], 0
v_mul_f32 v242, v238, v242
v_mul_f32 v243, v239, v243
v_mfma_f32_16x16x32_bf16 v[208:211], v[20:23], a[4:7], 0
v_exp_f32 v240, v240
v_mfma_f32_16x16x32_bf16 v[212:215], v[20:23], a[8:11], 0
v_exp_f32 v241, v241
v_exp_f32 v242, v242
v_mfma_f32_16x16x32_bf16 v[216:219], v[20:23], a[12:15], 0
buffer_load_dwordx4 v[20:23], v1, s[8:11], s29 offen offset:2048
v_exp_f32 v243, v243
s_waitcnt lgkmcnt(4)
v_mfma_f32_16x16x32_bf16 v[140:143], v[24:27], a[192:195], v[140:143]
v_add_f32 v240, 1.0, v240
v_add_f32 v241, 1.0, v241
v_mfma_f32_16x16x32_bf16 v[144:147], v[24:27], a[196:199], v[144:147]
v_add_f32 v242, 1.0, v242
v_add_f32 v243, 1.0, v243
v_mfma_f32_16x16x32_bf16 v[148:151], v[24:27], a[200:203], v[148:151]
v_rcp_f32 v240, v240
v_mfma_f32_16x16x32_bf16 v[152:155], v[24:27], a[204:207], v[152:155]
buffer_load_dwordx4 v[24:27], v1, s[8:11], s29 offen offset:3072
v_rcp_f32 v241, v241
v_rcp_f32 v242, v242
s_waitcnt lgkmcnt(0)
v_mfma_f32_16x16x32_bf16 v[140:143], v[28:31], a[208:211], v[140:143]
v_rcp_f32 v243, v243
v_mfma_f32_16x16x32_bf16 v[144:147], v[28:31], a[212:215], v[144:147]
v_mul_f32 v236, v236, v240
v_mul_f32 v237, v237, v241
v_mfma_f32_16x16x32_bf16 v[148:151], v[28:31], a[216:219], v[148:151]
v_mul_f32 v238, v238, v242
v_mul_f32 v239, v239, v243
v_mfma_f32_16x16x32_bf16 v[152:155], v[28:31], a[220:223], v[152:155]
s_add_u32 s29, s22, 81920
buffer_load_dwordx4 v[28:31], v1, s[8:11], s29 offen offset:0
v_cvt_pk_bf16_f32 v244, v236, v237
s_waitcnt vmcnt(13)
v_mfma_f32_16x16x32_bf16 v[156:159], v[32:35], a[192:195], v[156:159]
v_cvt_pk_bf16_f32 v245, v238, v239
ds_write_b64 v6, v[244:245] offset:24576
v_mfma_f32_16x16x32_bf16 v[160:163], v[32:35], a[196:199], v[160:163]
v_fma_f32 v240, v17, v232, v228
v_mfma_f32_16x16x32_bf16 v[164:167], v[32:35], a[200:203], v[164:167]
v_fma_f32 v241, v17, v233, v229
v_fma_f32 v242, v17, v234, v230
v_mfma_f32_16x16x32_bf16 v[168:171], v[32:35], a[204:207], v[168:171]
buffer_load_dwordx4 v[32:35], v1, s[8:11], s29 offen offset:1024
v_fma_f32 v243, v17, v235, v231
v_fma_f32 v236, v112, v13, v240
v_mfma_f32_16x16x32_bf16 v[156:159], v[36:39], a[208:211], v[156:159]
v_fma_f32 v237, v113, v13, v241
v_mfma_f32_16x16x32_bf16 v[160:163], v[36:39], a[212:215], v[160:163]
v_fma_f32 v238, v114, v13, v242
v_fma_f32 v239, v115, v13, v243
v_mfma_f32_16x16x32_bf16 v[164:167], v[36:39], a[216:219], v[164:167]
v_mul_f32 v240, v236, v236
v_mfma_f32_16x16x32_bf16 v[168:171], v[36:39], a[220:223], v[168:171]
buffer_load_dwordx4 v[36:39], v1, s[8:11], s29 offen offset:2048
v_mul_f32 v241, v237, v237
v_mul_f32 v242, v238, v238
v_mfma_f32_16x16x32_bf16 v[172:175], v[40:43], a[192:195], v[172:175]
v_mul_f32 v243, v239, v239
v_fmaak_f32 v240, v240, v9, 0xc0135761
v_mfma_f32_16x16x32_bf16 v[176:179], v[40:43], a[196:199], v[176:179]
v_fmaak_f32 v241, v241, v9, 0xc0135761
v_mfma_f32_16x16x32_bf16 v[180:183], v[40:43], a[200:203], v[180:183]
v_fmaak_f32 v242, v242, v9, 0xc0135761
v_fmaak_f32 v243, v243, v9, 0xc0135761
v_mfma_f32_16x16x32_bf16 v[184:187], v[40:43], a[204:207], v[184:187]
buffer_load_dwordx4 v[40:43], v1, s[8:11], s29 offen offset:3072
v_mul_f32 v240, v236, v240
s_waitcnt vmcnt(13)
v_mfma_f32_16x16x32_bf16 v[172:175], v[44:47], a[208:211], v[172:175]
v_mul_f32 v241, v237, v241
v_mul_f32 v242, v238, v242
v_mfma_f32_16x16x32_bf16 v[176:179], v[44:47], a[212:215], v[176:179]
v_mul_f32 v243, v239, v243
v_exp_f32 v240, v240
v_mfma_f32_16x16x32_bf16 v[180:183], v[44:47], a[216:219], v[180:183]
v_exp_f32 v241, v241
v_mfma_f32_16x16x32_bf16 v[184:187], v[44:47], a[220:223], v[184:187]
s_add_u32 s29, s22, 86016
buffer_load_dwordx4 v[44:47], v1, s[8:11], s29 offen offset:0
v_exp_f32 v242, v242
v_exp_f32 v243, v243
v_mfma_f32_16x16x32_bf16 v[188:191], v[48:51], a[192:195], v[188:191]
v_add_f32 v240, 1.0, v240
v_mfma_f32_16x16x32_bf16 v[192:195], v[48:51], a[196:199], v[192:195]
v_add_f32 v241, 1.0, v241
v_add_f32 v242, 1.0, v242
v_mfma_f32_16x16x32_bf16 v[196:199], v[48:51], a[200:203], v[196:199]
v_add_f32 v243, 1.0, v243
v_rcp_f32 v240, v240
v_mfma_f32_16x16x32_bf16 v[200:203], v[48:51], a[204:207], v[200:203]
buffer_load_dwordx4 v[48:51], v1, s[8:11], s29 offen offset:1024
v_rcp_f32 v241, v241
v_mfma_f32_16x16x32_bf16 v[188:191], v[52:55], a[208:211], v[188:191]
v_rcp_f32 v242, v242
v_rcp_f32 v243, v243
v_mfma_f32_16x16x32_bf16 v[192:195], v[52:55], a[212:215], v[192:195]
v_mul_f32 v236, v236, v240
v_mfma_f32_16x16x32_bf16 v[196:199], v[52:55], a[216:219], v[196:199]
v_mul_f32 v237, v237, v241
v_mul_f32 v238, v238, v242
v_mfma_f32_16x16x32_bf16 v[200:203], v[52:55], a[220:223], v[200:203]
s_add_u32 s29, s22, 90112
buffer_load_dwordx4 v[52:55], v1, s[8:11], s29 offen offset:2048
v_mul_f32 v239, v239, v243
v_cvt_pk_bf16_f32 v246, v236, v237
s_waitcnt vmcnt(11)
v_mfma_f32_16x16x32_bf16 v[204:207], v[56:59], a[16:19], v[204:207]
v_cvt_pk_bf16_f32 v247, v238, v239
v_mfma_f32_16x16x32_bf16 v[208:211], v[56:59], a[20:23], v[208:211]
ds_write_b64 v6, v[246:247] offset:25600
v_fma_f32 v240, v18, v232, v228
v_mfma_f32_16x16x32_bf16 v[212:215], v[56:59], a[24:27], v[212:215]
v_fma_f32 v241, v18, v233, v229
v_mfma_f32_16x16x32_bf16 v[216:219], v[56:59], a[28:31], v[216:219]
buffer_load_dwordx4 v[56:59], v1, s[8:11], s29 offen offset:3072
v_fma_f32 v242, v18, v234, v230
v_fma_f32 v243, v18, v235, v231
v_mfma_f32_16x16x32_bf16 v[204:207], v[60:63], a[32:35], v[204:207]
v_fma_f32 v236, v116, v14, v240
v_fma_f32 v237, v117, v14, v241
v_mfma_f32_16x16x32_bf16 v[208:211], v[60:63], a[36:39], v[208:211]
v_fma_f32 v238, v118, v14, v242
v_mfma_f32_16x16x32_bf16 v[212:215], v[60:63], a[40:43], v[212:215]
v_fma_f32 v239, v119, v14, v243
v_mul_f32 v240, v236, v236
v_mfma_f32_16x16x32_bf16 v[216:219], v[60:63], a[44:47], v[216:219]
s_add_u32 s29, s22, 94208
buffer_load_dwordx4 v[60:63], v1, s[8:11], s29 offen offset:0
v_mul_f32 v241, v237, v237
v_mfma_f32_16x16x32_bf16 v[204:207], v[64:67], a[48:51], v[204:207]
v_mul_f32 v242, v238, v238
v_mul_f32 v243, v239, v239
v_mfma_f32_16x16x32_bf16 v[208:211], v[64:67], a[52:55], v[208:211]
v_fmaak_f32 v240, v240, v9, 0xc0135761
v_fmaak_f32 v241, v241, v9, 0xc0135761
v_mfma_f32_16x16x32_bf16 v[212:215], v[64:67], a[56:59], v[212:215]
v_fmaak_f32 v242, v242, v9, 0xc0135761
v_mfma_f32_16x16x32_bf16 v[216:219], v[64:67], a[60:63], v[216:219]
s_add_u32 s29, s22, 12288
buffer_load_dwordx4 v[64:67], v1, s[8:11], s29 offen offset:2048
v_fmaak_f32 v243, v243, v9, 0xc0135761
v_mul_f32 v240, v236, v240
s_waitcnt vmcnt(11)
v_mfma_f32_16x16x32_bf16 v[204:207], v[68:71], a[64:67], v[204:207]
v_mul_f32 v241, v237, v241
v_mfma_f32_16x16x32_bf16 v[208:211], v[68:71], a[68:71], v[208:211]
v_mul_f32 v242, v238, v242
v_mul_f32 v243, v239, v243
v_mfma_f32_16x16x32_bf16 v[212:215], v[68:71], a[72:75], v[212:215]
v_exp_f32 v240, v240
v_exp_f32 v241, v241
v_mfma_f32_16x16x32_bf16 v[216:219], v[68:71], a[76:79], v[216:219]
buffer_load_dwordx4 v[68:71], v1, s[8:11], s29 offen offset:3072
v_exp_f32 v242, v242
v_mfma_f32_16x16x32_bf16 v[204:207], v[72:75], a[80:83], v[204:207]
v_exp_f32 v243, v243
v_add_f32 v240, 1.0, v240
v_mfma_f32_16x16x32_bf16 v[208:211], v[72:75], a[84:87], v[208:211]
v_add_f32 v241, 1.0, v241
v_mfma_f32_16x16x32_bf16 v[212:215], v[72:75], a[88:91], v[212:215]
v_add_f32 v242, 1.0, v242
v_add_f32 v243, 1.0, v243
v_mfma_f32_16x16x32_bf16 v[216:219], v[72:75], a[92:95], v[216:219]
s_add_u32 s29, s22, 32768
buffer_load_dwordx4 v[72:75], v1, s[8:11], s29 offen offset:0
v_rcp_f32 v240, v240
v_rcp_f32 v241, v241
v_mfma_f32_16x16x32_bf16 v[204:207], v[20:23], a[96:99], v[204:207]
v_rcp_f32 v242, v242
v_mfma_f32_16x16x32_bf16 v[208:211], v[20:23], a[100:103], v[208:211]
v_rcp_f32 v243, v243
v_mul_f32 v236, v236, v240
v_mfma_f32_16x16x32_bf16 v[212:215], v[20:23], a[104:107], v[212:215]
v_mul_f32 v237, v237, v241
v_mfma_f32_16x16x32_bf16 v[216:219], v[20:23], a[108:111], v[216:219]
buffer_load_dwordx4 v[20:23], v1, s[8:11], s29 offen offset:1024
v_mul_f32 v238, v238, v242
v_mul_f32 v239, v239, v243
s_waitcnt vmcnt(11)
v_mfma_f32_16x16x32_bf16 v[204:207], v[24:27], a[112:115], v[204:207]
v_cvt_pk_bf16_f32 v244, v236, v237
v_cvt_pk_bf16_f32 v245, v238, v239
v_mfma_f32_16x16x32_bf16 v[208:211], v[24:27], a[116:119], v[208:211]
ds_write_b64 v6, v[244:245] offset:26624
v_mfma_f32_16x16x32_bf16 v[212:215], v[24:27], a[120:123], v[212:215]
v_fma_f32 v240, v19, v232, v228
v_fma_f32 v241, v19, v233, v229
v_mfma_f32_16x16x32_bf16 v[216:219], v[24:27], a[124:127], v[216:219]
s_add_u32 s29, s22, 49152
buffer_load_dwordx4 v[24:27], v1, s[8:11], s29 offen offset:2048
v_fma_f32 v242, v19, v234, v230
v_mfma_f32_16x16x32_bf16 v[204:207], v[28:31], a[128:131], v[204:207]
v_fma_f32 v243, v19, v235, v231
v_fma_f32 v236, v120, v15, v240
v_mfma_f32_16x16x32_bf16 v[208:211], v[28:31], a[132:135], v[208:211]
v_fma_f32 v237, v121, v15, v241
v_fma_f32 v238, v122, v15, v242
v_mfma_f32_16x16x32_bf16 v[212:215], v[28:31], a[136:139], v[212:215]
v_fma_f32 v239, v123, v15, v243
v_mfma_f32_16x16x32_bf16 v[216:219], v[28:31], a[140:143], v[216:219]
buffer_load_dwordx4 v[28:31], v1, s[8:11], s29 offen offset:3072
v_mul_f32 v240, v236, v236
v_mul_f32 v241, v237, v237
v_mfma_f32_16x16x32_bf16 v[204:207], v[32:35], a[144:147], v[204:207]
v_mul_f32 v242, v238, v238
v_mfma_f32_16x16x32_bf16 v[208:211], v[32:35], a[148:151], v[208:211]
v_mul_f32 v243, v239, v239
v_fmaak_f32 v240, v240, v9, 0xc0135761
v_mfma_f32_16x16x32_bf16 v[212:215], v[32:35], a[152:155], v[212:215]
v_fmaak_f32 v241, v241, v9, 0xc0135761
v_fmaak_f32 v242, v242, v9, 0xc0135761
v_mfma_f32_16x16x32_bf16 v[216:219], v[32:35], a[156:159], v[216:219]
s_add_u32 s29, s22, 69632
buffer_load_dwordx4 v[32:35], v1, s[8:11], s29 offen offset:0
v_fmaak_f32 v243, v243, v9, 0xc0135761
s_waitcnt vmcnt(11)
v_mfma_f32_16x16x32_bf16 v[204:207], v[36:39], a[160:163], v[204:207]
v_mul_f32 v240, v236, v240
v_mul_f32 v241, v237, v241
v_mfma_f32_16x16x32_bf16 v[208:211], v[36:39], a[164:167], v[208:211]
v_mul_f32 v242, v238, v242
v_mfma_f32_16x16x32_bf16 v[212:215], v[36:39], a[168:171], v[212:215]
v_mul_f32 v243, v239, v243
v_exp_f32 v240, v240
v_mfma_f32_16x16x32_bf16 v[216:219], v[36:39], a[172:175], v[216:219]
buffer_load_dwordx4 v[36:39], v1, s[8:11], s29 offen offset:1024
v_exp_f32 v241, v241
v_exp_f32 v242, v242
v_mfma_f32_16x16x32_bf16 v[204:207], v[40:43], a[176:179], v[204:207]
v_exp_f32 v243, v243
v_mfma_f32_16x16x32_bf16 v[208:211], v[40:43], a[180:183], v[208:211]
v_add_f32 v240, 1.0, v240
v_add_f32 v241, 1.0, v241
v_mfma_f32_16x16x32_bf16 v[212:215], v[40:43], a[184:187], v[212:215]
v_add_f32 v242, 1.0, v242
v_mfma_f32_16x16x32_bf16 v[216:219], v[40:43], a[188:191], v[216:219]
s_add_u32 s29, s22, 86016
buffer_load_dwordx4 v[40:43], v1, s[8:11], s29 offen offset:2048
v_add_f32 v243, 1.0, v243
v_rcp_f32 v240, v240
v_mfma_f32_16x16x32_bf16 v[204:207], v[44:47], a[192:195], v[204:207]
v_rcp_f32 v241, v241
v_rcp_f32 v242, v242
v_mfma_f32_16x16x32_bf16 v[208:211], v[44:47], a[196:199], v[208:211]
v_rcp_f32 v243, v243
v_mfma_f32_16x16x32_bf16 v[212:215], v[44:47], a[200:203], v[212:215]
v_mul_f32 v236, v236, v240
v_mul_f32 v237, v237, v241
v_mfma_f32_16x16x32_bf16 v[216:219], v[44:47], a[204:207], v[216:219]
buffer_load_dwordx4 v[44:47], v1, s[8:11], s29 offen offset:3072
v_mul_f32 v238, v238, v242
s_waitcnt vmcnt(11)
v_mfma_f32_16x16x32_bf16 v[204:207], v[48:51], a[208:211], v[204:207]
v_mul_f32 v239, v239, v243
v_cvt_pk_bf16_f32 v246, v236, v237
v_mfma_f32_16x16x32_bf16 v[208:211], v[48:51], a[212:215], v[208:211]
v_cvt_pk_bf16_f32 v247, v238, v239
ds_write_b64 v6, v[246:247] offset:27648
v_mfma_f32_16x16x32_bf16 v[212:215], v[48:51], a[216:219], v[212:215]
v_fma_f32 v240, v16, v224, v220
v_mfma_f32_16x16x32_bf16 v[216:219], v[48:51], a[220:223], v[216:219]
s_add_u32 s29, s22, 94208
buffer_load_dwordx4 v[48:51], v1, s[8:11], s29 offen offset:1024
v_fma_f32 v241, v16, v225, v221
v_fma_f32 v242, v16, v226, v222
v_mfma_f32_16x16x32_bf16 v[108:111], v[52:55], a[0:3], 0
s_waitcnt lgkmcnt(0)
s_barrier
ds_read_b128 a[224:227], v8 offset:20480
v_fma_f32 v243, v16, v227, v223
v_mfma_f32_16x16x32_bf16 v[112:115], v[52:55], a[4:7], 0
ds_read_b128 a[228:231], v8 offset:21504
v_fma_f32 v236, v124, v12, v240
v_fma_f32 v237, v125, v12, v241
v_mfma_f32_16x16x32_bf16 v[116:119], v[52:55], a[8:11], 0
ds_read_b128 a[232:235], v8 offset:22528
v_fma_f32 v238, v126, v12, v242
v_fma_f32 v239, v127, v12, v243
v_mfma_f32_16x16x32_bf16 v[120:123], v[52:55], a[12:15], 0
buffer_load_dwordx4 v[52:55], v1, s[8:11], s29 offen offset:2048
ds_read_b128 a[236:239], v8 offset:23552
v_mul_f32 v240, v236, v236
v_mfma_f32_16x16x32_bf16 v[108:111], v[56:59], a[16:19], v[108:111]
ds_read_b128 a[240:243], v8 offset:24576
v_mul_f32 v241, v237, v237
v_mul_f32 v242, v238, v238
v_mfma_f32_16x16x32_bf16 v[112:115], v[56:59], a[20:23], v[112:115]
ds_read_b128 a[244:247], v8 offset:25600
v_mul_f32 v243, v239, v239
v_mfma_f32_16x16x32_bf16 v[116:119], v[56:59], a[24:27], v[116:119]
ds_read_b128 a[248:251], v8 offset:26624
v_fmaak_f32 v240, v240, v9, 0xc0135761
v_fmaak_f32 v241, v241, v9, 0xc0135761
v_mfma_f32_16x16x32_bf16 v[120:123], v[56:59], a[28:31], v[120:123]
buffer_load_dwordx4 v[56:59], v1, s[8:11], s29 offen offset:3072
ds_read_b128 a[252:255], v8 offset:27648
v_fmaak_f32 v242, v242, v9, 0xc0135761
v_fmaak_f32 v243, v243, v9, 0xc0135761
s_waitcnt vmcnt(11)
v_mfma_f32_16x16x32_bf16 v[108:111], v[60:63], a[32:35], v[108:111]
v_mul_f32 v240, v236, v240
v_mfma_f32_16x16x32_bf16 v[112:115], v[60:63], a[36:39], v[112:115]
v_mul_f32 v241, v237, v241
v_mul_f32 v242, v238, v242
v_mfma_f32_16x16x32_bf16 v[116:119], v[60:63], a[40:43], v[116:119]
v_mul_f32 v243, v239, v243
v_mfma_f32_16x16x32_bf16 v[120:123], v[60:63], a[44:47], v[120:123]
s_add_u32 s29, s22, 98304
buffer_load_dwordx4 v[60:63], v1, s[8:11], s29 offen offset:0
v_exp_f32 v240, v240
v_exp_f32 v241, v241
s_waitcnt lgkmcnt(4)
v_mfma_f32_16x16x32_bf16 v[140:143], v[64:67], a[224:227], v[140:143]
v_exp_f32 v242, v242
v_exp_f32 v243, v243
v_mfma_f32_16x16x32_bf16 v[144:147], v[64:67], a[228:231], v[144:147]
v_add_f32 v240, 1.0, v240
v_mfma_f32_16x16x32_bf16 v[148:151], v[64:67], a[232:235], v[148:151]
v_add_f32 v241, 1.0, v241
v_add_f32 v242, 1.0, v242
v_mfma_f32_16x16x32_bf16 v[152:155], v[64:67], a[236:239], v[152:155]
buffer_load_dwordx4 v[64:67], v1, s[8:11], s29 offen offset:1024
v_add_f32 v243, 1.0, v243
s_waitcnt lgkmcnt(0)
v_mfma_f32_16x16x32_bf16 v[140:143], v[68:71], a[240:243], v[140:143]
v_rcp_f32 v240, v240
v_rcp_f32 v241, v241
v_mfma_f32_16x16x32_bf16 v[144:147], v[68:71], a[244:247], v[144:147]
v_rcp_f32 v242, v242
v_rcp_f32 v243, v243
v_mfma_f32_16x16x32_bf16 v[148:151], v[68:71], a[248:251], v[148:151]
v_mul_f32 v236, v236, v240
v_mfma_f32_16x16x32_bf16 v[152:155], v[68:71], a[252:255], v[152:155]
buffer_load_dwordx4 v[68:71], v1, s[8:11], s29 offen offset:2048
v_mul_f32 v237, v237, v241
v_mul_f32 v238, v238, v242
s_waitcnt vmcnt(11)
v_mfma_f32_16x16x32_bf16 v[156:159], v[72:75], a[224:227], v[156:159]
v_mul_f32 v239, v239, v243
v_mfma_f32_16x16x32_bf16 v[160:163], v[72:75], a[228:231], v[160:163]
v_cvt_pk_bf16_f32 v244, v236, v237
v_cvt_pk_bf16_f32 v245, v238, v239
v_mfma_f32_16x16x32_bf16 v[164:167], v[72:75], a[232:235], v[164:167]
ds_write_b64 v6, v[244:245] offset:32768
v_fma_f32 v240, v17, v224, v220
v_mfma_f32_16x16x32_bf16 v[168:171], v[72:75], a[236:239], v[168:171]
buffer_load_dwordx4 v[72:75], v1, s[8:11], s29 offen offset:3072
v_fma_f32 v241, v17, v225, v221
v_mfma_f32_16x16x32_bf16 v[156:159], v[20:23], a[240:243], v[156:159]
v_fma_f32 v242, v17, v226, v222
v_fma_f32 v243, v17, v227, v223
v_mfma_f32_16x16x32_bf16 v[160:163], v[20:23], a[244:247], v[160:163]
v_fma_f32 v236, v128, v13, v240
v_mfma_f32_16x16x32_bf16 v[164:167], v[20:23], a[248:251], v[164:167]
v_fma_f32 v237, v129, v13, v241
v_fma_f32 v238, v130, v13, v242
v_mfma_f32_16x16x32_bf16 v[168:171], v[20:23], a[252:255], v[168:171]
s_add_u32 s29, s22, 102400
buffer_load_dwordx4 v[20:23], v1, s[8:11], s29 offen offset:0
v_fma_f32 v239, v131, v13, v243
v_mul_f32 v240, v236, v236
v_mfma_f32_16x16x32_bf16 v[172:175], v[24:27], a[224:227], v[172:175]
v_mul_f32 v241, v237, v237
v_mfma_f32_16x16x32_bf16 v[176:179], v[24:27], a[228:231], v[176:179]
v_mul_f32 v242, v238, v238
v_mul_f32 v243, v239, v239
v_mfma_f32_16x16x32_bf16 v[180:183], v[24:27], a[232:235], v[180:183]
v_fmaak_f32 v240, v240, v9, 0xc0135761
v_mfma_f32_16x16x32_bf16 v[184:187], v[24:27], a[236:239], v[184:187]
buffer_load_dwordx4 v[24:27], v1, s[8:11], s29 offen offset:1024
v_fmaak_f32 v241, v241, v9, 0xc0135761
v_fmaak_f32 v242, v242, v9, 0xc0135761
s_waitcnt vmcnt(11)
v_mfma_f32_16x16x32_bf16 v[172:175], v[28:31], a[240:243], v[172:175]
v_fmaak_f32 v243, v243, v9, 0xc0135761
v_mul_f32 v240, v236, v240
v_mfma_f32_16x16x32_bf16 v[176:179], v[28:31], a[244:247], v[176:179]
v_mul_f32 v241, v237, v241
v_mfma_f32_16x16x32_bf16 v[180:183], v[28:31], a[248:251], v[180:183]
v_mul_f32 v242, v238, v242
v_mul_f32 v243, v239, v243
v_mfma_f32_16x16x32_bf16 v[184:187], v[28:31], a[252:255], v[184:187]
buffer_load_dwordx4 v[28:31], v1, s[8:11], s29 offen offset:2048
v_exp_f32 v240, v240
v_mfma_f32_16x16x32_bf16 v[188:191], v[32:35], a[224:227], v[188:191]
v_exp_f32 v241, v241
v_exp_f32 v242, v242
v_mfma_f32_16x16x32_bf16 v[192:195], v[32:35], a[228:231], v[192:195]
v_exp_f32 v243, v243
v_add_f32 v240, 1.0, v240
v_mfma_f32_16x16x32_bf16 v[196:199], v[32:35], a[232:235], v[196:199]
v_add_f32 v241, 1.0, v241
v_mfma_f32_16x16x32_bf16 v[200:203], v[32:35], a[236:239], v[200:203]
buffer_load_dwordx4 v[32:35], v1, s[8:11], s29 offen offset:3072
v_add_f32 v242, 1.0, v242
v_add_f32 v243, 1.0, v243
v_mfma_f32_16x16x32_bf16 v[188:191], v[36:39], a[240:243], v[188:191]
v_rcp_f32 v240, v240
v_mfma_f32_16x16x32_bf16 v[192:195], v[36:39], a[244:247], v[192:195]
v_rcp_f32 v241, v241
v_rcp_f32 v242, v242
v_mfma_f32_16x16x32_bf16 v[196:199], v[36:39], a[248:251], v[196:199]
v_rcp_f32 v243, v243
v_mul_f32 v236, v236, v240
v_mfma_f32_16x16x32_bf16 v[200:203], v[36:39], a[252:255], v[200:203]
s_add_u32 s29, s22, 106496
buffer_load_dwordx4 v[36:39], v1, s[8:11], s29 offen offset:0
v_mul_f32 v237, v237, v241
s_waitcnt vmcnt(11)
v_mfma_f32_16x16x32_bf16 v[204:207], v[40:43], a[224:227], v[204:207]
v_mul_f32 v238, v238, v242
v_mul_f32 v239, v239, v243
v_mfma_f32_16x16x32_bf16 v[208:211], v[40:43], a[228:231], v[208:211]
v_cvt_pk_bf16_f32 v246, v236, v237
v_mfma_f32_16x16x32_bf16 v[212:215], v[40:43], a[232:235], v[212:215]
v_cvt_pk_bf16_f32 v247, v238, v239
ds_write_b64 v6, v[246:247] offset:33792
v_mfma_f32_16x16x32_bf16 v[216:219], v[40:43], a[236:239], v[216:219]
buffer_load_dwordx4 v[40:43], v1, s[8:11], s29 offen offset:1024
v_fma_f32 v240, v18, v224, v220
v_fma_f32 v241, v18, v225, v221
v_mfma_f32_16x16x32_bf16 v[204:207], v[44:47], a[240:243], v[204:207]
v_fma_f32 v242, v18, v226, v222
v_mfma_f32_16x16x32_bf16 v[208:211], v[44:47], a[244:247], v[208:211]
v_fma_f32 v243, v18, v227, v223
v_fma_f32 v236, v132, v14, v240
v_mfma_f32_16x16x32_bf16 v[212:215], v[44:47], a[248:251], v[212:215]
v_fma_f32 v237, v133, v14, v241
v_mfma_f32_16x16x32_bf16 v[216:219], v[44:47], a[252:255], v[216:219]
s_add_u32 s29, s22, 110592
buffer_load_dwordx4 v[44:47], v1, s[8:11], s29 offen offset:0
v_fma_f32 v238, v134, v14, v242
v_fma_f32 v239, v135, v14, v243
v_mfma_f32_16x16x32_bf16 v[108:111], v[48:51], a[48:51], v[108:111]
v_mul_f32 v240, v236, v236
v_mul_f32 v241, v237, v237
v_mfma_f32_16x16x32_bf16 v[112:115], v[48:51], a[52:55], v[112:115]
v_mul_f32 v242, v238, v238
v_mfma_f32_16x16x32_bf16 v[116:119], v[48:51], a[56:59], v[116:119]
v_mul_f32 v243, v239, v239
v_fmaak_f32 v240, v240, v9, 0xc0135761
v_mfma_f32_16x16x32_bf16 v[120:123], v[48:51], a[60:63], v[120:123]
s_add_u32 s29, s22, 16384
buffer_load_dwordx4 v[48:51], v1, s[8:11], s29 offen offset:0
v_fmaak_f32 v241, v241, v9, 0xc0135761
s_waitcnt vmcnt(11)
v_mfma_f32_16x16x32_bf16 v[108:111], v[52:55], a[64:67], v[108:111]
v_fmaak_f32 v242, v242, v9, 0xc0135761
v_fmaak_f32 v243, v243, v9, 0xc0135761
v_mfma_f32_16x16x32_bf16 v[112:115], v[52:55], a[68:71], v[112:115]
v_mul_f32 v240, v236, v240
v_mul_f32 v241, v237, v241
v_mfma_f32_16x16x32_bf16 v[116:119], v[52:55], a[72:75], v[116:119]
v_mul_f32 v242, v238, v242
v_mfma_f32_16x16x32_bf16 v[120:123], v[52:55], a[76:79], v[120:123]
buffer_load_dwordx4 v[52:55], v1, s[8:11], s29 offen offset:1024
v_mul_f32 v243, v239, v243
v_exp_f32 v240, v240
v_mfma_f32_16x16x32_bf16 v[108:111], v[56:59], a[80:83], v[108:111]
v_exp_f32 v241, v241
v_mfma_f32_16x16x32_bf16 v[112:115], v[56:59], a[84:87], v[112:115]
v_exp_f32 v242, v242
v_exp_f32 v243, v243
v_mfma_f32_16x16x32_bf16 v[116:119], v[56:59], a[88:91], v[116:119]
v_add_f32 v240, 1.0, v240
v_add_f32 v241, 1.0, v241
v_mfma_f32_16x16x32_bf16 v[120:123], v[56:59], a[92:95], v[120:123]
s_add_u32 s29, s22, 32768
buffer_load_dwordx4 v[56:59], v1, s[8:11], s29 offen offset:2048
v_add_f32 v242, 1.0, v242
v_mfma_f32_16x16x32_bf16 v[108:111], v[60:63], a[96:99], v[108:111]
v_add_f32 v243, 1.0, v243
v_rcp_f32 v240, v240
v_mfma_f32_16x16x32_bf16 v[112:115], v[60:63], a[100:103], v[112:115]
v_rcp_f32 v241, v241
v_mfma_f32_16x16x32_bf16 v[116:119], v[60:63], a[104:107], v[116:119]
v_rcp_f32 v242, v242
v_rcp_f32 v243, v243
v_mfma_f32_16x16x32_bf16 v[120:123], v[60:63], a[108:111], v[120:123]
buffer_load_dwordx4 v[60:63], v1, s[8:11], s29 offen offset:3072
v_mul_f32 v236, v236, v240
v_mul_f32 v237, v237, v241
s_waitcnt vmcnt(11)
v_mfma_f32_16x16x32_bf16 v[108:111], v[64:67], a[112:115], v[108:111]
v_mul_f32 v238, v238, v242
v_mfma_f32_16x16x32_bf16 v[112:115], v[64:67], a[116:119], v[112:115]
v_mul_f32 v239, v239, v243
v_cvt_pk_bf16_f32 v244, v236, v237
v_mfma_f32_16x16x32_bf16 v[116:119], v[64:67], a[120:123], v[116:119]
v_cvt_pk_bf16_f32 v245, v238, v239
v_mfma_f32_16x16x32_bf16 v[120:123], v[64:67], a[124:127], v[120:123]
s_add_u32 s29, s22, 53248
buffer_load_dwordx4 v[64:67], v1, s[8:11], s29 offen offset:0
ds_write_b64 v6, v[244:245] offset:34816
v_fma_f32 v240, v19, v224, v220
v_mfma_f32_16x16x32_bf16 v[108:111], v[68:71], a[128:131], v[108:111]
v_fma_f32 v241, v19, v225, v221
v_fma_f32 v242, v19, v226, v222
v_mfma_f32_16x16x32_bf16 v[112:115], v[68:71], a[132:135], v[112:115]
v_fma_f32 v243, v19, v227, v223
v_mfma_f32_16x16x32_bf16 v[116:119], v[68:71], a[136:139], v[116:119]
v_fma_f32 v236, v136, v15, v240
v_fma_f32 v237, v137, v15, v241
v_mfma_f32_16x16x32_bf16 v[120:123], v[68:71], a[140:143], v[120:123]
buffer_load_dwordx4 v[68:71], v1, s[8:11], s29 offen offset:1024
v_fma_f32 v238, v138, v15, v242
v_mfma_f32_16x16x32_bf16 v[108:111], v[72:75], a[144:147], v[108:111]
v_fma_f32 v239, v139, v15, v243
v_mul_f32 v240, v236, v236
v_mfma_f32_16x16x32_bf16 v[112:115], v[72:75], a[148:151], v[112:115]
v_mul_f32 v241, v237, v237
v_mul_f32 v242, v238, v238
v_mfma_f32_16x16x32_bf16 v[116:119], v[72:75], a[152:155], v[116:119]
v_mul_f32 v243, v239, v239
v_mfma_f32_16x16x32_bf16 v[120:123], v[72:75], a[156:159], v[120:123]
s_add_u32 s29, s22, 69632
buffer_load_dwordx4 v[72:75], v1, s[8:11], s29 offen offset:2048
v_fmaak_f32 v240, v240, v9, 0xc0135761
v_fmaak_f32 v241, v241, v9, 0xc0135761
s_waitcnt vmcnt(11)
v_mfma_f32_16x16x32_bf16 v[108:111], v[20:23], a[160:163], v[108:111]
v_fmaak_f32 v242, v242, v9, 0xc0135761
v_mfma_f32_16x16x32_bf16 v[112:115], v[20:23], a[164:167], v[112:115]
v_fmaak_f32 v243, v243, v9, 0xc0135761
v_mul_f32 v240, v236, v240
v_mfma_f32_16x16x32_bf16 v[116:119], v[20:23], a[168:171], v[116:119]
v_mul_f32 v241, v237, v241
v_mul_f32 v242, v238, v242
v_mfma_f32_16x16x32_bf16 v[120:123], v[20:23], a[172:175], v[120:123]
buffer_load_dwordx4 v[20:23], v1, s[8:11], s29 offen offset:3072
v_mul_f32 v243, v239, v243
v_mfma_f32_16x16x32_bf16 v[108:111], v[24:27], a[176:179], v[108:111]
v_exp_f32 v240, v240
v_exp_f32 v241, v241
v_mfma_f32_16x16x32_bf16 v[112:115], v[24:27], a[180:183], v[112:115]
v_exp_f32 v242, v242
v_mfma_f32_16x16x32_bf16 v[116:119], v[24:27], a[184:187], v[116:119]
v_exp_f32 v243, v243
v_add_f32 v240, 1.0, v240
v_mfma_f32_16x16x32_bf16 v[120:123], v[24:27], a[188:191], v[120:123]
s_add_u32 s29, s22, 90112
buffer_load_dwordx4 v[24:27], v1, s[8:11], s29 offen offset:0
v_add_f32 v241, 1.0, v241
v_add_f32 v242, 1.0, v242
v_mfma_f32_16x16x32_bf16 v[108:111], v[28:31], a[192:195], v[108:111]
v_add_f32 v243, 1.0, v243
v_mfma_f32_16x16x32_bf16 v[112:115], v[28:31], a[196:199], v[112:115]
v_rcp_f32 v240, v240
v_rcp_f32 v241, v241
v_mfma_f32_16x16x32_bf16 v[116:119], v[28:31], a[200:203], v[116:119]
v_rcp_f32 v242, v242
v_mfma_f32_16x16x32_bf16 v[120:123], v[28:31], a[204:207], v[120:123]
buffer_load_dwordx4 v[28:31], v1, s[8:11], s29 offen offset:1024
v_rcp_f32 v243, v243
v_mul_f32 v236, v236, v240
s_waitcnt vmcnt(11)
v_mfma_f32_16x16x32_bf16 v[108:111], v[32:35], a[208:211], v[108:111]
v_mul_f32 v237, v237, v241
v_mul_f32 v238, v238, v242
v_mfma_f32_16x16x32_bf16 v[112:115], v[32:35], a[212:215], v[112:115]
v_mul_f32 v239, v239, v243
v_mfma_f32_16x16x32_bf16 v[116:119], v[32:35], a[216:219], v[116:119]
v_cvt_pk_bf16_f32 v246, v236, v237
v_cvt_pk_bf16_f32 v247, v238, v239
v_mfma_f32_16x16x32_bf16 v[120:123], v[32:35], a[220:223], v[120:123]
s_add_u32 s29, s22, 106496
buffer_load_dwordx4 v[32:35], v1, s[8:11], s29 offen offset:2048
ds_write_b64 v6, v[246:247] offset:35840
v_mfma_f32_16x16x32_bf16 v[108:111], v[36:39], a[224:227], v[108:111]
s_waitcnt lgkmcnt(0)
s_barrier
ds_read_b128 v[76:79], v8 offset:28672
v_mfma_f32_16x16x32_bf16 v[112:115], v[36:39], a[228:231], v[112:115]
ds_read_b128 v[80:83], v8 offset:29696
v_mfma_f32_16x16x32_bf16 v[116:119], v[36:39], a[232:235], v[116:119]
ds_read_b128 v[84:87], v8 offset:30720
v_mfma_f32_16x16x32_bf16 v[120:123], v[36:39], a[236:239], v[120:123]
buffer_load_dwordx4 v[36:39], v1, s[8:11], s29 offen offset:3072
ds_read_b128 v[88:91], v8 offset:31744
v_mfma_f32_16x16x32_bf16 v[108:111], v[40:43], a[240:243], v[108:111]
ds_read_b128 v[92:95], v8 offset:32768
v_mfma_f32_16x16x32_bf16 v[112:115], v[40:43], a[244:247], v[112:115]
ds_read_b128 v[96:99], v8 offset:33792
v_mfma_f32_16x16x32_bf16 v[116:119], v[40:43], a[248:251], v[116:119]
ds_read_b128 v[100:103], v8 offset:34816
v_mfma_f32_16x16x32_bf16 v[120:123], v[40:43], a[252:255], v[120:123]
s_add_u32 s29, s22, 110592
buffer_load_dwordx4 v[40:43], v1, s[8:11], s29 offen offset:1024
ds_read_b128 v[104:107], v8 offset:35840
s_waitcnt vmcnt(11)
v_mfma_f32_16x16x32_bf16 v[124:127], v[44:47], a[0:3], 0
v_mfma_f32_16x16x32_bf16 v[128:131], v[44:47], a[4:7], 0
v_mfma_f32_16x16x32_bf16 v[132:135], v[44:47], a[8:11], 0
v_mfma_f32_16x16x32_bf16 v[136:139], v[44:47], a[12:15], 0
buffer_load_dwordx4 v[44:47], v1, s[8:11], s29 offen offset:2048
s_waitcnt lgkmcnt(4)
v_mfma_f32_16x16x32_bf16 v[140:143], v[48:51], v[76:79], v[140:143]
v_mfma_f32_16x16x32_bf16 v[144:147], v[48:51], v[80:83], v[144:147]
v_mfma_f32_16x16x32_bf16 v[148:151], v[48:51], v[84:87], v[148:151]
v_mfma_f32_16x16x32_bf16 v[152:155], v[48:51], v[88:91], v[152:155]
buffer_load_dwordx4 v[48:51], v1, s[8:11], s29 offen offset:3072
s_waitcnt lgkmcnt(0)
v_mfma_f32_16x16x32_bf16 v[140:143], v[52:55], v[92:95], v[140:143]
v_mfma_f32_16x16x32_bf16 v[144:147], v[52:55], v[96:99], v[144:147]
v_mfma_f32_16x16x32_bf16 v[148:151], v[52:55], v[100:103], v[148:151]
v_mfma_f32_16x16x32_bf16 v[152:155], v[52:55], v[104:107], v[152:155]
s_add_u32 s29, s22, 114688
buffer_load_dwordx4 v[52:55], v1, s[8:11], s29 offen offset:0
s_waitcnt vmcnt(11)
v_mfma_f32_16x16x32_bf16 v[156:159], v[56:59], v[76:79], v[156:159]
v_mfma_f32_16x16x32_bf16 v[160:163], v[56:59], v[80:83], v[160:163]
v_mfma_f32_16x16x32_bf16 v[164:167], v[56:59], v[84:87], v[164:167]
v_cvt_pk_bf16_f32 v140, v140, v141
v_mfma_f32_16x16x32_bf16 v[168:171], v[56:59], v[88:91], v[168:171]
buffer_load_dwordx4 v[56:59], v1, s[8:11], s29 offen offset:1024
v_cvt_pk_bf16_f32 v141, v142, v143
v_cvt_pk_bf16_f32 v142, v144, v145
v_mfma_f32_16x16x32_bf16 v[156:159], v[60:63], v[92:95], v[156:159]
v_cvt_pk_bf16_f32 v143, v146, v147
v_mfma_f32_16x16x32_bf16 v[160:163], v[60:63], v[96:99], v[160:163]
v_cvt_pk_bf16_f32 v148, v148, v149
v_cvt_pk_bf16_f32 v149, v150, v151
v_mfma_f32_16x16x32_bf16 v[164:167], v[60:63], v[100:103], v[164:167]
v_cvt_pk_bf16_f32 v150, v152, v153
v_cvt_pk_bf16_f32 v151, v154, v155
v_mfma_f32_16x16x32_bf16 v[168:171], v[60:63], v[104:107], v[168:171]
buffer_load_dwordx4 v[60:63], v1, s[8:11], s29 offen offset:2048
v_mfma_f32_16x16x32_bf16 v[172:175], v[64:67], v[76:79], v[172:175]
v_mfma_f32_16x16x32_bf16 v[176:179], v[64:67], v[80:83], v[176:179]
v_mfma_f32_16x16x32_bf16 v[180:183], v[64:67], v[84:87], v[180:183]
v_cvt_pk_bf16_f32 v156, v156, v157
v_cvt_pk_bf16_f32 v157, v158, v159
v_mfma_f32_16x16x32_bf16 v[184:187], v[64:67], v[88:91], v[184:187]
buffer_load_dwordx4 v[64:67], v1, s[8:11], s29 offen offset:3072
v_cvt_pk_bf16_f32 v158, v160, v161
v_cvt_pk_bf16_f32 v159, v162, v163
s_waitcnt vmcnt(11)
v_mfma_f32_16x16x32_bf16 v[172:175], v[68:71], v[92:95], v[172:175]
v_cvt_pk_bf16_f32 v164, v164, v165
v_mfma_f32_16x16x32_bf16 v[176:179], v[68:71], v[96:99], v[176:179]
v_cvt_pk_bf16_f32 v165, v166, v167
v_cvt_pk_bf16_f32 v166, v168, v169
v_mfma_f32_16x16x32_bf16 v[180:183], v[68:71], v[100:103], v[180:183]
v_cvt_pk_bf16_f32 v167, v170, v171
v_mfma_f32_16x16x32_bf16 v[184:187], v[68:71], v[104:107], v[184:187]
s_add_u32 s29, s22, 118784
buffer_load_dwordx4 v[68:71], v1, s[8:11], s29 offen offset:0
v_mfma_f32_16x16x32_bf16 v[188:191], v[72:75], v[76:79], v[188:191]
v_mfma_f32_16x16x32_bf16 v[192:195], v[72:75], v[80:83], v[192:195]
v_mfma_f32_16x16x32_bf16 v[196:199], v[72:75], v[84:87], v[196:199]
v_cvt_pk_bf16_f32 v172, v172, v173
v_cvt_pk_bf16_f32 v173, v174, v175
v_mfma_f32_16x16x32_bf16 v[200:203], v[72:75], v[88:91], v[200:203]
buffer_load_dwordx4 v[72:75], v1, s[8:11], s29 offen offset:1024
v_cvt_pk_bf16_f32 v174, v176, v177
v_mfma_f32_16x16x32_bf16 v[188:191], v[20:23], v[92:95], v[188:191]
v_cvt_pk_bf16_f32 v175, v178, v179
v_cvt_pk_bf16_f32 v180, v180, v181
v_mfma_f32_16x16x32_bf16 v[192:195], v[20:23], v[96:99], v[192:195]
v_cvt_pk_bf16_f32 v181, v182, v183
v_cvt_pk_bf16_f32 v182, v184, v185
v_mfma_f32_16x16x32_bf16 v[196:199], v[20:23], v[100:103], v[196:199]
v_cvt_pk_bf16_f32 v183, v186, v187
v_mfma_f32_16x16x32_bf16 v[200:203], v[20:23], v[104:107], v[200:203]
buffer_load_dwordx4 v[20:23], v1, s[8:11], s29 offen offset:2048
s_add_u32 s31, s25, 0
buffer_store_dwordx4 v[140:143], v1, s[8:11], s31 offen offset:0 sc1
s_add_u32 s31, s25, 0
buffer_store_dwordx4 v[148:151], v1, s[8:11], s31 offen offset:1024 sc1
s_waitcnt vmcnt(13)
v_mfma_f32_16x16x32_bf16 v[204:207], v[24:27], v[76:79], v[204:207]
s_add_u32 s31, s25, 0
buffer_store_dwordx4 v[156:159], v1, s[8:11], s31 offen offset:2048 sc1
v_mfma_f32_16x16x32_bf16 v[208:211], v[24:27], v[80:83], v[208:211]
s_add_u32 s31, s25, 0
buffer_store_dwordx4 v[164:167], v1, s[8:11], s31 offen offset:3072 sc1
s_add_u32 s31, s25, 4096
buffer_store_dwordx4 v[172:175], v1, s[8:11], s31 offen offset:0 sc1
v_mfma_f32_16x16x32_bf16 v[212:215], v[24:27], v[84:87], v[212:215]
s_add_u32 s31, s25, 4096
buffer_store_dwordx4 v[180:183], v1, s[8:11], s31 offen offset:1024 sc1
v_cvt_pk_bf16_f32 v188, v188, v189
v_mfma_f32_16x16x32_bf16 v[216:219], v[24:27], v[88:91], v[216:219]
buffer_load_dwordx4 v[24:27], v1, s[8:11], s29 offen offset:3072
v_cvt_pk_bf16_f32 v189, v190, v191
v_mfma_f32_16x16x32_bf16 v[204:207], v[28:31], v[92:95], v[204:207]
v_cvt_pk_bf16_f32 v190, v192, v193
v_cvt_pk_bf16_f32 v191, v194, v195
v_mfma_f32_16x16x32_bf16 v[208:211], v[28:31], v[96:99], v[208:211]
v_cvt_pk_bf16_f32 v196, v196, v197
v_mfma_f32_16x16x32_bf16 v[212:215], v[28:31], v[100:103], v[212:215]
v_cvt_pk_bf16_f32 v197, v198, v199
v_cvt_pk_bf16_f32 v198, v200, v201
v_mfma_f32_16x16x32_bf16 v[216:219], v[28:31], v[104:107], v[216:219]
s_add_u32 s29, s22, 122880
buffer_load_dwordx4 v[28:31], v1, s[8:11], s29 offen offset:0
v_cvt_pk_bf16_f32 v199, v202, v203
v_mfma_f32_16x16x32_bf16 v[108:111], v[32:35], v[76:79], v[108:111]
v_mfma_f32_16x16x32_bf16 v[112:115], v[32:35], v[80:83], v[112:115]
v_mfma_f32_16x16x32_bf16 v[116:119], v[32:35], v[84:87], v[116:119]
v_cvt_pk_bf16_f32 v204, v204, v205
v_mfma_f32_16x16x32_bf16 v[120:123], v[32:35], v[88:91], v[120:123]
buffer_load_dwordx4 v[32:35], v1, s[8:11], s29 offen offset:1024
v_cvt_pk_bf16_f32 v205, v206, v207
v_cvt_pk_bf16_f32 v206, v208, v209
s_waitcnt vmcnt(17)
v_mfma_f32_16x16x32_bf16 v[108:111], v[36:39], v[92:95], v[108:111]
v_cvt_pk_bf16_f32 v207, v210, v211
v_cvt_pk_bf16_f32 v212, v212, v213
v_mfma_f32_16x16x32_bf16 v[112:115], v[36:39], v[96:99], v[112:115]
v_cvt_pk_bf16_f32 v213, v214, v215
v_mfma_f32_16x16x32_bf16 v[116:119], v[36:39], v[100:103], v[116:119]
v_cvt_pk_bf16_f32 v214, v216, v217
v_cvt_pk_bf16_f32 v215, v218, v219
v_mfma_f32_16x16x32_bf16 v[120:123], v[36:39], v[104:107], v[120:123]
buffer_load_dwordx4 v[36:39], v1, s[8:11], s29 offen offset:2048
v_mfma_f32_16x16x32_bf16 v[124:127], v[40:43], a[16:19], v[124:127]
v_mfma_f32_16x16x32_bf16 v[128:131], v[40:43], a[20:23], v[128:131]
v_mfma_f32_16x16x32_bf16 v[132:135], v[40:43], a[24:27], v[132:135]
v_cvt_pk_bf16_f32 v108, v108, v109
v_mfma_f32_16x16x32_bf16 v[136:139], v[40:43], a[28:31], v[136:139]
buffer_load_dwordx4 v[40:43], v1, s[8:11], s29 offen offset:3072
v_cvt_pk_bf16_f32 v109, v110, v111
v_cvt_pk_bf16_f32 v110, v112, v113
v_mfma_f32_16x16x32_bf16 v[124:127], v[44:47], a[32:35], v[124:127]
v_cvt_pk_bf16_f32 v111, v114, v115
v_mfma_f32_16x16x32_bf16 v[128:131], v[44:47], a[36:39], v[128:131]
v_cvt_pk_bf16_f32 v116, v116, v117
v_cvt_pk_bf16_f32 v117, v118, v119
v_mfma_f32_16x16x32_bf16 v[132:135], v[44:47], a[40:43], v[132:135]
v_cvt_pk_bf16_f32 v118, v120, v121
v_cvt_pk_bf16_f32 v119, v122, v123
v_mfma_f32_16x16x32_bf16 v[136:139], v[44:47], a[44:47], v[136:139]
s_add_u32 s29, s22, 126976
buffer_load_dwordx4 v[44:47], v1, s[8:11], s29 offen offset:0
s_add_u32 s31, s25, 4096
buffer_store_dwordx4 v[188:191], v1, s[8:11], s31 offen offset:2048 sc1
s_waitcnt vmcnt(18)
v_mfma_f32_16x16x32_bf16 v[124:127], v[48:51], a[48:51], v[124:127]
s_add_u32 s31, s25, 4096
buffer_store_dwordx4 v[196:199], v1, s[8:11], s31 offen offset:3072 sc1
s_add_u32 s31, s25, 8192
buffer_store_dwordx4 v[204:207], v1, s[8:11], s31 offen offset:0 sc1
v_mfma_f32_16x16x32_bf16 v[128:131], v[48:51], a[52:55], v[128:131]
s_add_u32 s31, s25, 8192
buffer_store_dwordx4 v[212:215], v1, s[8:11], s31 offen offset:1024 sc1
v_mfma_f32_16x16x32_bf16 v[132:135], v[48:51], a[56:59], v[132:135]
s_add_u32 s31, s25, 8192
buffer_store_dwordx4 v[108:111], v1, s[8:11], s31 offen offset:2048 sc1
s_add_u32 s31, s25, 8192
buffer_store_dwordx4 v[116:119], v1, s[8:11], s31 offen offset:3072 sc1
v_mfma_f32_16x16x32_bf16 v[136:139], v[48:51], a[60:63], v[136:139]
buffer_load_dwordx4 v[48:51], v1, s[8:11], s29 offen offset:1024
v_mfma_f32_16x16x32_bf16 v[124:127], v[52:55], a[64:67], v[124:127]
v_mfma_f32_16x16x32_bf16 v[128:131], v[52:55], a[68:71], v[128:131]
v_mfma_f32_16x16x32_bf16 v[132:135], v[52:55], a[72:75], v[132:135]
v_mfma_f32_16x16x32_bf16 v[136:139], v[52:55], a[76:79], v[136:139]
buffer_load_dwordx4 v[52:55], v1, s[8:11], s29 offen offset:2048
v_mfma_f32_16x16x32_bf16 v[124:127], v[56:59], a[80:83], v[124:127]
v_mfma_f32_16x16x32_bf16 v[128:131], v[56:59], a[84:87], v[128:131]
v_mfma_f32_16x16x32_bf16 v[132:135], v[56:59], a[88:91], v[132:135]
v_mfma_f32_16x16x32_bf16 v[136:139], v[56:59], a[92:95], v[136:139]
buffer_load_dwordx4 v[56:59], v1, s[8:11], s29 offen offset:3072
s_waitcnt vmcnt(23)
v_mfma_f32_16x16x32_bf16 v[124:127], v[60:63], a[96:99], v[124:127]
v_mfma_f32_16x16x32_bf16 v[128:131], v[60:63], a[100:103], v[128:131]
v_mfma_f32_16x16x32_bf16 v[132:135], v[60:63], a[104:107], v[132:135]
v_mfma_f32_16x16x32_bf16 v[136:139], v[60:63], a[108:111], v[136:139]
s_add_u32 s29, s22, 131072
buffer_load_dwordx4 v[60:63], v1, s[8:11], s29 offen offset:0
v_mfma_f32_16x16x32_bf16 v[124:127], v[64:67], a[112:115], v[124:127]
v_mfma_f32_16x16x32_bf16 v[128:131], v[64:67], a[116:119], v[128:131]
v_mfma_f32_16x16x32_bf16 v[132:135], v[64:67], a[120:123], v[132:135]
v_mfma_f32_16x16x32_bf16 v[136:139], v[64:67], a[124:127], v[136:139]
buffer_load_dwordx4 v[64:67], v1, s[8:11], s29 offen offset:1024
v_mfma_f32_16x16x32_bf16 v[124:127], v[68:71], a[128:131], v[124:127]
v_mfma_f32_16x16x32_bf16 v[128:131], v[68:71], a[132:135], v[128:131]
v_mfma_f32_16x16x32_bf16 v[132:135], v[68:71], a[136:139], v[132:135]
v_mfma_f32_16x16x32_bf16 v[136:139], v[68:71], a[140:143], v[136:139]
buffer_load_dwordx4 v[68:71], v1, s[8:11], s29 offen offset:2048
s_waitcnt vmcnt(17)
v_mfma_f32_16x16x32_bf16 v[124:127], v[72:75], a[144:147], v[124:127]
v_mfma_f32_16x16x32_bf16 v[128:131], v[72:75], a[148:151], v[128:131]
v_mfma_f32_16x16x32_bf16 v[132:135], v[72:75], a[152:155], v[132:135]
v_mfma_f32_16x16x32_bf16 v[136:139], v[72:75], a[156:159], v[136:139]
buffer_load_dwordx4 v[72:75], v1, s[8:11], s29 offen offset:3072
v_mfma_f32_16x16x32_bf16 v[124:127], v[20:23], a[160:163], v[124:127]
v_mfma_f32_16x16x32_bf16 v[128:131], v[20:23], a[164:167], v[128:131]
v_mfma_f32_16x16x32_bf16 v[132:135], v[20:23], a[168:171], v[132:135]
v_mfma_f32_16x16x32_bf16 v[136:139], v[20:23], a[172:175], v[136:139]
s_add_u32 s29, s22, 135168
buffer_load_dwordx4 v[20:23], v1, s[8:11], s29 offen offset:0
v_mfma_f32_16x16x32_bf16 v[124:127], v[24:27], a[176:179], v[124:127]
v_mfma_f32_16x16x32_bf16 v[128:131], v[24:27], a[180:183], v[128:131]
v_mfma_f32_16x16x32_bf16 v[132:135], v[24:27], a[184:187], v[132:135]
v_mfma_f32_16x16x32_bf16 v[136:139], v[24:27], a[188:191], v[136:139]
buffer_load_dwordx4 v[24:27], v1, s[8:11], s29 offen offset:1024
s_waitcnt vmcnt(17)
v_mfma_f32_16x16x32_bf16 v[124:127], v[28:31], a[192:195], v[124:127]
v_mfma_f32_16x16x32_bf16 v[128:131], v[28:31], a[196:199], v[128:131]
v_mfma_f32_16x16x32_bf16 v[132:135], v[28:31], a[200:203], v[132:135]
v_mfma_f32_16x16x32_bf16 v[136:139], v[28:31], a[204:207], v[136:139]
buffer_load_dwordx4 v[28:31], v1, s[8:11], s29 offen offset:2048
v_mfma_f32_16x16x32_bf16 v[124:127], v[32:35], a[208:211], v[124:127]
v_mfma_f32_16x16x32_bf16 v[128:131], v[32:35], a[212:215], v[128:131]
v_mfma_f32_16x16x32_bf16 v[132:135], v[32:35], a[216:219], v[132:135]
v_mfma_f32_16x16x32_bf16 v[136:139], v[32:35], a[220:223], v[136:139]
buffer_load_dwordx4 v[32:35], v1, s[8:11], s29 offen offset:3072
v_mfma_f32_16x16x32_bf16 v[124:127], v[36:39], a[224:227], v[124:127]
v_mfma_f32_16x16x32_bf16 v[128:131], v[36:39], a[228:231], v[128:131]
v_mfma_f32_16x16x32_bf16 v[132:135], v[36:39], a[232:235], v[132:135]
v_mfma_f32_16x16x32_bf16 v[136:139], v[36:39], a[236:239], v[136:139]
s_add_u32 s29, s22, 139264
buffer_load_dwordx4 v[36:39], v1, s[8:11], s29 offen offset:0
s_waitcnt vmcnt(11)
v_mfma_f32_16x16x32_bf16 v[124:127], v[40:43], a[240:243], v[124:127]
v_mfma_f32_16x16x32_bf16 v[128:131], v[40:43], a[244:247], v[128:131]
v_mfma_f32_16x16x32_bf16 v[132:135], v[40:43], a[248:251], v[132:135]
v_mfma_f32_16x16x32_bf16 v[136:139], v[40:43], a[252:255], v[136:139]
buffer_load_dwordx4 v[40:43], v1, s[8:11], s29 offen offset:1024
v_mfma_f32_16x16x32_bf16 v[124:127], v[44:47], v[76:79], v[124:127]
v_mfma_f32_16x16x32_bf16 v[128:131], v[44:47], v[80:83], v[128:131]
v_mfma_f32_16x16x32_bf16 v[132:135], v[44:47], v[84:87], v[132:135]
v_mfma_f32_16x16x32_bf16 v[136:139], v[44:47], v[88:91], v[136:139]
buffer_load_dwordx4 v[44:47], v1, s[8:11], s29 offen offset:2048
v_mfma_f32_16x16x32_bf16 v[124:127], v[48:51], v[92:95], v[124:127]
v_mfma_f32_16x16x32_bf16 v[128:131], v[48:51], v[96:99], v[128:131]
v_mfma_f32_16x16x32_bf16 v[132:135], v[48:51], v[100:103], v[132:135]
v_mfma_f32_16x16x32_bf16 v[136:139], v[48:51], v[104:107], v[136:139]
buffer_load_dwordx4 v[48:51], v1, s[8:11], s29 offen offset:3072
s_waitcnt vmcnt(11)
v_mfma_f32_16x16x32_bf16 v[140:143], v[52:55], a[0:3], 0
v_mfma_f32_16x16x32_bf16 v[144:147], v[52:55], a[4:7], 0
v_mfma_f32_16x16x32_bf16 v[148:151], v[52:55], a[8:11], 0
v_cvt_pk_bf16_f32 v124, v124, v125
v_cvt_pk_bf16_f32 v125, v126, v127
v_mfma_f32_16x16x32_bf16 v[152:155], v[52:55], a[12:15], 0
s_add_u32 s29, s22, 143360
buffer_load_dwordx4 v[52:55], v1, s[8:11], s29 offen offset:0
v_cvt_pk_bf16_f32 v126, v128, v129
v_cvt_pk_bf16_f32 v127, v130, v131
v_mfma_f32_16x16x32_bf16 v[140:143], v[56:59], a[16:19], v[140:143]
v_cvt_pk_bf16_f32 v132, v132, v133
v_mfma_f32_16x16x32_bf16 v[144:147], v[56:59], a[20:23], v[144:147]
v_cvt_pk_bf16_f32 v133, v134, v135
v_cvt_pk_bf16_f32 v134, v136, v137
v_mfma_f32_16x16x32_bf16 v[148:151], v[56:59], a[24:27], v[148:151]
v_cvt_pk_bf16_f32 v135, v138, v139
v_mfma_f32_16x16x32_bf16 v[152:155], v[56:59], a[28:31], v[152:155]
buffer_load_dwordx4 v[56:59], v1, s[8:11], s29 offen offset:1024
v_mfma_f32_16x16x32_bf16 v[140:143], v[60:63], a[32:35], v[140:143]
v_mfma_f32_16x16x32_bf16 v[144:147], v[60:63], a[36:39], v[144:147]
v_mfma_f32_16x16x32_bf16 v[148:151], v[60:63], a[40:43], v[148:151]
v_mfma_f32_16x16x32_bf16 v[152:155], v[60:63], a[44:47], v[152:155]
buffer_load_dwordx4 v[60:63], v1, s[8:11], s29 offen offset:2048
s_waitcnt vmcnt(11)
v_mfma_f32_16x16x32_bf16 v[140:143], v[64:67], a[48:51], v[140:143]
v_mfma_f32_16x16x32_bf16 v[144:147], v[64:67], a[52:55], v[144:147]
v_mfma_f32_16x16x32_bf16 v[148:151], v[64:67], a[56:59], v[148:151]
v_mfma_f32_16x16x32_bf16 v[152:155], v[64:67], a[60:63], v[152:155]
buffer_load_dwordx4 v[64:67], v1, s[8:11], s29 offen offset:3072
v_mfma_f32_16x16x32_bf16 v[140:143], v[68:71], a[64:67], v[140:143]
v_mfma_f32_16x16x32_bf16 v[144:147], v[68:71], a[68:71], v[144:147]
v_mfma_f32_16x16x32_bf16 v[148:151], v[68:71], a[72:75], v[148:151]
v_mfma_f32_16x16x32_bf16 v[152:155], v[68:71], a[76:79], v[152:155]
s_add_u32 s29, s22, 147456
buffer_load_dwordx4 v[68:71], v1, s[8:11], s29 offen offset:0
v_mfma_f32_16x16x32_bf16 v[140:143], v[72:75], a[80:83], v[140:143]
v_mfma_f32_16x16x32_bf16 v[144:147], v[72:75], a[84:87], v[144:147]
v_mfma_f32_16x16x32_bf16 v[148:151], v[72:75], a[88:91], v[148:151]
v_mfma_f32_16x16x32_bf16 v[152:155], v[72:75], a[92:95], v[152:155]
buffer_load_dwordx4 v[72:75], v1, s[8:11], s29 offen offset:1024
s_waitcnt vmcnt(11)
v_mfma_f32_16x16x32_bf16 v[140:143], v[20:23], a[96:99], v[140:143]
v_mfma_f32_16x16x32_bf16 v[144:147], v[20:23], a[100:103], v[144:147]
v_mfma_f32_16x16x32_bf16 v[148:151], v[20:23], a[104:107], v[148:151]
v_mfma_f32_16x16x32_bf16 v[152:155], v[20:23], a[108:111], v[152:155]
buffer_load_dwordx4 v[20:23], v1, s[8:11], s29 offen offset:2048
v_mfma_f32_16x16x32_bf16 v[140:143], v[24:27], a[112:115], v[140:143]
v_mfma_f32_16x16x32_bf16 v[144:147], v[24:27], a[116:119], v[144:147]
v_mfma_f32_16x16x32_bf16 v[148:151], v[24:27], a[120:123], v[148:151]
v_mfma_f32_16x16x32_bf16 v[152:155], v[24:27], a[124:127], v[152:155]
buffer_load_dwordx4 v[24:27], v1, s[8:11], s29 offen offset:3072
v_mfma_f32_16x16x32_bf16 v[140:143], v[28:31], a[128:131], v[140:143]
v_mfma_f32_16x16x32_bf16 v[144:147], v[28:31], a[132:135], v[144:147]
v_mfma_f32_16x16x32_bf16 v[148:151], v[28:31], a[136:139], v[148:151]
v_mfma_f32_16x16x32_bf16 v[152:155], v[28:31], a[140:143], v[152:155]
s_add_u32 s29, s22, 151552
buffer_load_dwordx4 v[28:31], v1, s[8:11], s29 offen offset:0
s_waitcnt vmcnt(11)
v_mfma_f32_16x16x32_bf16 v[140:143], v[32:35], a[144:147], v[140:143]
v_mfma_f32_16x16x32_bf16 v[144:147], v[32:35], a[148:151], v[144:147]
v_mfma_f32_16x16x32_bf16 v[148:151], v[32:35], a[152:155], v[148:151]
v_mfma_f32_16x16x32_bf16 v[152:155], v[32:35], a[156:159], v[152:155]
buffer_load_dwordx4 v[32:35], v1, s[8:11], s29 offen offset:1024
v_mfma_f32_16x16x32_bf16 v[140:143], v[36:39], a[160:163], v[140:143]
v_mfma_f32_16x16x32_bf16 v[144:147], v[36:39], a[164:167], v[144:147]
v_mfma_f32_16x16x32_bf16 v[148:151], v[36:39], a[168:171], v[148:151]
v_mfma_f32_16x16x32_bf16 v[152:155], v[36:39], a[172:175], v[152:155]
buffer_load_dwordx4 v[36:39], v1, s[8:11], s29 offen offset:2048
v_mfma_f32_16x16x32_bf16 v[140:143], v[40:43], a[176:179], v[140:143]
v_mfma_f32_16x16x32_bf16 v[144:147], v[40:43], a[180:183], v[144:147]
v_mfma_f32_16x16x32_bf16 v[148:151], v[40:43], a[184:187], v[148:151]
v_mfma_f32_16x16x32_bf16 v[152:155], v[40:43], a[188:191], v[152:155]
buffer_load_dwordx4 v[40:43], v1, s[8:11], s29 offen offset:3072
s_waitcnt vmcnt(11)
v_mfma_f32_16x16x32_bf16 v[140:143], v[44:47], a[192:195], v[140:143]
v_mfma_f32_16x16x32_bf16 v[144:147], v[44:47], a[196:199], v[144:147]
v_mfma_f32_16x16x32_bf16 v[148:151], v[44:47], a[200:203], v[148:151]
v_mfma_f32_16x16x32_bf16 v[152:155], v[44:47], a[204:207], v[152:155]
s_add_u32 s29, s22, 155648
buffer_load_dwordx4 v[44:47], v1, s[8:11], s29 offen offset:0
v_mfma_f32_16x16x32_bf16 v[140:143], v[48:51], a[208:211], v[140:143]
v_mfma_f32_16x16x32_bf16 v[144:147], v[48:51], a[212:215], v[144:147]
v_mfma_f32_16x16x32_bf16 v[148:151], v[48:51], a[216:219], v[148:151]
v_mfma_f32_16x16x32_bf16 v[152:155], v[48:51], a[220:223], v[152:155]
buffer_load_dwordx4 v[48:51], v1, s[8:11], s29 offen offset:1024
v_mfma_f32_16x16x32_bf16 v[140:143], v[52:55], a[224:227], v[140:143]
v_mfma_f32_16x16x32_bf16 v[144:147], v[52:55], a[228:231], v[144:147]
v_mfma_f32_16x16x32_bf16 v[148:151], v[52:55], a[232:235], v[148:151]
v_mfma_f32_16x16x32_bf16 v[152:155], v[52:55], a[236:239], v[152:155]
buffer_load_dwordx4 v[52:55], v1, s[8:11], s29 offen offset:2048
s_waitcnt vmcnt(11)
v_mfma_f32_16x16x32_bf16 v[140:143], v[56:59], a[240:243], v[140:143]
v_mfma_f32_16x16x32_bf16 v[144:147], v[56:59], a[244:247], v[144:147]
v_mfma_f32_16x16x32_bf16 v[148:151], v[56:59], a[248:251], v[148:151]
v_mfma_f32_16x16x32_bf16 v[152:155], v[56:59], a[252:255], v[152:155]
buffer_load_dwordx4 v[56:59], v1, s[8:11], s29 offen offset:3072
v_mfma_f32_16x16x32_bf16 v[140:143], v[60:63], v[76:79], v[140:143]
v_mfma_f32_16x16x32_bf16 v[144:147], v[60:63], v[80:83], v[144:147]
v_mfma_f32_16x16x32_bf16 v[148:151], v[60:63], v[84:87], v[148:151]
v_mfma_f32_16x16x32_bf16 v[152:155], v[60:63], v[88:91], v[152:155]
s_add_u32 s29, s22, 159744
buffer_load_dwordx4 v[60:63], v1, s[8:11], s29 offen offset:0
v_mfma_f32_16x16x32_bf16 v[140:143], v[64:67], v[92:95], v[140:143]
v_mfma_f32_16x16x32_bf16 v[144:147], v[64:67], v[96:99], v[144:147]
v_mfma_f32_16x16x32_bf16 v[148:151], v[64:67], v[100:103], v[148:151]
v_mfma_f32_16x16x32_bf16 v[152:155], v[64:67], v[104:107], v[152:155]
buffer_load_dwordx4 v[64:67], v1, s[8:11], s29 offen offset:1024
s_waitcnt vmcnt(11)
v_mfma_f32_16x16x32_bf16 v[156:159], v[68:71], a[0:3], 0
v_mfma_f32_16x16x32_bf16 v[160:163], v[68:71], a[4:7], 0
v_mfma_f32_16x16x32_bf16 v[164:167], v[68:71], a[8:11], 0
v_cvt_pk_bf16_f32 v140, v140, v141
v_mfma_f32_16x16x32_bf16 v[168:171], v[68:71], a[12:15], 0
buffer_load_dwordx4 v[68:71], v1, s[8:11], s29 offen offset:2048
v_cvt_pk_bf16_f32 v141, v142, v143
v_cvt_pk_bf16_f32 v142, v144, v145
v_mfma_f32_16x16x32_bf16 v[156:159], v[72:75], a[16:19], v[156:159]
v_cvt_pk_bf16_f32 v143, v146, v147
v_mfma_f32_16x16x32_bf16 v[160:163], v[72:75], a[20:23], v[160:163]
v_cvt_pk_bf16_f32 v148, v148, v149
v_cvt_pk_bf16_f32 v149, v150, v151
v_mfma_f32_16x16x32_bf16 v[164:167], v[72:75], a[24:27], v[164:167]
v_cvt_pk_bf16_f32 v150, v152, v153
v_cvt_pk_bf16_f32 v151, v154, v155
v_mfma_f32_16x16x32_bf16 v[168:171], v[72:75], a[28:31], v[168:171]
buffer_load_dwordx4 v[72:75], v1, s[8:11], s29 offen offset:3072
s_add_u32 s31, s25, 12288
buffer_store_dwordx4 v[124:127], v1, s[8:11], s31 offen offset:0 sc1
v_mfma_f32_16x16x32_bf16 v[156:159], v[20:23], a[32:35], v[156:159]
s_add_u32 s31, s25, 12288
buffer_store_dwordx4 v[132:135], v1, s[8:11], s31 offen offset:1024 sc1
s_add_u32 s31, s25, 12288
buffer_store_dwordx4 v[140:143], v1, s[8:11], s31 offen offset:2048 sc1
v_mfma_f32_16x16x32_bf16 v[160:163], v[20:23], a[36:39], v[160:163]
s_add_u32 s31, s25, 12288
buffer_store_dwordx4 v[148:151], v1, s[8:11], s31 offen offset:3072 sc1
v_mfma_f32_16x16x32_bf16 v[164:167], v[20:23], a[40:43], v[164:167]
v_mfma_f32_16x16x32_bf16 v[168:171], v[20:23], a[44:47], v[168:171]
s_add_u32 s29, s22, 163840
buffer_load_dwordx4 v[20:23], v1, s[8:11], s29 offen offset:0
s_waitcnt vmcnt(15)
v_mfma_f32_16x16x32_bf16 v[156:159], v[24:27], a[48:51], v[156:159]
v_mfma_f32_16x16x32_bf16 v[160:163], v[24:27], a[52:55], v[160:163]
v_mfma_f32_16x16x32_bf16 v[164:167], v[24:27], a[56:59], v[164:167]
v_mfma_f32_16x16x32_bf16 v[168:171], v[24:27], a[60:63], v[168:171]
buffer_load_dwordx4 v[24:27], v1, s[8:11], s29 offen offset:1024
v_mfma_f32_16x16x32_bf16 v[156:159], v[28:31], a[64:67], v[156:159]
v_mfma_f32_16x16x32_bf16 v[160:163], v[28:31], a[68:71], v[160:163]
v_mfma_f32_16x16x32_bf16 v[164:167], v[28:31], a[72:75], v[164:167]
v_mfma_f32_16x16x32_bf16 v[168:171], v[28:31], a[76:79], v[168:171]
v_mfma_f32_16x16x32_bf16 v[156:159], v[32:35], a[80:83], v[156:159]
v_mfma_f32_16x16x32_bf16 v[160:163], v[32:35], a[84:87], v[160:163]
v_mfma_f32_16x16x32_bf16 v[164:167], v[32:35], a[88:91], v[164:167]
v_mfma_f32_16x16x32_bf16 v[168:171], v[32:35], a[92:95], v[168:171]
s_waitcnt vmcnt(13)
v_mfma_f32_16x16x32_bf16 v[156:159], v[36:39], a[96:99], v[156:159]
v_mfma_f32_16x16x32_bf16 v[160:163], v[36:39], a[100:103], v[160:163]
v_mfma_f32_16x16x32_bf16 v[164:167], v[36:39], a[104:107], v[164:167]
v_mfma_f32_16x16x32_bf16 v[168:171], v[36:39], a[108:111], v[168:171]
v_mfma_f32_16x16x32_bf16 v[156:159], v[40:43], a[112:115], v[156:159]
v_mfma_f32_16x16x32_bf16 v[160:163], v[40:43], a[116:119], v[160:163]
v_mfma_f32_16x16x32_bf16 v[164:167], v[40:43], a[120:123], v[164:167]
v_mfma_f32_16x16x32_bf16 v[168:171], v[40:43], a[124:127], v[168:171]
v_mfma_f32_16x16x32_bf16 v[156:159], v[44:47], a[128:131], v[156:159]
v_mfma_f32_16x16x32_bf16 v[160:163], v[44:47], a[132:135], v[160:163]
v_mfma_f32_16x16x32_bf16 v[164:167], v[44:47], a[136:139], v[164:167]
v_mfma_f32_16x16x32_bf16 v[168:171], v[44:47], a[140:143], v[168:171]
s_waitcnt vmcnt(10)
v_mfma_f32_16x16x32_bf16 v[156:159], v[48:51], a[144:147], v[156:159]
v_mfma_f32_16x16x32_bf16 v[160:163], v[48:51], a[148:151], v[160:163]
v_mfma_f32_16x16x32_bf16 v[164:167], v[48:51], a[152:155], v[164:167]
v_mfma_f32_16x16x32_bf16 v[168:171], v[48:51], a[156:159], v[168:171]
v_mfma_f32_16x16x32_bf16 v[156:159], v[52:55], a[160:163], v[156:159]
v_mfma_f32_16x16x32_bf16 v[160:163], v[52:55], a[164:167], v[160:163]
v_mfma_f32_16x16x32_bf16 v[164:167], v[52:55], a[168:171], v[164:167]
v_mfma_f32_16x16x32_bf16 v[168:171], v[52:55], a[172:175], v[168:171]
v_mfma_f32_16x16x32_bf16 v[156:159], v[56:59], a[176:179], v[156:159]
v_mfma_f32_16x16x32_bf16 v[160:163], v[56:59], a[180:183], v[160:163]
v_mfma_f32_16x16x32_bf16 v[164:167], v[56:59], a[184:187], v[164:167]
v_mfma_f32_16x16x32_bf16 v[168:171], v[56:59], a[188:191], v[168:171]
s_waitcnt vmcnt(7)
v_mfma_f32_16x16x32_bf16 v[156:159], v[60:63], a[192:195], v[156:159]
v_mfma_f32_16x16x32_bf16 v[160:163], v[60:63], a[196:199], v[160:163]
v_mfma_f32_16x16x32_bf16 v[164:167], v[60:63], a[200:203], v[164:167]
v_mfma_f32_16x16x32_bf16 v[168:171], v[60:63], a[204:207], v[168:171]
v_mfma_f32_16x16x32_bf16 v[156:159], v[64:67], a[208:211], v[156:159]
v_mfma_f32_16x16x32_bf16 v[160:163], v[64:67], a[212:215], v[160:163]
v_mfma_f32_16x16x32_bf16 v[164:167], v[64:67], a[216:219], v[164:167]
v_mfma_f32_16x16x32_bf16 v[168:171], v[64:67], a[220:223], v[168:171]
v_mfma_f32_16x16x32_bf16 v[156:159], v[68:71], a[224:227], v[156:159]
v_mfma_f32_16x16x32_bf16 v[160:163], v[68:71], a[228:231], v[160:163]
v_mfma_f32_16x16x32_bf16 v[164:167], v[68:71], a[232:235], v[164:167]
v_mfma_f32_16x16x32_bf16 v[168:171], v[68:71], a[236:239], v[168:171]
s_waitcnt vmcnt(0)
v_mfma_f32_16x16x32_bf16 v[156:159], v[72:75], a[240:243], v[156:159]
v_mfma_f32_16x16x32_bf16 v[160:163], v[72:75], a[244:247], v[160:163]
v_mfma_f32_16x16x32_bf16 v[164:167], v[72:75], a[248:251], v[164:167]
v_mfma_f32_16x16x32_bf16 v[168:171], v[72:75], a[252:255], v[168:171]
v_mfma_f32_16x16x32_bf16 v[156:159], v[20:23], v[76:79], v[156:159]
v_mfma_f32_16x16x32_bf16 v[160:163], v[20:23], v[80:83], v[160:163]
v_mfma_f32_16x16x32_bf16 v[164:167], v[20:23], v[84:87], v[164:167]
v_mfma_f32_16x16x32_bf16 v[168:171], v[20:23], v[88:91], v[168:171]
v_mfma_f32_16x16x32_bf16 v[156:159], v[24:27], v[92:95], v[156:159]
v_mfma_f32_16x16x32_bf16 v[160:163], v[24:27], v[96:99], v[160:163]
v_mfma_f32_16x16x32_bf16 v[164:167], v[24:27], v[100:103], v[164:167]
v_mfma_f32_16x16x32_bf16 v[168:171], v[24:27], v[104:107], v[168:171]
s_nop 4
v_cvt_pk_bf16_f32 v156, v156, v157
v_cvt_pk_bf16_f32 v157, v158, v159
v_cvt_pk_bf16_f32 v158, v160, v161
v_cvt_pk_bf16_f32 v159, v162, v163
v_cvt_pk_bf16_f32 v164, v164, v165
v_cvt_pk_bf16_f32 v165, v166, v167
v_cvt_pk_bf16_f32 v166, v168, v169
v_cvt_pk_bf16_f32 v167, v170, v171
s_add_u32 s31, s25, 16384
buffer_store_dwordx4 v[156:159], v1, s[8:11], s31 offen offset:0 sc1
s_add_u32 s31, s25, 16384
buffer_store_dwordx4 v[164:167], v1, s[8:11], s31 offen offset:1024 sc1
k4_kernel_end:
s_lshl_b32 s52, s13, 3
s_add_u32 s53, s52, s14
s_lshl_b32 s53, s53, 2
s_add_u32 s53, s53, 39848960
s_waitcnt vmcnt(0) lgkmcnt(0)
s_barrier
s_cmp_lg_u32 s12, 0
s_cbranch_scc1 sig_31
v_mov_b32 v12, s96
v_mov_b32 v13, 0
s_mov_b64 exec, 1
buffer_store_dword v12, v13, s[8:11], s53 offen sc1
s_mov_b64 exec, -1
sig_31:
s_lshl_b32 s52, s52, 2
s_add_u32 s52, s52, 39848960
s_mul_i32 s54, s13, 36
s_lshl_b32 s55, s12, 3
s_add_u32 s55, s55, s14
s_add_u32 s23, s54, s55
s_mov_b32 s56, s12
s_mov_b32 s57, s14
s_branch P5_start
s_nop 7
s_nop 7
P5_start:
s_load_dwordx2 s[4:5], s[0:1], 80
s_load_dwordx2 s[6:7], s[0:1], 64
s_load_dwordx2 s[20:21], s[0:1], 56
v_and_b32 v1, 63, v0
v_lshlrev_b32 v3, 4, v1
s_mul_hi_u32 s24, s23, 119304648
s_mul_i32 s25, s24, 36
s_sub_u32 s25, s23, s25
s_cmp_ge_u32 s25, 18
s_cselect_b32 s26, 1, 0
s_mul_i32 s27, s26, 18
s_sub_u32 s27, s25, s27
s_mul_i32 s28, s24, 73728
s_lshl_b32 s29, s27, 1
s_add_u32 s29, s29, 0
s_mul_hi_u32 s30, s29, 477218589
s_mul_i32 s31, s30, 9
s_sub_u32 s31, s29, s31
s_mul_i32 s30, s30, 18432
s_lshl_b32 s31, s31, 1
s_add_u32 s31, s31, s26
s_lshl_b32 s31, s31, 10
s_add_u32 s32, s30, s31
s_add_u32 s32, s32, s28
s_add_u32 s32, s32, 20578304
s_lshl_b32 s29, s27, 1
s_add_u32 s29, s29, 1
s_mul_hi_u32 s30, s29, 477218589
s_mul_i32 s31, s30, 9
s_sub_u32 s31, s29, s31
s_mul_i32 s30, s30, 18432
s_lshl_b32 s31, s31, 1
s_add_u32 s31, s31, s26
s_lshl_b32 s31, s31, 10
s_add_u32 s33, s30, s31
s_add_u32 s33, s33, s28
s_add_u32 s33, s33, 20578304
s_mul_i32 s30, s26, 36864
s_lshl_b32 s31, s27, 10
s_add_u32 s34, s30, s31
s_add_u32 s34, s34, s28
s_add_u32 s34, s34, 4980736
s_add_u32 s35, s34, 18432
s_lshl_b32 s36, s27, 6
s_lshl_b32 s37, s24, 1
s_add_u32 s37, s37, s26
s_mul_i32 s37, s37, 1152
s_add_u32 s37, s37, s36
s_add_u32 s38, s37, 1179648
v_lshrrev_b32 v4, 4, v1
v_lshlrev_b32 v5, 4, v4
v_and_b32 v6, 15, v1
v_mul_u32_u24 v6, 73728, v6
v_add_u32 v6, v6, v5
s_mov_b32 s40, 0x00003f80
s_mov_b32 s41, 0x3f800000
s_waitcnt lgkmcnt(0)
s_mov_b32 s8, s4
s_and_b32 s9, s5, 0xffff
s_mov_b32 s10, 39878656
s_mov_b32 s11, 0x20000
s_mov_b32 s12, s6
s_and_b32 s13, s7, 0xffff
s_mov_b32 s14, 2359296
s_mov_b32 s15, 0x20000
s_mov_b32 s16, s20
s_and_b32 s17, s21, 0xffff
s_mov_b32 s18, 1152
s_mov_b32 s19, 0x20000
s_cmp_lg_u32 s56, 0
s_cbranch_scc1 w_32
v_and_b32 v12, 7, v0
v_lshlrev_b32 v12, 2, v12
s_mov_b32 s97, 0
poll_33:
buffer_load_dword v13, v12, s[8:11], s52 offen sc1
s_waitcnt vmcnt(0)
v_cmp_ne_u32 vcc, s96, v13
s_add_u32 s97, s97, 1
s_cmp_gt_u32 s97, 200000
s_cbranch_scc1 poll_33_d
s_cmp_eq_u64 vcc, 0
s_cbranch_scc1 poll_33_d
s_sleep 2
s_branch poll_33
poll_33_d:
w_32:
s_barrier
s_cmp_lg_u32 s56, 0
s_cbranch_scc1 P5_one
s_cmp_ge_u32 s57, 4
s_cbranch_scc1 P5_one
s_add_u32 s23, s54, s57
s_add_u32 s23, s23, 32
s_mul_hi_u32 s24, s23, 119304648
s_mul_i32 s25, s24, 36
s_sub_u32 s25, s23, s25
s_cmp_ge_u32 s25, 18
s_cselect_b32 s26, 1, 0
s_mul_i32 s27, s26, 18
s_sub_u32 s27, s25, s27
s_mul_i32 s28, s24, 73728
s_lshl_b32 s29, s27, 1
s_add_u32 s29, s29, 0
s_mul_hi_u32 s30, s29, 477218589
s_mul_i32 s31, s30, 9
s_sub_u32 s31, s29, s31
s_mul_i32 s30, s30, 18432
s_lshl_b32 s31, s31, 1
s_add_u32 s31, s31, s26
s_lshl_b32 s31, s31, 10
s_add_u32 s44, s30, s31
s_add_u32 s44, s44, s28
s_add_u32 s44, s44, 20578304
s_lshl_b32 s29, s27, 1
s_add_u32 s29, s29, 1
s_mul_hi_u32 s30, s29, 477218589
s_mul_i32 s31, s30, 9
s_sub_u32 s31, s29, s31
s_mul_i32 s30, s30, 18432
s_lshl_b32 s31, s31, 1
s_add_u32 s31, s31, s26
s_lshl_b32 s31, s31, 10
s_add_u32 s45, s30, s31
s_add_u32 s45, s45, s28
s_add_u32 s45, s45, 20578304
s_mul_i32 s30, s26, 36864
s_lshl_b32 s31, s27, 10
s_add_u32 s46, s30, s31
s_add_u32 s46, s46, s28
s_add_u32 s46, s46, 4980736
s_add_u32 s47, s46, 18432
s_lshl_b32 s48, s27, 6
s_lshl_b32 s49, s24, 1
s_add_u32 s49, s49, s26
s_mul_i32 s49, s49, 1152
s_add_u32 s49, s49, s48
s_add_u32 s50, s49, 1179648
buffer_load_dwordx4 v[16:19], v3, s[8:11], s32 offen sc1
buffer_load_dwordx4 v[20:23], v3, s[8:11], s33 offen sc1
s_add_u32 s32, s32, 2359296
s_add_u32 s33, s33, 2359296
buffer_load_dwordx4 v[24:27], v3, s[8:11], s32 offen sc1
buffer_load_dwordx4 v[28:31], v3, s[8:11], s33 offen sc1
s_add_u32 s32, s32, 2359296
s_add_u32 s33, s33, 2359296
buffer_load_dwordx4 v[32:35], v3, s[8:11], s32 offen sc1
buffer_load_dwordx4 v[36:39], v3, s[8:11], s33 offen sc1
s_add_u32 s32, s32, 2359296
s_add_u32 s33, s33, 2359296
buffer_load_dwordx4 v[40:43], v3, s[8:11], s32 offen sc1
buffer_load_dwordx4 v[44:47], v3, s[8:11], s33 offen sc1
s_add_u32 s32, s32, 2359296
s_add_u32 s33, s33, 2359296
buffer_load_dwordx4 v[48:51], v3, s[8:11], s32 offen sc1
buffer_load_dwordx4 v[52:55], v3, s[8:11], s33 offen sc1
s_add_u32 s32, s32, 2359296
s_add_u32 s33, s33, 2359296
buffer_load_dwordx4 v[56:59], v3, s[8:11], s32 offen sc1
buffer_load_dwordx4 v[60:63], v3, s[8:11], s33 offen sc1
s_add_u32 s32, s32, 2359296
s_add_u32 s33, s33, 2359296
buffer_load_dwordx4 v[64:67], v3, s[8:11], s32 offen sc1
buffer_load_dwordx4 v[68:71], v3, s[8:11], s33 offen sc1
s_add_u32 s32, s32, 2359296
s_add_u32 s33, s33, 2359296
buffer_load_dwordx4 v[72:75], v3, s[8:11], s32 offen sc1
buffer_load_dwordx4 v[76:79], v3, s[8:11], s33 offen sc1
buffer_load_dwordx4 v[80:83], v3, s[8:11], s34 offen sc1
buffer_load_dwordx4 v[84:87], v3, s[8:11], s35 offen sc1
buffer_load_dwordx4 v[88:91], v5, s[16:19], s36 offen
buffer_load_dwordx4 v[92:95], v3, s[8:11], s44 offen sc1
buffer_load_dwordx4 v[96:99], v3, s[8:11], s45 offen sc1
s_add_u32 s44, s44, 2359296
s_add_u32 s45, s45, 2359296
buffer_load_dwordx4 v[100:103], v3, s[8:11], s44 offen sc1
buffer_load_dwordx4 v[104:107], v3, s[8:11], s45 offen sc1
s_add_u32 s44, s44, 2359296
s_add_u32 s45, s45, 2359296
buffer_load_dwordx4 v[108:111], v3, s[8:11], s44 offen sc1
buffer_load_dwordx4 v[112:115], v3, s[8:11], s45 offen sc1
s_add_u32 s44, s44, 2359296
s_add_u32 s45, s45, 2359296
buffer_load_dwordx4 v[116:119], v3, s[8:11], s44 offen sc1
buffer_load_dwordx4 v[120:123], v3, s[8:11], s45 offen sc1
s_add_u32 s44, s44, 2359296
s_add_u32 s45, s45, 2359296
buffer_load_dwordx4 v[124:127], v3, s[8:11], s44 offen sc1
buffer_load_dwordx4 v[128:131], v3, s[8:11], s45 offen sc1
s_add_u32 s44, s44, 2359296
s_add_u32 s45, s45, 2359296
buffer_load_dwordx4 v[132:135], v3, s[8:11], s44 offen sc1
buffer_load_dwordx4 v[136:139], v3, s[8:11], s45 offen sc1
s_add_u32 s44, s44, 2359296
s_add_u32 s45, s45, 2359296
buffer_load_dwordx4 v[140:143], v3, s[8:11], s44 offen sc1
buffer_load_dwordx4 v[144:147], v3, s[8:11], s45 offen sc1
s_add_u32 s44, s44, 2359296
s_add_u32 s45, s45, 2359296
buffer_load_dwordx4 v[148:151], v3, s[8:11], s44 offen sc1
buffer_load_dwordx4 v[152:155], v3, s[8:11], s45 offen sc1
buffer_load_dwordx4 v[156:159], v3, s[8:11], s46 offen sc1
buffer_load_dwordx4 v[160:163], v3, s[8:11], s47 offen sc1
buffer_load_dwordx4 v[164:167], v5, s[16:19], s48 offen
s_waitcnt vmcnt(36)
v_dot2_f32_bf16 v168, v16, s40, 0
v_dot2_f32_bf16 v169, v16, s41, 0
v_dot2_f32_bf16 v170, v17, s40, 0
v_dot2_f32_bf16 v171, v17, s41, 0
v_dot2_f32_bf16 v172, v18, s40, 0
v_dot2_f32_bf16 v173, v18, s41, 0
v_dot2_f32_bf16 v174, v19, s40, 0
v_dot2_f32_bf16 v175, v19, s41, 0
v_dot2_f32_bf16 v176, v20, s40, 0
v_dot2_f32_bf16 v177, v20, s41, 0
v_dot2_f32_bf16 v178, v21, s40, 0
v_dot2_f32_bf16 v179, v21, s41, 0
v_dot2_f32_bf16 v180, v22, s40, 0
v_dot2_f32_bf16 v181, v22, s41, 0
v_dot2_f32_bf16 v182, v23, s40, 0
v_dot2_f32_bf16 v183, v23, s41, 0
s_waitcnt vmcnt(34)
v_dot2_f32_bf16 v168, v24, s40, v168
v_dot2_f32_bf16 v169, v24, s41, v169
v_dot2_f32_bf16 v170, v25, s40, v170
v_dot2_f32_bf16 v171, v25, s41, v171
v_dot2_f32_bf16 v172, v26, s40, v172
v_dot2_f32_bf16 v173, v26, s41, v173
v_dot2_f32_bf16 v174, v27, s40, v174
v_dot2_f32_bf16 v175, v27, s41, v175
v_dot2_f32_bf16 v176, v28, s40, v176
v_dot2_f32_bf16 v177, v28, s41, v177
v_dot2_f32_bf16 v178, v29, s40, v178
v_dot2_f32_bf16 v179, v29, s41, v179
v_dot2_f32_bf16 v180, v30, s40, v180
v_dot2_f32_bf16 v181, v30, s41, v181
v_dot2_f32_bf16 v182, v31, s40, v182
v_dot2_f32_bf16 v183, v31, s41, v183
s_waitcnt vmcnt(32)
v_dot2_f32_bf16 v168, v32, s40, v168
v_dot2_f32_bf16 v169, v32, s41, v169
v_dot2_f32_bf16 v170, v33, s40, v170
v_dot2_f32_bf16 v171, v33, s41, v171
v_dot2_f32_bf16 v172, v34, s40, v172
v_dot2_f32_bf16 v173, v34, s41, v173
v_dot2_f32_bf16 v174, v35, s40, v174
v_dot2_f32_bf16 v175, v35, s41, v175
v_dot2_f32_bf16 v176, v36, s40, v176
v_dot2_f32_bf16 v177, v36, s41, v177
v_dot2_f32_bf16 v178, v37, s40, v178
v_dot2_f32_bf16 v179, v37, s41, v179
v_dot2_f32_bf16 v180, v38, s40, v180
v_dot2_f32_bf16 v181, v38, s41, v181
v_dot2_f32_bf16 v182, v39, s40, v182
v_dot2_f32_bf16 v183, v39, s41, v183
s_waitcnt vmcnt(30)
v_dot2_f32_bf16 v168, v40, s40, v168
v_dot2_f32_bf16 v169, v40, s41, v169
v_dot2_f32_bf16 v170, v41, s40, v170
v_dot2_f32_bf16 v171, v41, s41, v171
v_dot2_f32_bf16 v172, v42, s40, v172
v_dot2_f32_bf16 v173, v42, s41, v173
v_dot2_f32_bf16 v174, v43, s40, v174
v_dot2_f32_bf16 v175, v43, s41, v175
v_dot2_f32_bf16 v176, v44, s40, v176
v_dot2_f32_bf16 v177, v44, s41, v177
v_dot2_f32_bf16 v178, v45, s40, v178
v_dot2_f32_bf16 v179, v45, s41, v179
v_dot2_f32_bf16 v180, v46, s40, v180
v_dot2_f32_bf16 v181, v46, s41, v181
v_dot2_f32_bf16 v182, v47, s40, v182
v_dot2_f32_bf16 v183, v47, s41, v183
s_waitcnt vmcnt(28)
v_dot2_f32_bf16 v168, v48, s40, v168
v_dot2_f32_bf16 v169, v48, s41, v169
v_dot2_f32_bf16 v170, v49, s40, v170
v_dot2_f32_bf16 v171, v49, s41, v171
v_dot2_f32_bf16 v172, v50, s40, v172
v_dot2_f32_bf16 v173, v50, s41, v173
v_dot2_f32_bf16 v174, v51, s40, v174
v_dot2_f32_bf16 v175, v51, s41, v175
v_dot2_f32_bf16 v176, v52, s40, v176
v_dot2_f32_bf16 v177, v52, s41, v177
v_dot2_f32_bf16 v178, v53, s40, v178
v_dot2_f32_bf16 v179, v53, s41, v179
v_dot2_f32_bf16 v180, v54, s40, v180
v_dot2_f32_bf16 v181, v54, s41, v181
v_dot2_f32_bf16 v182, v55, s40, v182
v_dot2_f32_bf16 v183, v55, s41, v183
s_waitcnt vmcnt(26)
v_dot2_f32_bf16 v168, v56, s40, v168
v_dot2_f32_bf16 v169, v56, s41, v169
v_dot2_f32_bf16 v170, v57, s40, v170
v_dot2_f32_bf16 v171, v57, s41, v171
v_dot2_f32_bf16 v172, v58, s40, v172
v_dot2_f32_bf16 v173, v58, s41, v173
v_dot2_f32_bf16 v174, v59, s40, v174
v_dot2_f32_bf16 v175, v59, s41, v175
v_dot2_f32_bf16 v176, v60, s40, v176
v_dot2_f32_bf16 v177, v60, s41, v177
v_dot2_f32_bf16 v178, v61, s40, v178
v_dot2_f32_bf16 v179, v61, s41, v179
v_dot2_f32_bf16 v180, v62, s40, v180
v_dot2_f32_bf16 v181, v62, s41, v181
v_dot2_f32_bf16 v182, v63, s40, v182
v_dot2_f32_bf16 v183, v63, s41, v183
s_waitcnt vmcnt(24)
v_dot2_f32_bf16 v168, v64, s40, v168
v_dot2_f32_bf16 v169, v64, s41, v169
v_dot2_f32_bf16 v170, v65, s40, v170
v_dot2_f32_bf16 v171, v65, s41, v171
v_dot2_f32_bf16 v172, v66, s40, v172
v_dot2_f32_bf16 v173, v66, s41, v173
v_dot2_f32_bf16 v174, v67, s40, v174
v_dot2_f32_bf16 v175, v67, s41, v175
v_dot2_f32_bf16 v176, v68, s40, v176
v_dot2_f32_bf16 v177, v68, s41, v177
v_dot2_f32_bf16 v178, v69, s40, v178
v_dot2_f32_bf16 v179, v69, s41, v179
v_dot2_f32_bf16 v180, v70, s40, v180
v_dot2_f32_bf16 v181, v70, s41, v181
v_dot2_f32_bf16 v182, v71, s40, v182
v_dot2_f32_bf16 v183, v71, s41, v183
s_waitcnt vmcnt(22)
v_dot2_f32_bf16 v168, v72, s40, v168
v_dot2_f32_bf16 v169, v72, s41, v169
v_dot2_f32_bf16 v170, v73, s40, v170
v_dot2_f32_bf16 v171, v73, s41, v171
v_dot2_f32_bf16 v172, v74, s40, v172
v_dot2_f32_bf16 v173, v74, s41, v173
v_dot2_f32_bf16 v174, v75, s40, v174
v_dot2_f32_bf16 v175, v75, s41, v175
v_dot2_f32_bf16 v176, v76, s40, v176
v_dot2_f32_bf16 v177, v76, s41, v177
v_dot2_f32_bf16 v178, v77, s40, v178
v_dot2_f32_bf16 v179, v77, s41, v179
v_dot2_f32_bf16 v180, v78, s40, v180
v_dot2_f32_bf16 v181, v78, s41, v181
v_dot2_f32_bf16 v182, v79, s40, v182
v_dot2_f32_bf16 v183, v79, s41, v183
s_waitcnt vmcnt(19)
v_cvt_pk_bf16_f32 v16, v168, v169
v_lshlrev_b32 v17, 16, v16
v_and_b32 v18, 0xffff0000, v16
v_lshlrev_b32 v19, 16, v88
v_and_b32 v20, 0xffff0000, v88
v_add_f32 v17, v17, v19
v_add_f32 v18, v18, v20
v_cvt_pk_bf16_f32 v16, v17, v18
v_lshlrev_b32 v17, 16, v16
v_and_b32 v18, 0xffff0000, v16
v_lshlrev_b32 v19, 16, v80
v_and_b32 v20, 0xffff0000, v80
v_add_f32 v17, v17, v19
v_add_f32 v18, v18, v20
v_cvt_pk_bf16_f32 v184, v17, v18
v_cvt_pk_bf16_f32 v24, v170, v171
v_lshlrev_b32 v25, 16, v24
v_and_b32 v26, 0xffff0000, v24
v_lshlrev_b32 v27, 16, v89
v_and_b32 v28, 0xffff0000, v89
v_add_f32 v25, v25, v27
v_add_f32 v26, v26, v28
v_cvt_pk_bf16_f32 v24, v25, v26
v_lshlrev_b32 v25, 16, v24
v_and_b32 v26, 0xffff0000, v24
v_lshlrev_b32 v27, 16, v81
v_and_b32 v28, 0xffff0000, v81
v_add_f32 v25, v25, v27
v_add_f32 v26, v26, v28
v_cvt_pk_bf16_f32 v185, v25, v26
v_cvt_pk_bf16_f32 v16, v176, v177
v_lshlrev_b32 v17, 16, v16
v_and_b32 v18, 0xffff0000, v16
v_lshlrev_b32 v19, 16, v90
v_and_b32 v20, 0xffff0000, v90
v_add_f32 v17, v17, v19
v_add_f32 v18, v18, v20
v_cvt_pk_bf16_f32 v16, v17, v18
v_lshlrev_b32 v17, 16, v16
v_and_b32 v18, 0xffff0000, v16
v_lshlrev_b32 v19, 16, v82
v_and_b32 v20, 0xffff0000, v82
v_add_f32 v17, v17, v19
v_add_f32 v18, v18, v20
v_cvt_pk_bf16_f32 v186, v17, v18
v_cvt_pk_bf16_f32 v24, v178, v179
v_lshlrev_b32 v25, 16, v24
v_and_b32 v26, 0xffff0000, v24
v_lshlrev_b32 v27, 16, v91
v_and_b32 v28, 0xffff0000, v91
v_add_f32 v25, v25, v27
v_add_f32 v26, v26, v28
v_cvt_pk_bf16_f32 v24, v25, v26
v_lshlrev_b32 v25, 16, v24
v_and_b32 v26, 0xffff0000, v24
v_lshlrev_b32 v27, 16, v83
v_and_b32 v28, 0xffff0000, v83
v_add_f32 v25, v25, v27
v_add_f32 v26, v26, v28
v_cvt_pk_bf16_f32 v187, v25, v26
buffer_store_dwordx4 v[184:187], v6, s[12:15], s37 offen
v_cvt_pk_bf16_f32 v16, v172, v173
v_lshlrev_b32 v17, 16, v16
v_and_b32 v18, 0xffff0000, v16
v_lshlrev_b32 v19, 16, v88
v_and_b32 v20, 0xffff0000, v88
v_add_f32 v17, v17, v19
v_add_f32 v18, v18, v20
v_cvt_pk_bf16_f32 v16, v17, v18
v_lshlrev_b32 v17, 16, v16
v_and_b32 v18, 0xffff0000, v16
v_lshlrev_b32 v19, 16, v84
v_and_b32 v20, 0xffff0000, v84
v_add_f32 v17, v17, v19
v_add_f32 v18, v18, v20
v_cvt_pk_bf16_f32 v188, v17, v18
v_cvt_pk_bf16_f32 v24, v174, v175
v_lshlrev_b32 v25, 16, v24
v_and_b32 v26, 0xffff0000, v24
v_lshlrev_b32 v27, 16, v89
v_and_b32 v28, 0xffff0000, v89
v_add_f32 v25, v25, v27
v_add_f32 v26, v26, v28
v_cvt_pk_bf16_f32 v24, v25, v26
v_lshlrev_b32 v25, 16, v24
v_and_b32 v26, 0xffff0000, v24
v_lshlrev_b32 v27, 16, v85
v_and_b32 v28, 0xffff0000, v85
v_add_f32 v25, v25, v27
v_add_f32 v26, v26, v28
v_cvt_pk_bf16_f32 v189, v25, v26
v_cvt_pk_bf16_f32 v16, v180, v181
v_lshlrev_b32 v17, 16, v16
v_and_b32 v18, 0xffff0000, v16
v_lshlrev_b32 v19, 16, v90
v_and_b32 v20, 0xffff0000, v90
v_add_f32 v17, v17, v19
v_add_f32 v18, v18, v20
v_cvt_pk_bf16_f32 v16, v17, v18
v_lshlrev_b32 v17, 16, v16
v_and_b32 v18, 0xffff0000, v16
v_lshlrev_b32 v19, 16, v86
v_and_b32 v20, 0xffff0000, v86
v_add_f32 v17, v17, v19
v_add_f32 v18, v18, v20
v_cvt_pk_bf16_f32 v190, v17, v18
v_cvt_pk_bf16_f32 v24, v182, v183
v_lshlrev_b32 v25, 16, v24
v_and_b32 v26, 0xffff0000, v24
v_lshlrev_b32 v27, 16, v91
v_and_b32 v28, 0xffff0000, v91
v_add_f32 v25, v25, v27
v_add_f32 v26, v26, v28
v_cvt_pk_bf16_f32 v24, v25, v26
v_lshlrev_b32 v25, 16, v24
v_and_b32 v26, 0xffff0000, v24
v_lshlrev_b32 v27, 16, v87
v_and_b32 v28, 0xffff0000, v87
v_add_f32 v25, v25, v27
v_add_f32 v26, v26, v28
v_cvt_pk_bf16_f32 v191, v25, v26
buffer_store_dwordx4 v[188:191], v6, s[12:15], s38 offen
s_waitcnt vmcnt(19)
v_dot2_f32_bf16 v192, v92, s40, 0
v_dot2_f32_bf16 v193, v92, s41, 0
v_dot2_f32_bf16 v194, v93, s40, 0
v_dot2_f32_bf16 v195, v93, s41, 0
v_dot2_f32_bf16 v196, v94, s40, 0
v_dot2_f32_bf16 v197, v94, s41, 0
v_dot2_f32_bf16 v198, v95, s40, 0
v_dot2_f32_bf16 v199, v95, s41, 0
v_dot2_f32_bf16 v200, v96, s40, 0
v_dot2_f32_bf16 v201, v96, s41, 0
v_dot2_f32_bf16 v202, v97, s40, 0
v_dot2_f32_bf16 v203, v97, s41, 0
v_dot2_f32_bf16 v204, v98, s40, 0
v_dot2_f32_bf16 v205, v98, s41, 0
v_dot2_f32_bf16 v206, v99, s40, 0
v_dot2_f32_bf16 v207, v99, s41, 0
s_waitcnt vmcnt(17)
v_dot2_f32_bf16 v192, v100, s40, v192
v_dot2_f32_bf16 v193, v100, s41, v193
v_dot2_f32_bf16 v194, v101, s40, v194
v_dot2_f32_bf16 v195, v101, s41, v195
v_dot2_f32_bf16 v196, v102, s40, v196
v_dot2_f32_bf16 v197, v102, s41, v197
v_dot2_f32_bf16 v198, v103, s40, v198
v_dot2_f32_bf16 v199, v103, s41, v199
v_dot2_f32_bf16 v200, v104, s40, v200
v_dot2_f32_bf16 v201, v104, s41, v201
v_dot2_f32_bf16 v202, v105, s40, v202
v_dot2_f32_bf16 v203, v105, s41, v203
v_dot2_f32_bf16 v204, v106, s40, v204
v_dot2_f32_bf16 v205, v106, s41, v205
v_dot2_f32_bf16 v206, v107, s40, v206
v_dot2_f32_bf16 v207, v107, s41, v207
s_waitcnt vmcnt(15)
v_dot2_f32_bf16 v192, v108, s40, v192
v_dot2_f32_bf16 v193, v108, s41, v193
v_dot2_f32_bf16 v194, v109, s40, v194
v_dot2_f32_bf16 v195, v109, s41, v195
v_dot2_f32_bf16 v196, v110, s40, v196
v_dot2_f32_bf16 v197, v110, s41, v197
v_dot2_f32_bf16 v198, v111, s40, v198
v_dot2_f32_bf16 v199, v111, s41, v199
v_dot2_f32_bf16 v200, v112, s40, v200
v_dot2_f32_bf16 v201, v112, s41, v201
v_dot2_f32_bf16 v202, v113, s40, v202
v_dot2_f32_bf16 v203, v113, s41, v203
v_dot2_f32_bf16 v204, v114, s40, v204
v_dot2_f32_bf16 v205, v114, s41, v205
v_dot2_f32_bf16 v206, v115, s40, v206
v_dot2_f32_bf16 v207, v115, s41, v207
s_waitcnt vmcnt(13)
v_dot2_f32_bf16 v192, v116, s40, v192
v_dot2_f32_bf16 v193, v116, s41, v193
v_dot2_f32_bf16 v194, v117, s40, v194
v_dot2_f32_bf16 v195, v117, s41, v195
v_dot2_f32_bf16 v196, v118, s40, v196
v_dot2_f32_bf16 v197, v118, s41, v197
v_dot2_f32_bf16 v198, v119, s40, v198
v_dot2_f32_bf16 v199, v119, s41, v199
v_dot2_f32_bf16 v200, v120, s40, v200
v_dot2_f32_bf16 v201, v120, s41, v201
v_dot2_f32_bf16 v202, v121, s40, v202
v_dot2_f32_bf16 v203, v121, s41, v203
v_dot2_f32_bf16 v204, v122, s40, v204
v_dot2_f32_bf16 v205, v122, s41, v205
v_dot2_f32_bf16 v206, v123, s40, v206
v_dot2_f32_bf16 v207, v123, s41, v207
s_waitcnt vmcnt(11)
v_dot2_f32_bf16 v192, v124, s40, v192
v_dot2_f32_bf16 v193, v124, s41, v193
v_dot2_f32_bf16 v194, v125, s40, v194
v_dot2_f32_bf16 v195, v125, s41, v195
v_dot2_f32_bf16 v196, v126, s40, v196
v_dot2_f32_bf16 v197, v126, s41, v197
v_dot2_f32_bf16 v198, v127, s40, v198
v_dot2_f32_bf16 v199, v127, s41, v199
v_dot2_f32_bf16 v200, v128, s40, v200
v_dot2_f32_bf16 v201, v128, s41, v201
v_dot2_f32_bf16 v202, v129, s40, v202
v_dot2_f32_bf16 v203, v129, s41, v203
v_dot2_f32_bf16 v204, v130, s40, v204
v_dot2_f32_bf16 v205, v130, s41, v205
v_dot2_f32_bf16 v206, v131, s40, v206
v_dot2_f32_bf16 v207, v131, s41, v207
s_waitcnt vmcnt(9)
v_dot2_f32_bf16 v192, v132, s40, v192
v_dot2_f32_bf16 v193, v132, s41, v193
v_dot2_f32_bf16 v194, v133, s40, v194
v_dot2_f32_bf16 v195, v133, s41, v195
v_dot2_f32_bf16 v196, v134, s40, v196
v_dot2_f32_bf16 v197, v134, s41, v197
v_dot2_f32_bf16 v198, v135, s40, v198
v_dot2_f32_bf16 v199, v135, s41, v199
v_dot2_f32_bf16 v200, v136, s40, v200
v_dot2_f32_bf16 v201, v136, s41, v201
v_dot2_f32_bf16 v202, v137, s40, v202
v_dot2_f32_bf16 v203, v137, s41, v203
v_dot2_f32_bf16 v204, v138, s40, v204
v_dot2_f32_bf16 v205, v138, s41, v205
v_dot2_f32_bf16 v206, v139, s40, v206
v_dot2_f32_bf16 v207, v139, s41, v207
s_waitcnt vmcnt(7)
v_dot2_f32_bf16 v192, v140, s40, v192
v_dot2_f32_bf16 v193, v140, s41, v193
v_dot2_f32_bf16 v194, v141, s40, v194
v_dot2_f32_bf16 v195, v141, s41, v195
v_dot2_f32_bf16 v196, v142, s40, v196
v_dot2_f32_bf16 v197, v142, s41, v197
v_dot2_f32_bf16 v198, v143, s40, v198
v_dot2_f32_bf16 v199, v143, s41, v199
v_dot2_f32_bf16 v200, v144, s40, v200
v_dot2_f32_bf16 v201, v144, s41, v201
v_dot2_f32_bf16 v202, v145, s40, v202
v_dot2_f32_bf16 v203, v145, s41, v203
v_dot2_f32_bf16 v204, v146, s40, v204
v_dot2_f32_bf16 v205, v146, s41, v205
v_dot2_f32_bf16 v206, v147, s40, v206
v_dot2_f32_bf16 v207, v147, s41, v207
s_waitcnt vmcnt(5)
v_dot2_f32_bf16 v192, v148, s40, v192
v_dot2_f32_bf16 v193, v148, s41, v193
v_dot2_f32_bf16 v194, v149, s40, v194
v_dot2_f32_bf16 v195, v149, s41, v195
v_dot2_f32_bf16 v196, v150, s40, v196
v_dot2_f32_bf16 v197, v150, s41, v197
v_dot2_f32_bf16 v198, v151, s40, v198
v_dot2_f32_bf16 v199, v151, s41, v199
v_dot2_f32_bf16 v200, v152, s40, v200
v_dot2_f32_bf16 v201, v152, s41, v201
v_dot2_f32_bf16 v202, v153, s40, v202
v_dot2_f32_bf16 v203, v153, s41, v203
v_dot2_f32_bf16 v204, v154, s40, v204
v_dot2_f32_bf16 v205, v154, s41, v205
v_dot2_f32_bf16 v206, v155, s40, v206
v_dot2_f32_bf16 v207, v155, s41, v207
s_waitcnt vmcnt(2)
v_cvt_pk_bf16_f32 v92, v192, v193
v_lshlrev_b32 v93, 16, v92
v_and_b32 v94, 0xffff0000, v92
v_lshlrev_b32 v95, 16, v164
v_and_b32 v96, 0xffff0000, v164
v_add_f32 v93, v93, v95
v_add_f32 v94, v94, v96
v_cvt_pk_bf16_f32 v92, v93, v94
v_lshlrev_b32 v93, 16, v92
v_and_b32 v94, 0xffff0000, v92
v_lshlrev_b32 v95, 16, v156
v_and_b32 v96, 0xffff0000, v156
v_add_f32 v93, v93, v95
v_add_f32 v94, v94, v96
v_cvt_pk_bf16_f32 v208, v93, v94
v_cvt_pk_bf16_f32 v100, v194, v195
v_lshlrev_b32 v101, 16, v100
v_and_b32 v102, 0xffff0000, v100
v_lshlrev_b32 v103, 16, v165
v_and_b32 v104, 0xffff0000, v165
v_add_f32 v101, v101, v103
v_add_f32 v102, v102, v104
v_cvt_pk_bf16_f32 v100, v101, v102
v_lshlrev_b32 v101, 16, v100
v_and_b32 v102, 0xffff0000, v100
v_lshlrev_b32 v103, 16, v157
v_and_b32 v104, 0xffff0000, v157
v_add_f32 v101, v101, v103
v_add_f32 v102, v102, v104
v_cvt_pk_bf16_f32 v209, v101, v102
v_cvt_pk_bf16_f32 v92, v200, v201
v_lshlrev_b32 v93, 16, v92
v_and_b32 v94, 0xffff0000, v92
v_lshlrev_b32 v95, 16, v166
v_and_b32 v96, 0xffff0000, v166
v_add_f32 v93, v93, v95
v_add_f32 v94, v94, v96
v_cvt_pk_bf16_f32 v92, v93, v94
v_lshlrev_b32 v93, 16, v92
v_and_b32 v94, 0xffff0000, v92
v_lshlrev_b32 v95, 16, v158
v_and_b32 v96, 0xffff0000, v158
v_add_f32 v93, v93, v95
v_add_f32 v94, v94, v96
v_cvt_pk_bf16_f32 v210, v93, v94
v_cvt_pk_bf16_f32 v100, v202, v203
v_lshlrev_b32 v101, 16, v100
v_and_b32 v102, 0xffff0000, v100
v_lshlrev_b32 v103, 16, v167
v_and_b32 v104, 0xffff0000, v167
v_add_f32 v101, v101, v103
v_add_f32 v102, v102, v104
v_cvt_pk_bf16_f32 v100, v101, v102
v_lshlrev_b32 v101, 16, v100
v_and_b32 v102, 0xffff0000, v100
v_lshlrev_b32 v103, 16, v159
v_and_b32 v104, 0xffff0000, v159
v_add_f32 v101, v101, v103
v_add_f32 v102, v102, v104
v_cvt_pk_bf16_f32 v211, v101, v102
buffer_store_dwordx4 v[208:211], v6, s[12:15], s49 offen
v_cvt_pk_bf16_f32 v92, v196, v197
v_lshlrev_b32 v93, 16, v92
v_and_b32 v94, 0xffff0000, v92
v_lshlrev_b32 v95, 16, v164
v_and_b32 v96, 0xffff0000, v164
v_add_f32 v93, v93, v95
v_add_f32 v94, v94, v96
v_cvt_pk_bf16_f32 v92, v93, v94
v_lshlrev_b32 v93, 16, v92
v_and_b32 v94, 0xffff0000, v92
v_lshlrev_b32 v95, 16, v160
v_and_b32 v96, 0xffff0000, v160
v_add_f32 v93, v93, v95
v_add_f32 v94, v94, v96
v_cvt_pk_bf16_f32 v212, v93, v94
v_cvt_pk_bf16_f32 v100, v198, v199
v_lshlrev_b32 v101, 16, v100
v_and_b32 v102, 0xffff0000, v100
v_lshlrev_b32 v103, 16, v165
v_and_b32 v104, 0xffff0000, v165
v_add_f32 v101, v101, v103
v_add_f32 v102, v102, v104
v_cvt_pk_bf16_f32 v100, v101, v102
v_lshlrev_b32 v101, 16, v100
v_and_b32 v102, 0xffff0000, v100
v_lshlrev_b32 v103, 16, v161
v_and_b32 v104, 0xffff0000, v161
v_add_f32 v101, v101, v103
v_add_f32 v102, v102, v104
v_cvt_pk_bf16_f32 v213, v101, v102
v_cvt_pk_bf16_f32 v92, v204, v205
v_lshlrev_b32 v93, 16, v92
v_and_b32 v94, 0xffff0000, v92
v_lshlrev_b32 v95, 16, v166
v_and_b32 v96, 0xffff0000, v166
v_add_f32 v93, v93, v95
v_add_f32 v94, v94, v96
v_cvt_pk_bf16_f32 v92, v93, v94
v_lshlrev_b32 v93, 16, v92
v_and_b32 v94, 0xffff0000, v92
v_lshlrev_b32 v95, 16, v162
v_and_b32 v96, 0xffff0000, v162
v_add_f32 v93, v93, v95
v_add_f32 v94, v94, v96
v_cvt_pk_bf16_f32 v214, v93, v94
v_cvt_pk_bf16_f32 v100, v206, v207
v_lshlrev_b32 v101, 16, v100
v_and_b32 v102, 0xffff0000, v100
v_lshlrev_b32 v103, 16, v167
v_and_b32 v104, 0xffff0000, v167
v_add_f32 v101, v101, v103
v_add_f32 v102, v102, v104
v_cvt_pk_bf16_f32 v100, v101, v102
v_lshlrev_b32 v101, 16, v100
v_and_b32 v102, 0xffff0000, v100
v_lshlrev_b32 v103, 16, v163
v_and_b32 v104, 0xffff0000, v163
v_add_f32 v101, v101, v103
v_add_f32 v102, v102, v104
v_cvt_pk_bf16_f32 v215, v101, v102
buffer_store_dwordx4 v[212:215], v6, s[12:15], s50 offen
s_branch P5_done
P5_one:
buffer_load_dwordx4 v[16:19], v3, s[8:11], s32 offen sc1
buffer_load_dwordx4 v[20:23], v3, s[8:11], s33 offen sc1
s_add_u32 s32, s32, 2359296
s_add_u32 s33, s33, 2359296
buffer_load_dwordx4 v[24:27], v3, s[8:11], s32 offen sc1
buffer_load_dwordx4 v[28:31], v3, s[8:11], s33 offen sc1
s_add_u32 s32, s32, 2359296
s_add_u32 s33, s33, 2359296
buffer_load_dwordx4 v[32:35], v3, s[8:11], s32 offen sc1
buffer_load_dwordx4 v[36:39], v3, s[8:11], s33 offen sc1
s_add_u32 s32, s32, 2359296
s_add_u32 s33, s33, 2359296
buffer_load_dwordx4 v[40:43], v3, s[8:11], s32 offen sc1
buffer_load_dwordx4 v[44:47], v3, s[8:11], s33 offen sc1
s_add_u32 s32, s32, 2359296
s_add_u32 s33, s33, 2359296
buffer_load_dwordx4 v[48:51], v3, s[8:11], s32 offen sc1
buffer_load_dwordx4 v[52:55], v3, s[8:11], s33 offen sc1
s_add_u32 s32, s32, 2359296
s_add_u32 s33, s33, 2359296
buffer_load_dwordx4 v[56:59], v3, s[8:11], s32 offen sc1
buffer_load_dwordx4 v[60:63], v3, s[8:11], s33 offen sc1
s_add_u32 s32, s32, 2359296
s_add_u32 s33, s33, 2359296
buffer_load_dwordx4 v[64:67], v3, s[8:11], s32 offen sc1
buffer_load_dwordx4 v[68:71], v3, s[8:11], s33 offen sc1
s_add_u32 s32, s32, 2359296
s_add_u32 s33, s33, 2359296
buffer_load_dwordx4 v[72:75], v3, s[8:11], s32 offen sc1
buffer_load_dwordx4 v[76:79], v3, s[8:11], s33 offen sc1
buffer_load_dwordx4 v[80:83], v3, s[8:11], s34 offen sc1
buffer_load_dwordx4 v[84:87], v3, s[8:11], s35 offen sc1
buffer_load_dwordx4 v[88:91], v5, s[16:19], s36 offen
s_waitcnt vmcnt(17)
v_dot2_f32_bf16 v96, v16, s40, 0
v_dot2_f32_bf16 v97, v16, s41, 0
v_dot2_f32_bf16 v98, v17, s40, 0
v_dot2_f32_bf16 v99, v17, s41, 0
v_dot2_f32_bf16 v100, v18, s40, 0
v_dot2_f32_bf16 v101, v18, s41, 0
v_dot2_f32_bf16 v102, v19, s40, 0
v_dot2_f32_bf16 v103, v19, s41, 0
v_dot2_f32_bf16 v104, v20, s40, 0
v_dot2_f32_bf16 v105, v20, s41, 0
v_dot2_f32_bf16 v106, v21, s40, 0
v_dot2_f32_bf16 v107, v21, s41, 0
v_dot2_f32_bf16 v108, v22, s40, 0
v_dot2_f32_bf16 v109, v22, s41, 0
v_dot2_f32_bf16 v110, v23, s40, 0
v_dot2_f32_bf16 v111, v23, s41, 0
s_waitcnt vmcnt(15)
v_dot2_f32_bf16 v96, v24, s40, v96
v_dot2_f32_bf16 v97, v24, s41, v97
v_dot2_f32_bf16 v98, v25, s40, v98
v_dot2_f32_bf16 v99, v25, s41, v99
v_dot2_f32_bf16 v100, v26, s40, v100
v_dot2_f32_bf16 v101, v26, s41, v101
v_dot2_f32_bf16 v102, v27, s40, v102
v_dot2_f32_bf16 v103, v27, s41, v103
v_dot2_f32_bf16 v104, v28, s40, v104
v_dot2_f32_bf16 v105, v28, s41, v105
v_dot2_f32_bf16 v106, v29, s40, v106
v_dot2_f32_bf16 v107, v29, s41, v107
v_dot2_f32_bf16 v108, v30, s40, v108
v_dot2_f32_bf16 v109, v30, s41, v109
v_dot2_f32_bf16 v110, v31, s40, v110
v_dot2_f32_bf16 v111, v31, s41, v111
s_waitcnt vmcnt(13)
v_dot2_f32_bf16 v96, v32, s40, v96
v_dot2_f32_bf16 v97, v32, s41, v97
v_dot2_f32_bf16 v98, v33, s40, v98
v_dot2_f32_bf16 v99, v33, s41, v99
v_dot2_f32_bf16 v100, v34, s40, v100
v_dot2_f32_bf16 v101, v34, s41, v101
v_dot2_f32_bf16 v102, v35, s40, v102
v_dot2_f32_bf16 v103, v35, s41, v103
v_dot2_f32_bf16 v104, v36, s40, v104
v_dot2_f32_bf16 v105, v36, s41, v105
v_dot2_f32_bf16 v106, v37, s40, v106
v_dot2_f32_bf16 v107, v37, s41, v107
v_dot2_f32_bf16 v108, v38, s40, v108
v_dot2_f32_bf16 v109, v38, s41, v109
v_dot2_f32_bf16 v110, v39, s40, v110
v_dot2_f32_bf16 v111, v39, s41, v111
s_waitcnt vmcnt(11)
v_dot2_f32_bf16 v96, v40, s40, v96
v_dot2_f32_bf16 v97, v40, s41, v97
v_dot2_f32_bf16 v98, v41, s40, v98
v_dot2_f32_bf16 v99, v41, s41, v99
v_dot2_f32_bf16 v100, v42, s40, v100
v_dot2_f32_bf16 v101, v42, s41, v101
v_dot2_f32_bf16 v102, v43, s40, v102
v_dot2_f32_bf16 v103, v43, s41, v103
v_dot2_f32_bf16 v104, v44, s40, v104
v_dot2_f32_bf16 v105, v44, s41, v105
v_dot2_f32_bf16 v106, v45, s40, v106
v_dot2_f32_bf16 v107, v45, s41, v107
v_dot2_f32_bf16 v108, v46, s40, v108
v_dot2_f32_bf16 v109, v46, s41, v109
v_dot2_f32_bf16 v110, v47, s40, v110
v_dot2_f32_bf16 v111, v47, s41, v111
s_waitcnt vmcnt(9)
v_dot2_f32_bf16 v96, v48, s40, v96
v_dot2_f32_bf16 v97, v48, s41, v97
v_dot2_f32_bf16 v98, v49, s40, v98
v_dot2_f32_bf16 v99, v49, s41, v99
v_dot2_f32_bf16 v100, v50, s40, v100
v_dot2_f32_bf16 v101, v50, s41, v101
v_dot2_f32_bf16 v102, v51, s40, v102
v_dot2_f32_bf16 v103, v51, s41, v103
v_dot2_f32_bf16 v104, v52, s40, v104
v_dot2_f32_bf16 v105, v52, s41, v105
v_dot2_f32_bf16 v106, v53, s40, v106
v_dot2_f32_bf16 v107, v53, s41, v107
v_dot2_f32_bf16 v108, v54, s40, v108
v_dot2_f32_bf16 v109, v54, s41, v109
v_dot2_f32_bf16 v110, v55, s40, v110
v_dot2_f32_bf16 v111, v55, s41, v111
s_waitcnt vmcnt(7)
v_dot2_f32_bf16 v96, v56, s40, v96
v_dot2_f32_bf16 v97, v56, s41, v97
v_dot2_f32_bf16 v98, v57, s40, v98
v_dot2_f32_bf16 v99, v57, s41, v99
v_dot2_f32_bf16 v100, v58, s40, v100
v_dot2_f32_bf16 v101, v58, s41, v101
v_dot2_f32_bf16 v102, v59, s40, v102
v_dot2_f32_bf16 v103, v59, s41, v103
v_dot2_f32_bf16 v104, v60, s40, v104
v_dot2_f32_bf16 v105, v60, s41, v105
v_dot2_f32_bf16 v106, v61, s40, v106
v_dot2_f32_bf16 v107, v61, s41, v107
v_dot2_f32_bf16 v108, v62, s40, v108
v_dot2_f32_bf16 v109, v62, s41, v109
v_dot2_f32_bf16 v110, v63, s40, v110
v_dot2_f32_bf16 v111, v63, s41, v111
s_waitcnt vmcnt(5)
v_dot2_f32_bf16 v96, v64, s40, v96
v_dot2_f32_bf16 v97, v64, s41, v97
v_dot2_f32_bf16 v98, v65, s40, v98
v_dot2_f32_bf16 v99, v65, s41, v99
v_dot2_f32_bf16 v100, v66, s40, v100
v_dot2_f32_bf16 v101, v66, s41, v101
v_dot2_f32_bf16 v102, v67, s40, v102
v_dot2_f32_bf16 v103, v67, s41, v103
v_dot2_f32_bf16 v104, v68, s40, v104
v_dot2_f32_bf16 v105, v68, s41, v105
v_dot2_f32_bf16 v106, v69, s40, v106
v_dot2_f32_bf16 v107, v69, s41, v107
v_dot2_f32_bf16 v108, v70, s40, v108
v_dot2_f32_bf16 v109, v70, s41, v109
v_dot2_f32_bf16 v110, v71, s40, v110
v_dot2_f32_bf16 v111, v71, s41, v111
s_waitcnt vmcnt(3)
v_dot2_f32_bf16 v96, v72, s40, v96
v_dot2_f32_bf16 v97, v72, s41, v97
v_dot2_f32_bf16 v98, v73, s40, v98
v_dot2_f32_bf16 v99, v73, s41, v99
v_dot2_f32_bf16 v100, v74, s40, v100
v_dot2_f32_bf16 v101, v74, s41, v101
v_dot2_f32_bf16 v102, v75, s40, v102
v_dot2_f32_bf16 v103, v75, s41, v103
v_dot2_f32_bf16 v104, v76, s40, v104
v_dot2_f32_bf16 v105, v76, s41, v105
v_dot2_f32_bf16 v106, v77, s40, v106
v_dot2_f32_bf16 v107, v77, s41, v107
v_dot2_f32_bf16 v108, v78, s40, v108
v_dot2_f32_bf16 v109, v78, s41, v109
v_dot2_f32_bf16 v110, v79, s40, v110
v_dot2_f32_bf16 v111, v79, s41, v111
s_waitcnt vmcnt(0)
v_cvt_pk_bf16_f32 v16, v96, v97
v_lshlrev_b32 v17, 16, v16
v_and_b32 v18, 0xffff0000, v16
v_lshlrev_b32 v19, 16, v88
v_and_b32 v20, 0xffff0000, v88
v_add_f32 v17, v17, v19
v_add_f32 v18, v18, v20
v_cvt_pk_bf16_f32 v16, v17, v18
v_lshlrev_b32 v17, 16, v16
v_and_b32 v18, 0xffff0000, v16
v_lshlrev_b32 v19, 16, v80
v_and_b32 v20, 0xffff0000, v80
v_add_f32 v17, v17, v19
v_add_f32 v18, v18, v20
v_cvt_pk_bf16_f32 v112, v17, v18
v_cvt_pk_bf16_f32 v24, v98, v99
v_lshlrev_b32 v25, 16, v24
v_and_b32 v26, 0xffff0000, v24
v_lshlrev_b32 v27, 16, v89
v_and_b32 v28, 0xffff0000, v89
v_add_f32 v25, v25, v27
v_add_f32 v26, v26, v28
v_cvt_pk_bf16_f32 v24, v25, v26
v_lshlrev_b32 v25, 16, v24
v_and_b32 v26, 0xffff0000, v24
v_lshlrev_b32 v27, 16, v81
v_and_b32 v28, 0xffff0000, v81
v_add_f32 v25, v25, v27
v_add_f32 v26, v26, v28
v_cvt_pk_bf16_f32 v113, v25, v26
v_cvt_pk_bf16_f32 v16, v104, v105
v_lshlrev_b32 v17, 16, v16
v_and_b32 v18, 0xffff0000, v16
v_lshlrev_b32 v19, 16, v90
v_and_b32 v20, 0xffff0000, v90
v_add_f32 v17, v17, v19
v_add_f32 v18, v18, v20
v_cvt_pk_bf16_f32 v16, v17, v18
v_lshlrev_b32 v17, 16, v16
v_and_b32 v18, 0xffff0000, v16
v_lshlrev_b32 v19, 16, v82
v_and_b32 v20, 0xffff0000, v82
v_add_f32 v17, v17, v19
v_add_f32 v18, v18, v20
v_cvt_pk_bf16_f32 v114, v17, v18
v_cvt_pk_bf16_f32 v24, v106, v107
v_lshlrev_b32 v25, 16, v24
v_and_b32 v26, 0xffff0000, v24
v_lshlrev_b32 v27, 16, v91
v_and_b32 v28, 0xffff0000, v91
v_add_f32 v25, v25, v27
v_add_f32 v26, v26, v28
v_cvt_pk_bf16_f32 v24, v25, v26
v_lshlrev_b32 v25, 16, v24
v_and_b32 v26, 0xffff0000, v24
v_lshlrev_b32 v27, 16, v83
v_and_b32 v28, 0xffff0000, v83
v_add_f32 v25, v25, v27
v_add_f32 v26, v26, v28
v_cvt_pk_bf16_f32 v115, v25, v26
buffer_store_dwordx4 v[112:115], v6, s[12:15], s37 offen
v_cvt_pk_bf16_f32 v16, v100, v101
v_lshlrev_b32 v17, 16, v16
v_and_b32 v18, 0xffff0000, v16
v_lshlrev_b32 v19, 16, v88
v_and_b32 v20, 0xffff0000, v88
v_add_f32 v17, v17, v19
v_add_f32 v18, v18, v20
v_cvt_pk_bf16_f32 v16, v17, v18
v_lshlrev_b32 v17, 16, v16
v_and_b32 v18, 0xffff0000, v16
v_lshlrev_b32 v19, 16, v84
v_and_b32 v20, 0xffff0000, v84
v_add_f32 v17, v17, v19
v_add_f32 v18, v18, v20
v_cvt_pk_bf16_f32 v116, v17, v18
v_cvt_pk_bf16_f32 v24, v102, v103
v_lshlrev_b32 v25, 16, v24
v_and_b32 v26, 0xffff0000, v24
v_lshlrev_b32 v27, 16, v89
v_and_b32 v28, 0xffff0000, v89
v_add_f32 v25, v25, v27
v_add_f32 v26, v26, v28
v_cvt_pk_bf16_f32 v24, v25, v26
v_lshlrev_b32 v25, 16, v24
v_and_b32 v26, 0xffff0000, v24
v_lshlrev_b32 v27, 16, v85
v_and_b32 v28, 0xffff0000, v85
v_add_f32 v25, v25, v27
v_add_f32 v26, v26, v28
v_cvt_pk_bf16_f32 v117, v25, v26
v_cvt_pk_bf16_f32 v16, v108, v109
v_lshlrev_b32 v17, 16, v16
v_and_b32 v18, 0xffff0000, v16
v_lshlrev_b32 v19, 16, v90
v_and_b32 v20, 0xffff0000, v90
v_add_f32 v17, v17, v19
v_add_f32 v18, v18, v20
v_cvt_pk_bf16_f32 v16, v17, v18
v_lshlrev_b32 v17, 16, v16
v_and_b32 v18, 0xffff0000, v16
v_lshlrev_b32 v19, 16, v86
v_and_b32 v20, 0xffff0000, v86
v_add_f32 v17, v17, v19
v_add_f32 v18, v18, v20
v_cvt_pk_bf16_f32 v118, v17, v18
v_cvt_pk_bf16_f32 v24, v110, v111
v_lshlrev_b32 v25, 16, v24
v_and_b32 v26, 0xffff0000, v24
v_lshlrev_b32 v27, 16, v91
v_and_b32 v28, 0xffff0000, v91
v_add_f32 v25, v25, v27
v_add_f32 v26, v26, v28
v_cvt_pk_bf16_f32 v24, v25, v26
v_lshlrev_b32 v25, 16, v24
v_and_b32 v26, 0xffff0000, v24
v_lshlrev_b32 v27, 16, v87
v_and_b32 v28, 0xffff0000, v87
v_add_f32 v25, v25, v27
v_add_f32 v26, v26, v28
v_cvt_pk_bf16_f32 v119, v25, v26
buffer_store_dwordx4 v[116:119], v6, s[12:15], s38 offen
P5_done:
mega_kernel_exit:
s_endpgm
code_end_lbl:
.fill (104448 - (code_end_lbl - k1_kernel))/4, 4, 0xbf800000

.section .rodata,"a"
.p2align 6
.amdhsa_kernel mega_kernel
  .amdhsa_next_free_vgpr 512
  .amdhsa_next_free_sgpr 100
  .amdhsa_accum_offset 256
  .amdhsa_group_segment_fixed_size 0
  .amdhsa_kernarg_size 88
  .amdhsa_user_sgpr_count 2
  .amdhsa_user_sgpr_kernarg_segment_ptr 1
  .amdhsa_system_sgpr_workgroup_id_x 1
  .amdhsa_float_denorm_mode_32 3
.end_amdhsa_kernel
```
